```python
import torch

def _softmax(x, axis=-1):
    return torch.softmax(x, dim=axis)
def _gelu(x):
    return torch.nn.functional.gelu(x, approximate="tanh")
def _silu(x):
    return torch.nn.functional.silu(x)
def _sigmoid(x):
    return torch.sigmoid(x)
def _layernorm(x, axis=-1, eps=1e-5):
    m = x.mean(dim=axis, keepdim=True)
    v = x.var(dim=axis, keepdim=True, unbiased=False)
    return (x - m) / torch.sqrt(v + eps)
def _scatter_add(tgt, idx, src, axis=0):
    return tgt.clone().index_add_(axis, idx, src)
def _segment_sum(src, seg, n):
    out = torch.zeros((n,) + src.shape[1:], dtype=src.dtype)
    return out.index_add_(0, seg, src)
def _pad(x, pw):
    flat = tuple(v for pair in reversed(pw) for v in pair)
    return torch.nn.functional.pad(x, flat)

kernel_name = 'recurrent_scan__linear_kernel_hedgehog__glu_gated_bilinear__prompt'

def setup_inputs():

    _w = (lambda a: (lambda t: t.to(torch.bfloat16) if t.is_floating_point() else t)(torch.as_tensor(a)))
    def _A_setup():
        B, S, D, H = 1, 2048, 512, 32
        Dh = D // H
        return {
            "x": _w((lambda *s: torch.randn(*s, dtype=torch.bfloat16) * 0.05)(B, S, D)),
            "wqkv": _w((lambda *s: torch.randn(*s, dtype=torch.bfloat16) * 0.8)(D, 3 * D)),
            "w_phi": _w((lambda *s: torch.randn(*s, dtype=torch.bfloat16) * 0.8)(H, Dh, Dh) * (Dh ** -0.5)),
            "wo": _w((lambda *s: torch.randn(*s, dtype=torch.bfloat16) * 0.8)(D, D)),
        }
    _A_in = _A_setup()

    def _B_setup():
        B, S, D, F = 1, 2048, 512, 1792
        return {
            "x": _w((lambda *s: torch.randn(*s, dtype=torch.bfloat16) * 0.05)(B, S, D)),
            "w_gate": _w((lambda *s: torch.randn(*s, dtype=torch.bfloat16) * 0.2)(D, F) * (D ** -0.5)),
            "w_up": _w((lambda *s: torch.randn(*s, dtype=torch.bfloat16) * 0.2)(D, F) * (D ** -0.5)),
            "w_down": _w((lambda *s: torch.randn(*s, dtype=torch.bfloat16) * 0.2)(F, D) * (F ** -0.5)),
        }
    _B_in = _B_setup()

    return {
        "A_x": _A_in["x"],
        "A_wqkv": _A_in["wqkv"],
        "A_w_phi": _A_in["w_phi"],
        "A_wo": _A_in["wo"],
        "B_x": _B_in["x"],
        "B_w_gate": _B_in["w_gate"],
        "B_w_up": _B_in["w_up"],
        "B_w_down": _B_in["w_down"],
    }

def reference(A_x, A_wqkv, A_w_phi, A_wo, B_x, B_w_gate, B_w_up, B_w_down):
    def _A_ref(x, wqkv, w_phi, wo):
        B, S, D = x.shape
        H = 32; Dh = D // H
        qkv = (lambda x, *d: x.permute(*d))((x @ wqkv).reshape(B, S, 3, H, Dh), 2, 0, 3, 1, 4)
        q, k, v = qkv[0], qkv[1], qkv[2]
        pq = torch.einsum("bhsd,hdf->bhsf", q, w_phi)
        pk = torch.einsum("bhsd,hdf->bhsf", k, w_phi)
        phi_q = torch.concatenate([_softmax(pq, axis=-1), _softmax(-pq, axis=-1)], axis=-1)
        phi_k = torch.concatenate([_softmax(pk, axis=-1), _softmax(-pk, axis=-1)], axis=-1)
        kv = torch.einsum("bhsf,bhsd->bhfd", phi_k, v)
        z  = torch.einsum("bhsf->bhf", phi_k)
        num = torch.einsum("bhqf,bhfd->bhqd", phi_q, kv)
        den = torch.einsum("bhqf,bhf->bhq", phi_q, z)[..., None] + 1e-6
        o = num / den
        return (lambda x, *d: x.permute(*d))(o, 0, 2, 1, 3).reshape(B, S, D) @ wo

    def _B_ref(x, w_gate, w_up, w_down):
        g = torch.einsum("bsd,df->bsf", x, w_gate)
        u = torch.einsum("bsd,df->bsf", x, w_up)
        h = g * u
        return torch.einsum("bsf,fd->bsd", h, w_down)

    x = A_x
    xn = _layernorm(x, axis=-1)
    s = _A_ref(xn, A_wqkv, A_w_phi, A_wo)
    g = _silu(_B_ref(xn, B_w_gate, B_w_up, B_w_down))
    return x + s * g
```

```asm
; @launch grid=(256,1,1) block=(512,1,1) lds=163840
.amdgcn_target "amdgcn-amd-amdhsa--gfx950"
.text
.globl recurrent_scan__linear_kernel_hedgehog__glu_gated_bilinear__prompt_kernel
.p2align 8
.type recurrent_scan__linear_kernel_hedgehog__glu_gated_bilinear__prompt_kernel,@function
recurrent_scan__linear_kernel_hedgehog__glu_gated_bilinear__prompt_kernel:
    s_cmp_ge_u32 s2, 256
    s_cbranch_scc1 L_exit
    s_load_dwordx2 s[8:9], s[0:1], 0
    s_load_dwordx2 s[12:13], s[0:1], 8
    s_getpc_b64 s[88:89]
L_pc:
    s_and_b32 s66, s2, 0xf8
    s_mul_i32 s66, s66, 3
    v_cmp_gt_u32 vcc, 24, v0
    s_cbranch_vccz L_nopf
    v_min_u32 v3, 23, v0
    v_add_lshl_u32 v3, v3, s66, 7
    v_min_u32 v3, L_tab-L_pc+252, v3
    global_load_dword v53, v3, s[88:89]
L_nopf:
    v_readfirstlane_b32 s56, v0
    v_and_b32 v1, 63, v0
    s_bfe_u32 s69, s2, 0x20003
    s_bfe_u32 s68, s2, 0x20001
    s_lshr_b32 s61, s2, 5
    s_lshl2_add_u32 s58, s68, s69
    s_lshl1_add_u32 s61, s69, s61
    s_lshr_b32 s56, s56, 6
    v_lshrrev_b32 v4, 3, v1
    v_lshrrev_b32 v5, 4, v1
    v_and_b32 v6, 7, v1
    v_xor_b32 v5, v5, v6
    v_lshlrev_b32 v4, 10, v4
    v_lshl_add_u32 v48, v5, 4, v4
    s_mov_b32 s10, 2097152
    s_mov_b32 s11, 0x20000
    s_and_b32 s66, s56, 3
    s_add_u32 s75, s66, 8
    s_lshl_b32 s75, s75, 12
    s_lshl2_add_u32 s79, s58, s66
    s_lshl_b32 s79, s79, 15
    v_xor_b32 v4, 64, v48
    v_add_u32 v49, 7168, v4
    v_add_u32 v50, 14336, v48
    v_add_u32 v51, 21504, v4
    s_cmp_lt_u32 s56, 4
    s_cbranch_scc1 L_nox
    s_waitcnt lgkmcnt(0)
    s_add_u32 s66, s61, 0
    s_and_b32 s66, s66, 7
    s_lshl_b32 s66, s66, 7
    s_add_u32 s66, s66, s79
    s_add_u32 m0, s75, 0
    s_nop 0
    buffer_load_dwordx4 v48, s[8:11], s66 offen offset:0 lds
    buffer_load_dwordx4 v49, s[8:11], s66 offen offset:1024 lds
    buffer_load_dwordx4 v50, s[8:11], s66 offen offset:2048 lds
    buffer_load_dwordx4 v51, s[8:11], s66 offen offset:3072 lds
    s_add_u32 s66, s61, 1
    s_and_b32 s66, s66, 7
    s_lshl_b32 s66, s66, 7
    s_add_u32 s66, s66, s79
    s_add_u32 m0, s75, 16384
    s_nop 0
    buffer_load_dwordx4 v48, s[8:11], s66 offen offset:0 lds
    buffer_load_dwordx4 v49, s[8:11], s66 offen offset:1024 lds
    buffer_load_dwordx4 v50, s[8:11], s66 offen offset:2048 lds
    buffer_load_dwordx4 v51, s[8:11], s66 offen offset:3072 lds
L_nox:
    s_lshr_b32 s74, s2, 3
    s_and_b32 s71, s2, 7
    s_lshr_b32 s60, s74, 4
    s_lshl_b32 s62, s69, 1
    s_and_b32 s68, s2, 1
    s_bfe_u32 s69, s2, 0x20005
    s_lshl2_add_u32 s59, s68, s69
    s_load_dwordx2 s[16:17], s[0:1], 16
    s_load_dwordx2 s[44:45], s[0:1], 80
    s_load_dwordx2 s[24:25], s[0:1], 40
    s_load_dwordx2 s[28:29], s[0:1], 48
    s_load_dwordx2 s[20:21], s[0:1], 24
    s_load_dwordx2 s[32:33], s[0:1], 56
    s_load_dwordx2 s[36:37], s[0:1], 64
    s_load_dwordx2 s[40:41], s[0:1], 72
    s_mov_b32 s14, 1572864
    s_mov_b32 s15, 0x20000
    s_mov_b32 s18, 16384
    s_mov_b32 s19, 0x20000
    s_mov_b32 s22, 524288
    s_mov_b32 s23, 0x20000
    s_mov_b32 s26, 1835008
    s_mov_b32 s27, 0x20000
    s_mov_b32 s30, 1835008
    s_mov_b32 s31, 0x20000
    s_mov_b32 s34, 1835008
    s_mov_b32 s35, 0x20000
    s_mov_b32 s38, 2097152
    s_mov_b32 s39, 0x20000
    s_mov_b32 s42, 256
    s_mov_b32 s43, 0x20000
    s_mov_b32 s46, 11534336
    s_mov_b32 s47, 0x20000
    s_lshl_b32 s73, s59, 7
    s_lshl_b32 s66, s60, 6
    s_add_u32 s73, s73, s66
    s_add_u32 s73, s73, 1024
    s_lshr_b32 s69, s74, 3
    s_and_b32 s68, s71, 1
    s_lshl_b32 s68, s68, 2
    s_add_u32 s64, s68, s69
    s_and_b32 s67, s74, 7
    s_lshr_b32 s68, s71, 1
    s_lshl_b32 s68, s68, 3
    s_add_u32 s63, s68, s67
    s_and_b32 s69, s69, 1
    s_lshl_b32 s69, s69, 1
    s_add_u32 s69, s69, s60
    s_lshl_b32 s69, s69, 1
    s_add_u32 s65, s69, s67
    s_and_b32 s57, s56, 1
    s_mov_b32 s72, 0x3fb8aa3b
    s_add_u32 s88, s88, L_tab-L_pc
    s_addc_u32 s89, s89, 0
    s_waitcnt lgkmcnt(0)
    s_cmp_lt_u32 s56, 4
    s_cbranch_scc1 L_comp
    s_cmp_lt_u32 s56, 6
    s_cbranch_scc1 L_dma
L_attn:
    s_cmp_eq_u32 s60, 1
    s_cbranch_scc1 L_attn1
    s_lshl_b32 s69, s59, 2
    s_add_u32 s69, s69, s57
    s_add_u32 s68, s69, 0
    v_lshrrev_b32 v103, 5, v1
    v_and_b32 v101, 15, v1
    v_lshrrev_b32 v100, 4, v1
    v_lshlrev_b32 v102, 7, v103
    v_lshl_add_u32 v102, v101, 1, v102
    s_lshl_b32 s70, s69, 9
    v_mov_b32 v105, v102
    v_mov_b32 v3, 0
    v_mov_b32 v34, 0
    v_mov_b32 v2, 1
    v_mov_b32 v7, 16384
    v_lshlrev_b32 v104, 7, v1
    s_add_u32 s66, s2, s57
    s_cmp_lg_u32 s66, 0
    s_cbranch_scc1 L_noinit
    s_movk_i32 s66, 0x0
    buffer_store_dword v3, v104, s[44:47], s66 offen sc1
    s_movk_i32 s66, 0x2000
    buffer_store_dword v3, v104, s[44:47], s66 offen sc1
    s_movk_i32 s66, 0x4000
    buffer_store_dword v3, v104, s[44:47], s66 offen sc1
L_noinit:
    v_and_b32 v102, 1, v100
    v_mul_u32_u24 v102, 0x8000, v102
    v_lshl_or_b32 v15, v102, 16, v102
    s_lshl_b32 s66, s58, 10
    v_lshlrev_b32 v4, 9, v1
    v_add_u32 v4, s66, v4
    v_lshl_add_u32 v27, v1, 2, v7
    ds_write_b32 v27, v3 offset:0
    ds_write_b32 v27, v3 offset:256
    ds_write_b32 v27, v3 offset:512
    ds_write_b32 v27, v3 offset:768
    ds_write_b32 v27, v3 offset:1024
    ds_write_b32 v27, v3 offset:1280
    ds_write_b32 v27, v3 offset:1536
    ds_write_b32 v27, v3 offset:1792
    s_waitcnt lgkmcnt(0)
    s_add_u32 s66, s61, 2
    s_and_b32 s66, s66, 7
    s_lshl_b32 s66, s66, 7
    s_add_u32 s66, s66, s79
    s_add_u32 m0, s75, 32768
    s_nop 0
    buffer_load_dwordx4 v48, s[8:11], s66 offen offset:0 lds
    buffer_load_dwordx4 v49, s[8:11], s66 offen offset:1024 lds
    buffer_load_dwordx4 v50, s[8:11], s66 offen offset:2048 lds
    buffer_load_dwordx4 v51, s[8:11], s66 offen offset:3072 lds
    s_add_u32 s66, s61, 3
    s_and_b32 s66, s66, 7
    s_lshl_b32 s66, s66, 7
    s_add_u32 s66, s66, s79
    s_add_u32 m0, s75, 49152
    s_nop 0
    buffer_load_dwordx4 v48, s[8:11], s66 offen offset:0 lds
    buffer_load_dwordx4 v49, s[8:11], s66 offen offset:1024 lds
    buffer_load_dwordx4 v50, s[8:11], s66 offen offset:2048 lds
    buffer_load_dwordx4 v51, s[8:11], s66 offen offset:3072 lds
    s_waitcnt vmcnt(8)
    s_barrier
    s_add_u32 s66, s61, 4
    s_and_b32 s66, s66, 7
    s_lshl_b32 s66, s66, 7
    s_add_u32 s66, s66, s79
    s_add_u32 m0, s75, 65536
    s_nop 0
    buffer_load_dwordx4 v48, s[8:11], s66 offen offset:0 lds
    buffer_load_dwordx4 v49, s[8:11], s66 offen offset:1024 lds
    buffer_load_dwordx4 v50, s[8:11], s66 offen offset:2048 lds
    buffer_load_dwordx4 v51, s[8:11], s66 offen offset:3072 lds
    s_add_u32 s66, s61, 5
    s_and_b32 s66, s66, 7
    s_lshl_b32 s66, s66, 7
    s_add_u32 s66, s66, s79
    s_add_u32 m0, s75, 81920
    s_nop 0
    buffer_load_dwordx4 v48, s[8:11], s66 offen offset:0 lds
    buffer_load_dwordx4 v49, s[8:11], s66 offen offset:1024 lds
    buffer_load_dwordx4 v50, s[8:11], s66 offen offset:2048 lds
    buffer_load_dwordx4 v51, s[8:11], s66 offen offset:3072 lds
    s_waitcnt vmcnt(8)
    s_barrier
    s_add_u32 s66, s61, 6
    s_and_b32 s66, s66, 7
    s_lshl_b32 s66, s66, 7
    s_add_u32 s66, s66, s79
    s_add_u32 m0, s75, 98304
    s_nop 0
    buffer_load_dwordx4 v48, s[8:11], s66 offen offset:0 lds
    buffer_load_dwordx4 v49, s[8:11], s66 offen offset:1024 lds
    buffer_load_dwordx4 v50, s[8:11], s66 offen offset:2048 lds
    buffer_load_dwordx4 v51, s[8:11], s66 offen offset:3072 lds
    s_add_u32 s66, s61, 7
    s_and_b32 s66, s66, 7
    s_lshl_b32 s66, s66, 7
    s_add_u32 s66, s66, s79
    s_add_u32 m0, s75, 114688
    s_nop 0
    buffer_load_dwordx4 v48, s[8:11], s66 offen offset:0 lds
    buffer_load_dwordx4 v49, s[8:11], s66 offen offset:1024 lds
    buffer_load_dwordx4 v50, s[8:11], s66 offen offset:2048 lds
    buffer_load_dwordx4 v51, s[8:11], s66 offen offset:3072 lds
    s_add_u32 s66, s2, s57
    s_cmp_lg_u32 s66, 0
    s_cbranch_scc1 L_sk1
    buffer_store_dword v2, v3, s[40:43], 0 offen sc1
L_sk1:
    s_waitcnt vmcnt(8)
    s_barrier
    buffer_load_ushort v72, v105, s[16:19], s70 offen offset:0
    buffer_load_ushort v73, v105, s[16:19], s70 offen offset:32
    buffer_load_ushort v74, v105, s[16:19], s70 offen offset:64
    buffer_load_ushort v75, v105, s[16:19], s70 offen offset:96
    buffer_load_ushort v76, v105, s[16:19], s70 offen offset:256
    buffer_load_ushort v77, v105, s[16:19], s70 offen offset:288
    buffer_load_ushort v78, v105, s[16:19], s70 offen offset:320
    buffer_load_ushort v79, v105, s[16:19], s70 offen offset:352
    s_waitcnt vmcnt(8)
    s_barrier
    s_barrier
    s_lshl_b32 s66, s68, 8
    s_add_u32 s66, s66, 0x4000
    v_mov_b32 v5, s66
    s_lshl_b32 s66, s69, 8
    s_add_u32 s54, s66, 0x4000
    s_lshl_b32 s66, s57, 11
    s_add_u32 s66, s66, 131072
    v_lshlrev_b32 v104, 4, v1
    v_add_u32 v8, s66, v104
    v_and_b32 v102, 1, v1
    v_lshlrev_b32 v9, 9, v102
    v_lshl_add_u32 v9, v100, 7, v9
    v_bfe_u32 v102, v1, 2, 2
    v_lshl_add_u32 v9, v102, 4, v9
    v_bfe_u32 v102, v1, 1, 1
    v_lshl_add_u32 v9, v102, 3, v9
    v_add_u32 v9, s66, v9
    s_lshl_b32 s66, s68, 4
    s_add_u32 s66, s66, s58
    s_lshl_b32 s67, s66, 10
    s_add_u32 s67, s67, 65536
    v_add_u32 v10, s67, v104
    s_lshl_b32 s67, s66, 7
    s_add_u32 s67, s67, 1179648
    v_lshlrev_b32 v11, 6, v101
    v_lshl_add_u32 v11, v100, 4, v11
    v_add_u32 v11, s67, v11
    s_lshl_b32 s66, s58, 1
    s_add_u32 s66, s66, s57
    s_and_b32 s49, s66, 7
    s_lshr_b32 s66, s66, 3
    s_lshl_b32 s70, s59, 2
    s_add_u32 s70, s70, s66
    s_lshl_b32 s66, s70, 8
    s_add_u32 s54, s66, 0x4000
    v_mov_b32 v6, s54
    s_lshl_b32 s71, s49, 7
    s_lshl_b32 s67, s70, 14
    s_add_u32 s67, s67, s71
    s_add_u32 s67, s67, 65536
    v_lshrrev_b32 v102, 3, v1
    v_lshlrev_b32 v12, 10, v102
    v_and_b32 v102, 7, v1
    v_lshl_add_u32 v12, v102, 4, v12
    v_add_u32 v12, s67, v12
    s_lshl_b32 s67, s70, 10
    s_add_u32 s67, s67, s71
    s_add_u32 s67, s67, 1245184
    v_lshlrev_b32 v14, 4, v102
    v_lshl_add_u32 v14, v103, 2, v14
    v_and_b32 v102, 1, v100
    v_lshl_add_u32 v14, v102, 3, v14
    v_add_u32 v14, s67, v14
    s_lshl_b32 s67, s70, 11
    s_add_u32 s67, s67, 1179648
    v_lshlrev_b32 v13, 7, v101
    v_lshl_add_u32 v13, v100, 4, v13
    v_add_u32 v13, s67, v13
    s_lshl_b32 s67, s70, 7
    s_add_u32 s67, s67, 1277952
    v_lshlrev_b32 v4, 6, v101
    v_lshl_add_u32 v4, v100, 4, v4
    v_add_u32 v4, s67, v4
    v_and_b32 v101, 3, v1
    v_and_b32 v102, 1, v1
    v_lshlrev_b32 v102, 4, v102
    v_mov_b32 v103, 0x3f80
    v_lshlrev_b32 v102, v102, v103
    v_cmp_gt_u32 vcc, 2, v101
    s_nop 1
    v_cndmask_b32 v32, 0, v102, vcc
    v_sub_u32 v33, v102, v32
    s_waitcnt vmcnt(0)
    v_lshl_or_b32 v36, v73, 16, v72
    v_lshl_or_b32 v37, v75, 16, v74
    v_lshl_or_b32 v38, v77, 16, v76
    v_lshl_or_b32 v39, v79, 16, v78
    v_xor_b32 v36, v36, v15
    v_xor_b32 v37, v37, v15
    v_xor_b32 v38, v38, v15
    v_xor_b32 v39, v39, v15
    v_and_b32 v72, 31, v1
    v_lshlrev_b32 v72, 2, v72
    v_add_u32 v72, 18432, v72
    v_lshrrev_b32 v73, 4, v1
    v_lshlrev_b32 v73, 4, v73
    v_add_u32 v73, 18944, v73
    s_waitcnt lgkmcnt(0)
    s_mov_b32 s80, 0
L_cw2:
    ds_read_b32 v27, v7 offset:32
    s_add_u32 s80, s80, 1
    s_waitcnt lgkmcnt(0)
    v_cmp_le_u32 vcc, 4, v27
    s_cbranch_vccnz L_cx2
    s_sleep 2
    s_cmp_lt_u32 s80, 0x1000000
    s_cbranch_scc1 L_cw2
L_cx2:
    ds_read_b32 v16, v72 offset:0
    ds_read_b32 v17, v72 offset:128
    ds_read_b32 v18, v72 offset:256
    ds_read_b32 v19, v72 offset:384
    ds_read_b128 v[192:195], v73 offset:0
    ds_read_b128 v[196:199], v73 offset:64
    ds_read_b128 v[200:203], v73 offset:128
    ds_read_b128 v[204:207], v73 offset:192
    ds_read_b128 v[112:115], v8 offset:0
    ds_read_b128 v[116:119], v8 offset:8192
    ds_read_b128 v[120:123], v8 offset:16384
    ds_read_b128 v[124:127], v8 offset:24576
    s_waitcnt lgkmcnt(0)
    v_mul_f32 v20, s72, v16
    v_mul_f32 v21, s72, v17
    v_mul_f32 v22, s72, v18
    v_mul_f32 v23, s72, v19
    s_setprio 3
    v_mfma_f32_32x32x16_bf16 v[72:87], v[36:39], v[112:115], 0
    v_mfma_f32_32x32x16_bf16 v[88:103], v[36:39], v[116:119], 0
    s_setprio 0
    s_nop 9
    v_max3_f32 v104, v72, v73, v74
    v_max3_f32 v108, v88, v89, v90
    v_max3_f32 v105, v80, v81, v82
    v_max3_f32 v109, v96, v97, v98
    v_max3_f32 v106, v75, v76, v77
    v_max3_f32 v110, v91, v92, v93
    v_max3_f32 v107, v83, v84, v85
    v_max3_f32 v111, v99, v100, v101
    v_max3_f32 v104, v104, v78, v79
    v_max3_f32 v108, v108, v94, v95
    v_max3_f32 v105, v105, v86, v87
    v_max3_f32 v109, v109, v102, v103
    v_max_f32 v104, v104, v106
    v_max_f32 v108, v108, v110
    v_max_f32 v105, v105, v107
    v_max_f32 v109, v109, v111
    s_nop 0
    v_permlane32_swap_b32 v104, v105
    v_permlane32_swap_b32 v108, v109
    v_max_f32 v104, v104, v105
    v_max_f32 v108, v108, v109
    v_mul_f32 v104, v20, v104
    v_mul_f32 v108, v21, v108
    v_mov_b32 v105, v104
    v_mov_b32 v109, v108
    s_nop 0
    v_permlane32_swap_b32 v104, v105
    v_permlane32_swap_b32 v108, v109
    v_fma_f32 v72, v72, v20, -v104
    v_fma_f32 v88, v88, v21, -v108
    v_fma_f32 v73, v73, v20, -v104
    v_fma_f32 v89, v89, v21, -v108
    v_fma_f32 v74, v74, v20, -v104
    v_fma_f32 v90, v90, v21, -v108
    v_fma_f32 v75, v75, v20, -v104
    v_fma_f32 v91, v91, v21, -v108
    v_fma_f32 v76, v76, v20, -v104
    v_fma_f32 v92, v92, v21, -v108
    v_fma_f32 v77, v77, v20, -v104
    v_fma_f32 v93, v93, v21, -v108
    v_fma_f32 v78, v78, v20, -v104
    v_fma_f32 v94, v94, v21, -v108
    v_fma_f32 v79, v79, v20, -v104
    v_fma_f32 v95, v95, v21, -v108
    v_fma_f32 v80, v80, v20, -v105
    v_fma_f32 v96, v96, v21, -v109
    v_fma_f32 v81, v81, v20, -v105
    v_fma_f32 v97, v97, v21, -v109
    v_fma_f32 v82, v82, v20, -v105
    v_fma_f32 v98, v98, v21, -v109
    v_fma_f32 v83, v83, v20, -v105
    v_fma_f32 v99, v99, v21, -v109
    v_fma_f32 v84, v84, v20, -v105
    v_fma_f32 v100, v100, v21, -v109
    v_fma_f32 v85, v85, v20, -v105
    v_fma_f32 v101, v101, v21, -v109
    v_fma_f32 v86, v86, v20, -v105
    v_fma_f32 v102, v102, v21, -v109
    v_fma_f32 v87, v87, v20, -v105
    v_fma_f32 v103, v103, v21, -v109
    v_exp_f32 v72, v72
    v_exp_f32 v88, v88
    v_exp_f32 v73, v73
    v_exp_f32 v89, v89
    v_exp_f32 v74, v74
    v_exp_f32 v90, v90
    v_exp_f32 v75, v75
    v_exp_f32 v91, v91
    v_exp_f32 v76, v76
    v_exp_f32 v92, v92
    v_exp_f32 v77, v77
    v_exp_f32 v93, v93
    v_exp_f32 v78, v78
    v_exp_f32 v94, v94
    v_exp_f32 v79, v79
    v_exp_f32 v95, v95
    v_exp_f32 v80, v80
    v_exp_f32 v96, v96
    v_exp_f32 v81, v81
    v_exp_f32 v97, v97
    v_exp_f32 v82, v82
    v_exp_f32 v98, v98
    v_exp_f32 v83, v83
    v_exp_f32 v99, v99
    v_exp_f32 v84, v84
    v_exp_f32 v100, v100
    v_exp_f32 v85, v85
    v_exp_f32 v101, v101
    v_exp_f32 v86, v86
    v_exp_f32 v102, v102
    v_exp_f32 v87, v87
    v_exp_f32 v103, v103
    v_add_f32 v104, v72, v73
    v_add_f32 v108, v88, v89
    v_add_f32 v106, v74, v75
    v_add_f32 v110, v90, v91
    v_add_f32 v105, v80, v81
    v_add_f32 v109, v96, v97
    v_add_f32 v107, v82, v83
    v_add_f32 v111, v98, v99
    v_add_f32 v104, v104, v76
    v_add_f32 v108, v108, v92
    v_add_f32 v106, v106, v77
    v_add_f32 v110, v110, v93
    v_add_f32 v105, v105, v84
    v_add_f32 v109, v109, v100
    v_add_f32 v107, v107, v85
    v_add_f32 v111, v111, v101
    v_add_f32 v104, v104, v78
    v_add_f32 v108, v108, v94
    v_add_f32 v106, v106, v79
    v_add_f32 v110, v110, v95
    v_add_f32 v105, v105, v86
    v_add_f32 v109, v109, v102
    v_add_f32 v107, v107, v87
    v_add_f32 v111, v111, v103
    v_add_f32 v104, v104, v106
    v_add_f32 v108, v108, v110
    v_add_f32 v105, v105, v107
    v_add_f32 v109, v109, v111
    s_nop 0
    v_permlane32_swap_b32 v104, v105
    v_permlane32_swap_b32 v108, v109
    v_add_f32 v104, v104, v105
    v_add_f32 v108, v108, v109
    v_rcp_f32 v104, v104
    v_rcp_f32 v108, v108
    v_mul_f32 v104, v104, v16
    v_mul_f32 v108, v108, v17
    v_mov_b32 v105, v104
    v_mov_b32 v109, v108
    s_nop 0
    v_permlane32_swap_b32 v104, v105
    v_permlane32_swap_b32 v108, v109
    v_mul_f32 v72, v72, v104
    v_mul_f32 v88, v88, v108
    v_mul_f32 v73, v73, v104
    v_mul_f32 v89, v89, v108
    v_mul_f32 v74, v74, v104
    v_mul_f32 v90, v90, v108
    v_mul_f32 v75, v75, v104
    v_mul_f32 v91, v91, v108
    v_mul_f32 v76, v76, v104
    v_mul_f32 v92, v92, v108
    v_mul_f32 v77, v77, v104
    v_mul_f32 v93, v93, v108
    v_mul_f32 v78, v78, v104
    v_mul_f32 v94, v94, v108
    v_mul_f32 v79, v79, v104
    v_mul_f32 v95, v95, v108
    v_mul_f32 v80, v80, v105
    v_mul_f32 v96, v96, v109
    v_mul_f32 v81, v81, v105
    v_mul_f32 v97, v97, v109
    v_mul_f32 v82, v82, v105
    v_mul_f32 v98, v98, v109
    v_mul_f32 v83, v83, v105
    v_mul_f32 v99, v99, v109
    v_mul_f32 v84, v84, v105
    v_mul_f32 v100, v100, v109
    v_mul_f32 v85, v85, v105
    v_mul_f32 v101, v101, v109
    v_mul_f32 v86, v86, v105
    v_mul_f32 v102, v102, v109
    v_mul_f32 v87, v87, v105
    v_mul_f32 v103, v103, v109
    v_cvt_pk_bf16_f32 v208, v72, v73
    v_cvt_pk_bf16_f32 v216, v88, v89
    v_cvt_pk_bf16_f32 v209, v74, v75
    v_cvt_pk_bf16_f32 v217, v90, v91
    v_cvt_pk_bf16_f32 v210, v76, v77
    v_cvt_pk_bf16_f32 v218, v92, v93
    v_cvt_pk_bf16_f32 v211, v78, v79
    v_cvt_pk_bf16_f32 v219, v94, v95
    v_cvt_pk_bf16_f32 v212, v80, v81
    v_cvt_pk_bf16_f32 v220, v96, v97
    v_cvt_pk_bf16_f32 v213, v82, v83
    v_cvt_pk_bf16_f32 v221, v98, v99
    v_cvt_pk_bf16_f32 v214, v84, v85
    v_cvt_pk_bf16_f32 v222, v100, v101
    v_cvt_pk_bf16_f32 v215, v86, v87
    v_cvt_pk_bf16_f32 v223, v102, v103
    ds_write_b128 v8, v[208:211] offset:0
    ds_write_b128 v8, v[212:215] offset:8192
    ds_write_b128 v8, v[216:219] offset:16384
    ds_write_b128 v8, v[220:223] offset:24576
    s_setprio 3
    v_mfma_f32_32x32x16_bf16 v[72:87], v[36:39], v[120:123], 0
    v_mfma_f32_32x32x16_bf16 v[88:103], v[36:39], v[124:127], 0
    s_setprio 0
    s_nop 9
    v_max3_f32 v104, v72, v73, v74
    v_max3_f32 v108, v88, v89, v90
    v_max3_f32 v105, v80, v81, v82
    v_max3_f32 v109, v96, v97, v98
    v_max3_f32 v106, v75, v76, v77
    v_max3_f32 v110, v91, v92, v93
    v_max3_f32 v107, v83, v84, v85
    v_max3_f32 v111, v99, v100, v101
    v_max3_f32 v104, v104, v78, v79
    v_max3_f32 v108, v108, v94, v95
    v_max3_f32 v105, v105, v86, v87
    v_max3_f32 v109, v109, v102, v103
    v_max_f32 v104, v104, v106
    v_max_f32 v108, v108, v110
    v_max_f32 v105, v105, v107
    v_max_f32 v109, v109, v111
    s_nop 0
    v_permlane32_swap_b32 v104, v105
    v_permlane32_swap_b32 v108, v109
    v_max_f32 v104, v104, v105
    v_max_f32 v108, v108, v109
    v_mul_f32 v104, v22, v104
    v_mul_f32 v108, v23, v108
    v_mov_b32 v105, v104
    v_mov_b32 v109, v108
    s_nop 0
    v_permlane32_swap_b32 v104, v105
    v_permlane32_swap_b32 v108, v109
    v_fma_f32 v72, v72, v22, -v104
    v_fma_f32 v88, v88, v23, -v108
    v_fma_f32 v73, v73, v22, -v104
    v_fma_f32 v89, v89, v23, -v108
    v_fma_f32 v74, v74, v22, -v104
    v_fma_f32 v90, v90, v23, -v108
    v_fma_f32 v75, v75, v22, -v104
    v_fma_f32 v91, v91, v23, -v108
    v_fma_f32 v76, v76, v22, -v104
    v_fma_f32 v92, v92, v23, -v108
    v_fma_f32 v77, v77, v22, -v104
    v_fma_f32 v93, v93, v23, -v108
    v_fma_f32 v78, v78, v22, -v104
    v_fma_f32 v94, v94, v23, -v108
    v_fma_f32 v79, v79, v22, -v104
    v_fma_f32 v95, v95, v23, -v108
    v_fma_f32 v80, v80, v22, -v105
    v_fma_f32 v96, v96, v23, -v109
    v_fma_f32 v81, v81, v22, -v105
    v_fma_f32 v97, v97, v23, -v109
    v_fma_f32 v82, v82, v22, -v105
    v_fma_f32 v98, v98, v23, -v109
    v_fma_f32 v83, v83, v22, -v105
    v_fma_f32 v99, v99, v23, -v109
    v_fma_f32 v84, v84, v22, -v105
    v_fma_f32 v100, v100, v23, -v109
    v_fma_f32 v85, v85, v22, -v105
    v_fma_f32 v101, v101, v23, -v109
    v_fma_f32 v86, v86, v22, -v105
    v_fma_f32 v102, v102, v23, -v109
    v_fma_f32 v87, v87, v22, -v105
    v_fma_f32 v103, v103, v23, -v109
    v_exp_f32 v72, v72
    v_exp_f32 v88, v88
    v_exp_f32 v73, v73
    v_exp_f32 v89, v89
    v_exp_f32 v74, v74
    v_exp_f32 v90, v90
    v_exp_f32 v75, v75
    v_exp_f32 v91, v91
    v_exp_f32 v76, v76
    v_exp_f32 v92, v92
    ds_read_b64_tr_b16 v[224:225], v9 offset:1024
    ds_read_b64_tr_b16 v[226:227], v9 offset:1088
    ds_read_b64_tr_b16 v[228:229], v9 offset:0
    ds_read_b64_tr_b16 v[230:231], v9 offset:64
    ds_read_b64_tr_b16 v[232:233], v9 offset:8192
    ds_read_b64_tr_b16 v[234:235], v9 offset:8256
    ds_read_b64_tr_b16 v[236:237], v9 offset:9216
    ds_read_b64_tr_b16 v[238:239], v9 offset:9280
    ds_read_b64_tr_b16 v[240:241], v9 offset:16384
    ds_read_b64_tr_b16 v[242:243], v9 offset:16448
    ds_read_b64_tr_b16 v[244:245], v9 offset:24576
    ds_read_b64_tr_b16 v[246:247], v9 offset:24640
    v_exp_f32 v77, v77
    v_exp_f32 v93, v93
    v_exp_f32 v78, v78
    v_exp_f32 v94, v94
    v_exp_f32 v79, v79
    v_exp_f32 v95, v95
    v_exp_f32 v80, v80
    v_exp_f32 v96, v96
    v_exp_f32 v81, v81
    v_exp_f32 v97, v97
    v_exp_f32 v82, v82
    v_exp_f32 v98, v98
    v_exp_f32 v83, v83
    v_exp_f32 v99, v99
    v_exp_f32 v84, v84
    v_exp_f32 v100, v100
    v_exp_f32 v85, v85
    v_exp_f32 v101, v101
    v_exp_f32 v86, v86
    v_exp_f32 v102, v102
    v_exp_f32 v87, v87
    v_exp_f32 v103, v103
    v_add_f32 v104, v72, v73
    v_add_f32 v108, v88, v89
    v_add_f32 v106, v74, v75
    v_add_f32 v110, v90, v91
    v_add_f32 v105, v80, v81
    v_add_f32 v109, v96, v97
    v_add_f32 v107, v82, v83
    v_add_f32 v111, v98, v99
    v_add_f32 v104, v104, v76
    v_add_f32 v108, v108, v92
    v_add_f32 v106, v106, v77
    v_add_f32 v110, v110, v93
    v_add_f32 v105, v105, v84
    v_add_f32 v109, v109, v100
    v_add_f32 v107, v107, v85
    v_add_f32 v111, v111, v101
    v_add_f32 v104, v104, v78
    v_add_f32 v108, v108, v94
    v_add_f32 v106, v106, v79
    v_add_f32 v110, v110, v95
    v_add_f32 v105, v105, v86
    v_add_f32 v109, v109, v102
    v_add_f32 v107, v107, v87
    v_add_f32 v111, v111, v103
    v_add_f32 v104, v104, v106
    v_add_f32 v108, v108, v110
    v_add_f32 v105, v105, v107
    v_add_f32 v109, v109, v111
    s_waitcnt lgkmcnt(0)
    s_setprio 3
    v_mfma_f32_16x16x32_bf16 v[56:59], v[228:231], v[224:227], 0
    v_mfma_f32_16x16x32_bf16 v[64:67], v[228:231], v[192:195], 0
    v_mfma_f32_16x16x32_bf16 v[60:63], v[232:235], v[224:227], 0
    v_mfma_f32_16x16x32_bf16 v[68:71], v[232:235], v[192:195], 0
    v_mfma_f32_16x16x32_bf16 v[56:59], v[240:243], v[236:239], v[56:59]
    v_mfma_f32_16x16x32_bf16 v[64:67], v[240:243], v[196:199], v[64:67]
    v_mfma_f32_16x16x32_bf16 v[60:63], v[244:247], v[236:239], v[60:63]
    v_mfma_f32_16x16x32_bf16 v[68:71], v[244:247], v[196:199], v[68:71]
    s_setprio 0
    v_permlane32_swap_b32 v104, v105
    v_permlane32_swap_b32 v108, v109
    v_add_f32 v104, v104, v105
    v_add_f32 v108, v108, v109
    v_rcp_f32 v104, v104
    v_rcp_f32 v108, v108
    v_mul_f32 v104, v104, v18
    v_mul_f32 v108, v108, v19
    v_mov_b32 v105, v104
    v_mov_b32 v109, v108
    s_nop 0
    v_permlane32_swap_b32 v104, v105
    v_permlane32_swap_b32 v108, v109
    v_mul_f32 v72, v72, v104
    v_mul_f32 v88, v88, v108
    v_mul_f32 v73, v73, v104
    v_mul_f32 v89, v89, v108
    v_mul_f32 v74, v74, v104
    v_mul_f32 v90, v90, v108
    v_mul_f32 v75, v75, v104
    v_mul_f32 v91, v91, v108
    v_mul_f32 v76, v76, v104
    v_mul_f32 v92, v92, v108
    v_mul_f32 v77, v77, v104
    v_mul_f32 v93, v93, v108
    v_mul_f32 v78, v78, v104
    v_mul_f32 v94, v94, v108
    v_mul_f32 v79, v79, v104
    v_mul_f32 v95, v95, v108
    v_mul_f32 v80, v80, v105
    v_mul_f32 v96, v96, v109
    v_mul_f32 v81, v81, v105
    v_mul_f32 v97, v97, v109
    v_mul_f32 v82, v82, v105
    v_mul_f32 v98, v98, v109
    v_mul_f32 v83, v83, v105
    v_mul_f32 v99, v99, v109
    v_mul_f32 v84, v84, v105
    v_mul_f32 v100, v100, v109
    v_mul_f32 v85, v85, v105
    v_mul_f32 v101, v101, v109
    v_mul_f32 v86, v86, v105
    v_mul_f32 v102, v102, v109
    v_mul_f32 v87, v87, v105
    v_mul_f32 v103, v103, v109
    v_cvt_pk_bf16_f32 v208, v72, v73
    v_cvt_pk_bf16_f32 v216, v88, v89
    v_cvt_pk_bf16_f32 v209, v74, v75
    v_cvt_pk_bf16_f32 v217, v90, v91
    v_cvt_pk_bf16_f32 v210, v76, v77
    v_cvt_pk_bf16_f32 v218, v92, v93
    v_cvt_pk_bf16_f32 v211, v78, v79
    v_cvt_pk_bf16_f32 v219, v94, v95
    v_cvt_pk_bf16_f32 v212, v80, v81
    v_cvt_pk_bf16_f32 v220, v96, v97
    v_cvt_pk_bf16_f32 v213, v82, v83
    v_cvt_pk_bf16_f32 v221, v98, v99
    v_cvt_pk_bf16_f32 v214, v84, v85
    v_cvt_pk_bf16_f32 v222, v100, v101
    v_cvt_pk_bf16_f32 v215, v86, v87
    v_cvt_pk_bf16_f32 v223, v102, v103
    ds_write_b128 v8, v[208:211] offset:0
    ds_write_b128 v8, v[212:215] offset:8192
    ds_write_b128 v8, v[216:219] offset:16384
    ds_write_b128 v8, v[220:223] offset:24576
    ds_read_b64_tr_b16 v[224:225], v9 offset:17408
    ds_read_b64_tr_b16 v[226:227], v9 offset:17472
    ds_read_b64_tr_b16 v[228:229], v9 offset:0
    ds_read_b64_tr_b16 v[230:231], v9 offset:64
    ds_read_b64_tr_b16 v[232:233], v9 offset:8192
    ds_read_b64_tr_b16 v[234:235], v9 offset:8256
    ds_read_b64_tr_b16 v[236:237], v9 offset:25600
    ds_read_b64_tr_b16 v[238:239], v9 offset:25664
    ds_read_b64_tr_b16 v[240:241], v9 offset:16384
    ds_read_b64_tr_b16 v[242:243], v9 offset:16448
    ds_read_b64_tr_b16 v[244:245], v9 offset:24576
    ds_read_b64_tr_b16 v[246:247], v9 offset:24640
    v_and_b32 v72, 15, v1
    v_cmp_eq_u32 vcc, 1, v72
    s_mov_b64 exec, 1
    ds_add_u32 v7, v2 offset:52
    s_mov_b64 exec, -1
    s_waitcnt lgkmcnt(1)
    s_setprio 3
    v_mfma_f32_16x16x32_bf16 v[56:59], v[228:231], v[224:227], v[56:59]
    v_mfma_f32_16x16x32_bf16 v[64:67], v[228:231], v[200:203], v[64:67]
    v_mfma_f32_16x16x32_bf16 v[60:63], v[232:235], v[224:227], v[60:63]
    v_mfma_f32_16x16x32_bf16 v[68:71], v[232:235], v[200:203], v[68:71]
    v_mfma_f32_16x16x32_bf16 v[56:59], v[240:243], v[236:239], v[56:59]
    v_mfma_f32_16x16x32_bf16 v[64:67], v[240:243], v[204:207], v[64:67]
    v_mfma_f32_16x16x32_bf16 v[60:63], v[244:247], v[236:239], v[60:63]
    v_mfma_f32_16x16x32_bf16 v[68:71], v[244:247], v[204:207], v[68:71]
    s_setprio 0
    s_nop 3
    v_cvt_pk_bf16_f32 v56, v56, v57
    v_cvt_pk_bf16_f32 v57, v58, v59
    v_cvt_pk_bf16_f32 v58, v60, v61
    v_cvt_pk_bf16_f32 v59, v62, v63
    v_cndmask_b32 v64, v64, v68, vcc
    v_cndmask_b32 v65, v65, v69, vcc
    v_cndmask_b32 v66, v66, v70, vcc
    v_cndmask_b32 v67, v67, v71, vcc
    buffer_store_dwordx4 v[56:59], v10, s[44:47], 0 offen sc1
    s_mov_b32 exec_lo, 0x00030003
    s_mov_b32 exec_hi, 0x00030003
    buffer_store_dwordx4 v[64:67], v11, s[44:47], 0 offen sc1
    s_mov_b64 exec, -1
    s_setprio 0
    ds_read_b32 v25, v7 offset:1792
    s_waitcnt lgkmcnt(0)
    v_cmp_eq_u32 vcc, 1, v25
    s_cbranch_vccnz L_ok3
    s_mov_b32 s80, 0
L_spin3:
    s_sleep 4
    buffer_load_dword v25, v3, s[40:43], 0 offen offset:0 sc1
    s_add_u32 s80, s80, 1
    s_waitcnt vmcnt(0)
    v_cmp_eq_u32 vcc, 1, v25
    s_cbranch_vccnz L_ok3
    s_cmp_lt_u32 s80, 0x80000
    s_cbranch_scc1 L_spin3
L_ok3:
    s_waitcnt vmcnt(0)
    s_mov_b64 exec, 1
    buffer_atomic_add v2, v5, s[44:47], 0 offen offset:0 sc1
    s_mov_b64 exec, -1
    s_load_dword s50, s[44:45], s54 offset:0 glc
    s_waitcnt lgkmcnt(0)
    s_cmp_eq_u32 s50, 16
    s_cbranch_scc1 L_ok4
    s_mov_b32 s80, 0
L_spin4:
    s_sleep 4
    s_load_dword s50, s[44:45], s54 offset:0 glc
    s_add_u32 s80, s80, 1
    s_waitcnt lgkmcnt(0)
    s_cmp_eq_u32 s50, 16
    s_cbranch_scc1 L_ok4
    s_cmp_lt_u32 s80, 0x80000
    s_cbranch_scc1 L_spin4
L_ok4:
    buffer_load_dwordx4 v[192:195], v12, s[44:47], 0 offen sc1
    s_movk_i32 s66, 8192
    buffer_load_dwordx4 v[196:199], v12, s[44:47], s66 offen sc1
    s_cmp_lg_u32 s49, 0
    s_cbranch_scc1 L_sk5
    buffer_load_dwordx4 v[56:59], v13, s[44:47], 0 offen sc1
    buffer_load_dwordx4 v[60:63], v13, s[44:47], 0 offen offset:64 sc1
    v_and_b32 v72, 15, v1
    v_cmp_eq_u32 vcc, 1, v72
    s_waitcnt vmcnt(0)
    v_add_f32_dpp v56, v56, v56 row_ror:8 row_mask:0xf bank_mask:0xf
    v_add_f32_dpp v57, v57, v57 row_ror:8 row_mask:0xf bank_mask:0xf
    v_add_f32_dpp v58, v58, v58 row_ror:8 row_mask:0xf bank_mask:0xf
    v_add_f32_dpp v59, v59, v59 row_ror:8 row_mask:0xf bank_mask:0xf
    v_add_f32_dpp v60, v60, v60 row_ror:8 row_mask:0xf bank_mask:0xf
    v_add_f32_dpp v61, v61, v61 row_ror:8 row_mask:0xf bank_mask:0xf
    v_add_f32_dpp v62, v62, v62 row_ror:8 row_mask:0xf bank_mask:0xf
    v_add_f32_dpp v63, v63, v63 row_ror:8 row_mask:0xf bank_mask:0xf
    v_add_f32_dpp v56, v56, v56 row_ror:4 row_mask:0xf bank_mask:0xf
    v_add_f32_dpp v57, v57, v57 row_ror:4 row_mask:0xf bank_mask:0xf
    v_add_f32_dpp v58, v58, v58 row_ror:4 row_mask:0xf bank_mask:0xf
    v_add_f32_dpp v59, v59, v59 row_ror:4 row_mask:0xf bank_mask:0xf
    v_add_f32_dpp v60, v60, v60 row_ror:4 row_mask:0xf bank_mask:0xf
    v_add_f32_dpp v61, v61, v61 row_ror:4 row_mask:0xf bank_mask:0xf
    v_add_f32_dpp v62, v62, v62 row_ror:4 row_mask:0xf bank_mask:0xf
    v_add_f32_dpp v63, v63, v63 row_ror:4 row_mask:0xf bank_mask:0xf
    v_add_f32_dpp v56, v56, v56 row_ror:2 row_mask:0xf bank_mask:0xf
    v_add_f32_dpp v57, v57, v57 row_ror:2 row_mask:0xf bank_mask:0xf
    v_add_f32_dpp v58, v58, v58 row_ror:2 row_mask:0xf bank_mask:0xf
    v_add_f32_dpp v59, v59, v59 row_ror:2 row_mask:0xf bank_mask:0xf
    v_add_f32_dpp v60, v60, v60 row_ror:2 row_mask:0xf bank_mask:0xf
    v_add_f32_dpp v61, v61, v61 row_ror:2 row_mask:0xf bank_mask:0xf
    v_add_f32_dpp v62, v62, v62 row_ror:2 row_mask:0xf bank_mask:0xf
    v_add_f32_dpp v63, v63, v63 row_ror:2 row_mask:0xf bank_mask:0xf
    v_add_f32_dpp v56, v56, v56 row_ror:1 row_mask:0xf bank_mask:0xf
    v_add_f32_dpp v57, v57, v57 row_ror:1 row_mask:0xf bank_mask:0xf
    v_add_f32_dpp v58, v58, v58 row_ror:1 row_mask:0xf bank_mask:0xf
    v_add_f32_dpp v59, v59, v59 row_ror:1 row_mask:0xf bank_mask:0xf
    v_add_f32_dpp v60, v60, v60 row_ror:1 row_mask:0xf bank_mask:0xf
    v_add_f32_dpp v61, v61, v61 row_ror:1 row_mask:0xf bank_mask:0xf
    v_add_f32_dpp v62, v62, v62 row_ror:1 row_mask:0xf bank_mask:0xf
    v_add_f32_dpp v63, v63, v63 row_ror:1 row_mask:0xf bank_mask:0xf
    v_cndmask_b32 v56, v56, v60, vcc
    v_cndmask_b32 v57, v57, v61, vcc
    v_cndmask_b32 v58, v58, v62, vcc
    v_cndmask_b32 v59, v59, v63, vcc
    s_mov_b32 exec_lo, 0x00030003
    s_mov_b32 exec_hi, 0x00030003
    buffer_store_dwordx4 v[56:59], v4, s[44:47], 0 offen sc1
    s_mov_b64 exec, -1
    s_branch L_l2b
L_sk5:
    s_waitcnt vmcnt(0)
L_l2b:
    s_setprio 3
    v_mfma_f32_4x4x4_16b_bf16 v[72:75], v[32:33], v[192:193], 0
    v_mfma_f32_4x4x4_16b_bf16 v[76:79], v[32:33], v[194:195], 0
    s_nop 0
    v_mfma_f32_4x4x4_16b_bf16 v[72:75], v[32:33], v[196:197], v[72:75]
    v_mfma_f32_4x4x4_16b_bf16 v[76:79], v[32:33], v[198:199], v[76:79]
    s_setprio 0
    s_nop 2
    v_add_f32_dpp v72, v72, v72 row_ror:8 row_mask:0xf bank_mask:0xf
    v_add_f32_dpp v73, v73, v73 row_ror:8 row_mask:0xf bank_mask:0xf
    v_add_f32_dpp v74, v74, v74 row_ror:8 row_mask:0xf bank_mask:0xf
    v_add_f32_dpp v75, v75, v75 row_ror:8 row_mask:0xf bank_mask:0xf
    v_add_f32_dpp v76, v76, v76 row_ror:8 row_mask:0xf bank_mask:0xf
    v_add_f32_dpp v77, v77, v77 row_ror:8 row_mask:0xf bank_mask:0xf
    v_add_f32_dpp v78, v78, v78 row_ror:8 row_mask:0xf bank_mask:0xf
    v_add_f32_dpp v79, v79, v79 row_ror:8 row_mask:0xf bank_mask:0xf
    v_permlane16_swap_b32 v72, v76
    v_permlane16_swap_b32 v73, v77
    v_permlane16_swap_b32 v74, v78
    v_permlane16_swap_b32 v75, v79
    v_add_f32 v72, v72, v76
    v_add_f32 v73, v73, v77
    v_add_f32 v74, v74, v78
    v_add_f32 v75, v75, v79
    s_nop 0
    v_permlane32_swap_b32 v72, v74
    v_permlane32_swap_b32 v73, v75
    v_add_f32 v72, v72, v74
    v_add_f32 v73, v73, v75
    v_cvt_pk_bf16_f32 v72, v72, v73
    s_mov_b32 exec_lo, 0x00ff00ff
    s_mov_b32 exec_hi, 0x00ff00ff
    buffer_store_dword v72, v14, s[44:47], 0 offen sc1
    s_mov_b64 exec, -1
    s_waitcnt vmcnt(0)
    s_mov_b64 exec, 1
    buffer_atomic_add v2, v6, s[44:47], 0 offen offset:128 sc1
    s_mov_b64 exec, -1
    s_endpgm
L_attn1:
    s_lshl_b32 s69, s59, 2
    s_add_u32 s69, s69, s57
    s_add_u32 s68, s69, 2
    v_lshrrev_b32 v103, 5, v1
    v_and_b32 v101, 15, v1
    v_lshrrev_b32 v100, 4, v1
    v_lshlrev_b32 v102, 7, v103
    v_lshl_add_u32 v102, v101, 1, v102
    s_lshl_b32 s70, s69, 9
    v_mov_b32 v105, v102
    v_mov_b32 v3, 0
    v_mov_b32 v34, 0
    v_mov_b32 v2, 1
    v_mov_b32 v7, 16384
    v_and_b32 v102, 1, v100
    v_mul_u32_u24 v102, 0x8000, v102
    v_lshl_or_b32 v15, v102, 16, v102
    s_lshl_b32 s66, s58, 10
    v_lshlrev_b32 v4, 9, v1
    v_add_u32 v4, s66, v4
    v_lshl_add_u32 v27, v1, 2, v7
    ds_write_b32 v27, v3 offset:0
    ds_write_b32 v27, v3 offset:256
    ds_write_b32 v27, v3 offset:512
    ds_write_b32 v27, v3 offset:768
    ds_write_b32 v27, v3 offset:1024
    ds_write_b32 v27, v3 offset:1280
    ds_write_b32 v27, v3 offset:1536
    ds_write_b32 v27, v3 offset:1792
    s_waitcnt lgkmcnt(0)
    s_add_u32 s66, s61, 2
    s_and_b32 s66, s66, 7
    s_lshl_b32 s66, s66, 7
    s_add_u32 s66, s66, s79
    s_add_u32 m0, s75, 32768
    s_nop 0
    buffer_load_dwordx4 v48, s[8:11], s66 offen offset:0 lds
    buffer_load_dwordx4 v49, s[8:11], s66 offen offset:1024 lds
    buffer_load_dwordx4 v50, s[8:11], s66 offen offset:2048 lds
    buffer_load_dwordx4 v51, s[8:11], s66 offen offset:3072 lds
    s_add_u32 s66, s61, 3
    s_and_b32 s66, s66, 7
    s_lshl_b32 s66, s66, 7
    s_add_u32 s66, s66, s79
    s_add_u32 m0, s75, 49152
    s_nop 0
    buffer_load_dwordx4 v48, s[8:11], s66 offen offset:0 lds
    buffer_load_dwordx4 v49, s[8:11], s66 offen offset:1024 lds
    buffer_load_dwordx4 v50, s[8:11], s66 offen offset:2048 lds
    buffer_load_dwordx4 v51, s[8:11], s66 offen offset:3072 lds
    s_waitcnt vmcnt(8)
    s_barrier
    s_add_u32 s66, s61, 4
    s_and_b32 s66, s66, 7
    s_lshl_b32 s66, s66, 7
    s_add_u32 s66, s66, s79
    s_add_u32 m0, s75, 65536
    s_nop 0
    buffer_load_dwordx4 v48, s[8:11], s66 offen offset:0 lds
    buffer_load_dwordx4 v49, s[8:11], s66 offen offset:1024 lds
    buffer_load_dwordx4 v50, s[8:11], s66 offen offset:2048 lds
    buffer_load_dwordx4 v51, s[8:11], s66 offen offset:3072 lds
    s_add_u32 s66, s61, 5
    s_and_b32 s66, s66, 7
    s_lshl_b32 s66, s66, 7
    s_add_u32 s66, s66, s79
    s_add_u32 m0, s75, 81920
    s_nop 0
    buffer_load_dwordx4 v48, s[8:11], s66 offen offset:0 lds
    buffer_load_dwordx4 v49, s[8:11], s66 offen offset:1024 lds
    buffer_load_dwordx4 v50, s[8:11], s66 offen offset:2048 lds
    buffer_load_dwordx4 v51, s[8:11], s66 offen offset:3072 lds
    s_waitcnt vmcnt(8)
    s_barrier
    s_add_u32 s66, s61, 6
    s_and_b32 s66, s66, 7
    s_lshl_b32 s66, s66, 7
    s_add_u32 s66, s66, s79
    s_add_u32 m0, s75, 98304
    s_nop 0
    buffer_load_dwordx4 v48, s[8:11], s66 offen offset:0 lds
    buffer_load_dwordx4 v49, s[8:11], s66 offen offset:1024 lds
    buffer_load_dwordx4 v50, s[8:11], s66 offen offset:2048 lds
    buffer_load_dwordx4 v51, s[8:11], s66 offen offset:3072 lds
    s_add_u32 s66, s61, 7
    s_and_b32 s66, s66, 7
    s_lshl_b32 s66, s66, 7
    s_add_u32 s66, s66, s79
    s_add_u32 m0, s75, 114688
    s_nop 0
    buffer_load_dwordx4 v48, s[8:11], s66 offen offset:0 lds
    buffer_load_dwordx4 v49, s[8:11], s66 offen offset:1024 lds
    buffer_load_dwordx4 v50, s[8:11], s66 offen offset:2048 lds
    buffer_load_dwordx4 v51, s[8:11], s66 offen offset:3072 lds
    s_waitcnt vmcnt(8)
    s_barrier
    buffer_load_ushort v72, v105, s[16:19], s70 offen offset:0
    buffer_load_ushort v73, v105, s[16:19], s70 offen offset:32
    buffer_load_ushort v74, v105, s[16:19], s70 offen offset:64
    buffer_load_ushort v75, v105, s[16:19], s70 offen offset:96
    buffer_load_ushort v76, v105, s[16:19], s70 offen offset:256
    buffer_load_ushort v77, v105, s[16:19], s70 offen offset:288
    buffer_load_ushort v78, v105, s[16:19], s70 offen offset:320
    buffer_load_ushort v79, v105, s[16:19], s70 offen offset:352
    buffer_load_ushort v80, v105, s[16:19], s70 offen offset:1024
    buffer_load_ushort v81, v105, s[16:19], s70 offen offset:1056
    buffer_load_ushort v82, v105, s[16:19], s70 offen offset:1088
    buffer_load_ushort v83, v105, s[16:19], s70 offen offset:1120
    buffer_load_ushort v84, v105, s[16:19], s70 offen offset:1280
    buffer_load_ushort v85, v105, s[16:19], s70 offen offset:1312
    buffer_load_ushort v86, v105, s[16:19], s70 offen offset:1344
    buffer_load_ushort v87, v105, s[16:19], s70 offen offset:1376
    s_waitcnt vmcnt(16)
    s_barrier
    s_barrier
    s_lshl_b32 s66, s68, 8
    s_add_u32 s66, s66, 0x4000
    v_mov_b32 v5, s66
    s_lshl_b32 s66, s69, 8
    s_add_u32 s54, s66, 0x4000
    s_lshl_b32 s66, s57, 11
    s_add_u32 s66, s66, 131072
    v_lshlrev_b32 v104, 4, v1
    v_add_u32 v8, s66, v104
    v_and_b32 v102, 1, v1
    v_lshlrev_b32 v9, 9, v102
    v_lshl_add_u32 v9, v100, 7, v9
    v_bfe_u32 v102, v1, 2, 2
    v_lshl_add_u32 v9, v102, 4, v9
    v_bfe_u32 v102, v1, 1, 1
    v_lshl_add_u32 v9, v102, 3, v9
    v_add_u32 v9, s66, v9
    s_lshl_b32 s66, s68, 4
    s_add_u32 s66, s66, s58
    s_lshl_b32 s67, s66, 10
    s_add_u32 s67, s67, 65536
    v_add_u32 v10, s67, v104
    s_lshl_b32 s67, s66, 7
    s_add_u32 s67, s67, 1179648
    v_lshlrev_b32 v11, 6, v101
    v_lshl_add_u32 v11, v100, 4, v11
    v_add_u32 v11, s67, v11
    s_lshl_b32 s67, s69, 10
    s_add_u32 s67, s67, 1245184
    v_add_u32 v12, s67, v104
    s_lshl_b32 s67, s69, 7
    s_add_u32 s67, s67, 1277952
    v_lshlrev_b32 v13, 4, v100
    v_add_u32 v13, s67, v13
    s_mul_i32 s67, s58, 576
    s_add_u32 s67, s67, s69
    s_add_u32 s67, s67, s57
    s_add_u32 s67, s67, 112
    s_lshl_b32 s67, s67, 10
    s_add_u32 s67, s67, 2097152
    v_and_b32 v102, 1, v100
    v_lshlrev_b32 v14, 10, v102
    v_lshl_add_u32 v14, v103, 8, v14
    v_lshl_add_u32 v14, v101, 4, v14
    v_add_u32 v14, s67, v14
    s_waitcnt vmcnt(0)
    v_lshl_or_b32 v36, v73, 16, v72
    v_lshl_or_b32 v37, v75, 16, v74
    v_lshl_or_b32 v38, v77, 16, v76
    v_lshl_or_b32 v39, v79, 16, v78
    v_xor_b32 v36, v36, v15
    v_xor_b32 v37, v37, v15
    v_xor_b32 v38, v38, v15
    v_xor_b32 v39, v39, v15
    v_lshl_or_b32 v40, v81, 16, v80
    v_lshl_or_b32 v41, v83, 16, v82
    v_lshl_or_b32 v42, v85, 16, v84
    v_lshl_or_b32 v43, v87, 16, v86
    v_xor_b32 v40, v40, v15
    v_xor_b32 v41, v41, v15
    v_xor_b32 v42, v42, v15
    v_xor_b32 v43, v43, v15
    v_and_b32 v72, 31, v1
    v_lshlrev_b32 v72, 2, v72
    v_add_u32 v72, 18432, v72
    v_lshrrev_b32 v73, 4, v1
    v_lshlrev_b32 v73, 4, v73
    v_add_u32 v73, 18944, v73
    s_waitcnt lgkmcnt(0)
    s_mov_b32 s80, 0
L_cw6:
    ds_read_b32 v27, v7 offset:32
    s_add_u32 s80, s80, 1
    s_waitcnt lgkmcnt(0)
    v_cmp_le_u32 vcc, 4, v27
    s_cbranch_vccnz L_cx6
    s_sleep 2
    s_cmp_lt_u32 s80, 0x1000000
    s_cbranch_scc1 L_cw6
L_cx6:
    ds_read_b32 v16, v72 offset:0
    ds_read_b32 v17, v72 offset:128
    ds_read_b32 v18, v72 offset:256
    ds_read_b32 v19, v72 offset:384
    ds_read_b128 v[192:195], v73 offset:0
    ds_read_b128 v[196:199], v73 offset:64
    ds_read_b128 v[200:203], v73 offset:128
    ds_read_b128 v[204:207], v73 offset:192
    ds_read_b128 v[112:115], v8 offset:0
    ds_read_b128 v[116:119], v8 offset:8192
    ds_read_b128 v[120:123], v8 offset:16384
    ds_read_b128 v[124:127], v8 offset:24576
    s_waitcnt lgkmcnt(0)
    v_mul_f32 v20, s72, v16
    v_mul_f32 v21, s72, v17
    v_mul_f32 v22, s72, v18
    v_mul_f32 v23, s72, v19
    s_setprio 3
    v_mfma_f32_32x32x16_bf16 v[72:87], v[40:43], v[112:115], 0
    v_mfma_f32_32x32x16_bf16 v[88:103], v[40:43], v[116:119], 0
    s_setprio 0
    s_nop 9
    v_max3_f32 v104, v72, v73, v74
    v_max3_f32 v108, v88, v89, v90
    v_max3_f32 v105, v80, v81, v82
    v_max3_f32 v109, v96, v97, v98
    v_max3_f32 v106, v75, v76, v77
    v_max3_f32 v110, v91, v92, v93
    v_max3_f32 v107, v83, v84, v85
    v_max3_f32 v111, v99, v100, v101
    v_max3_f32 v104, v104, v78, v79
    v_max3_f32 v108, v108, v94, v95
    v_max3_f32 v105, v105, v86, v87
    v_max3_f32 v109, v109, v102, v103
    v_max_f32 v104, v104, v106
    v_max_f32 v108, v108, v110
    v_max_f32 v105, v105, v107
    v_max_f32 v109, v109, v111
    s_nop 0
    v_permlane32_swap_b32 v104, v105
    v_permlane32_swap_b32 v108, v109
    v_max_f32 v104, v104, v105
    v_max_f32 v108, v108, v109
    v_mul_f32 v104, v20, v104
    v_mul_f32 v108, v21, v108
    v_mov_b32 v105, v104
    v_mov_b32 v109, v108
    s_nop 0
    v_permlane32_swap_b32 v104, v105
    v_permlane32_swap_b32 v108, v109
    v_fma_f32 v72, v72, v20, -v104
    v_fma_f32 v88, v88, v21, -v108
    v_fma_f32 v73, v73, v20, -v104
    v_fma_f32 v89, v89, v21, -v108
    v_fma_f32 v74, v74, v20, -v104
    v_fma_f32 v90, v90, v21, -v108
    v_fma_f32 v75, v75, v20, -v104
    v_fma_f32 v91, v91, v21, -v108
    v_fma_f32 v76, v76, v20, -v104
    v_fma_f32 v92, v92, v21, -v108
    v_fma_f32 v77, v77, v20, -v104
    v_fma_f32 v93, v93, v21, -v108
    v_fma_f32 v78, v78, v20, -v104
    v_fma_f32 v94, v94, v21, -v108
    v_fma_f32 v79, v79, v20, -v104
    v_fma_f32 v95, v95, v21, -v108
    v_fma_f32 v80, v80, v20, -v105
    v_fma_f32 v96, v96, v21, -v109
    v_fma_f32 v81, v81, v20, -v105
    v_fma_f32 v97, v97, v21, -v109
    v_fma_f32 v82, v82, v20, -v105
    v_fma_f32 v98, v98, v21, -v109
    v_fma_f32 v83, v83, v20, -v105
    v_fma_f32 v99, v99, v21, -v109
    v_fma_f32 v84, v84, v20, -v105
    v_fma_f32 v100, v100, v21, -v109
    v_fma_f32 v85, v85, v20, -v105
    v_fma_f32 v101, v101, v21, -v109
    v_fma_f32 v86, v86, v20, -v105
    v_fma_f32 v102, v102, v21, -v109
    v_fma_f32 v87, v87, v20, -v105
    v_fma_f32 v103, v103, v21, -v109
    v_exp_f32 v72, v72
    v_exp_f32 v88, v88
    v_exp_f32 v73, v73
    v_exp_f32 v89, v89
    v_exp_f32 v74, v74
    v_exp_f32 v90, v90
    v_exp_f32 v75, v75
    v_exp_f32 v91, v91
    v_exp_f32 v76, v76
    v_exp_f32 v92, v92
    v_exp_f32 v77, v77
    v_exp_f32 v93, v93
    v_exp_f32 v78, v78
    v_exp_f32 v94, v94
    v_exp_f32 v79, v79
    v_exp_f32 v95, v95
    v_exp_f32 v80, v80
    v_exp_f32 v96, v96
    v_exp_f32 v81, v81
    v_exp_f32 v97, v97
    v_exp_f32 v82, v82
    v_exp_f32 v98, v98
    v_exp_f32 v83, v83
    v_exp_f32 v99, v99
    v_exp_f32 v84, v84
    v_exp_f32 v100, v100
    v_exp_f32 v85, v85
    v_exp_f32 v101, v101
    v_exp_f32 v86, v86
    v_exp_f32 v102, v102
    v_exp_f32 v87, v87
    v_exp_f32 v103, v103
    v_add_f32 v104, v72, v73
    v_add_f32 v108, v88, v89
    v_add_f32 v106, v74, v75
    v_add_f32 v110, v90, v91
    v_add_f32 v105, v80, v81
    v_add_f32 v109, v96, v97
    v_add_f32 v107, v82, v83
    v_add_f32 v111, v98, v99
    v_add_f32 v104, v104, v76
    v_add_f32 v108, v108, v92
    v_add_f32 v106, v106, v77
    v_add_f32 v110, v110, v93
    v_add_f32 v105, v105, v84
    v_add_f32 v109, v109, v100
    v_add_f32 v107, v107, v85
    v_add_f32 v111, v111, v101
    v_add_f32 v104, v104, v78
    v_add_f32 v108, v108, v94
    v_add_f32 v106, v106, v79
    v_add_f32 v110, v110, v95
    v_add_f32 v105, v105, v86
    v_add_f32 v109, v109, v102
    v_add_f32 v107, v107, v87
    v_add_f32 v111, v111, v103
    v_add_f32 v104, v104, v106
    v_add_f32 v108, v108, v110
    v_add_f32 v105, v105, v107
    v_add_f32 v109, v109, v111
    s_nop 0
    v_permlane32_swap_b32 v104, v105
    v_permlane32_swap_b32 v108, v109
    v_add_f32 v104, v104, v105
    v_add_f32 v108, v108, v109
    v_rcp_f32 v104, v104
    v_rcp_f32 v108, v108
    v_mul_f32 v104, v104, v16
    v_mul_f32 v108, v108, v17
    v_mov_b32 v105, v104
    v_mov_b32 v109, v108
    s_nop 0
    v_permlane32_swap_b32 v104, v105
    v_permlane32_swap_b32 v108, v109
    v_mul_f32 v72, v72, v104
    v_mul_f32 v88, v88, v108
    v_mul_f32 v73, v73, v104
    v_mul_f32 v89, v89, v108
    v_mul_f32 v74, v74, v104
    v_mul_f32 v90, v90, v108
    v_mul_f32 v75, v75, v104
    v_mul_f32 v91, v91, v108
    v_mul_f32 v76, v76, v104
    v_mul_f32 v92, v92, v108
    v_mul_f32 v77, v77, v104
    v_mul_f32 v93, v93, v108
    v_mul_f32 v78, v78, v104
    v_mul_f32 v94, v94, v108
    v_mul_f32 v79, v79, v104
    v_mul_f32 v95, v95, v108
    v_mul_f32 v80, v80, v105
    v_mul_f32 v96, v96, v109
    v_mul_f32 v81, v81, v105
    v_mul_f32 v97, v97, v109
    v_mul_f32 v82, v82, v105
    v_mul_f32 v98, v98, v109
    v_mul_f32 v83, v83, v105
    v_mul_f32 v99, v99, v109
    v_mul_f32 v84, v84, v105
    v_mul_f32 v100, v100, v109
    v_mul_f32 v85, v85, v105
    v_mul_f32 v101, v101, v109
    v_mul_f32 v86, v86, v105
    v_mul_f32 v102, v102, v109
    v_mul_f32 v87, v87, v105
    v_mul_f32 v103, v103, v109
    v_cvt_pk_bf16_f32 v208, v72, v73
    v_cvt_pk_bf16_f32 v216, v88, v89
    v_cvt_pk_bf16_f32 v209, v74, v75
    v_cvt_pk_bf16_f32 v217, v90, v91
    v_cvt_pk_bf16_f32 v210, v76, v77
    v_cvt_pk_bf16_f32 v218, v92, v93
    v_cvt_pk_bf16_f32 v211, v78, v79
    v_cvt_pk_bf16_f32 v219, v94, v95
    v_cvt_pk_bf16_f32 v212, v80, v81
    v_cvt_pk_bf16_f32 v220, v96, v97
    v_cvt_pk_bf16_f32 v213, v82, v83
    v_cvt_pk_bf16_f32 v221, v98, v99
    v_cvt_pk_bf16_f32 v214, v84, v85
    v_cvt_pk_bf16_f32 v222, v100, v101
    v_cvt_pk_bf16_f32 v215, v86, v87
    v_cvt_pk_bf16_f32 v223, v102, v103
    ds_write_b128 v8, v[208:211] offset:0
    ds_write_b128 v8, v[212:215] offset:8192
    ds_write_b128 v8, v[216:219] offset:16384
    ds_write_b128 v8, v[220:223] offset:24576
    s_setprio 3
    v_mfma_f32_32x32x16_bf16 v[72:87], v[40:43], v[120:123], 0
    v_mfma_f32_32x32x16_bf16 v[88:103], v[40:43], v[124:127], 0
    s_setprio 0
    s_nop 9
    v_max3_f32 v104, v72, v73, v74
    v_max3_f32 v108, v88, v89, v90
    v_max3_f32 v105, v80, v81, v82
    v_max3_f32 v109, v96, v97, v98
    v_max3_f32 v106, v75, v76, v77
    v_max3_f32 v110, v91, v92, v93
    v_max3_f32 v107, v83, v84, v85
    v_max3_f32 v111, v99, v100, v101
    v_max3_f32 v104, v104, v78, v79
    v_max3_f32 v108, v108, v94, v95
    v_max3_f32 v105, v105, v86, v87
    v_max3_f32 v109, v109, v102, v103
    v_max_f32 v104, v104, v106
    v_max_f32 v108, v108, v110
    v_max_f32 v105, v105, v107
    v_max_f32 v109, v109, v111
    s_nop 0
    v_permlane32_swap_b32 v104, v105
    v_permlane32_swap_b32 v108, v109
    v_max_f32 v104, v104, v105
    v_max_f32 v108, v108, v109
    v_mul_f32 v104, v22, v104
    v_mul_f32 v108, v23, v108
    v_mov_b32 v105, v104
    v_mov_b32 v109, v108
    s_nop 0
    v_permlane32_swap_b32 v104, v105
    v_permlane32_swap_b32 v108, v109
    v_fma_f32 v72, v72, v22, -v104
    v_fma_f32 v88, v88, v23, -v108
    v_fma_f32 v73, v73, v22, -v104
    v_fma_f32 v89, v89, v23, -v108
    v_fma_f32 v74, v74, v22, -v104
    v_fma_f32 v90, v90, v23, -v108
    v_fma_f32 v75, v75, v22, -v104
    v_fma_f32 v91, v91, v23, -v108
    v_fma_f32 v76, v76, v22, -v104
    v_fma_f32 v92, v92, v23, -v108
    v_fma_f32 v77, v77, v22, -v104
    v_fma_f32 v93, v93, v23, -v108
    v_fma_f32 v78, v78, v22, -v104
    v_fma_f32 v94, v94, v23, -v108
    v_fma_f32 v79, v79, v22, -v104
    v_fma_f32 v95, v95, v23, -v108
    v_fma_f32 v80, v80, v22, -v105
    v_fma_f32 v96, v96, v23, -v109
    v_fma_f32 v81, v81, v22, -v105
    v_fma_f32 v97, v97, v23, -v109
    v_fma_f32 v82, v82, v22, -v105
    v_fma_f32 v98, v98, v23, -v109
    v_fma_f32 v83, v83, v22, -v105
    v_fma_f32 v99, v99, v23, -v109
    v_fma_f32 v84, v84, v22, -v105
    v_fma_f32 v100, v100, v23, -v109
    v_fma_f32 v85, v85, v22, -v105
    v_fma_f32 v101, v101, v23, -v109
    v_fma_f32 v86, v86, v22, -v105
    v_fma_f32 v102, v102, v23, -v109
    v_fma_f32 v87, v87, v22, -v105
    v_fma_f32 v103, v103, v23, -v109
    v_exp_f32 v72, v72
    v_exp_f32 v88, v88
    v_exp_f32 v73, v73
    v_exp_f32 v89, v89
    v_exp_f32 v74, v74
    v_exp_f32 v90, v90
    v_exp_f32 v75, v75
    v_exp_f32 v91, v91
    v_exp_f32 v76, v76
    v_exp_f32 v92, v92
    ds_read_b64_tr_b16 v[224:225], v9 offset:1024
    ds_read_b64_tr_b16 v[226:227], v9 offset:1088
    ds_read_b64_tr_b16 v[228:229], v9 offset:0
    ds_read_b64_tr_b16 v[230:231], v9 offset:64
    ds_read_b64_tr_b16 v[232:233], v9 offset:8192
    ds_read_b64_tr_b16 v[234:235], v9 offset:8256
    ds_read_b64_tr_b16 v[236:237], v9 offset:9216
    ds_read_b64_tr_b16 v[238:239], v9 offset:9280
    ds_read_b64_tr_b16 v[240:241], v9 offset:16384
    ds_read_b64_tr_b16 v[242:243], v9 offset:16448
    ds_read_b64_tr_b16 v[244:245], v9 offset:24576
    ds_read_b64_tr_b16 v[246:247], v9 offset:24640
    v_exp_f32 v77, v77
    v_exp_f32 v93, v93
    v_exp_f32 v78, v78
    v_exp_f32 v94, v94
    v_exp_f32 v79, v79
    v_exp_f32 v95, v95
    v_exp_f32 v80, v80
    v_exp_f32 v96, v96
    v_exp_f32 v81, v81
    v_exp_f32 v97, v97
    v_exp_f32 v82, v82
    v_exp_f32 v98, v98
    v_exp_f32 v83, v83
    v_exp_f32 v99, v99
    v_exp_f32 v84, v84
    v_exp_f32 v100, v100
    v_exp_f32 v85, v85
    v_exp_f32 v101, v101
    v_exp_f32 v86, v86
    v_exp_f32 v102, v102
    v_exp_f32 v87, v87
    v_exp_f32 v103, v103
    v_add_f32 v104, v72, v73
    v_add_f32 v108, v88, v89
    v_add_f32 v106, v74, v75
    v_add_f32 v110, v90, v91
    v_add_f32 v105, v80, v81
    v_add_f32 v109, v96, v97
    v_add_f32 v107, v82, v83
    v_add_f32 v111, v98, v99
    v_add_f32 v104, v104, v76
    v_add_f32 v108, v108, v92
    v_add_f32 v106, v106, v77
    v_add_f32 v110, v110, v93
    v_add_f32 v105, v105, v84
    v_add_f32 v109, v109, v100
    v_add_f32 v107, v107, v85
    v_add_f32 v111, v111, v101
    v_add_f32 v104, v104, v78
    v_add_f32 v108, v108, v94
    v_add_f32 v106, v106, v79
    v_add_f32 v110, v110, v95
    v_add_f32 v105, v105, v86
    v_add_f32 v109, v109, v102
    v_add_f32 v107, v107, v87
    v_add_f32 v111, v111, v103
    v_add_f32 v104, v104, v106
    v_add_f32 v108, v108, v110
    v_add_f32 v105, v105, v107
    v_add_f32 v109, v109, v111
    s_waitcnt lgkmcnt(0)
    s_setprio 3
    v_mfma_f32_16x16x32_bf16 v[56:59], v[228:231], v[224:227], 0
    v_mfma_f32_16x16x32_bf16 v[64:67], v[228:231], v[192:195], 0
    v_mfma_f32_16x16x32_bf16 v[60:63], v[232:235], v[224:227], 0
    v_mfma_f32_16x16x32_bf16 v[68:71], v[232:235], v[192:195], 0
    v_mfma_f32_16x16x32_bf16 v[56:59], v[240:243], v[236:239], v[56:59]
    v_mfma_f32_16x16x32_bf16 v[64:67], v[240:243], v[196:199], v[64:67]
    v_mfma_f32_16x16x32_bf16 v[60:63], v[244:247], v[236:239], v[60:63]
    v_mfma_f32_16x16x32_bf16 v[68:71], v[244:247], v[196:199], v[68:71]
    s_setprio 0
    v_permlane32_swap_b32 v104, v105
    v_permlane32_swap_b32 v108, v109
    v_add_f32 v104, v104, v105
    v_add_f32 v108, v108, v109
    v_rcp_f32 v104, v104
    v_rcp_f32 v108, v108
    v_mul_f32 v104, v104, v18
    v_mul_f32 v108, v108, v19
    v_mov_b32 v105, v104
    v_mov_b32 v109, v108
    s_nop 0
    v_permlane32_swap_b32 v104, v105
    v_permlane32_swap_b32 v108, v109
    v_mul_f32 v72, v72, v104
    v_mul_f32 v88, v88, v108
    v_mul_f32 v73, v73, v104
    v_mul_f32 v89, v89, v108
    v_mul_f32 v74, v74, v104
    v_mul_f32 v90, v90, v108
    v_mul_f32 v75, v75, v104
    v_mul_f32 v91, v91, v108
    v_mul_f32 v76, v76, v104
    v_mul_f32 v92, v92, v108
    v_mul_f32 v77, v77, v104
    v_mul_f32 v93, v93, v108
    v_mul_f32 v78, v78, v104
    v_mul_f32 v94, v94, v108
    v_mul_f32 v79, v79, v104
    v_mul_f32 v95, v95, v108
    v_mul_f32 v80, v80, v105
    v_mul_f32 v96, v96, v109
    v_mul_f32 v81, v81, v105
    v_mul_f32 v97, v97, v109
    v_mul_f32 v82, v82, v105
    v_mul_f32 v98, v98, v109
    v_mul_f32 v83, v83, v105
    v_mul_f32 v99, v99, v109
    v_mul_f32 v84, v84, v105
    v_mul_f32 v100, v100, v109
    v_mul_f32 v85, v85, v105
    v_mul_f32 v101, v101, v109
    v_mul_f32 v86, v86, v105
    v_mul_f32 v102, v102, v109
    v_mul_f32 v87, v87, v105
    v_mul_f32 v103, v103, v109
    v_cvt_pk_bf16_f32 v208, v72, v73
    v_cvt_pk_bf16_f32 v216, v88, v89
    v_cvt_pk_bf16_f32 v209, v74, v75
    v_cvt_pk_bf16_f32 v217, v90, v91
    v_cvt_pk_bf16_f32 v210, v76, v77
    v_cvt_pk_bf16_f32 v218, v92, v93
    v_cvt_pk_bf16_f32 v211, v78, v79
    v_cvt_pk_bf16_f32 v219, v94, v95
    v_cvt_pk_bf16_f32 v212, v80, v81
    v_cvt_pk_bf16_f32 v220, v96, v97
    v_cvt_pk_bf16_f32 v213, v82, v83
    v_cvt_pk_bf16_f32 v221, v98, v99
    v_cvt_pk_bf16_f32 v214, v84, v85
    v_cvt_pk_bf16_f32 v222, v100, v101
    v_cvt_pk_bf16_f32 v215, v86, v87
    v_cvt_pk_bf16_f32 v223, v102, v103
    ds_write_b128 v8, v[208:211] offset:0
    ds_write_b128 v8, v[212:215] offset:8192
    ds_write_b128 v8, v[216:219] offset:16384
    ds_write_b128 v8, v[220:223] offset:24576
    ds_read_b64_tr_b16 v[224:225], v9 offset:17408
    ds_read_b64_tr_b16 v[226:227], v9 offset:17472
    ds_read_b64_tr_b16 v[228:229], v9 offset:0
    ds_read_b64_tr_b16 v[230:231], v9 offset:64
    ds_read_b64_tr_b16 v[232:233], v9 offset:8192
    ds_read_b64_tr_b16 v[234:235], v9 offset:8256
    ds_read_b64_tr_b16 v[236:237], v9 offset:25600
    ds_read_b64_tr_b16 v[238:239], v9 offset:25664
    ds_read_b64_tr_b16 v[240:241], v9 offset:16384
    ds_read_b64_tr_b16 v[242:243], v9 offset:16448
    ds_read_b64_tr_b16 v[244:245], v9 offset:24576
    ds_read_b64_tr_b16 v[246:247], v9 offset:24640
    v_and_b32 v72, 15, v1
    v_cmp_eq_u32 vcc, 1, v72
    s_waitcnt lgkmcnt(0)
    s_setprio 3
    v_mfma_f32_16x16x32_bf16 v[56:59], v[228:231], v[224:227], v[56:59]
    v_mfma_f32_16x16x32_bf16 v[64:67], v[228:231], v[200:203], v[64:67]
    v_mfma_f32_16x16x32_bf16 v[60:63], v[232:235], v[224:227], v[60:63]
    v_mfma_f32_16x16x32_bf16 v[68:71], v[232:235], v[200:203], v[68:71]
    v_mfma_f32_16x16x32_bf16 v[56:59], v[240:243], v[236:239], v[56:59]
    v_mfma_f32_16x16x32_bf16 v[64:67], v[240:243], v[204:207], v[64:67]
    v_mfma_f32_16x16x32_bf16 v[60:63], v[244:247], v[236:239], v[60:63]
    v_mfma_f32_16x16x32_bf16 v[68:71], v[244:247], v[204:207], v[68:71]
    s_setprio 0
    s_nop 3
    v_cvt_pk_bf16_f32 v56, v56, v57
    v_cvt_pk_bf16_f32 v57, v58, v59
    v_cvt_pk_bf16_f32 v58, v60, v61
    v_cvt_pk_bf16_f32 v59, v62, v63
    v_cndmask_b32 v64, v64, v68, vcc
    v_cndmask_b32 v65, v65, v69, vcc
    v_cndmask_b32 v66, v66, v70, vcc
    v_cndmask_b32 v67, v67, v71, vcc
    buffer_store_dwordx4 v[56:59], v10, s[44:47], 0 offen sc1
    s_mov_b32 exec_lo, 0x00030003
    s_mov_b32 exec_hi, 0x00030003
    buffer_store_dwordx4 v[64:67], v11, s[44:47], 0 offen sc1
    s_mov_b64 exec, -1
    s_setprio 0
    s_waitcnt lgkmcnt(0)
    s_mov_b32 s80, 0
L_cw7:
    ds_read_b32 v27, v7 offset:36
    s_add_u32 s80, s80, 1
    s_waitcnt lgkmcnt(0)
    v_cmp_le_u32 vcc, 4, v27
    s_cbranch_vccnz L_cx7
    s_sleep 2
    s_cmp_lt_u32 s80, 0x1000000
    s_cbranch_scc1 L_cw7
L_cx7:
    ds_read_b128 v[128:131], v8 offset:4096
    ds_read_b128 v[132:135], v8 offset:12288
    ds_read_b128 v[144:147], v8 offset:20480
    ds_read_b128 v[148:151], v8 offset:28672
    ds_read_b128 v[160:163], v8 offset:5120
    ds_read_b128 v[164:167], v8 offset:13312
    ds_read_b128 v[176:179], v8 offset:21504
    ds_read_b128 v[180:183], v8 offset:29696
    s_mov_b64 exec, 1
    ds_add_u32 v7, v2 offset:52
    s_mov_b64 exec, -1
    s_waitcnt lgkmcnt(1)
    s_setprio 3
    v_mfma_f32_32x32x16_bf16 v[72:87], v[36:39], v[128:131], 0
    v_mfma_f32_32x32x16_bf16 v[88:103], v[36:39], v[132:135], 0
    s_setprio 0
    s_nop 9
    v_max3_f32 v104, v72, v73, v74
    v_max3_f32 v108, v88, v89, v90
    v_max3_f32 v105, v80, v81, v82
    v_max3_f32 v109, v96, v97, v98
    v_max3_f32 v106, v75, v76, v77
    v_max3_f32 v110, v91, v92, v93
    v_max3_f32 v107, v83, v84, v85
    v_max3_f32 v111, v99, v100, v101
    v_max3_f32 v104, v104, v78, v79
    v_max3_f32 v108, v108, v94, v95
    v_max3_f32 v105, v105, v86, v87
    v_max3_f32 v109, v109, v102, v103
    v_max_f32 v104, v104, v106
    v_max_f32 v108, v108, v110
    v_max_f32 v105, v105, v107
    v_max_f32 v109, v109, v111
    s_nop 0
    v_permlane32_swap_b32 v104, v105
    v_permlane32_swap_b32 v108, v109
    v_max_f32 v104, v104, v105
    v_max_f32 v108, v108, v109
    v_mul_f32 v104, v20, v104
    v_mul_f32 v108, v21, v108
    v_mov_b32 v105, v104
    v_mov_b32 v109, v108
    s_nop 0
    v_permlane32_swap_b32 v104, v105
    v_permlane32_swap_b32 v108, v109
    v_fma_f32 v72, v72, v20, -v104
    v_fma_f32 v88, v88, v21, -v108
    v_fma_f32 v73, v73, v20, -v104
    v_fma_f32 v89, v89, v21, -v108
    v_fma_f32 v74, v74, v20, -v104
    v_fma_f32 v90, v90, v21, -v108
    v_fma_f32 v75, v75, v20, -v104
    v_fma_f32 v91, v91, v21, -v108
    v_fma_f32 v76, v76, v20, -v104
    v_fma_f32 v92, v92, v21, -v108
    ds_read_b32 v25, v7 offset:1792
    s_waitcnt lgkmcnt(0)
    v_cmp_eq_u32 vcc, 1, v25
    s_cbranch_vccnz L_ok8
    s_mov_b32 s80, 0
L_spin8:
    s_sleep 4
    buffer_load_dword v25, v3, s[40:43], 0 offen offset:0 sc1
    s_add_u32 s80, s80, 1
    s_waitcnt vmcnt(0)
    v_cmp_eq_u32 vcc, 1, v25
    s_cbranch_vccnz L_ok8
    s_cmp_lt_u32 s80, 0x80000
    s_cbranch_scc1 L_spin8
L_ok8:
    s_waitcnt vmcnt(0)
    s_mov_b64 exec, 1
    buffer_atomic_add v2, v5, s[44:47], 0 offen offset:0 sc1
    s_mov_b64 exec, -1
    v_fma_f32 v77, v77, v20, -v104
    v_fma_f32 v93, v93, v21, -v108
    v_fma_f32 v78, v78, v20, -v104
    v_fma_f32 v94, v94, v21, -v108
    v_fma_f32 v79, v79, v20, -v104
    v_fma_f32 v95, v95, v21, -v108
    v_fma_f32 v80, v80, v20, -v105
    v_fma_f32 v96, v96, v21, -v109
    v_fma_f32 v81, v81, v20, -v105
    v_fma_f32 v97, v97, v21, -v109
    v_fma_f32 v82, v82, v20, -v105
    v_fma_f32 v98, v98, v21, -v109
    v_fma_f32 v83, v83, v20, -v105
    v_fma_f32 v99, v99, v21, -v109
    v_fma_f32 v84, v84, v20, -v105
    v_fma_f32 v100, v100, v21, -v109
    v_fma_f32 v85, v85, v20, -v105
    v_fma_f32 v101, v101, v21, -v109
    v_fma_f32 v86, v86, v20, -v105
    v_fma_f32 v102, v102, v21, -v109
    v_fma_f32 v87, v87, v20, -v105
    v_fma_f32 v103, v103, v21, -v109
    v_exp_f32 v72, v72
    v_exp_f32 v88, v88
    v_exp_f32 v73, v73
    v_exp_f32 v89, v89
    v_exp_f32 v74, v74
    v_exp_f32 v90, v90
    v_exp_f32 v75, v75
    v_exp_f32 v91, v91
    v_exp_f32 v76, v76
    v_exp_f32 v92, v92
    v_exp_f32 v77, v77
    v_exp_f32 v93, v93
    v_exp_f32 v78, v78
    v_exp_f32 v94, v94
    v_exp_f32 v79, v79
    v_exp_f32 v95, v95
    v_exp_f32 v80, v80
    v_exp_f32 v96, v96
    v_exp_f32 v81, v81
    v_exp_f32 v97, v97
    v_exp_f32 v82, v82
    v_exp_f32 v98, v98
    v_exp_f32 v83, v83
    v_exp_f32 v99, v99
    v_exp_f32 v84, v84
    v_exp_f32 v100, v100
    v_exp_f32 v85, v85
    v_exp_f32 v101, v101
    v_exp_f32 v86, v86
    v_exp_f32 v102, v102
    v_exp_f32 v87, v87
    v_exp_f32 v103, v103
    v_add_f32 v104, v72, v73
    v_add_f32 v108, v88, v89
    v_add_f32 v106, v74, v75
    v_add_f32 v110, v90, v91
    v_add_f32 v105, v80, v81
    v_add_f32 v109, v96, v97
    v_add_f32 v107, v82, v83
    v_add_f32 v111, v98, v99
    v_add_f32 v104, v104, v76
    v_add_f32 v108, v108, v92
    v_add_f32 v106, v106, v77
    v_add_f32 v110, v110, v93
    v_add_f32 v105, v105, v84
    v_add_f32 v109, v109, v100
    v_add_f32 v107, v107, v85
    v_add_f32 v111, v111, v101
    v_add_f32 v104, v104, v78
    v_add_f32 v108, v108, v94
    v_add_f32 v106, v106, v79
    v_add_f32 v110, v110, v95
    v_add_f32 v105, v105, v86
    v_add_f32 v109, v109, v102
    v_add_f32 v107, v107, v87
    v_add_f32 v111, v111, v103
    v_add_f32 v104, v104, v106
    v_add_f32 v108, v108, v110
    v_add_f32 v105, v105, v107
    v_add_f32 v109, v109, v111
    s_nop 0
    v_permlane32_swap_b32 v104, v105
    v_permlane32_swap_b32 v108, v109
    v_add_f32 v104, v104, v105
    v_add_f32 v108, v108, v109
    v_rcp_f32 v104, v104
    v_rcp_f32 v108, v108
    v_mov_b32 v105, v104
    v_mov_b32 v109, v108
    s_nop 0
    v_permlane32_swap_b32 v104, v105
    v_permlane32_swap_b32 v108, v109
    v_mul_f32 v72, v72, v104
    v_mul_f32 v88, v88, v108
    v_mul_f32 v73, v73, v104
    v_mul_f32 v89, v89, v108
    v_mul_f32 v74, v74, v104
    v_mul_f32 v90, v90, v108
    v_mul_f32 v75, v75, v104
    v_mul_f32 v91, v91, v108
    v_mul_f32 v76, v76, v104
    v_mul_f32 v92, v92, v108
    v_mul_f32 v77, v77, v104
    v_mul_f32 v93, v93, v108
    v_mul_f32 v78, v78, v104
    v_mul_f32 v94, v94, v108
    v_mul_f32 v79, v79, v104
    v_mul_f32 v95, v95, v108
    v_mul_f32 v80, v80, v105
    v_mul_f32 v96, v96, v109
    v_mul_f32 v81, v81, v105
    v_mul_f32 v97, v97, v109
    v_mul_f32 v82, v82, v105
    v_mul_f32 v98, v98, v109
    v_mul_f32 v83, v83, v105
    v_mul_f32 v99, v99, v109
    v_mul_f32 v84, v84, v105
    v_mul_f32 v100, v100, v109
    v_mul_f32 v85, v85, v105
    v_mul_f32 v101, v101, v109
    v_mul_f32 v86, v86, v105
    v_mul_f32 v102, v102, v109
    v_mul_f32 v87, v87, v105
    v_mul_f32 v103, v103, v109
    v_cvt_pk_bf16_f32 v128, v72, v73
    v_cvt_pk_bf16_f32 v136, v88, v89
    v_cvt_pk_bf16_f32 v129, v74, v75
    v_cvt_pk_bf16_f32 v137, v90, v91
    v_cvt_pk_bf16_f32 v130, v76, v77
    v_cvt_pk_bf16_f32 v138, v92, v93
    v_cvt_pk_bf16_f32 v131, v78, v79
    v_cvt_pk_bf16_f32 v139, v94, v95
    v_cvt_pk_bf16_f32 v132, v80, v81
    v_cvt_pk_bf16_f32 v140, v96, v97
    v_cvt_pk_bf16_f32 v133, v82, v83
    v_cvt_pk_bf16_f32 v141, v98, v99
    v_cvt_pk_bf16_f32 v134, v84, v85
    v_cvt_pk_bf16_f32 v142, v100, v101
    v_cvt_pk_bf16_f32 v135, v86, v87
    v_cvt_pk_bf16_f32 v143, v102, v103
    s_setprio 3
    v_mfma_f32_32x32x16_bf16 v[72:87], v[36:39], v[144:147], 0
    v_mfma_f32_32x32x16_bf16 v[88:103], v[36:39], v[148:151], 0
    s_setprio 0
    s_nop 9
    v_max3_f32 v104, v72, v73, v74
    v_max3_f32 v108, v88, v89, v90
    v_max3_f32 v105, v80, v81, v82
    v_max3_f32 v109, v96, v97, v98
    v_max3_f32 v106, v75, v76, v77
    v_max3_f32 v110, v91, v92, v93
    v_max3_f32 v107, v83, v84, v85
    v_max3_f32 v111, v99, v100, v101
    v_max3_f32 v104, v104, v78, v79
    v_max3_f32 v108, v108, v94, v95
    v_max3_f32 v105, v105, v86, v87
    v_max3_f32 v109, v109, v102, v103
    v_max_f32 v104, v104, v106
    v_max_f32 v108, v108, v110
    v_max_f32 v105, v105, v107
    v_max_f32 v109, v109, v111
    s_nop 0
    v_permlane32_swap_b32 v104, v105
    v_permlane32_swap_b32 v108, v109
    v_max_f32 v104, v104, v105
    v_max_f32 v108, v108, v109
    v_mul_f32 v104, v22, v104
    v_mul_f32 v108, v23, v108
    v_mov_b32 v105, v104
    v_mov_b32 v109, v108
    s_nop 0
    v_permlane32_swap_b32 v104, v105
    v_permlane32_swap_b32 v108, v109
    v_fma_f32 v72, v72, v22, -v104
    v_fma_f32 v88, v88, v23, -v108
    v_fma_f32 v73, v73, v22, -v104
    v_fma_f32 v89, v89, v23, -v108
    v_fma_f32 v74, v74, v22, -v104
    v_fma_f32 v90, v90, v23, -v108
    v_fma_f32 v75, v75, v22, -v104
    v_fma_f32 v91, v91, v23, -v108
    v_fma_f32 v76, v76, v22, -v104
    v_fma_f32 v92, v92, v23, -v108
    v_fma_f32 v77, v77, v22, -v104
    v_fma_f32 v93, v93, v23, -v108
    v_fma_f32 v78, v78, v22, -v104
    v_fma_f32 v94, v94, v23, -v108
    v_fma_f32 v79, v79, v22, -v104
    v_fma_f32 v95, v95, v23, -v108
    v_fma_f32 v80, v80, v22, -v105
    v_fma_f32 v96, v96, v23, -v109
    v_fma_f32 v81, v81, v22, -v105
    v_fma_f32 v97, v97, v23, -v109
    v_fma_f32 v82, v82, v22, -v105
    v_fma_f32 v98, v98, v23, -v109
    v_fma_f32 v83, v83, v22, -v105
    v_fma_f32 v99, v99, v23, -v109
    v_fma_f32 v84, v84, v22, -v105
    v_fma_f32 v100, v100, v23, -v109
    v_fma_f32 v85, v85, v22, -v105
    v_fma_f32 v101, v101, v23, -v109
    v_fma_f32 v86, v86, v22, -v105
    v_fma_f32 v102, v102, v23, -v109
    v_fma_f32 v87, v87, v22, -v105
    v_fma_f32 v103, v103, v23, -v109
    v_exp_f32 v72, v72
    v_exp_f32 v88, v88
    v_exp_f32 v73, v73
    v_exp_f32 v89, v89
    v_exp_f32 v74, v74
    v_exp_f32 v90, v90
    v_exp_f32 v75, v75
    v_exp_f32 v91, v91
    v_exp_f32 v76, v76
    v_exp_f32 v92, v92
    v_exp_f32 v77, v77
    v_exp_f32 v93, v93
    v_exp_f32 v78, v78
    v_exp_f32 v94, v94
    v_exp_f32 v79, v79
    v_exp_f32 v95, v95
    v_exp_f32 v80, v80
    v_exp_f32 v96, v96
    v_exp_f32 v81, v81
    v_exp_f32 v97, v97
    v_exp_f32 v82, v82
    v_exp_f32 v98, v98
    v_exp_f32 v83, v83
    v_exp_f32 v99, v99
    v_exp_f32 v84, v84
    v_exp_f32 v100, v100
    v_exp_f32 v85, v85
    v_exp_f32 v101, v101
    v_exp_f32 v86, v86
    v_exp_f32 v102, v102
    v_exp_f32 v87, v87
    v_exp_f32 v103, v103
    v_add_f32 v104, v72, v73
    v_add_f32 v108, v88, v89
    v_add_f32 v106, v74, v75
    v_add_f32 v110, v90, v91
    v_add_f32 v105, v80, v81
    v_add_f32 v109, v96, v97
    v_add_f32 v107, v82, v83
    v_add_f32 v111, v98, v99
    v_add_f32 v104, v104, v76
    v_add_f32 v108, v108, v92
    v_add_f32 v106, v106, v77
    v_add_f32 v110, v110, v93
    v_add_f32 v105, v105, v84
    v_add_f32 v109, v109, v100
    v_add_f32 v107, v107, v85
    v_add_f32 v111, v111, v101
    v_add_f32 v104, v104, v78
    v_add_f32 v108, v108, v94
    v_add_f32 v106, v106, v79
    v_add_f32 v110, v110, v95
    v_add_f32 v105, v105, v86
    v_add_f32 v109, v109, v102
    v_add_f32 v107, v107, v87
    v_add_f32 v111, v111, v103
    v_add_f32 v104, v104, v106
    v_add_f32 v108, v108, v110
    v_add_f32 v105, v105, v107
    v_add_f32 v109, v109, v111
    s_nop 0
    v_permlane32_swap_b32 v104, v105
    v_permlane32_swap_b32 v108, v109
    v_add_f32 v104, v104, v105
    v_add_f32 v108, v108, v109
    v_rcp_f32 v104, v104
    v_rcp_f32 v108, v108
    v_mov_b32 v105, v104
    v_mov_b32 v109, v108
    s_nop 0
    v_permlane32_swap_b32 v104, v105
    v_permlane32_swap_b32 v108, v109
    v_mul_f32 v72, v72, v104
    v_mul_f32 v88, v88, v108
    v_mul_f32 v73, v73, v104
    v_mul_f32 v89, v89, v108
    v_mul_f32 v74, v74, v104
    v_mul_f32 v90, v90, v108
    v_mul_f32 v75, v75, v104
    v_mul_f32 v91, v91, v108
    v_mul_f32 v76, v76, v104
    v_mul_f32 v92, v92, v108
    v_mul_f32 v77, v77, v104
    v_mul_f32 v93, v93, v108
    v_mul_f32 v78, v78, v104
    v_mul_f32 v94, v94, v108
    v_mul_f32 v79, v79, v104
    v_mul_f32 v95, v95, v108
    v_mul_f32 v80, v80, v105
    v_mul_f32 v96, v96, v109
    v_mul_f32 v81, v81, v105
    v_mul_f32 v97, v97, v109
    v_mul_f32 v82, v82, v105
    v_mul_f32 v98, v98, v109
    v_mul_f32 v83, v83, v105
    v_mul_f32 v99, v99, v109
    v_mul_f32 v84, v84, v105
    v_mul_f32 v100, v100, v109
    v_mul_f32 v85, v85, v105
    v_mul_f32 v101, v101, v109
    v_mul_f32 v86, v86, v105
    v_mul_f32 v102, v102, v109
    v_mul_f32 v87, v87, v105
    v_mul_f32 v103, v103, v109
    v_cvt_pk_bf16_f32 v144, v72, v73
    v_cvt_pk_bf16_f32 v152, v88, v89
    v_cvt_pk_bf16_f32 v145, v74, v75
    v_cvt_pk_bf16_f32 v153, v90, v91
    v_cvt_pk_bf16_f32 v146, v76, v77
    v_cvt_pk_bf16_f32 v154, v92, v93
    v_cvt_pk_bf16_f32 v147, v78, v79
    v_cvt_pk_bf16_f32 v155, v94, v95
    v_cvt_pk_bf16_f32 v148, v80, v81
    v_cvt_pk_bf16_f32 v156, v96, v97
    v_cvt_pk_bf16_f32 v149, v82, v83
    v_cvt_pk_bf16_f32 v157, v98, v99
    v_cvt_pk_bf16_f32 v150, v84, v85
    v_cvt_pk_bf16_f32 v158, v100, v101
    v_cvt_pk_bf16_f32 v151, v86, v87
    v_cvt_pk_bf16_f32 v159, v102, v103
    s_setprio 3
    v_mfma_f32_32x32x16_bf16 v[72:87], v[40:43], v[160:163], 0
    v_mfma_f32_32x32x16_bf16 v[88:103], v[40:43], v[164:167], 0
    s_setprio 0
    s_nop 9
    v_max3_f32 v104, v72, v73, v74
    v_max3_f32 v108, v88, v89, v90
    v_max3_f32 v105, v80, v81, v82
    v_max3_f32 v109, v96, v97, v98
    v_max3_f32 v106, v75, v76, v77
    v_max3_f32 v110, v91, v92, v93
    v_max3_f32 v107, v83, v84, v85
    v_max3_f32 v111, v99, v100, v101
    v_max3_f32 v104, v104, v78, v79
    v_max3_f32 v108, v108, v94, v95
    v_max3_f32 v105, v105, v86, v87
    v_max3_f32 v109, v109, v102, v103
    v_max_f32 v104, v104, v106
    v_max_f32 v108, v108, v110
    v_max_f32 v105, v105, v107
    v_max_f32 v109, v109, v111
    s_nop 0
    v_permlane32_swap_b32 v104, v105
    v_permlane32_swap_b32 v108, v109
    v_max_f32 v104, v104, v105
    v_max_f32 v108, v108, v109
    v_mul_f32 v104, v20, v104
    v_mul_f32 v108, v21, v108
    v_mov_b32 v105, v104
    v_mov_b32 v109, v108
    s_nop 0
    v_permlane32_swap_b32 v104, v105
    v_permlane32_swap_b32 v108, v109
    v_fma_f32 v72, v72, v20, -v104
    v_fma_f32 v88, v88, v21, -v108
    v_fma_f32 v73, v73, v20, -v104
    v_fma_f32 v89, v89, v21, -v108
    v_fma_f32 v74, v74, v20, -v104
    v_fma_f32 v90, v90, v21, -v108
    v_fma_f32 v75, v75, v20, -v104
    v_fma_f32 v91, v91, v21, -v108
    v_fma_f32 v76, v76, v20, -v104
    v_fma_f32 v92, v92, v21, -v108
    v_fma_f32 v77, v77, v20, -v104
    v_fma_f32 v93, v93, v21, -v108
    v_fma_f32 v78, v78, v20, -v104
    v_fma_f32 v94, v94, v21, -v108
    v_fma_f32 v79, v79, v20, -v104
    v_fma_f32 v95, v95, v21, -v108
    v_fma_f32 v80, v80, v20, -v105
    v_fma_f32 v96, v96, v21, -v109
    v_fma_f32 v81, v81, v20, -v105
    v_fma_f32 v97, v97, v21, -v109
    v_fma_f32 v82, v82, v20, -v105
    v_fma_f32 v98, v98, v21, -v109
    v_fma_f32 v83, v83, v20, -v105
    v_fma_f32 v99, v99, v21, -v109
    v_fma_f32 v84, v84, v20, -v105
    v_fma_f32 v100, v100, v21, -v109
    v_fma_f32 v85, v85, v20, -v105
    v_fma_f32 v101, v101, v21, -v109
    v_fma_f32 v86, v86, v20, -v105
    v_fma_f32 v102, v102, v21, -v109
    v_fma_f32 v87, v87, v20, -v105
    v_fma_f32 v103, v103, v21, -v109
    v_exp_f32 v72, v72
    v_exp_f32 v88, v88
    v_exp_f32 v73, v73
    v_exp_f32 v89, v89
    v_exp_f32 v74, v74
    v_exp_f32 v90, v90
    v_exp_f32 v75, v75
    v_exp_f32 v91, v91
    v_exp_f32 v76, v76
    v_exp_f32 v92, v92
    v_exp_f32 v77, v77
    v_exp_f32 v93, v93
    v_exp_f32 v78, v78
    v_exp_f32 v94, v94
    v_exp_f32 v79, v79
    v_exp_f32 v95, v95
    v_exp_f32 v80, v80
    v_exp_f32 v96, v96
    v_exp_f32 v81, v81
    v_exp_f32 v97, v97
    v_exp_f32 v82, v82
    v_exp_f32 v98, v98
    v_exp_f32 v83, v83
    v_exp_f32 v99, v99
    v_exp_f32 v84, v84
    v_exp_f32 v100, v100
    v_exp_f32 v85, v85
    v_exp_f32 v101, v101
    v_exp_f32 v86, v86
    v_exp_f32 v102, v102
    v_exp_f32 v87, v87
    v_exp_f32 v103, v103
    v_add_f32 v104, v72, v73
    v_add_f32 v108, v88, v89
    v_add_f32 v106, v74, v75
    v_add_f32 v110, v90, v91
    v_add_f32 v105, v80, v81
    v_add_f32 v109, v96, v97
    v_add_f32 v107, v82, v83
    v_add_f32 v111, v98, v99
    v_add_f32 v104, v104, v76
    v_add_f32 v108, v108, v92
    v_add_f32 v106, v106, v77
    v_add_f32 v110, v110, v93
    v_add_f32 v105, v105, v84
    v_add_f32 v109, v109, v100
    v_add_f32 v107, v107, v85
    v_add_f32 v111, v111, v101
    v_add_f32 v104, v104, v78
    v_add_f32 v108, v108, v94
    v_add_f32 v106, v106, v79
    v_add_f32 v110, v110, v95
    v_add_f32 v105, v105, v86
    v_add_f32 v109, v109, v102
    v_add_f32 v107, v107, v87
    v_add_f32 v111, v111, v103
    v_add_f32 v104, v104, v106
    v_add_f32 v108, v108, v110
    v_add_f32 v105, v105, v107
    v_add_f32 v109, v109, v111
    s_nop 0
    v_permlane32_swap_b32 v104, v105
    v_permlane32_swap_b32 v108, v109
    v_add_f32 v104, v104, v105
    v_add_f32 v108, v108, v109
    v_rcp_f32 v104, v104
    v_rcp_f32 v108, v108
    v_mov_b32 v105, v104
    v_mov_b32 v109, v108
    s_nop 0
    v_permlane32_swap_b32 v104, v105
    v_permlane32_swap_b32 v108, v109
    v_mul_f32 v72, v72, v104
    v_mul_f32 v88, v88, v108
    v_mul_f32 v73, v73, v104
    v_mul_f32 v89, v89, v108
    v_mul_f32 v74, v74, v104
    v_mul_f32 v90, v90, v108
    v_mul_f32 v75, v75, v104
    v_mul_f32 v91, v91, v108
    v_mul_f32 v76, v76, v104
    v_mul_f32 v92, v92, v108
    v_mul_f32 v77, v77, v104
    v_mul_f32 v93, v93, v108
    v_mul_f32 v78, v78, v104
    v_mul_f32 v94, v94, v108
    v_mul_f32 v79, v79, v104
    v_mul_f32 v95, v95, v108
    v_mul_f32 v80, v80, v105
    v_mul_f32 v96, v96, v109
    v_mul_f32 v81, v81, v105
    v_mul_f32 v97, v97, v109
    v_mul_f32 v82, v82, v105
    v_mul_f32 v98, v98, v109
    v_mul_f32 v83, v83, v105
    v_mul_f32 v99, v99, v109
    v_mul_f32 v84, v84, v105
    v_mul_f32 v100, v100, v109
    v_mul_f32 v85, v85, v105
    v_mul_f32 v101, v101, v109
    v_mul_f32 v86, v86, v105
    v_mul_f32 v102, v102, v109
    v_mul_f32 v87, v87, v105
    v_mul_f32 v103, v103, v109
    v_cvt_pk_bf16_f32 v160, v72, v73
    v_cvt_pk_bf16_f32 v168, v88, v89
    v_cvt_pk_bf16_f32 v161, v74, v75
    v_cvt_pk_bf16_f32 v169, v90, v91
    v_cvt_pk_bf16_f32 v162, v76, v77
    v_cvt_pk_bf16_f32 v170, v92, v93
    v_cvt_pk_bf16_f32 v163, v78, v79
    v_cvt_pk_bf16_f32 v171, v94, v95
    v_cvt_pk_bf16_f32 v164, v80, v81
    v_cvt_pk_bf16_f32 v172, v96, v97
    v_cvt_pk_bf16_f32 v165, v82, v83
    v_cvt_pk_bf16_f32 v173, v98, v99
    v_cvt_pk_bf16_f32 v166, v84, v85
    v_cvt_pk_bf16_f32 v174, v100, v101
    v_cvt_pk_bf16_f32 v167, v86, v87
    v_cvt_pk_bf16_f32 v175, v102, v103
    s_setprio 3
    v_mfma_f32_32x32x16_bf16 v[72:87], v[40:43], v[176:179], 0
    v_mfma_f32_32x32x16_bf16 v[88:103], v[40:43], v[180:183], 0
    s_setprio 0
    s_nop 9
    v_max3_f32 v104, v72, v73, v74
    v_max3_f32 v108, v88, v89, v90
    v_max3_f32 v105, v80, v81, v82
    v_max3_f32 v109, v96, v97, v98
    v_max3_f32 v106, v75, v76, v77
    v_max3_f32 v110, v91, v92, v93
    v_max3_f32 v107, v83, v84, v85
    v_max3_f32 v111, v99, v100, v101
    v_max3_f32 v104, v104, v78, v79
    v_max3_f32 v108, v108, v94, v95
    v_max3_f32 v105, v105, v86, v87
    v_max3_f32 v109, v109, v102, v103
    v_max_f32 v104, v104, v106
    v_max_f32 v108, v108, v110
    v_max_f32 v105, v105, v107
    v_max_f32 v109, v109, v111
    s_nop 0
    v_permlane32_swap_b32 v104, v105
    v_permlane32_swap_b32 v108, v109
    v_max_f32 v104, v104, v105
    v_max_f32 v108, v108, v109
    v_mul_f32 v104, v22, v104
    v_mul_f32 v108, v23, v108
    v_mov_b32 v105, v104
    v_mov_b32 v109, v108
    s_nop 0
    v_permlane32_swap_b32 v104, v105
    v_permlane32_swap_b32 v108, v109
    v_fma_f32 v72, v72, v22, -v104
    v_fma_f32 v88, v88, v23, -v108
    v_fma_f32 v73, v73, v22, -v104
    v_fma_f32 v89, v89, v23, -v108
    v_fma_f32 v74, v74, v22, -v104
    v_fma_f32 v90, v90, v23, -v108
    v_fma_f32 v75, v75, v22, -v104
    v_fma_f32 v91, v91, v23, -v108
    v_fma_f32 v76, v76, v22, -v104
    v_fma_f32 v92, v92, v23, -v108
    v_fma_f32 v77, v77, v22, -v104
    v_fma_f32 v93, v93, v23, -v108
    v_fma_f32 v78, v78, v22, -v104
    v_fma_f32 v94, v94, v23, -v108
    v_fma_f32 v79, v79, v22, -v104
    v_fma_f32 v95, v95, v23, -v108
    v_fma_f32 v80, v80, v22, -v105
    v_fma_f32 v96, v96, v23, -v109
    v_fma_f32 v81, v81, v22, -v105
    v_fma_f32 v97, v97, v23, -v109
    v_fma_f32 v82, v82, v22, -v105
    v_fma_f32 v98, v98, v23, -v109
    v_fma_f32 v83, v83, v22, -v105
    v_fma_f32 v99, v99, v23, -v109
    v_fma_f32 v84, v84, v22, -v105
    v_fma_f32 v100, v100, v23, -v109
    v_fma_f32 v85, v85, v22, -v105
    v_fma_f32 v101, v101, v23, -v109
    v_fma_f32 v86, v86, v22, -v105
    v_fma_f32 v102, v102, v23, -v109
    v_fma_f32 v87, v87, v22, -v105
    v_fma_f32 v103, v103, v23, -v109
    v_exp_f32 v72, v72
    v_exp_f32 v88, v88
    v_exp_f32 v73, v73
    v_exp_f32 v89, v89
    v_exp_f32 v74, v74
    v_exp_f32 v90, v90
    v_exp_f32 v75, v75
    v_exp_f32 v91, v91
    v_exp_f32 v76, v76
    v_exp_f32 v92, v92
    v_exp_f32 v77, v77
    v_exp_f32 v93, v93
    v_exp_f32 v78, v78
    v_exp_f32 v94, v94
    v_exp_f32 v79, v79
    v_exp_f32 v95, v95
    v_exp_f32 v80, v80
    v_exp_f32 v96, v96
    v_exp_f32 v81, v81
    v_exp_f32 v97, v97
    v_exp_f32 v82, v82
    v_exp_f32 v98, v98
    v_exp_f32 v83, v83
    v_exp_f32 v99, v99
    v_exp_f32 v84, v84
    v_exp_f32 v100, v100
    v_exp_f32 v85, v85
    v_exp_f32 v101, v101
    v_exp_f32 v86, v86
    v_exp_f32 v102, v102
    v_exp_f32 v87, v87
    v_exp_f32 v103, v103
    v_add_f32 v104, v72, v73
    v_add_f32 v108, v88, v89
    v_add_f32 v106, v74, v75
    v_add_f32 v110, v90, v91
    v_add_f32 v105, v80, v81
    v_add_f32 v109, v96, v97
    v_add_f32 v107, v82, v83
    v_add_f32 v111, v98, v99
    v_add_f32 v104, v104, v76
    v_add_f32 v108, v108, v92
    v_add_f32 v106, v106, v77
    v_add_f32 v110, v110, v93
    v_add_f32 v105, v105, v84
    v_add_f32 v109, v109, v100
    v_add_f32 v107, v107, v85
    v_add_f32 v111, v111, v101
    v_add_f32 v104, v104, v78
    v_add_f32 v108, v108, v94
    v_add_f32 v106, v106, v79
    v_add_f32 v110, v110, v95
    v_add_f32 v105, v105, v86
    v_add_f32 v109, v109, v102
    v_add_f32 v107, v107, v87
    v_add_f32 v111, v111, v103
    v_add_f32 v104, v104, v106
    v_add_f32 v108, v108, v110
    v_add_f32 v105, v105, v107
    v_add_f32 v109, v109, v111
    s_nop 0
    v_permlane32_swap_b32 v104, v105
    v_permlane32_swap_b32 v108, v109
    v_add_f32 v104, v104, v105
    v_add_f32 v108, v108, v109
    v_rcp_f32 v104, v104
    v_rcp_f32 v108, v108
    v_mov_b32 v105, v104
    v_mov_b32 v109, v108
    s_nop 0
    v_permlane32_swap_b32 v104, v105
    v_permlane32_swap_b32 v108, v109
    v_mul_f32 v72, v72, v104
    v_mul_f32 v88, v88, v108
    v_mul_f32 v73, v73, v104
    v_mul_f32 v89, v89, v108
    v_mul_f32 v74, v74, v104
    v_mul_f32 v90, v90, v108
    v_mul_f32 v75, v75, v104
    v_mul_f32 v91, v91, v108
    v_mul_f32 v76, v76, v104
    v_mul_f32 v92, v92, v108
    v_mul_f32 v77, v77, v104
    v_mul_f32 v93, v93, v108
    v_mul_f32 v78, v78, v104
    v_mul_f32 v94, v94, v108
    v_mul_f32 v79, v79, v104
    v_mul_f32 v95, v95, v108
    v_mul_f32 v80, v80, v105
    v_mul_f32 v96, v96, v109
    v_mul_f32 v81, v81, v105
    v_mul_f32 v97, v97, v109
    v_mul_f32 v82, v82, v105
    v_mul_f32 v98, v98, v109
    v_mul_f32 v83, v83, v105
    v_mul_f32 v99, v99, v109
    v_mul_f32 v84, v84, v105
    v_mul_f32 v100, v100, v109
    v_mul_f32 v85, v85, v105
    v_mul_f32 v101, v101, v109
    v_mul_f32 v86, v86, v105
    v_mul_f32 v102, v102, v109
    v_mul_f32 v87, v87, v105
    v_mul_f32 v103, v103, v109
    v_cvt_pk_bf16_f32 v176, v72, v73
    v_cvt_pk_bf16_f32 v184, v88, v89
    v_cvt_pk_bf16_f32 v177, v74, v75
    v_cvt_pk_bf16_f32 v185, v90, v91
    v_cvt_pk_bf16_f32 v178, v76, v77
    v_cvt_pk_bf16_f32 v186, v92, v93
    v_cvt_pk_bf16_f32 v179, v78, v79
    v_cvt_pk_bf16_f32 v187, v94, v95
    v_cvt_pk_bf16_f32 v180, v80, v81
    v_cvt_pk_bf16_f32 v188, v96, v97
    v_cvt_pk_bf16_f32 v181, v82, v83
    v_cvt_pk_bf16_f32 v189, v98, v99
    v_cvt_pk_bf16_f32 v182, v84, v85
    v_cvt_pk_bf16_f32 v190, v100, v101
    v_cvt_pk_bf16_f32 v183, v86, v87
    v_cvt_pk_bf16_f32 v191, v102, v103
    s_load_dword s50, s[44:45], s54 offset:128 glc
    s_load_dword s51, s[44:45], s54 offset:640 glc
    s_waitcnt lgkmcnt(0)
    s_cmp_eq_u32 s50, 8
    s_cbranch_scc1 L_ok9
    s_mov_b32 s80, 0
L_spin9:
    s_sleep 4
    s_load_dword s50, s[44:45], s54 offset:128 glc
    s_add_u32 s80, s80, 1
    s_waitcnt lgkmcnt(0)
    s_cmp_eq_u32 s50, 8
    s_cbranch_scc1 L_ok9
    s_cmp_lt_u32 s80, 0x80000
    s_cbranch_scc1 L_spin9
L_ok9:
    s_waitcnt lgkmcnt(0)
    s_cmp_eq_u32 s51, 8
    s_cbranch_scc1 L_ok10
    s_mov_b32 s80, 0
L_spin10:
    s_sleep 4
    s_load_dword s51, s[44:45], s54 offset:640 glc
    s_add_u32 s80, s80, 1
    s_waitcnt lgkmcnt(0)
    s_cmp_eq_u32 s51, 8
    s_cbranch_scc1 L_ok10
    s_cmp_lt_u32 s80, 0x80000
    s_cbranch_scc1 L_spin10
L_ok10:
    buffer_load_dwordx4 v[112:115], v12, s[44:47], 0 offen offset:0 sc1
    buffer_load_dwordx4 v[56:59], v13, s[44:47], 0 offen offset:0 sc1
    buffer_load_dwordx4 v[60:63], v13, s[44:47], 0 offen offset:64 sc1
    buffer_load_dwordx4 v[116:119], v12, s[44:47], 0 offen offset:2048 sc1
    buffer_load_dwordx4 v[64:67], v13, s[44:47], 0 offen offset:256 sc1
    buffer_load_dwordx4 v[68:71], v13, s[44:47], 0 offen offset:320 sc1
    s_waitcnt vmcnt(0)
    v_mov_b32 v36, v112
    v_cvt_pk_bf16_f32 v38, v56, v57
    v_mov_b32 v37, v113
    v_cvt_pk_bf16_f32 v39, v58, v59
    v_mov_b32 v40, v114
    v_cvt_pk_bf16_f32 v42, v60, v61
    v_mov_b32 v41, v115
    v_cvt_pk_bf16_f32 v43, v62, v63
    v_permlane16_swap_b32 v36, v38
    v_permlane16_swap_b32 v37, v39
    v_permlane16_swap_b32 v40, v42
    v_permlane16_swap_b32 v41, v43
    v_permlane32_swap_b32 v36, v38
    v_permlane32_swap_b32 v37, v39
    v_permlane32_swap_b32 v40, v42
    v_permlane32_swap_b32 v41, v43
    s_setprio 3
    v_mfma_f32_32x32x16_bf16 v[192:207], v[36:39], v[128:131], 0
    v_mfma_f32_32x32x16_bf16 v[192:207], v[40:43], v[132:135], v[192:207]
    v_mfma_f32_32x32x16_bf16 v[208:223], v[36:39], v[136:139], 0
    v_mfma_f32_32x32x16_bf16 v[208:223], v[40:43], v[140:143], v[208:223]
    v_mfma_f32_32x32x16_bf16 v[224:239], v[36:39], v[144:147], 0
    v_mfma_f32_32x32x16_bf16 v[224:239], v[40:43], v[148:151], v[224:239]
    v_mfma_f32_32x32x16_bf16 v[240:255], v[36:39], v[152:155], 0
    v_mfma_f32_32x32x16_bf16 v[240:255], v[40:43], v[156:159], v[240:255]
    s_setprio 0
    s_nop 4
    v_add_f32 v200, 0x358637bd, v200
    v_rcp_f32 v200, v200
    s_nop 0
    v_mul_f32 v192, v192, v200
    v_mul_f32 v193, v193, v200
    v_mul_f32 v194, v194, v200
    v_mul_f32 v195, v195, v200
    v_mul_f32 v196, v196, v200
    v_mul_f32 v197, v197, v200
    v_mul_f32 v198, v198, v200
    v_mul_f32 v199, v199, v200
    v_cvt_pk_bf16_f32 v128, v192, v193
    v_cvt_pk_bf16_f32 v129, v194, v195
    v_cvt_pk_bf16_f32 v132, v196, v197
    v_cvt_pk_bf16_f32 v133, v198, v199
    v_add_f32 v216, 0x358637bd, v216
    v_rcp_f32 v216, v216
    s_nop 0
    v_mul_f32 v208, v208, v216
    v_mul_f32 v209, v209, v216
    v_mul_f32 v210, v210, v216
    v_mul_f32 v211, v211, v216
    v_mul_f32 v212, v212, v216
    v_mul_f32 v213, v213, v216
    v_mul_f32 v214, v214, v216
    v_mul_f32 v215, v215, v216
    v_cvt_pk_bf16_f32 v136, v208, v209
    v_cvt_pk_bf16_f32 v137, v210, v211
    v_cvt_pk_bf16_f32 v140, v212, v213
    v_cvt_pk_bf16_f32 v141, v214, v215
    v_add_f32 v232, 0x358637bd, v232
    v_rcp_f32 v232, v232
    s_nop 0
    v_mul_f32 v224, v224, v232
    v_mul_f32 v225, v225, v232
    v_mul_f32 v226, v226, v232
    v_mul_f32 v227, v227, v232
    v_mul_f32 v228, v228, v232
    v_mul_f32 v229, v229, v232
    v_mul_f32 v230, v230, v232
    v_mul_f32 v231, v231, v232
    v_cvt_pk_bf16_f32 v144, v224, v225
    v_cvt_pk_bf16_f32 v145, v226, v227
    v_cvt_pk_bf16_f32 v148, v228, v229
    v_cvt_pk_bf16_f32 v149, v230, v231
    v_add_f32 v248, 0x358637bd, v248
    v_rcp_f32 v248, v248
    s_nop 0
    v_mul_f32 v240, v240, v248
    v_mul_f32 v241, v241, v248
    v_mul_f32 v242, v242, v248
    v_mul_f32 v243, v243, v248
    v_mul_f32 v244, v244, v248
    v_mul_f32 v245, v245, v248
    v_mul_f32 v246, v246, v248
    v_mul_f32 v247, v247, v248
    v_cvt_pk_bf16_f32 v152, v240, v241
    v_cvt_pk_bf16_f32 v153, v242, v243
    v_cvt_pk_bf16_f32 v156, v244, v245
    v_cvt_pk_bf16_f32 v157, v246, v247
    v_mov_b32 v16, v116
    v_cvt_pk_bf16_f32 v18, v64, v65
    v_mov_b32 v17, v117
    v_cvt_pk_bf16_f32 v19, v66, v67
    v_mov_b32 v20, v118
    v_cvt_pk_bf16_f32 v22, v68, v69
    v_mov_b32 v21, v119
    v_cvt_pk_bf16_f32 v23, v70, v71
    v_permlane16_swap_b32 v16, v18
    v_permlane16_swap_b32 v17, v19
    v_permlane16_swap_b32 v20, v22
    v_permlane16_swap_b32 v21, v23
    v_permlane32_swap_b32 v16, v18
    v_permlane32_swap_b32 v17, v19
    v_permlane32_swap_b32 v20, v22
    v_permlane32_swap_b32 v21, v23
    s_setprio 3
    v_mfma_f32_32x32x16_bf16 v[192:207], v[16:19], v[160:163], 0
    v_mfma_f32_32x32x16_bf16 v[192:207], v[20:23], v[164:167], v[192:207]
    v_mfma_f32_32x32x16_bf16 v[208:223], v[16:19], v[168:171], 0
    v_mfma_f32_32x32x16_bf16 v[208:223], v[20:23], v[172:175], v[208:223]
    v_mfma_f32_32x32x16_bf16 v[224:239], v[16:19], v[176:179], 0
    v_mfma_f32_32x32x16_bf16 v[224:239], v[20:23], v[180:183], v[224:239]
    v_mfma_f32_32x32x16_bf16 v[240:255], v[16:19], v[184:187], 0
    v_mfma_f32_32x32x16_bf16 v[240:255], v[20:23], v[188:191], v[240:255]
    s_setprio 0
    s_nop 4
    v_add_f32 v200, 0x358637bd, v200
    v_rcp_f32 v200, v200
    s_nop 0
    v_mul_f32 v192, v192, v200
    v_mul_f32 v193, v193, v200
    v_mul_f32 v194, v194, v200
    v_mul_f32 v195, v195, v200
    v_mul_f32 v196, v196, v200
    v_mul_f32 v197, v197, v200
    v_mul_f32 v198, v198, v200
    v_mul_f32 v199, v199, v200
    v_cvt_pk_bf16_f32 v130, v192, v193
    v_cvt_pk_bf16_f32 v131, v194, v195
    v_cvt_pk_bf16_f32 v134, v196, v197
    v_cvt_pk_bf16_f32 v135, v198, v199
    s_mov_b32 s71, 0
    buffer_store_dwordx4 v[128:131], v14, s[44:47], s71 offen offset:0 sc1
    buffer_store_dwordx4 v[132:135], v14, s[44:47], s71 offen offset:512 sc1
    v_add_f32 v216, 0x358637bd, v216
    v_rcp_f32 v216, v216
    s_nop 0
    v_mul_f32 v208, v208, v216
    v_mul_f32 v209, v209, v216
    v_mul_f32 v210, v210, v216
    v_mul_f32 v211, v211, v216
    v_mul_f32 v212, v212, v216
    v_mul_f32 v213, v213, v216
    v_mul_f32 v214, v214, v216
    v_mul_f32 v215, v215, v216
    v_cvt_pk_bf16_f32 v138, v208, v209
    v_cvt_pk_bf16_f32 v139, v210, v211
    v_cvt_pk_bf16_f32 v142, v212, v213
    v_cvt_pk_bf16_f32 v143, v214, v215
    s_mov_b32 s71, 147456
    buffer_store_dwordx4 v[136:139], v14, s[44:47], s71 offen offset:0 sc1
    buffer_store_dwordx4 v[140:143], v14, s[44:47], s71 offen offset:512 sc1
    v_add_f32 v232, 0x358637bd, v232
    v_rcp_f32 v232, v232
    s_nop 0
    v_mul_f32 v224, v224, v232
    v_mul_f32 v225, v225, v232
    v_mul_f32 v226, v226, v232
    v_mul_f32 v227, v227, v232
    v_mul_f32 v228, v228, v232
    v_mul_f32 v229, v229, v232
    v_mul_f32 v230, v230, v232
    v_mul_f32 v231, v231, v232
    v_cvt_pk_bf16_f32 v146, v224, v225
    v_cvt_pk_bf16_f32 v147, v226, v227
    v_cvt_pk_bf16_f32 v150, v228, v229
    v_cvt_pk_bf16_f32 v151, v230, v231
    s_mov_b32 s71, 294912
    buffer_store_dwordx4 v[144:147], v14, s[44:47], s71 offen offset:0 sc1
    buffer_store_dwordx4 v[148:151], v14, s[44:47], s71 offen offset:512 sc1
    v_add_f32 v248, 0x358637bd, v248
    v_rcp_f32 v248, v248
    s_nop 0
    v_mul_f32 v240, v240, v248
    v_mul_f32 v241, v241, v248
    v_mul_f32 v242, v242, v248
    v_mul_f32 v243, v243, v248
    v_mul_f32 v244, v244, v248
    v_mul_f32 v245, v245, v248
    v_mul_f32 v246, v246, v248
    v_mul_f32 v247, v247, v248
    v_cvt_pk_bf16_f32 v154, v240, v241
    v_cvt_pk_bf16_f32 v155, v242, v243
    v_cvt_pk_bf16_f32 v158, v244, v245
    v_cvt_pk_bf16_f32 v159, v246, v247
    s_mov_b32 s71, 442368
    buffer_store_dwordx4 v[152:155], v14, s[44:47], s71 offen offset:0 sc1
    buffer_store_dwordx4 v[156:159], v14, s[44:47], s71 offen offset:512 sc1
    s_waitcnt vmcnt(0)
    s_mov_b64 exec, 3
    buffer_atomic_add v2, v4, s[44:47], 0 offen offset:384 sc1
    s_mov_b64 exec, -1
    s_endpgm
L_dma:
    s_cmp_eq_u32 s60, 1
    s_cbranch_scc1 L_dma1
    v_mov_b32 v9, 0
    v_mov_b32 v5, 0
    v_mov_b32 v8, 1
    v_mov_b32 v6, 16384
    v_and_b32 v7, 3, v1
    v_lshlrev_b32 v7, 8, v7
    v_add_u32 v7, 17152, v7
    s_lshl_b32 s48, s57, 8
    s_add_u32 s48, s48, 16640
    s_lshl_b32 s54, s63, 9
    s_lshl_b32 s76, s59, 7
    s_add_u32 s77, s76, 64
    v_lshrrev_b32 v64, 2, v1
    v_and_b32 v66, 3, v1
    v_lshrrev_b32 v65, 4, v1
    v_and_b32 v65, 2, v65
    v_xor_b32 v66, v66, v65
    v_mul_u32_u24 v64, 3072, v64
    v_lshl_add_u32 v68, v66, 4, v64
    v_mov_b32 v69, v68
    s_mov_b32 s67, s73
    v_add_u32 v68, s67, v68
    v_add_u32 v69, s67, v69
    v_add_u32 v32, 4096, v68
    v_add_u32 v33, 4096, v68
    v_add_u32 v34, 51200, v69
    v_add_u32 v35, 51200, v69
    v_lshrrev_b32 v64, 3, v1
    v_and_b32 v65, 2, v64
    v_lshlrev_b32 v65, 1, v65
    v_and_b32 v66, 7, v1
    v_xor_b32 v66, v66, v65
    v_mul_u32_u24 v64, 3584, v64
    v_lshl_add_u32 v68, v66, 4, v64
    v_xor_b32 v69, 32, v68
    s_lshl_b32 s67, s76, 1
    v_add_u32 v68, s67, v68
    v_add_u32 v69, s67, v69
    v_add_u32 v36, 4096, v68
    v_add_u32 v37, 3072, v68
    v_add_u32 v38, 30720, v69
    v_add_u32 v39, 29696, v69
    v_lshrrev_b32 v64, 3, v1
    v_and_b32 v65, 2, v64
    v_lshlrev_b32 v65, 1, v65
    v_and_b32 v66, 7, v1
    v_xor_b32 v66, v66, v65
    v_mul_u32_u24 v64, 3584, v64
    v_lshl_add_u32 v68, v66, 4, v64
    v_xor_b32 v69, 32, v68
    s_lshl_b32 s67, s77, 1
    v_add_u32 v68, s67, v68
    v_add_u32 v69, s67, v69
    v_add_u32 v40, 4096, v68
    v_add_u32 v41, 3072, v68
    v_add_u32 v42, 30720, v69
    v_add_u32 v43, 29696, v69
    s_lshl_b32 s78, s57, 13
    s_add_u32 s66, s61, s57
    v_lshlrev_b32 v65, 1, v1
    v_add_u32 v65, s66, v65
    v_and_b32 v65, 7, v65
    v_mul_u32_u24 v65, 196608, v65
    v_cmp_le_u32 vcc, 0, v1
    s_nop 1
    v_cndmask_b32 v5, v5, v65, vcc
    v_add_u32 v65, s61, v1
    v_add_u32 v65, 4, v65
    v_and_b32 v65, 7, v65
    v_lshlrev_b32 v65, 1, v65
    v_add_u32 v65, s57, v65
    v_mul_u32_u24 v65, 114688, v65
    v_cmp_le_u32 vcc, 4, v1
    s_nop 1
    v_cndmask_b32 v5, v5, v65, vcc
    v_add_u32 v65, s61, v1
    v_add_u32 v65, 4, v65
    v_and_b32 v65, 7, v65
    v_lshlrev_b32 v65, 1, v65
    v_add_u32 v65, s57, v65
    v_mul_u32_u24 v65, 114688, v65
    v_cmp_le_u32 vcc, 12, v1
    s_nop 1
    v_cndmask_b32 v5, v5, v65, vcc
    s_sub_u32 s12, s12, 4096
    s_subb_u32 s13, s13, 0
    s_add_u32 s14, s14, 4096
    s_sub_u32 s24, s24, 4096
    s_subb_u32 s25, s25, 0
    s_add_u32 s26, s26, 4096
    s_sub_u32 s28, s28, 4096
    s_subb_u32 s29, s29, 0
    s_add_u32 s30, s30, 4096
    v_readlane_b32 s84, v5, 0
    s_add_u32 s66, s61, 2
    s_and_b32 s66, s66, 7
    s_lshl_b32 s66, s66, 7
    s_add_u32 s66, s66, s79
    s_add_u32 m0, s75, 32768
    s_nop 0
    buffer_load_dwordx4 v48, s[8:11], s66 offen offset:0 lds
    buffer_load_dwordx4 v49, s[8:11], s66 offen offset:1024 lds
    buffer_load_dwordx4 v50, s[8:11], s66 offen offset:2048 lds
    buffer_load_dwordx4 v51, s[8:11], s66 offen offset:3072 lds
    s_add_u32 s66, s61, 3
    s_and_b32 s66, s66, 7
    s_lshl_b32 s66, s66, 7
    s_add_u32 s66, s66, s79
    s_add_u32 m0, s75, 49152
    s_nop 0
    buffer_load_dwordx4 v48, s[8:11], s66 offen offset:0 lds
    buffer_load_dwordx4 v49, s[8:11], s66 offen offset:1024 lds
    buffer_load_dwordx4 v50, s[8:11], s66 offen offset:2048 lds
    buffer_load_dwordx4 v51, s[8:11], s66 offen offset:3072 lds
    s_waitcnt vmcnt(8)
    s_barrier
    s_add_u32 s66, s61, 4
    s_and_b32 s66, s66, 7
    s_lshl_b32 s66, s66, 7
    s_add_u32 s66, s66, s79
    s_add_u32 m0, s75, 65536
    s_nop 0
    buffer_load_dwordx4 v48, s[8:11], s66 offen offset:0 lds
    buffer_load_dwordx4 v49, s[8:11], s66 offen offset:1024 lds
    buffer_load_dwordx4 v50, s[8:11], s66 offen offset:2048 lds
    buffer_load_dwordx4 v51, s[8:11], s66 offen offset:3072 lds
    s_add_u32 s66, s61, 5
    s_and_b32 s66, s66, 7
    s_lshl_b32 s66, s66, 7
    s_add_u32 s66, s66, s79
    s_add_u32 m0, s75, 81920
    s_nop 0
    buffer_load_dwordx4 v48, s[8:11], s66 offen offset:0 lds
    buffer_load_dwordx4 v49, s[8:11], s66 offen offset:1024 lds
    buffer_load_dwordx4 v50, s[8:11], s66 offen offset:2048 lds
    buffer_load_dwordx4 v51, s[8:11], s66 offen offset:3072 lds
    s_waitcnt vmcnt(8)
    s_barrier
    s_add_u32 s66, s61, 6
    s_and_b32 s66, s66, 7
    s_lshl_b32 s66, s66, 7
    s_add_u32 s66, s66, s79
    s_add_u32 m0, s75, 98304
    s_nop 0
    buffer_load_dwordx4 v48, s[8:11], s66 offen offset:0 lds
    buffer_load_dwordx4 v49, s[8:11], s66 offen offset:1024 lds
    buffer_load_dwordx4 v50, s[8:11], s66 offen offset:2048 lds
    buffer_load_dwordx4 v51, s[8:11], s66 offen offset:3072 lds
    s_add_u32 s66, s61, 7
    s_and_b32 s66, s66, 7
    s_lshl_b32 s66, s66, 7
    s_add_u32 s66, s66, s79
    s_add_u32 m0, s75, 114688
    s_nop 0
    buffer_load_dwordx4 v48, s[8:11], s66 offen offset:0 lds
    buffer_load_dwordx4 v49, s[8:11], s66 offen offset:1024 lds
    buffer_load_dwordx4 v50, s[8:11], s66 offen offset:2048 lds
    buffer_load_dwordx4 v51, s[8:11], s66 offen offset:3072 lds
    s_waitcnt vmcnt(8)
    s_barrier
    s_add_u32 m0, s78, 0
    v_readlane_b32 s86, v5, 1
    s_waitcnt vmcnt(6)
    buffer_load_dwordx4 v32, s[12:15], s84 offen offset:0 lds
    buffer_load_dwordx4 v33, s[12:15], s84 offen offset:1024 lds
    s_waitcnt vmcnt(6)
    buffer_load_dwordx4 v34, s[12:15], s84 offen offset:2048 lds
    buffer_load_dwordx4 v35, s[12:15], s84 offen offset:3072 lds
    s_add_u32 m0, s78, 4096
    s_add_u32 s84, s84, 98304
    s_waitcnt vmcnt(6)
    buffer_load_dwordx4 v32, s[12:15], s84 offen offset:0 lds
    buffer_load_dwordx4 v33, s[12:15], s84 offen offset:1024 lds
    s_waitcnt vmcnt(6)
    buffer_load_dwordx4 v34, s[12:15], s84 offen offset:2048 lds
    buffer_load_dwordx4 v35, s[12:15], s84 offen offset:3072 lds
    s_mov_b32 m0, s48
    v_mov_b32 v12, 4
    global_load_lds_dword v12, s[88:89]
    s_waitcnt vmcnt(9)
    s_barrier
    s_barrier
    s_add_u32 m0, s78, 32768
    v_readlane_b32 s84, v5, 2
    s_waitcnt vmcnt(6)
    buffer_load_dwordx4 v32, s[12:15], s86 offen offset:0 lds
    buffer_load_dwordx4 v33, s[12:15], s86 offen offset:1024 lds
    s_waitcnt vmcnt(6)
    buffer_load_dwordx4 v34, s[12:15], s86 offen offset:2048 lds
    buffer_load_dwordx4 v35, s[12:15], s86 offen offset:3072 lds
    s_add_u32 m0, s78, 36864
    s_add_u32 s86, s86, 98304
    s_waitcnt vmcnt(6)
    buffer_load_dwordx4 v32, s[12:15], s86 offen offset:0 lds
    buffer_load_dwordx4 v33, s[12:15], s86 offen offset:1024 lds
    s_waitcnt vmcnt(6)
    buffer_load_dwordx4 v34, s[12:15], s86 offen offset:2048 lds
    buffer_load_dwordx4 v35, s[12:15], s86 offen offset:3072 lds
    s_mov_b32 m0, s48
    v_mov_b32 v12, 8
    global_load_lds_dword v12, s[88:89]
    s_add_u32 m0, s78, 49152
    v_readlane_b32 s86, v5, 3
    s_waitcnt vmcnt(6)
    buffer_load_dwordx4 v32, s[12:15], s84 offen offset:0 lds
    buffer_load_dwordx4 v33, s[12:15], s84 offen offset:1024 lds
    s_waitcnt vmcnt(6)
    buffer_load_dwordx4 v34, s[12:15], s84 offen offset:2048 lds
    buffer_load_dwordx4 v35, s[12:15], s84 offen offset:3072 lds
    s_add_u32 m0, s78, 53248
    s_add_u32 s84, s84, 98304
    s_waitcnt vmcnt(6)
    buffer_load_dwordx4 v32, s[12:15], s84 offen offset:0 lds
    buffer_load_dwordx4 v33, s[12:15], s84 offen offset:1024 lds
    s_waitcnt vmcnt(6)
    buffer_load_dwordx4 v34, s[12:15], s84 offen offset:2048 lds
    buffer_load_dwordx4 v35, s[12:15], s84 offen offset:3072 lds
    s_mov_b32 m0, s48
    v_mov_b32 v12, 12
    global_load_lds_dword v12, s[88:89]
    s_add_u32 m0, s78, 65536
    v_readlane_b32 s84, v5, 4
    s_waitcnt vmcnt(6)
    buffer_load_dwordx4 v32, s[12:15], s86 offen offset:0 lds
    buffer_load_dwordx4 v33, s[12:15], s86 offen offset:1024 lds
    s_waitcnt vmcnt(6)
    buffer_load_dwordx4 v34, s[12:15], s86 offen offset:2048 lds
    buffer_load_dwordx4 v35, s[12:15], s86 offen offset:3072 lds
    s_add_u32 m0, s78, 69632
    s_add_u32 s86, s86, 98304
    s_waitcnt vmcnt(6)
    buffer_load_dwordx4 v32, s[12:15], s86 offen offset:0 lds
    buffer_load_dwordx4 v33, s[12:15], s86 offen offset:1024 lds
    s_waitcnt vmcnt(6)
    buffer_load_dwordx4 v34, s[12:15], s86 offen offset:2048 lds
    buffer_load_dwordx4 v35, s[12:15], s86 offen offset:3072 lds
    s_mov_b32 m0, s48
    v_mov_b32 v12, 16
    global_load_lds_dword v12, s[88:89]
    s_movk_i32 m0, 18176
    s_nop 0
    buffer_load_dword v9, s[40:43], 0 offen sc1 lds
    s_add_u32 m0, s78, 81920
    v_readlane_b32 s86, v5, 5
    s_waitcnt vmcnt(8)
    buffer_load_dwordx4 v36, s[24:27], s84 offen offset:0 lds
    buffer_load_dwordx4 v37, s[28:31], s84 offen offset:1024 lds
    s_waitcnt vmcnt(9)
    buffer_load_dwordx4 v38, s[24:27], s84 offen offset:2048 lds
    buffer_load_dwordx4 v39, s[28:31], s84 offen offset:3072 lds
    s_add_u32 m0, s78, 86016
    s_add_u32 s84, s84, 57344
    s_waitcnt vmcnt(10)
    buffer_load_dwordx4 v36, s[24:27], s84 offen offset:0 lds
    buffer_load_dwordx4 v37, s[28:31], s84 offen offset:1024 lds
    s_waitcnt vmcnt(11)
    buffer_load_dwordx4 v38, s[24:27], s84 offen offset:2048 lds
    buffer_load_dwordx4 v39, s[28:31], s84 offen offset:3072 lds
    s_mov_b32 m0, s48
    v_mov_b32 v12, 20
    global_load_lds_dword v12, s[88:89]
    s_add_u32 m0, s78, 98304
    v_readlane_b32 s84, v5, 6
    s_waitcnt vmcnt(13)
    buffer_load_dwordx4 v36, s[24:27], s86 offen offset:0 lds
    buffer_load_dwordx4 v37, s[28:31], s86 offen offset:1024 lds
    s_waitcnt vmcnt(14)
    buffer_load_dwordx4 v38, s[24:27], s86 offen offset:2048 lds
    buffer_load_dwordx4 v39, s[28:31], s86 offen offset:3072 lds
    s_add_u32 m0, s78, 102400
    s_add_u32 s86, s86, 57344
    s_waitcnt vmcnt(15)
    buffer_load_dwordx4 v36, s[24:27], s86 offen offset:0 lds
    buffer_load_dwordx4 v37, s[28:31], s86 offen offset:1024 lds
    s_waitcnt vmcnt(14)
    buffer_load_dwordx4 v38, s[24:27], s86 offen offset:2048 lds
    buffer_load_dwordx4 v39, s[28:31], s86 offen offset:3072 lds
    s_mov_b32 m0, s48
    v_mov_b32 v12, 24
    global_load_lds_dword v12, s[88:89]
    ds_read_b32 v28, v7
    s_add_u32 m0, s78, 114688
    v_readlane_b32 s86, v5, 7
    s_waitcnt vmcnt(15)
    buffer_load_dwordx4 v36, s[24:27], s84 offen offset:0 lds
    buffer_load_dwordx4 v37, s[28:31], s84 offen offset:1024 lds
    s_waitcnt vmcnt(15)
    buffer_load_dwordx4 v38, s[24:27], s84 offen offset:2048 lds
    buffer_load_dwordx4 v39, s[28:31], s84 offen offset:3072 lds
    s_add_u32 m0, s78, 118784
    s_add_u32 s84, s84, 57344
    s_waitcnt vmcnt(15)
    buffer_load_dwordx4 v36, s[24:27], s84 offen offset:0 lds
    buffer_load_dwordx4 v37, s[28:31], s84 offen offset:1024 lds
    s_waitcnt vmcnt(14)
    buffer_load_dwordx4 v38, s[24:27], s84 offen offset:2048 lds
    buffer_load_dwordx4 v39, s[28:31], s84 offen offset:3072 lds
    s_lshl_b32 s66, s63, 1
    s_add_u32 s66, s66, s57
    s_mul_i32 s66, s66, 147456
    s_add_u32 s66, s66, 2095104
    v_lshlrev_b32 v68, 4, v1
    v_add_u32 v2, s66, v68
    v_lshrrev_b32 v68, 3, v1
    v_and_b32 v69, 6, v68
    v_and_b32 v70, 7, v1
    v_xor_b32 v70, v70, v69
    v_lshlrev_b32 v68, 10, v68
    v_lshl_add_u32 v3, v70, 4, v68
    s_lshl_b32 s66, s57, 15
    s_lshl_b32 s67, s64, 7
    s_add_u32 s66, s66, s67
    v_add_u32 v3, s66, v3
    v_add_u32 v4, 7168, v3
    v_lshrrev_b32 v68, 3, v1
    v_lshlrev_b32 v68, 10, v68
    v_and_b32 v70, 7, v1
    v_lshl_add_u32 v15, v70, 4, v68
    s_lshl_b32 s67, s63, 16
    s_add_u32 s66, s66, s67
    v_add_u32 v15, s66, v15
    s_lshl_b32 s67, s63, 8
    s_add_u32 s67, s67, 32768
    v_lshlrev_b32 v16, 2, v1
    v_add_u32 v16, s67, v16
    s_lshl_b32 s66, s74, 1
    s_add_u32 s66, s66, s57
    v_lshrrev_b32 v66, 2, v1
    v_lshlrev_b32 v66, 10, v66
    v_and_b32 v67, 3, v1
    v_lshl_add_u32 v66, v67, 7, v66
    s_and_b32 s67, s64, 4
    s_lshl_b32 s67, s67, 7
    v_add_u32 v66, s67, v66
    s_mul_i32 s67, s66, 28672
    v_add_u32 v20, s67, v66
    s_mul_i32 s67, s66, 8192
    v_add_u32 v21, s67, v66
    s_lshl_b32 s66, s2, 1
    s_add_u32 s66, s66, s57
    s_mul_i32 s67, s66, 3584
    v_lshlrev_b32 v66, 7, v1
    v_add_u32 v18, s67, v66
    s_lshl_b32 s67, s66, 10
    v_add_u32 v19, s67, v66
    v_add_u32 v64, s65, v1
    v_and_b32 v66, 7, v64
    v_lshlrev_b32 v65, 13, v66
    v_cmp_le_u32 vcc, 20, v1
    s_nop 1
    v_cndmask_b32 v5, v5, v65, vcc
    v_lshrrev_b32 v67, 1, v66
    v_lshlrev_b32 v65, 1, v66
    v_sub_u32 v65, v65, v67
    v_add_u32 v65, 16, v65
    v_lshlrev_b32 v65, 12, v65
    v_cmp_le_u32 vcc, 28, v1
    s_nop 1
    v_cndmask_b32 v5, v5, v65, vcc
    v_lshlrev_b32 v65, 13, v66
    v_add_u32 v65, 4096, v65
    v_cmp_le_u32 vcc, 36, v1
    s_nop 1
    v_cndmask_b32 v5, v5, v65, vcc
    v_and_b32 v65, 3, v64
    v_mul_u32_u24 v65, 3, v65
    v_add_u32 v65, 17, v65
    v_lshlrev_b32 v65, 12, v65
    v_cmp_le_u32 vcc, 44, v1
    s_nop 1
    v_cndmask_b32 v5, v5, v65, vcc
    v_lshlrev_b32 v65, 12, v66
    v_cmp_le_u32 vcc, 48, v1
    s_nop 1
    v_cndmask_b32 v5, v5, v65, vcc
    s_waitcnt lgkmcnt(0)
    v_cmp_ge_u32 vcc, 0, v28
    s_cbranch_vccz L_fr11
    s_movk_i32 s81, 1
    s_call_b64 s[82:83], L_spin_d
L_fr11:
    ds_read_b32 v28, v7
    s_add_u32 m0, s78, 0
    v_readlane_b32 s84, v5, 8
    s_waitcnt vmcnt(14)
    buffer_load_dwordx4 v36, s[24:27], s86 offen offset:0 lds
    buffer_load_dwordx4 v37, s[28:31], s86 offen offset:1024 lds
    s_waitcnt vmcnt(14)
    buffer_load_dwordx4 v38, s[24:27], s86 offen offset:2048 lds
    buffer_load_dwordx4 v39, s[28:31], s86 offen offset:3072 lds
    s_add_u32 m0, s78, 4096
    s_add_u32 s86, s86, 57344
    s_waitcnt vmcnt(14)
    buffer_load_dwordx4 v36, s[24:27], s86 offen offset:0 lds
    buffer_load_dwordx4 v37, s[28:31], s86 offen offset:1024 lds
    s_waitcnt vmcnt(14)
    buffer_load_dwordx4 v38, s[24:27], s86 offen offset:2048 lds
    buffer_load_dwordx4 v39, s[28:31], s86 offen offset:3072 lds
    s_mov_b32 m0, s48
    v_mov_b32 v12, 32
    global_load_lds_dword v12, s[88:89]
    s_waitcnt lgkmcnt(0)
    v_cmp_ge_u32 vcc, 2, v28
    s_cbranch_vccz L_fr12
    s_movk_i32 s81, 3
    s_call_b64 s[82:83], L_spin_d
L_fr12:
    s_add_u32 m0, s78, 32768
    v_readlane_b32 s86, v5, 9
    s_waitcnt vmcnt(14)
    buffer_load_dwordx4 v36, s[24:27], s84 offen offset:0 lds
    buffer_load_dwordx4 v37, s[28:31], s84 offen offset:1024 lds
    s_waitcnt vmcnt(14)
    buffer_load_dwordx4 v38, s[24:27], s84 offen offset:2048 lds
    buffer_load_dwordx4 v39, s[28:31], s84 offen offset:3072 lds
    s_add_u32 m0, s78, 36864
    s_add_u32 s84, s84, 57344
    s_waitcnt vmcnt(14)
    buffer_load_dwordx4 v36, s[24:27], s84 offen offset:0 lds
    buffer_load_dwordx4 v37, s[28:31], s84 offen offset:1024 lds
    s_waitcnt vmcnt(14)
    buffer_load_dwordx4 v38, s[24:27], s84 offen offset:2048 lds
    buffer_load_dwordx4 v39, s[28:31], s84 offen offset:3072 lds
    ds_read_b32 v28, v7
    s_add_u32 m0, s78, 49152
    v_readlane_b32 s84, v5, 10
    s_waitcnt vmcnt(14)
    buffer_load_dwordx4 v36, s[24:27], s86 offen offset:0 lds
    buffer_load_dwordx4 v37, s[28:31], s86 offen offset:1024 lds
    s_waitcnt vmcnt(14)
    buffer_load_dwordx4 v38, s[24:27], s86 offen offset:2048 lds
    buffer_load_dwordx4 v39, s[28:31], s86 offen offset:3072 lds
    s_add_u32 m0, s78, 53248
    s_add_u32 s86, s86, 57344
    s_waitcnt vmcnt(14)
    buffer_load_dwordx4 v36, s[24:27], s86 offen offset:0 lds
    buffer_load_dwordx4 v37, s[28:31], s86 offen offset:1024 lds
    s_waitcnt vmcnt(14)
    buffer_load_dwordx4 v38, s[24:27], s86 offen offset:2048 lds
    buffer_load_dwordx4 v39, s[28:31], s86 offen offset:3072 lds
    s_mov_b32 m0, s48
    v_mov_b32 v12, 40
    global_load_lds_dword v12, s[88:89]
    s_waitcnt lgkmcnt(0)
    v_cmp_ge_u32 vcc, 4, v28
    s_cbranch_vccz L_fr13
    s_movk_i32 s81, 5
    s_call_b64 s[82:83], L_spin_d
L_fr13:
    s_add_u32 m0, s78, 65536
    v_readlane_b32 s86, v5, 11
    s_waitcnt vmcnt(14)
    buffer_load_dwordx4 v36, s[24:27], s84 offen offset:0 lds
    buffer_load_dwordx4 v37, s[28:31], s84 offen offset:1024 lds
    s_waitcnt vmcnt(14)
    buffer_load_dwordx4 v38, s[24:27], s84 offen offset:2048 lds
    buffer_load_dwordx4 v39, s[28:31], s84 offen offset:3072 lds
    s_add_u32 m0, s78, 69632
    s_add_u32 s84, s84, 57344
    s_waitcnt vmcnt(14)
    buffer_load_dwordx4 v36, s[24:27], s84 offen offset:0 lds
    buffer_load_dwordx4 v37, s[28:31], s84 offen offset:1024 lds
    s_waitcnt vmcnt(14)
    buffer_load_dwordx4 v38, s[24:27], s84 offen offset:2048 lds
    buffer_load_dwordx4 v39, s[28:31], s84 offen offset:3072 lds
    ds_read_b32 v28, v7
    s_add_u32 m0, s78, 81920
    v_readlane_b32 s84, v5, 12
    s_waitcnt vmcnt(14)
    buffer_load_dwordx4 v36, s[24:27], s86 offen offset:0 lds
    buffer_load_dwordx4 v37, s[28:31], s86 offen offset:1024 lds
    s_waitcnt vmcnt(14)
    buffer_load_dwordx4 v38, s[24:27], s86 offen offset:2048 lds
    buffer_load_dwordx4 v39, s[28:31], s86 offen offset:3072 lds
    s_add_u32 m0, s78, 86016
    s_add_u32 s86, s86, 57344
    s_waitcnt vmcnt(14)
    buffer_load_dwordx4 v36, s[24:27], s86 offen offset:0 lds
    buffer_load_dwordx4 v37, s[28:31], s86 offen offset:1024 lds
    s_waitcnt vmcnt(14)
    buffer_load_dwordx4 v38, s[24:27], s86 offen offset:2048 lds
    buffer_load_dwordx4 v39, s[28:31], s86 offen offset:3072 lds
    s_mov_b32 m0, s48
    v_mov_b32 v12, 48
    global_load_lds_dword v12, s[88:89]
    s_waitcnt lgkmcnt(0)
    v_cmp_ge_u32 vcc, 6, v28
    s_cbranch_vccz L_fr14
    s_movk_i32 s81, 7
    s_call_b64 s[82:83], L_spin_d
L_fr14:
    s_add_u32 m0, s78, 98304
    v_readlane_b32 s86, v5, 13
    s_waitcnt vmcnt(14)
    buffer_load_dwordx4 v40, s[24:27], s84 offen offset:0 lds
    buffer_load_dwordx4 v41, s[28:31], s84 offen offset:1024 lds
    s_waitcnt vmcnt(14)
    buffer_load_dwordx4 v42, s[24:27], s84 offen offset:2048 lds
    buffer_load_dwordx4 v43, s[28:31], s84 offen offset:3072 lds
    s_add_u32 m0, s78, 102400
    s_add_u32 s84, s84, 57344
    s_waitcnt vmcnt(14)
    buffer_load_dwordx4 v40, s[24:27], s84 offen offset:0 lds
    buffer_load_dwordx4 v41, s[28:31], s84 offen offset:1024 lds
    s_waitcnt vmcnt(14)
    buffer_load_dwordx4 v42, s[24:27], s84 offen offset:2048 lds
    buffer_load_dwordx4 v43, s[28:31], s84 offen offset:3072 lds
    s_mov_b32 m0, s48
    v_mov_b32 v12, 52
    global_load_lds_dword v12, s[88:89]
    ds_read_b32 v28, v7
    s_add_u32 m0, s78, 114688
    v_readlane_b32 s84, v5, 14
    s_waitcnt vmcnt(15)
    buffer_load_dwordx4 v40, s[24:27], s86 offen offset:0 lds
    buffer_load_dwordx4 v41, s[28:31], s86 offen offset:1024 lds
    s_waitcnt vmcnt(15)
    buffer_load_dwordx4 v42, s[24:27], s86 offen offset:2048 lds
    buffer_load_dwordx4 v43, s[28:31], s86 offen offset:3072 lds
    s_add_u32 m0, s78, 118784
    s_add_u32 s86, s86, 57344
    s_waitcnt vmcnt(15)
    buffer_load_dwordx4 v40, s[24:27], s86 offen offset:0 lds
    buffer_load_dwordx4 v41, s[28:31], s86 offen offset:1024 lds
    s_waitcnt vmcnt(14)
    buffer_load_dwordx4 v42, s[24:27], s86 offen offset:2048 lds
    buffer_load_dwordx4 v43, s[28:31], s86 offen offset:3072 lds
    s_mov_b32 m0, s48
    v_mov_b32 v12, 56
    global_load_lds_dword v12, s[88:89]
    s_waitcnt vmcnt(17)
    s_mov_b64 exec, 0xfffffff
    buffer_load_dword v24, v18, s[32:35], 0 offen
    s_mov_b64 exec, 0xff
    buffer_load_dword v24, v19, s[20:23], 0 offen
    s_mov_b64 exec, -1
    s_lshr_b32 s66, s78, 1
    s_add_u32 m0, s66, 20480
    s_waitcnt vmcnt(15)
    s_movk_i32 s67, 0
    buffer_load_dwordx4 v15, s[8:11], s67 offen offset:0 lds
    s_movk_i32 s67, 7168
    buffer_load_dwordx4 v15, s[8:11], s67 offen offset:1024 lds
    s_movk_i32 s67, 14336
    buffer_load_dwordx4 v15, s[8:11], s67 offen offset:2048 lds
    s_movk_i32 s67, 21504
    buffer_load_dwordx4 v15, s[8:11], s67 offen offset:3072 lds
    s_mov_b64 exec, -1
    s_waitcnt lgkmcnt(0)
    v_cmp_ge_u32 vcc, 8, v28
    s_cbranch_vccz L_fr15
    s_movk_i32 s81, 9
    s_call_b64 s[82:83], L_spin_d
L_fr15:
    s_add_u32 m0, s78, 0
    v_readlane_b32 s86, v5, 15
    s_waitcnt vmcnt(12)
    buffer_load_dwordx4 v40, s[24:27], s84 offen offset:0 lds
    buffer_load_dwordx4 v41, s[28:31], s84 offen offset:1024 lds
    s_waitcnt vmcnt(12)
    buffer_load_dwordx4 v42, s[24:27], s84 offen offset:2048 lds
    buffer_load_dwordx4 v43, s[28:31], s84 offen offset:3072 lds
    s_add_u32 m0, s78, 4096
    s_add_u32 s84, s84, 57344
    s_waitcnt vmcnt(12)
    buffer_load_dwordx4 v40, s[24:27], s84 offen offset:0 lds
    buffer_load_dwordx4 v41, s[28:31], s84 offen offset:1024 lds
    s_waitcnt vmcnt(11)
    buffer_load_dwordx4 v42, s[24:27], s84 offen offset:2048 lds
    buffer_load_dwordx4 v43, s[28:31], s84 offen offset:3072 lds
    ds_read_b32 v11, v6 offset:1792
    s_waitcnt lgkmcnt(0)
    v_cmp_eq_u32 vcc, 1, v11
    s_cbranch_vccnz L_ok16
    s_mov_b32 s80, 0
L_spin16:
    s_sleep 4
    buffer_load_dword v11, v9, s[40:43], 0 offen offset:0 sc1
    s_add_u32 s80, s80, 1
    s_waitcnt vmcnt(0)
    v_cmp_eq_u32 vcc, 1, v11
    s_cbranch_vccnz L_ok16
    s_cmp_lt_u32 s80, 0x80000
    s_cbranch_scc1 L_spin16
L_ok16:
    ds_read_b32 v28, v7
    s_add_u32 m0, s78, 32768
    v_readlane_b32 s84, v5, 16
    s_waitcnt vmcnt(13)
    buffer_load_dwordx4 v40, s[24:27], s86 offen offset:0 lds
    buffer_load_dwordx4 v41, s[28:31], s86 offen offset:1024 lds
    s_waitcnt vmcnt(14)
    buffer_load_dwordx4 v42, s[24:27], s86 offen offset:2048 lds
    buffer_load_dwordx4 v43, s[28:31], s86 offen offset:3072 lds
    s_add_u32 m0, s78, 36864
    s_add_u32 s86, s86, 57344
    s_waitcnt vmcnt(14)
    buffer_load_dwordx4 v40, s[24:27], s86 offen offset:0 lds
    buffer_load_dwordx4 v41, s[28:31], s86 offen offset:1024 lds
    s_waitcnt vmcnt(14)
    buffer_load_dwordx4 v42, s[24:27], s86 offen offset:2048 lds
    buffer_load_dwordx4 v43, s[28:31], s86 offen offset:3072 lds
    s_mov_b32 m0, s48
    v_mov_b32 v12, 64
    global_load_lds_dword v12, s[88:89]
    s_waitcnt lgkmcnt(0)
    v_cmp_ge_u32 vcc, 10, v28
    s_cbranch_vccz L_fr17
    s_movk_i32 s81, 11
    s_call_b64 s[82:83], L_spin_d
L_fr17:
    s_add_u32 m0, s78, 49152
    v_readlane_b32 s86, v5, 17
    s_waitcnt vmcnt(14)
    buffer_load_dwordx4 v40, s[24:27], s84 offen offset:0 lds
    buffer_load_dwordx4 v41, s[28:31], s84 offen offset:1024 lds
    s_waitcnt vmcnt(14)
    buffer_load_dwordx4 v42, s[24:27], s84 offen offset:2048 lds
    buffer_load_dwordx4 v43, s[28:31], s84 offen offset:3072 lds
    s_add_u32 m0, s78, 53248
    s_add_u32 s84, s84, 57344
    s_waitcnt vmcnt(14)
    buffer_load_dwordx4 v40, s[24:27], s84 offen offset:0 lds
    buffer_load_dwordx4 v41, s[28:31], s84 offen offset:1024 lds
    s_waitcnt vmcnt(14)
    buffer_load_dwordx4 v42, s[24:27], s84 offen offset:2048 lds
    buffer_load_dwordx4 v43, s[28:31], s84 offen offset:3072 lds
    ds_read_b32 v28, v7
    s_add_u32 m0, s78, 65536
    v_readlane_b32 s84, v5, 18
    s_waitcnt vmcnt(14)
    buffer_load_dwordx4 v40, s[24:27], s86 offen offset:0 lds
    buffer_load_dwordx4 v41, s[28:31], s86 offen offset:1024 lds
    s_waitcnt vmcnt(14)
    buffer_load_dwordx4 v42, s[24:27], s86 offen offset:2048 lds
    buffer_load_dwordx4 v43, s[28:31], s86 offen offset:3072 lds
    s_add_u32 m0, s78, 69632
    s_add_u32 s86, s86, 57344
    s_waitcnt vmcnt(14)
    buffer_load_dwordx4 v40, s[24:27], s86 offen offset:0 lds
    buffer_load_dwordx4 v41, s[28:31], s86 offen offset:1024 lds
    s_waitcnt vmcnt(14)
    buffer_load_dwordx4 v42, s[24:27], s86 offen offset:2048 lds
    buffer_load_dwordx4 v43, s[28:31], s86 offen offset:3072 lds
    s_mov_b32 m0, s48
    v_mov_b32 v12, 72
    global_load_lds_dword v12, s[88:89]
    s_waitcnt lgkmcnt(0)
    v_cmp_ge_u32 vcc, 12, v28
    s_cbranch_vccz L_fr18
    s_movk_i32 s81, 13
    s_call_b64 s[82:83], L_spin_d
L_fr18:
    s_add_u32 m0, s78, 81920
    v_readlane_b32 s86, v5, 19
    s_waitcnt vmcnt(14)
    buffer_load_dwordx4 v40, s[24:27], s84 offen offset:0 lds
    buffer_load_dwordx4 v41, s[28:31], s84 offen offset:1024 lds
    s_waitcnt vmcnt(14)
    buffer_load_dwordx4 v42, s[24:27], s84 offen offset:2048 lds
    buffer_load_dwordx4 v43, s[28:31], s84 offen offset:3072 lds
    s_add_u32 m0, s78, 86016
    s_add_u32 s84, s84, 57344
    s_waitcnt vmcnt(14)
    buffer_load_dwordx4 v40, s[24:27], s84 offen offset:0 lds
    buffer_load_dwordx4 v41, s[28:31], s84 offen offset:1024 lds
    s_waitcnt vmcnt(14)
    buffer_load_dwordx4 v42, s[24:27], s84 offen offset:2048 lds
    buffer_load_dwordx4 v43, s[28:31], s84 offen offset:3072 lds
    s_add_u32 m0, s78, 98304
    v_readlane_b32 s84, v5, 20
    s_waitcnt vmcnt(14)
    buffer_load_dwordx4 v40, s[24:27], s86 offen offset:0 lds
    buffer_load_dwordx4 v41, s[28:31], s86 offen offset:1024 lds
    s_waitcnt vmcnt(14)
    buffer_load_dwordx4 v42, s[24:27], s86 offen offset:2048 lds
    buffer_load_dwordx4 v43, s[28:31], s86 offen offset:3072 lds
    s_add_u32 m0, s78, 102400
    s_add_u32 s86, s86, 57344
    s_waitcnt vmcnt(14)
    buffer_load_dwordx4 v40, s[24:27], s86 offen offset:0 lds
    buffer_load_dwordx4 v41, s[28:31], s86 offen offset:1024 lds
    s_waitcnt vmcnt(14)
    buffer_load_dwordx4 v42, s[24:27], s86 offen offset:2048 lds
    buffer_load_dwordx4 v43, s[28:31], s86 offen offset:3072 lds
    s_mov_b32 m0, s48
    v_mov_b32 v12, 80
    global_load_lds_dword v12, s[88:89]
    s_waitcnt lgkmcnt(0)
    s_mov_b32 s80, 0
L_cw19:
    ds_read_b32 v29, v6 offset:52
    s_add_u32 s80, s80, 1
    s_waitcnt lgkmcnt(0)
    v_cmp_le_u32 vcc, 2, v29
    s_cbranch_vccnz L_cx19
    s_sleep 2
    s_cmp_lt_u32 s80, 0x1000000
    s_cbranch_scc1 L_cw19
L_cx19:
    s_lshl_b32 s84, s84, 4
    s_add_u32 m0, s78, 131072
    v_readlane_b32 s86, v5, 21
    s_waitcnt vmcnt(12)
    buffer_load_dwordx4 v3, s[32:35], s84 offen lds
    buffer_load_dwordx4 v4, s[32:35], s84 offen offset:1024 lds
    s_add_u32 m0, s78, 135168
    s_add_u32 s84, s84, 16384
    s_waitcnt vmcnt(12)
    buffer_load_dwordx4 v3, s[32:35], s84 offen lds
    buffer_load_dwordx4 v4, s[32:35], s84 offen offset:1024 lds
    ds_read_b32 v28, v7
    s_lshl_b32 s86, s86, 4
    s_add_u32 m0, s78, 147456
    v_readlane_b32 s84, v5, 22
    s_waitcnt vmcnt(12)
    buffer_load_dwordx4 v3, s[32:35], s86 offen lds
    buffer_load_dwordx4 v4, s[32:35], s86 offen offset:1024 lds
    s_add_u32 m0, s78, 151552
    s_add_u32 s86, s86, 16384
    s_waitcnt vmcnt(12)
    buffer_load_dwordx4 v3, s[32:35], s86 offen lds
    buffer_load_dwordx4 v4, s[32:35], s86 offen offset:1024 lds
    s_waitcnt lgkmcnt(0)
    v_cmp_ge_u32 vcc, 14, v28
    s_cbranch_vccz L_fr20
    s_movk_i32 s81, 15
    s_call_b64 s[82:83], L_spin_d
L_fr20:
    s_load_dword s55, s[44:45], s54 offset:0 glc
    s_lshl_b32 s84, s84, 4
    s_add_u32 m0, s78, 114688
    v_readlane_b32 s86, v5, 23
    s_waitcnt vmcnt(12)
    buffer_load_dwordx4 v3, s[32:35], s84 offen lds
    buffer_load_dwordx4 v4, s[32:35], s84 offen offset:1024 lds
    s_add_u32 m0, s78, 118784
    s_add_u32 s84, s84, 16384
    s_waitcnt vmcnt(12)
    s_branch L_dmaj
L_dma1:
    v_mov_b32 v9, 0
    v_mov_b32 v5, 0
    v_mov_b32 v8, 1
    v_mov_b32 v6, 16384
    v_and_b32 v7, 3, v1
    v_lshlrev_b32 v7, 8, v7
    v_add_u32 v7, 17152, v7
    s_lshl_b32 s48, s57, 8
    s_add_u32 s48, s48, 16640
    s_lshl_b32 s54, s63, 9
    s_mul_i32 s66, s59, 96
    s_add_u32 s66, s66, 1024
    s_and_b32 s67, s59, 1
    s_lshl_b32 s68, s67, 5
    s_add_u32 s76, s66, s68
    s_xor_b32 s67, s67, 1
    s_lshl_b32 s67, s67, 6
    s_add_u32 s77, s66, s67
    v_lshrrev_b32 v64, 2, v1
    v_and_b32 v66, 3, v1
    v_lshrrev_b32 v65, 4, v1
    v_and_b32 v65, 2, v65
    v_xor_b32 v66, v66, v65
    v_mul_u32_u24 v64, 3072, v64
    v_lshl_add_u32 v68, v66, 4, v64
    v_mov_b32 v69, v68
    s_mov_b32 s67, s73
    v_add_u32 v68, s67, v68
    v_add_u32 v69, s67, v69
    v_add_u32 v32, 4096, v68
    v_add_u32 v33, 4096, v68
    v_add_u32 v34, 51200, v69
    v_add_u32 v35, 51200, v69
    v_lshrrev_b32 v64, 2, v1
    v_and_b32 v66, 3, v1
    v_lshrrev_b32 v65, 4, v1
    v_and_b32 v65, 2, v65
    v_xor_b32 v66, v66, v65
    v_mul_u32_u24 v64, 3072, v64
    v_lshl_add_u32 v68, v66, 4, v64
    v_mov_b32 v69, v68
    s_lshl_b32 s67, s59, 7
    v_add_u32 v68, s67, v68
    v_add_u32 v69, s67, v69
    v_add_u32 v36, 4096, v68
    v_add_u32 v37, 3136, v68
    v_add_u32 v38, 51200, v69
    v_add_u32 v39, 50240, v69
    v_lshrrev_b32 v64, 3, v1
    v_and_b32 v65, 2, v64
    v_lshlrev_b32 v65, 1, v65
    v_and_b32 v66, 7, v1
    v_xor_b32 v66, v66, v65
    v_mul_u32_u24 v64, 3584, v64
    v_lshl_add_u32 v68, v66, 4, v64
    v_xor_b32 v69, 32, v68
    s_lshl_b32 s67, s76, 1
    v_add_u32 v68, s67, v68
    v_add_u32 v69, s67, v69
    v_add_u32 v40, 4096, v68
    v_add_u32 v41, 3072, v68
    v_add_u32 v42, 30720, v69
    v_add_u32 v43, 29696, v69
    v_lshrrev_b32 v64, 2, v1
    v_and_b32 v66, 3, v1
    v_lshrrev_b32 v65, 4, v1
    v_and_b32 v65, 2, v65
    v_xor_b32 v66, v66, v65
    v_mul_u32_u24 v64, 3584, v64
    v_lshl_add_u32 v68, v66, 4, v64
    v_mov_b32 v69, v68
    s_lshl_b32 s67, s77, 1
    v_add_u32 v68, s67, v68
    v_add_u32 v69, s67, v69
    v_add_u32 v44, 4096, v68
    v_add_u32 v45, 3072, v68
    v_add_u32 v46, 59392, v69
    v_add_u32 v47, 58368, v69
    s_lshl_b32 s78, s57, 13
    s_add_u32 s66, s61, s57
    v_lshlrev_b32 v65, 1, v1
    v_add_u32 v65, s66, v65
    v_and_b32 v65, 7, v65
    v_mul_u32_u24 v65, 196608, v65
    v_cmp_le_u32 vcc, 0, v1
    s_nop 1
    v_cndmask_b32 v5, v5, v65, vcc
    v_lshlrev_b32 v65, 1, v1
    v_add_u32 v65, s66, v65
    v_and_b32 v65, 7, v65
    v_mul_u32_u24 v65, 196608, v65
    v_cmp_le_u32 vcc, 4, v1
    s_nop 1
    v_cndmask_b32 v5, v5, v65, vcc
    v_add_u32 v65, s61, v1
    v_add_u32 v65, 0, v65
    v_and_b32 v65, 7, v65
    v_lshlrev_b32 v65, 1, v65
    v_add_u32 v65, s57, v65
    v_mul_u32_u24 v65, 114688, v65
    v_cmp_le_u32 vcc, 8, v1
    s_nop 1
    v_cndmask_b32 v5, v5, v65, vcc
    v_lshlrev_b32 v65, 1, v1
    v_add_u32 v65, s66, v65
    v_and_b32 v65, 7, v65
    v_mul_u32_u24 v65, 229376, v65
    v_cmp_le_u32 vcc, 16, v1
    s_nop 1
    v_cndmask_b32 v5, v5, v65, vcc
    s_sub_u32 s12, s12, 4096
    s_subb_u32 s13, s13, 0
    s_add_u32 s14, s14, 4096
    s_sub_u32 s24, s24, 4096
    s_subb_u32 s25, s25, 0
    s_add_u32 s26, s26, 4096
    s_sub_u32 s28, s28, 4096
    s_subb_u32 s29, s29, 0
    s_add_u32 s30, s30, 4096
    v_readlane_b32 s84, v5, 0
    s_add_u32 s66, s61, 2
    s_and_b32 s66, s66, 7
    s_lshl_b32 s66, s66, 7
    s_add_u32 s66, s66, s79
    s_add_u32 m0, s75, 32768
    s_nop 0
    buffer_load_dwordx4 v48, s[8:11], s66 offen offset:0 lds
    buffer_load_dwordx4 v49, s[8:11], s66 offen offset:1024 lds
    buffer_load_dwordx4 v50, s[8:11], s66 offen offset:2048 lds
    buffer_load_dwordx4 v51, s[8:11], s66 offen offset:3072 lds
    s_add_u32 s66, s61, 3
    s_and_b32 s66, s66, 7
    s_lshl_b32 s66, s66, 7
    s_add_u32 s66, s66, s79
    s_add_u32 m0, s75, 49152
    s_nop 0
    buffer_load_dwordx4 v48, s[8:11], s66 offen offset:0 lds
    buffer_load_dwordx4 v49, s[8:11], s66 offen offset:1024 lds
    buffer_load_dwordx4 v50, s[8:11], s66 offen offset:2048 lds
    buffer_load_dwordx4 v51, s[8:11], s66 offen offset:3072 lds
    s_waitcnt vmcnt(8)
    s_barrier
    s_add_u32 s66, s61, 4
    s_and_b32 s66, s66, 7
    s_lshl_b32 s66, s66, 7
    s_add_u32 s66, s66, s79
    s_add_u32 m0, s75, 65536
    s_nop 0
    buffer_load_dwordx4 v48, s[8:11], s66 offen offset:0 lds
    buffer_load_dwordx4 v49, s[8:11], s66 offen offset:1024 lds
    buffer_load_dwordx4 v50, s[8:11], s66 offen offset:2048 lds
    buffer_load_dwordx4 v51, s[8:11], s66 offen offset:3072 lds
    s_add_u32 s66, s61, 5
    s_and_b32 s66, s66, 7
    s_lshl_b32 s66, s66, 7
    s_add_u32 s66, s66, s79
    s_add_u32 m0, s75, 81920
    s_nop 0
    buffer_load_dwordx4 v48, s[8:11], s66 offen offset:0 lds
    buffer_load_dwordx4 v49, s[8:11], s66 offen offset:1024 lds
    buffer_load_dwordx4 v50, s[8:11], s66 offen offset:2048 lds
    buffer_load_dwordx4 v51, s[8:11], s66 offen offset:3072 lds
    s_waitcnt vmcnt(8)
    s_barrier
    s_add_u32 s66, s61, 6
    s_and_b32 s66, s66, 7
    s_lshl_b32 s66, s66, 7
    s_add_u32 s66, s66, s79
    s_add_u32 m0, s75, 98304
    s_nop 0
    buffer_load_dwordx4 v48, s[8:11], s66 offen offset:0 lds
    buffer_load_dwordx4 v49, s[8:11], s66 offen offset:1024 lds
    buffer_load_dwordx4 v50, s[8:11], s66 offen offset:2048 lds
    buffer_load_dwordx4 v51, s[8:11], s66 offen offset:3072 lds
    s_add_u32 s66, s61, 7
    s_and_b32 s66, s66, 7
    s_lshl_b32 s66, s66, 7
    s_add_u32 s66, s66, s79
    s_add_u32 m0, s75, 114688
    s_nop 0
    buffer_load_dwordx4 v48, s[8:11], s66 offen offset:0 lds
    buffer_load_dwordx4 v49, s[8:11], s66 offen offset:1024 lds
    buffer_load_dwordx4 v50, s[8:11], s66 offen offset:2048 lds
    buffer_load_dwordx4 v51, s[8:11], s66 offen offset:3072 lds
    s_waitcnt vmcnt(8)
    s_barrier
    s_add_u32 m0, s78, 0
    v_readlane_b32 s86, v5, 1
    s_waitcnt vmcnt(6)
    buffer_load_dwordx4 v32, s[12:15], s84 offen offset:0 lds
    buffer_load_dwordx4 v33, s[12:15], s84 offen offset:1024 lds
    s_waitcnt vmcnt(6)
    buffer_load_dwordx4 v34, s[12:15], s84 offen offset:2048 lds
    buffer_load_dwordx4 v35, s[12:15], s84 offen offset:3072 lds
    s_add_u32 m0, s78, 4096
    s_add_u32 s84, s84, 98304
    s_waitcnt vmcnt(6)
    buffer_load_dwordx4 v32, s[12:15], s84 offen offset:0 lds
    buffer_load_dwordx4 v33, s[12:15], s84 offen offset:1024 lds
    s_waitcnt vmcnt(6)
    buffer_load_dwordx4 v34, s[12:15], s84 offen offset:2048 lds
    buffer_load_dwordx4 v35, s[12:15], s84 offen offset:3072 lds
    s_mov_b32 m0, s48
    v_mov_b32 v12, 4
    global_load_lds_dword v12, s[88:89]
    s_waitcnt vmcnt(9)
    s_barrier
    s_barrier
    s_add_u32 m0, s78, 32768
    v_readlane_b32 s84, v5, 2
    s_waitcnt vmcnt(6)
    buffer_load_dwordx4 v32, s[12:15], s86 offen offset:0 lds
    buffer_load_dwordx4 v33, s[12:15], s86 offen offset:1024 lds
    s_waitcnt vmcnt(6)
    buffer_load_dwordx4 v34, s[12:15], s86 offen offset:2048 lds
    buffer_load_dwordx4 v35, s[12:15], s86 offen offset:3072 lds
    s_add_u32 m0, s78, 36864
    s_add_u32 s86, s86, 98304
    s_waitcnt vmcnt(6)
    buffer_load_dwordx4 v32, s[12:15], s86 offen offset:0 lds
    buffer_load_dwordx4 v33, s[12:15], s86 offen offset:1024 lds
    s_waitcnt vmcnt(6)
    buffer_load_dwordx4 v34, s[12:15], s86 offen offset:2048 lds
    buffer_load_dwordx4 v35, s[12:15], s86 offen offset:3072 lds
    s_mov_b32 m0, s48
    v_mov_b32 v12, 8
    global_load_lds_dword v12, s[88:89]
    s_add_u32 m0, s78, 49152
    v_readlane_b32 s86, v5, 3
    s_waitcnt vmcnt(6)
    buffer_load_dwordx4 v32, s[12:15], s84 offen offset:0 lds
    buffer_load_dwordx4 v33, s[12:15], s84 offen offset:1024 lds
    s_waitcnt vmcnt(6)
    buffer_load_dwordx4 v34, s[12:15], s84 offen offset:2048 lds
    buffer_load_dwordx4 v35, s[12:15], s84 offen offset:3072 lds
    s_add_u32 m0, s78, 53248
    s_add_u32 s84, s84, 98304
    s_waitcnt vmcnt(6)
    buffer_load_dwordx4 v32, s[12:15], s84 offen offset:0 lds
    buffer_load_dwordx4 v33, s[12:15], s84 offen offset:1024 lds
    s_waitcnt vmcnt(6)
    buffer_load_dwordx4 v34, s[12:15], s84 offen offset:2048 lds
    buffer_load_dwordx4 v35, s[12:15], s84 offen offset:3072 lds
    s_mov_b32 m0, s48
    v_mov_b32 v12, 12
    global_load_lds_dword v12, s[88:89]
    s_add_u32 m0, s78, 65536
    v_readlane_b32 s84, v5, 4
    s_waitcnt vmcnt(6)
    buffer_load_dwordx4 v32, s[12:15], s86 offen offset:0 lds
    buffer_load_dwordx4 v33, s[12:15], s86 offen offset:1024 lds
    s_waitcnt vmcnt(6)
    buffer_load_dwordx4 v34, s[12:15], s86 offen offset:2048 lds
    buffer_load_dwordx4 v35, s[12:15], s86 offen offset:3072 lds
    s_add_u32 m0, s78, 69632
    s_add_u32 s86, s86, 98304
    s_waitcnt vmcnt(6)
    buffer_load_dwordx4 v32, s[12:15], s86 offen offset:0 lds
    buffer_load_dwordx4 v33, s[12:15], s86 offen offset:1024 lds
    s_waitcnt vmcnt(6)
    buffer_load_dwordx4 v34, s[12:15], s86 offen offset:2048 lds
    buffer_load_dwordx4 v35, s[12:15], s86 offen offset:3072 lds
    s_mov_b32 m0, s48
    v_mov_b32 v12, 16
    global_load_lds_dword v12, s[88:89]
    s_movk_i32 m0, 18176
    s_nop 0
    buffer_load_dword v9, s[40:43], 0 offen sc1 lds
    s_add_u32 m0, s78, 81920
    v_readlane_b32 s86, v5, 5
    s_waitcnt vmcnt(8)
    buffer_load_dwordx4 v36, s[12:15], s84 offen offset:0 lds
    buffer_load_dwordx4 v37, s[12:15], s84 offen offset:1024 lds
    s_waitcnt vmcnt(9)
    buffer_load_dwordx4 v38, s[12:15], s84 offen offset:2048 lds
    buffer_load_dwordx4 v39, s[12:15], s84 offen offset:3072 lds
    s_add_u32 m0, s78, 86016
    s_add_u32 s84, s84, 98304
    s_waitcnt vmcnt(10)
    buffer_load_dwordx4 v36, s[12:15], s84 offen offset:0 lds
    buffer_load_dwordx4 v37, s[12:15], s84 offen offset:1024 lds
    s_waitcnt vmcnt(11)
    buffer_load_dwordx4 v38, s[12:15], s84 offen offset:2048 lds
    buffer_load_dwordx4 v39, s[12:15], s84 offen offset:3072 lds
    s_mov_b32 m0, s48
    v_mov_b32 v12, 20
    global_load_lds_dword v12, s[88:89]
    s_add_u32 m0, s78, 98304
    v_readlane_b32 s84, v5, 6
    s_waitcnt vmcnt(13)
    buffer_load_dwordx4 v36, s[12:15], s86 offen offset:0 lds
    buffer_load_dwordx4 v37, s[12:15], s86 offen offset:1024 lds
    s_waitcnt vmcnt(14)
    buffer_load_dwordx4 v38, s[12:15], s86 offen offset:2048 lds
    buffer_load_dwordx4 v39, s[12:15], s86 offen offset:3072 lds
    s_add_u32 m0, s78, 102400
    s_add_u32 s86, s86, 98304
    s_waitcnt vmcnt(15)
    buffer_load_dwordx4 v36, s[12:15], s86 offen offset:0 lds
    buffer_load_dwordx4 v37, s[12:15], s86 offen offset:1024 lds
    s_waitcnt vmcnt(14)
    buffer_load_dwordx4 v38, s[12:15], s86 offen offset:2048 lds
    buffer_load_dwordx4 v39, s[12:15], s86 offen offset:3072 lds
    s_mov_b32 m0, s48
    v_mov_b32 v12, 24
    global_load_lds_dword v12, s[88:89]
    ds_read_b32 v28, v7
    s_add_u32 m0, s78, 114688
    v_readlane_b32 s86, v5, 7
    s_waitcnt vmcnt(15)
    buffer_load_dwordx4 v36, s[12:15], s84 offen offset:0 lds
    buffer_load_dwordx4 v37, s[12:15], s84 offen offset:1024 lds
    s_waitcnt vmcnt(15)
    buffer_load_dwordx4 v38, s[12:15], s84 offen offset:2048 lds
    buffer_load_dwordx4 v39, s[12:15], s84 offen offset:3072 lds
    s_add_u32 m0, s78, 118784
    s_add_u32 s84, s84, 98304
    s_waitcnt vmcnt(15)
    buffer_load_dwordx4 v36, s[12:15], s84 offen offset:0 lds
    buffer_load_dwordx4 v37, s[12:15], s84 offen offset:1024 lds
    s_waitcnt vmcnt(14)
    buffer_load_dwordx4 v38, s[12:15], s84 offen offset:2048 lds
    buffer_load_dwordx4 v39, s[12:15], s84 offen offset:3072 lds
    s_mov_b32 m0, s48
    v_mov_b32 v12, 28
    global_load_lds_dword v12, s[88:89]
    s_lshl_b32 s66, s63, 1
    s_add_u32 s66, s66, s57
    s_mul_i32 s66, s66, 147456
    s_add_u32 s66, s66, 2095104
    v_lshlrev_b32 v68, 4, v1
    v_add_u32 v2, s66, v68
    v_lshrrev_b32 v68, 3, v1
    v_and_b32 v69, 6, v68
    v_and_b32 v70, 7, v1
    v_xor_b32 v70, v70, v69
    v_lshlrev_b32 v68, 10, v68
    v_lshl_add_u32 v3, v70, 4, v68
    s_lshl_b32 s66, s57, 15
    s_lshl_b32 s67, s64, 7
    s_add_u32 s66, s66, s67
    v_add_u32 v3, s66, v3
    v_add_u32 v4, 7168, v3
    v_lshrrev_b32 v68, 3, v1
    v_lshlrev_b32 v68, 10, v68
    v_and_b32 v70, 7, v1
    v_lshl_add_u32 v15, v70, 4, v68
    s_lshl_b32 s67, s63, 16
    s_add_u32 s66, s66, s67
    v_add_u32 v15, s66, v15
    s_lshl_b32 s67, s63, 8
    s_add_u32 s67, s67, 32768
    v_lshlrev_b32 v16, 2, v1
    v_add_u32 v16, s67, v16
    s_lshl_b32 s66, s74, 1
    s_add_u32 s66, s66, s57
    v_lshrrev_b32 v66, 2, v1
    v_lshlrev_b32 v66, 10, v66
    v_and_b32 v67, 3, v1
    v_lshl_add_u32 v66, v67, 7, v66
    s_and_b32 s67, s64, 4
    s_lshl_b32 s67, s67, 7
    v_add_u32 v66, s67, v66
    s_mul_i32 s67, s66, 28672
    v_add_u32 v20, s67, v66
    s_mul_i32 s67, s66, 8192
    v_add_u32 v21, s67, v66
    s_lshl_b32 s66, s2, 1
    s_add_u32 s66, s66, s57
    s_mul_i32 s67, s66, 3584
    v_lshlrev_b32 v66, 7, v1
    v_add_u32 v18, s67, v66
    s_lshl_b32 s67, s66, 10
    v_add_u32 v19, s67, v66
    v_add_u32 v64, s65, v1
    v_and_b32 v66, 7, v64
    v_lshlrev_b32 v65, 13, v66
    v_cmp_le_u32 vcc, 20, v1
    s_nop 1
    v_cndmask_b32 v5, v5, v65, vcc
    v_lshrrev_b32 v67, 1, v66
    v_lshlrev_b32 v65, 1, v66
    v_sub_u32 v65, v65, v67
    v_add_u32 v65, 16, v65
    v_lshlrev_b32 v65, 12, v65
    v_cmp_le_u32 vcc, 28, v1
    s_nop 1
    v_cndmask_b32 v5, v5, v65, vcc
    v_lshlrev_b32 v65, 13, v66
    v_add_u32 v65, 4096, v65
    v_cmp_le_u32 vcc, 36, v1
    s_nop 1
    v_cndmask_b32 v5, v5, v65, vcc
    v_and_b32 v65, 3, v64
    v_mul_u32_u24 v65, 3, v65
    v_add_u32 v65, 17, v65
    v_lshlrev_b32 v65, 12, v65
    v_cmp_le_u32 vcc, 44, v1
    s_nop 1
    v_cndmask_b32 v5, v5, v65, vcc
    v_lshlrev_b32 v65, 12, v66
    v_cmp_le_u32 vcc, 48, v1
    s_nop 1
    v_cndmask_b32 v5, v5, v65, vcc
    s_waitcnt lgkmcnt(0)
    v_cmp_ge_u32 vcc, 0, v28
    s_cbranch_vccz L_fr43
    s_movk_i32 s81, 1
    s_call_b64 s[82:83], L_spin_d
L_fr43:
    ds_read_b32 v28, v7
    s_add_u32 m0, s78, 0
    v_readlane_b32 s84, v5, 8
    s_waitcnt vmcnt(15)
    buffer_load_dwordx4 v36, s[12:15], s86 offen offset:0 lds
    buffer_load_dwordx4 v37, s[12:15], s86 offen offset:1024 lds
    s_waitcnt vmcnt(15)
    buffer_load_dwordx4 v38, s[12:15], s86 offen offset:2048 lds
    buffer_load_dwordx4 v39, s[12:15], s86 offen offset:3072 lds
    s_add_u32 m0, s78, 4096
    s_add_u32 s86, s86, 98304
    s_waitcnt vmcnt(15)
    buffer_load_dwordx4 v36, s[12:15], s86 offen offset:0 lds
    buffer_load_dwordx4 v37, s[12:15], s86 offen offset:1024 lds
    s_waitcnt vmcnt(14)
    buffer_load_dwordx4 v38, s[12:15], s86 offen offset:2048 lds
    buffer_load_dwordx4 v39, s[12:15], s86 offen offset:3072 lds
    s_mov_b32 m0, s48
    v_mov_b32 v12, 32
    global_load_lds_dword v12, s[88:89]
    s_waitcnt lgkmcnt(0)
    v_cmp_ge_u32 vcc, 2, v28
    s_cbranch_vccz L_fr44
    s_movk_i32 s81, 3
    s_call_b64 s[82:83], L_spin_d
L_fr44:
    s_add_u32 m0, s78, 32768
    v_readlane_b32 s86, v5, 9
    s_waitcnt vmcnt(15)
    buffer_load_dwordx4 v40, s[24:27], s84 offen offset:0 lds
    buffer_load_dwordx4 v41, s[28:31], s84 offen offset:1024 lds
    s_waitcnt vmcnt(15)
    buffer_load_dwordx4 v42, s[24:27], s84 offen offset:2048 lds
    buffer_load_dwordx4 v43, s[28:31], s84 offen offset:3072 lds
    s_add_u32 m0, s78, 36864
    s_add_u32 s84, s84, 57344
    s_waitcnt vmcnt(15)
    buffer_load_dwordx4 v40, s[24:27], s84 offen offset:0 lds
    buffer_load_dwordx4 v41, s[28:31], s84 offen offset:1024 lds
    s_waitcnt vmcnt(14)
    buffer_load_dwordx4 v42, s[24:27], s84 offen offset:2048 lds
    buffer_load_dwordx4 v43, s[28:31], s84 offen offset:3072 lds
    s_mov_b32 m0, s48
    v_mov_b32 v12, 36
    global_load_lds_dword v12, s[88:89]
    ds_read_b32 v28, v7
    s_add_u32 m0, s78, 49152
    v_readlane_b32 s84, v5, 10
    s_waitcnt vmcnt(15)
    buffer_load_dwordx4 v40, s[24:27], s86 offen offset:0 lds
    buffer_load_dwordx4 v41, s[28:31], s86 offen offset:1024 lds
    s_waitcnt vmcnt(15)
    buffer_load_dwordx4 v42, s[24:27], s86 offen offset:2048 lds
    buffer_load_dwordx4 v43, s[28:31], s86 offen offset:3072 lds
    s_add_u32 m0, s78, 53248
    s_add_u32 s86, s86, 57344
    s_waitcnt vmcnt(15)
    buffer_load_dwordx4 v40, s[24:27], s86 offen offset:0 lds
    buffer_load_dwordx4 v41, s[28:31], s86 offen offset:1024 lds
    s_waitcnt vmcnt(14)
    buffer_load_dwordx4 v42, s[24:27], s86 offen offset:2048 lds
    buffer_load_dwordx4 v43, s[28:31], s86 offen offset:3072 lds
    s_mov_b32 m0, s48
    v_mov_b32 v12, 40
    global_load_lds_dword v12, s[88:89]
    s_waitcnt vmcnt(17)
    s_mov_b64 exec, 0xfffffff
    buffer_load_dword v24, v18, s[32:35], 0 offen
    s_mov_b64 exec, 0xff
    buffer_load_dword v24, v19, s[20:23], 0 offen
    s_mov_b64 exec, -1
    s_lshr_b32 s66, s78, 1
    s_add_u32 m0, s66, 20480
    s_waitcnt vmcnt(15)
    s_movk_i32 s67, 0
    buffer_load_dwordx4 v15, s[8:11], s67 offen offset:0 lds
    s_movk_i32 s67, 7168
    buffer_load_dwordx4 v15, s[8:11], s67 offen offset:1024 lds
    s_movk_i32 s67, 14336
    buffer_load_dwordx4 v15, s[8:11], s67 offen offset:2048 lds
    s_movk_i32 s67, 21504
    buffer_load_dwordx4 v15, s[8:11], s67 offen offset:3072 lds
    s_mov_b64 exec, -1
    s_waitcnt lgkmcnt(0)
    v_cmp_ge_u32 vcc, 4, v28
    s_cbranch_vccz L_fr45
    s_movk_i32 s81, 5
    s_call_b64 s[82:83], L_spin_d
L_fr45:
    s_add_u32 m0, s78, 65536
    v_readlane_b32 s86, v5, 11
    s_waitcnt vmcnt(12)
    buffer_load_dwordx4 v40, s[24:27], s84 offen offset:0 lds
    buffer_load_dwordx4 v41, s[28:31], s84 offen offset:1024 lds
    s_waitcnt vmcnt(12)
    buffer_load_dwordx4 v42, s[24:27], s84 offen offset:2048 lds
    buffer_load_dwordx4 v43, s[28:31], s84 offen offset:3072 lds
    s_add_u32 m0, s78, 69632
    s_add_u32 s84, s84, 57344
    s_waitcnt vmcnt(12)
    buffer_load_dwordx4 v40, s[24:27], s84 offen offset:0 lds
    buffer_load_dwordx4 v41, s[28:31], s84 offen offset:1024 lds
    s_waitcnt vmcnt(11)
    buffer_load_dwordx4 v42, s[24:27], s84 offen offset:2048 lds
    buffer_load_dwordx4 v43, s[28:31], s84 offen offset:3072 lds
    ds_read_b32 v28, v7
    s_add_u32 m0, s78, 81920
    v_readlane_b32 s84, v5, 12
    s_waitcnt vmcnt(13)
    buffer_load_dwordx4 v40, s[24:27], s86 offen offset:0 lds
    buffer_load_dwordx4 v41, s[28:31], s86 offen offset:1024 lds
    s_waitcnt vmcnt(14)
    buffer_load_dwordx4 v42, s[24:27], s86 offen offset:2048 lds
    buffer_load_dwordx4 v43, s[28:31], s86 offen offset:3072 lds
    s_add_u32 m0, s78, 86016
    s_add_u32 s86, s86, 57344
    s_waitcnt vmcnt(14)
    buffer_load_dwordx4 v40, s[24:27], s86 offen offset:0 lds
    buffer_load_dwordx4 v41, s[28:31], s86 offen offset:1024 lds
    s_waitcnt vmcnt(14)
    buffer_load_dwordx4 v42, s[24:27], s86 offen offset:2048 lds
    buffer_load_dwordx4 v43, s[28:31], s86 offen offset:3072 lds
    s_mov_b32 m0, s48
    v_mov_b32 v12, 48
    global_load_lds_dword v12, s[88:89]
    s_waitcnt lgkmcnt(0)
    v_cmp_ge_u32 vcc, 6, v28
    s_cbranch_vccz L_fr46
    s_movk_i32 s81, 7
    s_call_b64 s[82:83], L_spin_d
L_fr46:
    s_add_u32 m0, s78, 98304
    v_readlane_b32 s86, v5, 13
    s_waitcnt vmcnt(14)
    buffer_load_dwordx4 v40, s[24:27], s84 offen offset:0 lds
    buffer_load_dwordx4 v41, s[28:31], s84 offen offset:1024 lds
    s_waitcnt vmcnt(14)
    buffer_load_dwordx4 v42, s[24:27], s84 offen offset:2048 lds
    buffer_load_dwordx4 v43, s[28:31], s84 offen offset:3072 lds
    s_add_u32 m0, s78, 102400
    s_add_u32 s84, s84, 57344
    s_waitcnt vmcnt(14)
    buffer_load_dwordx4 v40, s[24:27], s84 offen offset:0 lds
    buffer_load_dwordx4 v41, s[28:31], s84 offen offset:1024 lds
    s_waitcnt vmcnt(14)
    buffer_load_dwordx4 v42, s[24:27], s84 offen offset:2048 lds
    buffer_load_dwordx4 v43, s[28:31], s84 offen offset:3072 lds
    ds_read_b32 v28, v7
    s_add_u32 m0, s78, 114688
    v_readlane_b32 s84, v5, 14
    s_waitcnt vmcnt(14)
    buffer_load_dwordx4 v40, s[24:27], s86 offen offset:0 lds
    buffer_load_dwordx4 v41, s[28:31], s86 offen offset:1024 lds
    s_waitcnt vmcnt(14)
    buffer_load_dwordx4 v42, s[24:27], s86 offen offset:2048 lds
    buffer_load_dwordx4 v43, s[28:31], s86 offen offset:3072 lds
    s_add_u32 m0, s78, 118784
    s_add_u32 s86, s86, 57344
    s_waitcnt vmcnt(14)
    buffer_load_dwordx4 v40, s[24:27], s86 offen offset:0 lds
    buffer_load_dwordx4 v41, s[28:31], s86 offen offset:1024 lds
    s_waitcnt vmcnt(14)
    buffer_load_dwordx4 v42, s[24:27], s86 offen offset:2048 lds
    buffer_load_dwordx4 v43, s[28:31], s86 offen offset:3072 lds
    s_mov_b32 m0, s48
    v_mov_b32 v12, 56
    global_load_lds_dword v12, s[88:89]
    s_waitcnt lgkmcnt(0)
    v_cmp_ge_u32 vcc, 8, v28
    s_cbranch_vccz L_fr47
    s_movk_i32 s81, 9
    s_call_b64 s[82:83], L_spin_d
L_fr47:
    s_add_u32 m0, s78, 0
    v_readlane_b32 s86, v5, 15
    s_waitcnt vmcnt(14)
    buffer_load_dwordx4 v40, s[24:27], s84 offen offset:0 lds
    buffer_load_dwordx4 v41, s[28:31], s84 offen offset:1024 lds
    s_waitcnt vmcnt(14)
    buffer_load_dwordx4 v42, s[24:27], s84 offen offset:2048 lds
    buffer_load_dwordx4 v43, s[28:31], s84 offen offset:3072 lds
    s_add_u32 m0, s78, 4096
    s_add_u32 s84, s84, 57344
    s_waitcnt vmcnt(14)
    buffer_load_dwordx4 v40, s[24:27], s84 offen offset:0 lds
    buffer_load_dwordx4 v41, s[28:31], s84 offen offset:1024 lds
    s_waitcnt vmcnt(14)
    buffer_load_dwordx4 v42, s[24:27], s84 offen offset:2048 lds
    buffer_load_dwordx4 v43, s[28:31], s84 offen offset:3072 lds
    ds_read_b32 v11, v6 offset:1792
    s_waitcnt lgkmcnt(0)
    v_cmp_eq_u32 vcc, 1, v11
    s_cbranch_vccnz L_ok48
    s_mov_b32 s80, 0
L_spin48:
    s_sleep 4
    buffer_load_dword v11, v9, s[40:43], 0 offen offset:0 sc1
    s_add_u32 s80, s80, 1
    s_waitcnt vmcnt(0)
    v_cmp_eq_u32 vcc, 1, v11
    s_cbranch_vccnz L_ok48
    s_cmp_lt_u32 s80, 0x80000
    s_cbranch_scc1 L_spin48
L_ok48:
    ds_read_b32 v28, v7
    s_add_u32 m0, s78, 32768
    v_readlane_b32 s84, v5, 16
    s_waitcnt vmcnt(14)
    buffer_load_dwordx4 v40, s[24:27], s86 offen offset:0 lds
    buffer_load_dwordx4 v41, s[28:31], s86 offen offset:1024 lds
    s_waitcnt vmcnt(14)
    buffer_load_dwordx4 v42, s[24:27], s86 offen offset:2048 lds
    buffer_load_dwordx4 v43, s[28:31], s86 offen offset:3072 lds
    s_add_u32 m0, s78, 36864
    s_add_u32 s86, s86, 57344
    s_waitcnt vmcnt(14)
    buffer_load_dwordx4 v40, s[24:27], s86 offen offset:0 lds
    buffer_load_dwordx4 v41, s[28:31], s86 offen offset:1024 lds
    s_waitcnt vmcnt(14)
    buffer_load_dwordx4 v42, s[24:27], s86 offen offset:2048 lds
    buffer_load_dwordx4 v43, s[28:31], s86 offen offset:3072 lds
    s_mov_b32 m0, s48
    v_mov_b32 v12, 64
    global_load_lds_dword v12, s[88:89]
    s_waitcnt lgkmcnt(0)
    v_cmp_ge_u32 vcc, 10, v28
    s_cbranch_vccz L_fr49
    s_movk_i32 s81, 11
    s_call_b64 s[82:83], L_spin_d
L_fr49:
    s_add_u32 m0, s78, 49152
    v_readlane_b32 s86, v5, 17
    s_waitcnt vmcnt(12)
    buffer_load_dwordx4 v44, s[24:27], s84 offen offset:0 lds
    buffer_load_dwordx4 v45, s[28:31], s84 offen offset:1024 lds
    s_waitcnt vmcnt(10)
    buffer_load_dwordx4 v46, s[24:27], s84 offen offset:2048 lds
    buffer_load_dwordx4 v47, s[28:31], s84 offen offset:3072 lds
    s_add_u32 m0, s78, 53248
    s_add_u32 s84, s84, 114688
    s_waitcnt vmcnt(8)
    buffer_load_dwordx4 v44, s[24:27], s84 offen offset:0 lds
    buffer_load_dwordx4 v45, s[28:31], s84 offen offset:1024 lds
    s_waitcnt vmcnt(6)
    buffer_load_dwordx4 v46, s[24:27], s84 offen offset:2048 lds
    buffer_load_dwordx4 v47, s[28:31], s84 offen offset:3072 lds
    s_mov_b32 m0, s48
    v_mov_b32 v12, 68
    global_load_lds_dword v12, s[88:89]
    ds_read_b32 v28, v7
    s_add_u32 m0, s78, 65536
    v_readlane_b32 s84, v5, 18
    s_waitcnt vmcnt(6)
    buffer_load_dwordx4 v44, s[24:27], s86 offen offset:0 lds
    buffer_load_dwordx4 v45, s[28:31], s86 offen offset:1024 lds
    s_waitcnt vmcnt(6)
    buffer_load_dwordx4 v46, s[24:27], s86 offen offset:2048 lds
    buffer_load_dwordx4 v47, s[28:31], s86 offen offset:3072 lds
    s_add_u32 m0, s78, 69632
    s_add_u32 s86, s86, 114688
    s_waitcnt vmcnt(6)
    buffer_load_dwordx4 v44, s[24:27], s86 offen offset:0 lds
    buffer_load_dwordx4 v45, s[28:31], s86 offen offset:1024 lds
    s_waitcnt vmcnt(6)
    buffer_load_dwordx4 v46, s[24:27], s86 offen offset:2048 lds
    buffer_load_dwordx4 v47, s[28:31], s86 offen offset:3072 lds
    s_mov_b32 m0, s48
    v_mov_b32 v12, 72
    global_load_lds_dword v12, s[88:89]
    s_waitcnt lgkmcnt(0)
    v_cmp_ge_u32 vcc, 12, v28
    s_cbranch_vccz L_fr50
    s_movk_i32 s81, 13
    s_call_b64 s[82:83], L_spin_d
L_fr50:
    s_add_u32 m0, s78, 81920
    v_readlane_b32 s86, v5, 19
    s_waitcnt vmcnt(6)
    buffer_load_dwordx4 v44, s[24:27], s84 offen offset:0 lds
    buffer_load_dwordx4 v45, s[28:31], s84 offen offset:1024 lds
    s_waitcnt vmcnt(6)
    buffer_load_dwordx4 v46, s[24:27], s84 offen offset:2048 lds
    buffer_load_dwordx4 v47, s[28:31], s84 offen offset:3072 lds
    s_add_u32 m0, s78, 86016
    s_add_u32 s84, s84, 114688
    s_waitcnt vmcnt(6)
    buffer_load_dwordx4 v44, s[24:27], s84 offen offset:0 lds
    buffer_load_dwordx4 v45, s[28:31], s84 offen offset:1024 lds
    s_waitcnt vmcnt(6)
    buffer_load_dwordx4 v46, s[24:27], s84 offen offset:2048 lds
    buffer_load_dwordx4 v47, s[28:31], s84 offen offset:3072 lds
    s_mov_b32 m0, s48
    v_mov_b32 v12, 76
    global_load_lds_dword v12, s[88:89]
    s_add_u32 m0, s78, 98304
    v_readlane_b32 s84, v5, 20
    s_waitcnt vmcnt(6)
    buffer_load_dwordx4 v44, s[24:27], s86 offen offset:0 lds
    buffer_load_dwordx4 v45, s[28:31], s86 offen offset:1024 lds
    s_waitcnt vmcnt(6)
    buffer_load_dwordx4 v46, s[24:27], s86 offen offset:2048 lds
    buffer_load_dwordx4 v47, s[28:31], s86 offen offset:3072 lds
    s_add_u32 m0, s78, 102400
    s_add_u32 s86, s86, 114688
    s_waitcnt vmcnt(6)
    buffer_load_dwordx4 v44, s[24:27], s86 offen offset:0 lds
    buffer_load_dwordx4 v45, s[28:31], s86 offen offset:1024 lds
    s_waitcnt vmcnt(6)
    buffer_load_dwordx4 v46, s[24:27], s86 offen offset:2048 lds
    buffer_load_dwordx4 v47, s[28:31], s86 offen offset:3072 lds
    s_mov_b32 m0, s48
    v_mov_b32 v12, 80
    global_load_lds_dword v12, s[88:89]
    s_waitcnt lgkmcnt(0)
    s_mov_b32 s80, 0
L_cw51:
    ds_read_b32 v29, v6 offset:52
    s_add_u32 s80, s80, 1
    s_waitcnt lgkmcnt(0)
    v_cmp_le_u32 vcc, 2, v29
    s_cbranch_vccnz L_cx51
    s_sleep 2
    s_cmp_lt_u32 s80, 0x1000000
    s_cbranch_scc1 L_cw51
L_cx51:
    s_lshl_b32 s84, s84, 4
    s_add_u32 m0, s78, 131072
    v_readlane_b32 s86, v5, 21
    s_waitcnt vmcnt(6)
    buffer_load_dwordx4 v3, s[32:35], s84 offen lds
    buffer_load_dwordx4 v4, s[32:35], s84 offen offset:1024 lds
    s_add_u32 m0, s78, 135168
    s_add_u32 s84, s84, 16384
    s_waitcnt vmcnt(7)
    buffer_load_dwordx4 v3, s[32:35], s84 offen lds
    buffer_load_dwordx4 v4, s[32:35], s84 offen offset:1024 lds
    ds_read_b32 v28, v7
    s_lshl_b32 s86, s86, 4
    s_add_u32 m0, s78, 147456
    v_readlane_b32 s84, v5, 22
    s_waitcnt vmcnt(8)
    buffer_load_dwordx4 v3, s[32:35], s86 offen lds
    buffer_load_dwordx4 v4, s[32:35], s86 offen offset:1024 lds
    s_add_u32 m0, s78, 151552
    s_add_u32 s86, s86, 16384
    s_waitcnt vmcnt(9)
    buffer_load_dwordx4 v3, s[32:35], s86 offen lds
    buffer_load_dwordx4 v4, s[32:35], s86 offen offset:1024 lds
    s_waitcnt lgkmcnt(0)
    v_cmp_ge_u32 vcc, 14, v28
    s_cbranch_vccz L_fr52
    s_movk_i32 s81, 15
    s_call_b64 s[82:83], L_spin_d
L_fr52:
    s_load_dword s55, s[44:45], s54 offset:0 glc
    s_lshl_b32 s84, s84, 4
    s_add_u32 m0, s78, 114688
    v_readlane_b32 s86, v5, 23
    s_waitcnt vmcnt(10)
    buffer_load_dwordx4 v3, s[32:35], s84 offen lds
    buffer_load_dwordx4 v4, s[32:35], s84 offen offset:1024 lds
    s_add_u32 m0, s78, 118784
    s_add_u32 s84, s84, 16384
    s_waitcnt vmcnt(11)
L_dmaj:
    buffer_load_dwordx4 v3, s[32:35], s84 offen lds
    buffer_load_dwordx4 v4, s[32:35], s84 offen offset:1024 lds
    s_lshl_b32 s86, s86, 4
    s_add_u32 m0, s78, 0
    v_readlane_b32 s84, v5, 20
    s_waitcnt vmcnt(12)
    buffer_load_dwordx4 v3, s[32:35], s86 offen lds
    buffer_load_dwordx4 v4, s[32:35], s86 offen offset:1024 lds
    s_add_u32 m0, s78, 4096
    s_add_u32 s86, s86, 16384
    s_waitcnt vmcnt(12)
    buffer_load_dwordx4 v3, s[32:35], s86 offen lds
    buffer_load_dwordx4 v4, s[32:35], s86 offen offset:1024 lds
    s_waitcnt lgkmcnt(0)
    s_cmp_eq_u32 s55, 16
    s_cbranch_scc1 L_ok53
    s_mov_b32 s80, 0
L_spin53:
    s_sleep 4
    s_load_dword s55, s[44:45], s54 offset:0 glc
    s_add_u32 s80, s80, 1
    s_waitcnt lgkmcnt(0)
    s_cmp_eq_u32 s55, 16
    s_cbranch_scc1 L_ok53
    s_cmp_lt_u32 s80, 0x80000
    s_cbranch_scc1 L_spin53
L_ok53:
    s_movk_i32 m0, 19456
    s_nop 0
    buffer_load_dword v16, s[44:47], 0 offen sc1 lds
    s_add_u32 m0, s78, 131072
    v_readlane_b32 s86, v5, 21
    s_waitcnt vmcnt(12)
    buffer_load_dwordx4 v2, s[44:47], s84 offen offset:2048 sc1 lds
    buffer_load_dwordx4 v2, s[44:47], s84 offen offset:3072 sc1 lds
    s_add_u32 m0, s78, 135168
    s_add_u32 s84, s84, 2048
    s_waitcnt vmcnt(12)
    buffer_load_dwordx4 v2, s[44:47], s84 offen offset:2048 sc1 lds
    buffer_load_dwordx4 v2, s[44:47], s84 offen offset:3072 sc1 lds
    s_mov_b32 m0, s48
    v_mov_b32 v12, 84
    global_load_lds_dword v12, s[88:89]
    s_add_u32 m0, s78, 147456
    v_readlane_b32 s84, v5, 22
    s_waitcnt vmcnt(13)
    buffer_load_dwordx4 v2, s[44:47], s86 offen offset:2048 sc1 lds
    buffer_load_dwordx4 v2, s[44:47], s86 offen offset:3072 sc1 lds
    s_add_u32 m0, s78, 151552
    s_add_u32 s86, s86, 2048
    s_waitcnt vmcnt(13)
    buffer_load_dwordx4 v2, s[44:47], s86 offen offset:2048 sc1 lds
    buffer_load_dwordx4 v2, s[44:47], s86 offen offset:3072 sc1 lds
    s_mov_b32 m0, s48
    v_mov_b32 v12, 88
    global_load_lds_dword v12, s[88:89]
    s_add_u32 m0, s78, 114688
    v_readlane_b32 s86, v5, 23
    s_waitcnt vmcnt(14)
    buffer_load_dwordx4 v2, s[44:47], s84 offen offset:2048 sc1 lds
    buffer_load_dwordx4 v2, s[44:47], s84 offen offset:3072 sc1 lds
    s_add_u32 m0, s78, 118784
    s_add_u32 s84, s84, 2048
    s_waitcnt vmcnt(14)
    buffer_load_dwordx4 v2, s[44:47], s84 offen offset:2048 sc1 lds
    buffer_load_dwordx4 v2, s[44:47], s84 offen offset:3072 sc1 lds
    s_mov_b32 m0, s48
    v_mov_b32 v12, 92
    global_load_lds_dword v12, s[88:89]
    ds_read_b32 v28, v7
    s_add_u32 m0, s78, 0
    v_readlane_b32 s84, v5, 24
    s_waitcnt vmcnt(14)
    buffer_load_dwordx4 v2, s[44:47], s86 offen offset:2048 sc1 lds
    buffer_load_dwordx4 v2, s[44:47], s86 offen offset:3072 sc1 lds
    s_add_u32 m0, s78, 4096
    s_add_u32 s86, s86, 2048
    s_waitcnt vmcnt(14)
    buffer_load_dwordx4 v2, s[44:47], s86 offen offset:2048 sc1 lds
    buffer_load_dwordx4 v2, s[44:47], s86 offen offset:3072 sc1 lds
    s_mov_b32 m0, s48
    v_mov_b32 v12, 96
    global_load_lds_dword v12, s[88:89]
    s_waitcnt lgkmcnt(0)
    v_cmp_ge_u32 vcc, 15, v28
    s_cbranch_vccz L_fr54
    s_movk_i32 s81, 16
    s_call_b64 s[82:83], L_spin_d
L_fr54:
    ds_read_b32 v28, v7
    s_add_u32 m0, s78, 32768
    s_lshl_b32 s85, s84, 4
    v_readlane_b32 s86, v5, 25
    s_waitcnt vmcnt(14)
    buffer_load_dwordx4 v3, s[32:35], s85 offen lds
    buffer_load_dwordx4 v4, s[32:35], s85 offen offset:1024 lds
    s_waitcnt vmcnt(14)
    buffer_load_dwordx4 v2, s[44:47], s84 offen offset:2048 sc1 lds
    buffer_load_dwordx4 v2, s[44:47], s84 offen offset:3072 sc1 lds
    s_add_u32 m0, s78, 36864
    s_add_u32 s84, s84, 2048
    s_add_u32 s85, s85, 16384
    s_waitcnt vmcnt(13)
    buffer_load_dwordx4 v3, s[32:35], s85 offen lds
    buffer_load_dwordx4 v4, s[32:35], s85 offen offset:1024 lds
    s_waitcnt vmcnt(13)
    buffer_load_dwordx4 v2, s[44:47], s84 offen offset:2048 sc1 lds
    buffer_load_dwordx4 v2, s[44:47], s84 offen offset:3072 sc1 lds
    s_mov_b32 m0, s48
    v_mov_b32 v12, 100
    global_load_lds_dword v12, s[88:89]
    s_waitcnt lgkmcnt(0)
    v_cmp_ge_u32 vcc, 16, v28
    s_cbranch_vccz L_fr55
    s_movk_i32 s81, 17
    s_call_b64 s[82:83], L_spin_d
L_fr55:
    ds_read_b32 v28, v7
    s_add_u32 m0, s78, 49152
    s_lshl_b32 s87, s86, 4
    v_readlane_b32 s84, v5, 26
    s_waitcnt vmcnt(13)
    buffer_load_dwordx4 v3, s[32:35], s87 offen lds
    buffer_load_dwordx4 v4, s[32:35], s87 offen offset:1024 lds
    s_waitcnt vmcnt(13)
    buffer_load_dwordx4 v2, s[44:47], s86 offen offset:2048 sc1 lds
    buffer_load_dwordx4 v2, s[44:47], s86 offen offset:3072 sc1 lds
    s_add_u32 m0, s78, 53248
    s_add_u32 s86, s86, 2048
    s_add_u32 s87, s87, 16384
    s_waitcnt vmcnt(12)
    buffer_load_dwordx4 v3, s[32:35], s87 offen lds
    buffer_load_dwordx4 v4, s[32:35], s87 offen offset:1024 lds
    s_waitcnt vmcnt(12)
    buffer_load_dwordx4 v2, s[44:47], s86 offen offset:2048 sc1 lds
    buffer_load_dwordx4 v2, s[44:47], s86 offen offset:3072 sc1 lds
    s_mov_b32 m0, s48
    v_mov_b32 v12, 104
    global_load_lds_dword v12, s[88:89]
    s_waitcnt lgkmcnt(0)
    v_cmp_ge_u32 vcc, 18, v28
    s_cbranch_vccz L_fr56
    s_movk_i32 s81, 19
    s_call_b64 s[82:83], L_spin_d
L_fr56:
    s_load_dword s55, s[44:45], s54 offset:128 glc
    s_add_u32 m0, s78, 65536
    s_lshl_b32 s85, s84, 4
    v_readlane_b32 s86, v5, 27
    s_waitcnt vmcnt(13)
    buffer_load_dwordx4 v3, s[32:35], s85 offen lds
    buffer_load_dwordx4 v4, s[32:35], s85 offen offset:1024 lds
    s_waitcnt vmcnt(13)
    buffer_load_dwordx4 v2, s[44:47], s84 offen offset:2048 sc1 lds
    buffer_load_dwordx4 v2, s[44:47], s84 offen offset:3072 sc1 lds
    s_add_u32 m0, s78, 69632
    s_add_u32 s84, s84, 2048
    s_add_u32 s85, s85, 16384
    s_waitcnt vmcnt(12)
    buffer_load_dwordx4 v3, s[32:35], s85 offen lds
    buffer_load_dwordx4 v4, s[32:35], s85 offen offset:1024 lds
    s_waitcnt vmcnt(12)
    buffer_load_dwordx4 v2, s[44:47], s84 offen offset:2048 sc1 lds
    buffer_load_dwordx4 v2, s[44:47], s84 offen offset:3072 sc1 lds
    s_mov_b32 m0, s48
    v_mov_b32 v12, 108
    global_load_lds_dword v12, s[88:89]
    ds_read_b32 v28, v7
    s_add_u32 m0, s78, 81920
    s_lshl_b32 s87, s86, 4
    v_readlane_b32 s84, v5, 28
    s_waitcnt vmcnt(13)
    buffer_load_dwordx4 v3, s[32:35], s87 offen lds
    buffer_load_dwordx4 v4, s[32:35], s87 offen offset:1024 lds
    s_waitcnt vmcnt(13)
    buffer_load_dwordx4 v2, s[44:47], s86 offen offset:2048 sc1 lds
    buffer_load_dwordx4 v2, s[44:47], s86 offen offset:3072 sc1 lds
    s_add_u32 m0, s78, 86016
    s_add_u32 s86, s86, 2048
    s_add_u32 s87, s87, 16384
    s_waitcnt vmcnt(12)
    buffer_load_dwordx4 v3, s[32:35], s87 offen lds
    buffer_load_dwordx4 v4, s[32:35], s87 offen offset:1024 lds
    s_waitcnt vmcnt(12)
    buffer_load_dwordx4 v2, s[44:47], s86 offen offset:2048 sc1 lds
    buffer_load_dwordx4 v2, s[44:47], s86 offen offset:3072 sc1 lds
    s_mov_b32 m0, s48
    v_mov_b32 v12, 112
    global_load_lds_dword v12, s[88:89]
    s_waitcnt lgkmcnt(0)
    v_cmp_ge_u32 vcc, 19, v28
    s_cbranch_vccz L_fr57
    s_movk_i32 s81, 20
    s_call_b64 s[82:83], L_spin_d
L_fr57:
    s_waitcnt lgkmcnt(0)
    s_cmp_eq_u32 s55, 16
    s_cbranch_scc1 L_ok58
    s_mov_b32 s80, 0
L_spin58:
    s_sleep 4
    s_load_dword s55, s[44:45], s54 offset:128 glc
    s_add_u32 s80, s80, 1
    s_waitcnt lgkmcnt(0)
    s_cmp_eq_u32 s55, 16
    s_cbranch_scc1 L_ok58
    s_cmp_lt_u32 s80, 0x80000
    s_cbranch_scc1 L_spin58
L_ok58:
    ds_read_b32 v28, v7
    s_add_u32 m0, s78, 98304
    s_lshl_b32 s85, s84, 4
    v_readlane_b32 s86, v5, 29
    s_waitcnt vmcnt(13)
    buffer_load_dwordx4 v3, s[32:35], s85 offen lds
    buffer_load_dwordx4 v4, s[32:35], s85 offen offset:1024 lds
    s_waitcnt vmcnt(13)
    buffer_load_dwordx4 v2, s[44:47], s84 offen offset:2048 sc1 lds
    buffer_load_dwordx4 v2, s[44:47], s84 offen offset:3072 sc1 lds
    s_add_u32 m0, s78, 102400
    s_add_u32 s84, s84, 2048
    s_add_u32 s85, s85, 16384
    s_waitcnt vmcnt(12)
    buffer_load_dwordx4 v3, s[32:35], s85 offen lds
    buffer_load_dwordx4 v4, s[32:35], s85 offen offset:1024 lds
    s_waitcnt vmcnt(12)
    buffer_load_dwordx4 v2, s[44:47], s84 offen offset:2048 sc1 lds
    buffer_load_dwordx4 v2, s[44:47], s84 offen offset:3072 sc1 lds
    s_mov_b32 m0, s48
    v_mov_b32 v12, 116
    global_load_lds_dword v12, s[88:89]
    s_waitcnt lgkmcnt(0)
    v_cmp_ge_u32 vcc, 21, v28
    s_cbranch_vccz L_fr59
    s_movk_i32 s81, 22
    s_call_b64 s[82:83], L_spin_d
L_fr59:
    s_add_u32 m0, s78, 131072
    s_lshl_b32 s87, s86, 4
    v_readlane_b32 s84, v5, 30
    s_waitcnt vmcnt(13)
    buffer_load_dwordx4 v3, s[32:35], s87 offen lds
    buffer_load_dwordx4 v4, s[32:35], s87 offen offset:1024 lds
    s_waitcnt vmcnt(13)
    buffer_load_dwordx4 v2, s[44:47], s86 offen offset:2048 sc1 lds
    buffer_load_dwordx4 v2, s[44:47], s86 offen offset:3072 sc1 lds
    s_add_u32 m0, s78, 135168
    s_add_u32 s86, s86, 2048
    s_add_u32 s87, s87, 16384
    s_waitcnt vmcnt(12)
    buffer_load_dwordx4 v3, s[32:35], s87 offen lds
    buffer_load_dwordx4 v4, s[32:35], s87 offen offset:1024 lds
    s_waitcnt vmcnt(12)
    buffer_load_dwordx4 v2, s[44:47], s86 offen offset:2048 sc1 lds
    buffer_load_dwordx4 v2, s[44:47], s86 offen offset:3072 sc1 lds
    s_mov_b32 m0, s48
    v_mov_b32 v12, 120
    global_load_lds_dword v12, s[88:89]
    ds_read_b32 v28, v7
    s_add_u32 m0, s78, 147456
    s_lshl_b32 s85, s84, 4
    v_readlane_b32 s86, v5, 31
    s_waitcnt vmcnt(13)
    buffer_load_dwordx4 v3, s[32:35], s85 offen lds
    buffer_load_dwordx4 v4, s[32:35], s85 offen offset:1024 lds
    s_waitcnt vmcnt(13)
    buffer_load_dwordx4 v2, s[44:47], s84 offen offset:2048 sc1 lds
    buffer_load_dwordx4 v2, s[44:47], s84 offen offset:3072 sc1 lds
    s_add_u32 m0, s78, 151552
    s_add_u32 s84, s84, 2048
    s_add_u32 s85, s85, 16384
    s_waitcnt vmcnt(12)
    buffer_load_dwordx4 v3, s[32:35], s85 offen lds
    buffer_load_dwordx4 v4, s[32:35], s85 offen offset:1024 lds
    s_waitcnt vmcnt(12)
    buffer_load_dwordx4 v2, s[44:47], s84 offen offset:2048 sc1 lds
    buffer_load_dwordx4 v2, s[44:47], s84 offen offset:3072 sc1 lds
    s_mov_b32 m0, s48
    v_mov_b32 v12, 124
    global_load_lds_dword v12, s[88:89]
    s_waitcnt lgkmcnt(0)
    v_cmp_ge_u32 vcc, 23, v28
    s_cbranch_vccz L_fr60
    s_movk_i32 s81, 24
    s_call_b64 s[82:83], L_spin_d
L_fr60:
    s_add_u32 m0, s78, 114688
    s_lshl_b32 s87, s86, 4
    v_readlane_b32 s84, v5, 32
    s_waitcnt vmcnt(13)
    buffer_load_dwordx4 v3, s[32:35], s87 offen lds
    buffer_load_dwordx4 v4, s[32:35], s87 offen offset:1024 lds
    s_waitcnt vmcnt(13)
    buffer_load_dwordx4 v2, s[44:47], s86 offen offset:2048 sc1 lds
    buffer_load_dwordx4 v2, s[44:47], s86 offen offset:3072 sc1 lds
    s_add_u32 m0, s78, 118784
    s_add_u32 s86, s86, 2048
    s_add_u32 s87, s87, 16384
    s_waitcnt vmcnt(12)
    buffer_load_dwordx4 v3, s[32:35], s87 offen lds
    buffer_load_dwordx4 v4, s[32:35], s87 offen offset:1024 lds
    s_waitcnt vmcnt(12)
    buffer_load_dwordx4 v2, s[44:47], s86 offen offset:2048 sc1 lds
    buffer_load_dwordx4 v2, s[44:47], s86 offen offset:3072 sc1 lds
    s_mov_b32 m0, s48
    v_mov_b32 v12, 128
    global_load_lds_dword v12, s[88:89]
    ds_read_b32 v28, v7
    s_add_u32 m0, s78, 0
    s_lshl_b32 s85, s84, 4
    v_readlane_b32 s86, v5, 33
    s_waitcnt vmcnt(13)
    buffer_load_dwordx4 v3, s[32:35], s85 offen lds
    buffer_load_dwordx4 v4, s[32:35], s85 offen offset:1024 lds
    s_waitcnt vmcnt(13)
    buffer_load_dwordx4 v2, s[44:47], s84 offen offset:2048 sc1 lds
    buffer_load_dwordx4 v2, s[44:47], s84 offen offset:3072 sc1 lds
    s_add_u32 m0, s78, 4096
    s_add_u32 s84, s84, 2048
    s_add_u32 s85, s85, 16384
    s_waitcnt vmcnt(12)
    buffer_load_dwordx4 v3, s[32:35], s85 offen lds
    buffer_load_dwordx4 v4, s[32:35], s85 offen offset:1024 lds
    s_waitcnt vmcnt(12)
    buffer_load_dwordx4 v2, s[44:47], s84 offen offset:2048 sc1 lds
    buffer_load_dwordx4 v2, s[44:47], s84 offen offset:3072 sc1 lds
    s_mov_b32 m0, s48
    v_mov_b32 v12, 132
    global_load_lds_dword v12, s[88:89]
    s_waitcnt lgkmcnt(0)
    v_cmp_ge_u32 vcc, 25, v28
    s_cbranch_vccz L_fr61
    s_movk_i32 s81, 26
    s_call_b64 s[82:83], L_spin_d
L_fr61:
    ds_read_b32 v28, v7
    s_add_u32 m0, s78, 32768
    s_lshl_b32 s87, s86, 4
    v_readlane_b32 s84, v5, 34
    s_waitcnt vmcnt(13)
    buffer_load_dwordx4 v3, s[32:35], s87 offen lds
    buffer_load_dwordx4 v4, s[32:35], s87 offen offset:1024 lds
    s_waitcnt vmcnt(13)
    buffer_load_dwordx4 v2, s[44:47], s86 offen offset:2048 sc1 lds
    buffer_load_dwordx4 v2, s[44:47], s86 offen offset:3072 sc1 lds
    s_add_u32 m0, s78, 36864
    s_add_u32 s86, s86, 2048
    s_add_u32 s87, s87, 16384
    s_waitcnt vmcnt(12)
    buffer_load_dwordx4 v3, s[32:35], s87 offen lds
    buffer_load_dwordx4 v4, s[32:35], s87 offen offset:1024 lds
    s_waitcnt vmcnt(12)
    buffer_load_dwordx4 v2, s[44:47], s86 offen offset:2048 sc1 lds
    buffer_load_dwordx4 v2, s[44:47], s86 offen offset:3072 sc1 lds
    s_mov_b32 m0, s48
    v_mov_b32 v12, 136
    global_load_lds_dword v12, s[88:89]
    s_waitcnt lgkmcnt(0)
    v_cmp_ge_u32 vcc, 27, v28
    s_cbranch_vccz L_fr62
    s_movk_i32 s81, 28
    s_call_b64 s[82:83], L_spin_d
L_fr62:
    s_load_dword s55, s[44:45], s54 offset:256 glc
    s_add_u32 m0, s78, 49152
    s_lshl_b32 s85, s84, 4
    v_readlane_b32 s86, v5, 35
    s_waitcnt vmcnt(13)
    buffer_load_dwordx4 v3, s[32:35], s85 offen lds
    buffer_load_dwordx4 v4, s[32:35], s85 offen offset:1024 lds
    s_waitcnt vmcnt(13)
    buffer_load_dwordx4 v2, s[44:47], s84 offen offset:2048 sc1 lds
    buffer_load_dwordx4 v2, s[44:47], s84 offen offset:3072 sc1 lds
    s_add_u32 m0, s78, 53248
    s_add_u32 s84, s84, 2048
    s_add_u32 s85, s85, 16384
    s_waitcnt vmcnt(12)
    buffer_load_dwordx4 v3, s[32:35], s85 offen lds
    buffer_load_dwordx4 v4, s[32:35], s85 offen offset:1024 lds
    s_waitcnt vmcnt(12)
    buffer_load_dwordx4 v2, s[44:47], s84 offen offset:2048 sc1 lds
    buffer_load_dwordx4 v2, s[44:47], s84 offen offset:3072 sc1 lds
    s_mov_b32 m0, s48
    v_mov_b32 v12, 140
    global_load_lds_dword v12, s[88:89]
    s_add_u32 m0, s78, 65536
    s_lshl_b32 s87, s86, 4
    v_readlane_b32 s84, v5, 36
    s_waitcnt vmcnt(13)
    buffer_load_dwordx4 v3, s[32:35], s87 offen lds
    buffer_load_dwordx4 v4, s[32:35], s87 offen offset:1024 lds
    s_waitcnt vmcnt(13)
    buffer_load_dwordx4 v2, s[44:47], s86 offen offset:2048 sc1 lds
    buffer_load_dwordx4 v2, s[44:47], s86 offen offset:3072 sc1 lds
    s_add_u32 m0, s78, 69632
    s_add_u32 s86, s86, 2048
    s_add_u32 s87, s87, 16384
    s_waitcnt vmcnt(12)
    buffer_load_dwordx4 v3, s[32:35], s87 offen lds
    buffer_load_dwordx4 v4, s[32:35], s87 offen offset:1024 lds
    s_waitcnt vmcnt(12)
    buffer_load_dwordx4 v2, s[44:47], s86 offen offset:2048 sc1 lds
    buffer_load_dwordx4 v2, s[44:47], s86 offen offset:3072 sc1 lds
    s_mov_b32 m0, s48
    v_mov_b32 v12, 144
    global_load_lds_dword v12, s[88:89]
    s_waitcnt lgkmcnt(0)
    s_cmp_eq_u32 s55, 32
    s_cbranch_scc1 L_ok63
    s_mov_b32 s80, 0
L_spin63:
    s_sleep 4
    s_load_dword s55, s[44:45], s54 offset:256 glc
    s_add_u32 s80, s80, 1
    s_waitcnt lgkmcnt(0)
    s_cmp_eq_u32 s55, 32
    s_cbranch_scc1 L_ok63
    s_cmp_lt_u32 s80, 0x80000
    s_cbranch_scc1 L_spin63
L_ok63:
    ds_read_b32 v28, v7
    s_add_u32 m0, s78, 81920
    s_lshl_b32 s85, s84, 4
    v_readlane_b32 s86, v5, 37
    s_waitcnt vmcnt(13)
    buffer_load_dwordx4 v3, s[32:35], s85 offen lds
    buffer_load_dwordx4 v4, s[32:35], s85 offen offset:1024 lds
    s_waitcnt vmcnt(13)
    buffer_load_dwordx4 v2, s[44:47], s84 offen offset:2048 sc1 lds
    buffer_load_dwordx4 v2, s[44:47], s84 offen offset:3072 sc1 lds
    s_add_u32 m0, s78, 86016
    s_add_u32 s84, s84, 2048
    s_add_u32 s85, s85, 16384
    s_waitcnt vmcnt(12)
    buffer_load_dwordx4 v3, s[32:35], s85 offen lds
    buffer_load_dwordx4 v4, s[32:35], s85 offen offset:1024 lds
    s_waitcnt vmcnt(12)
    buffer_load_dwordx4 v2, s[44:47], s84 offen offset:2048 sc1 lds
    buffer_load_dwordx4 v2, s[44:47], s84 offen offset:3072 sc1 lds
    s_mov_b32 m0, s48
    v_mov_b32 v12, 148
    global_load_lds_dword v12, s[88:89]
    s_waitcnt lgkmcnt(0)
    v_cmp_ge_u32 vcc, 29, v28
    s_cbranch_vccz L_fr64
    s_movk_i32 s81, 30
    s_call_b64 s[82:83], L_spin_d
L_fr64:
    s_add_u32 m0, s78, 98304
    s_lshl_b32 s87, s86, 4
    v_readlane_b32 s84, v5, 38
    s_waitcnt vmcnt(13)
    buffer_load_dwordx4 v3, s[32:35], s87 offen lds
    buffer_load_dwordx4 v4, s[32:35], s87 offen offset:1024 lds
    s_waitcnt vmcnt(13)
    buffer_load_dwordx4 v2, s[44:47], s86 offen offset:2048 sc1 lds
    buffer_load_dwordx4 v2, s[44:47], s86 offen offset:3072 sc1 lds
    s_add_u32 m0, s78, 102400
    s_add_u32 s86, s86, 2048
    s_add_u32 s87, s87, 16384
    s_waitcnt vmcnt(12)
    buffer_load_dwordx4 v3, s[32:35], s87 offen lds
    buffer_load_dwordx4 v4, s[32:35], s87 offen offset:1024 lds
    s_waitcnt vmcnt(12)
    buffer_load_dwordx4 v2, s[44:47], s86 offen offset:2048 sc1 lds
    buffer_load_dwordx4 v2, s[44:47], s86 offen offset:3072 sc1 lds
    s_mov_b32 m0, s48
    v_mov_b32 v12, 152
    global_load_lds_dword v12, s[88:89]
    ds_read_b32 v28, v7
    s_add_u32 m0, s78, 131072
    s_lshl_b32 s85, s84, 4
    v_readlane_b32 s86, v5, 39
    s_waitcnt vmcnt(13)
    buffer_load_dwordx4 v3, s[32:35], s85 offen lds
    buffer_load_dwordx4 v4, s[32:35], s85 offen offset:1024 lds
    s_waitcnt vmcnt(13)
    buffer_load_dwordx4 v2, s[44:47], s84 offen offset:2048 sc1 lds
    buffer_load_dwordx4 v2, s[44:47], s84 offen offset:3072 sc1 lds
    s_add_u32 m0, s78, 135168
    s_add_u32 s84, s84, 2048
    s_add_u32 s85, s85, 16384
    s_waitcnt vmcnt(12)
    buffer_load_dwordx4 v3, s[32:35], s85 offen lds
    buffer_load_dwordx4 v4, s[32:35], s85 offen offset:1024 lds
    s_waitcnt vmcnt(12)
    buffer_load_dwordx4 v2, s[44:47], s84 offen offset:2048 sc1 lds
    buffer_load_dwordx4 v2, s[44:47], s84 offen offset:3072 sc1 lds
    s_mov_b32 m0, s48
    v_mov_b32 v12, 156
    global_load_lds_dword v12, s[88:89]
    s_waitcnt lgkmcnt(0)
    v_cmp_ge_u32 vcc, 31, v28
    s_cbranch_vccz L_fr65
    s_movk_i32 s81, 32
    s_call_b64 s[82:83], L_spin_d
L_fr65:
    s_add_u32 m0, s78, 147456
    s_lshl_b32 s87, s86, 4
    v_readlane_b32 s84, v5, 40
    s_waitcnt vmcnt(13)
    buffer_load_dwordx4 v3, s[32:35], s87 offen lds
    buffer_load_dwordx4 v4, s[32:35], s87 offen offset:1024 lds
    s_waitcnt vmcnt(13)
    buffer_load_dwordx4 v2, s[44:47], s86 offen offset:2048 sc1 lds
    buffer_load_dwordx4 v2, s[44:47], s86 offen offset:3072 sc1 lds
    s_add_u32 m0, s78, 151552
    s_add_u32 s86, s86, 2048
    s_add_u32 s87, s87, 16384
    s_waitcnt vmcnt(12)
    buffer_load_dwordx4 v3, s[32:35], s87 offen lds
    buffer_load_dwordx4 v4, s[32:35], s87 offen offset:1024 lds
    s_waitcnt vmcnt(12)
    buffer_load_dwordx4 v2, s[44:47], s86 offen offset:2048 sc1 lds
    buffer_load_dwordx4 v2, s[44:47], s86 offen offset:3072 sc1 lds
    s_mov_b32 m0, s48
    v_mov_b32 v12, 160
    global_load_lds_dword v12, s[88:89]
    ds_read_b32 v28, v7
    s_add_u32 m0, s78, 114688
    s_lshl_b32 s85, s84, 4
    v_readlane_b32 s86, v5, 41
    s_waitcnt vmcnt(13)
    buffer_load_dwordx4 v3, s[32:35], s85 offen lds
    buffer_load_dwordx4 v4, s[32:35], s85 offen offset:1024 lds
    s_waitcnt vmcnt(13)
    buffer_load_dwordx4 v2, s[44:47], s84 offen offset:2048 sc1 lds
    buffer_load_dwordx4 v2, s[44:47], s84 offen offset:3072 sc1 lds
    s_add_u32 m0, s78, 118784
    s_add_u32 s84, s84, 2048
    s_add_u32 s85, s85, 16384
    s_waitcnt vmcnt(12)
    buffer_load_dwordx4 v3, s[32:35], s85 offen lds
    buffer_load_dwordx4 v4, s[32:35], s85 offen offset:1024 lds
    s_waitcnt vmcnt(12)
    buffer_load_dwordx4 v2, s[44:47], s84 offen offset:2048 sc1 lds
    buffer_load_dwordx4 v2, s[44:47], s84 offen offset:3072 sc1 lds
    s_mov_b32 m0, s48
    v_mov_b32 v12, 164
    global_load_lds_dword v12, s[88:89]
    s_waitcnt lgkmcnt(0)
    v_cmp_ge_u32 vcc, 33, v28
    s_cbranch_vccz L_fr66
    s_movk_i32 s81, 34
    s_call_b64 s[82:83], L_spin_d
L_fr66:
    s_add_u32 m0, s78, 0
    s_lshl_b32 s87, s86, 4
    v_readlane_b32 s84, v5, 42
    s_waitcnt vmcnt(13)
    buffer_load_dwordx4 v3, s[32:35], s87 offen lds
    buffer_load_dwordx4 v4, s[32:35], s87 offen offset:1024 lds
    s_waitcnt vmcnt(13)
    buffer_load_dwordx4 v2, s[44:47], s86 offen offset:2048 sc1 lds
    buffer_load_dwordx4 v2, s[44:47], s86 offen offset:3072 sc1 lds
    s_add_u32 m0, s78, 4096
    s_add_u32 s86, s86, 2048
    s_add_u32 s87, s87, 16384
    s_waitcnt vmcnt(12)
    buffer_load_dwordx4 v3, s[32:35], s87 offen lds
    buffer_load_dwordx4 v4, s[32:35], s87 offen offset:1024 lds
    s_waitcnt vmcnt(12)
    buffer_load_dwordx4 v2, s[44:47], s86 offen offset:2048 sc1 lds
    buffer_load_dwordx4 v2, s[44:47], s86 offen offset:3072 sc1 lds
    s_mov_b32 m0, s48
    v_mov_b32 v12, 168
    global_load_lds_dword v12, s[88:89]
    ds_read_b32 v28, v7
    s_add_u32 m0, s78, 32768
    s_lshl_b32 s85, s84, 4
    v_readlane_b32 s86, v5, 43
    s_waitcnt vmcnt(13)
    buffer_load_dwordx4 v3, s[32:35], s85 offen lds
    buffer_load_dwordx4 v4, s[32:35], s85 offen offset:1024 lds
    s_waitcnt vmcnt(13)
    buffer_load_dwordx4 v2, s[44:47], s84 offen offset:2048 sc1 lds
    buffer_load_dwordx4 v2, s[44:47], s84 offen offset:3072 sc1 lds
    s_add_u32 m0, s78, 36864
    s_add_u32 s84, s84, 2048
    s_add_u32 s85, s85, 16384
    s_waitcnt vmcnt(12)
    buffer_load_dwordx4 v3, s[32:35], s85 offen lds
    buffer_load_dwordx4 v4, s[32:35], s85 offen offset:1024 lds
    s_waitcnt vmcnt(12)
    buffer_load_dwordx4 v2, s[44:47], s84 offen offset:2048 sc1 lds
    buffer_load_dwordx4 v2, s[44:47], s84 offen offset:3072 sc1 lds
    s_mov_b32 m0, s48
    v_mov_b32 v12, 172
    global_load_lds_dword v12, s[88:89]
    s_waitcnt lgkmcnt(0)
    v_cmp_ge_u32 vcc, 35, v28
    s_cbranch_vccz L_fr67
    s_movk_i32 s81, 36
    s_call_b64 s[82:83], L_spin_d
L_fr67:
    s_add_u32 m0, s78, 49152
    s_lshl_b32 s87, s86, 4
    v_readlane_b32 s84, v5, 44
    s_waitcnt vmcnt(13)
    buffer_load_dwordx4 v3, s[32:35], s87 offen lds
    buffer_load_dwordx4 v4, s[32:35], s87 offen offset:1024 lds
    s_waitcnt vmcnt(13)
    buffer_load_dwordx4 v2, s[44:47], s86 offen offset:2048 sc1 lds
    buffer_load_dwordx4 v2, s[44:47], s86 offen offset:3072 sc1 lds
    s_add_u32 m0, s78, 53248
    s_add_u32 s86, s86, 2048
    s_add_u32 s87, s87, 16384
    s_waitcnt vmcnt(12)
    buffer_load_dwordx4 v3, s[32:35], s87 offen lds
    buffer_load_dwordx4 v4, s[32:35], s87 offen offset:1024 lds
    s_waitcnt vmcnt(12)
    buffer_load_dwordx4 v2, s[44:47], s86 offen offset:2048 sc1 lds
    buffer_load_dwordx4 v2, s[44:47], s86 offen offset:3072 sc1 lds
    s_mov_b32 m0, s48
    v_mov_b32 v12, 176
    global_load_lds_dword v12, s[88:89]
    ds_read_b32 v28, v7
    s_add_u32 m0, s78, 65536
    s_lshl_b32 s85, s84, 4
    v_readlane_b32 s86, v5, 45
    s_waitcnt vmcnt(13)
    buffer_load_dwordx4 v3, s[32:35], s85 offen lds
    buffer_load_dwordx4 v4, s[32:35], s85 offen offset:1024 lds
    s_waitcnt vmcnt(13)
    buffer_load_dwordx4 v2, s[44:47], s84 offen offset:2048 sc1 lds
    buffer_load_dwordx4 v2, s[44:47], s84 offen offset:3072 sc1 lds
    s_add_u32 m0, s78, 69632
    s_add_u32 s84, s84, 2048
    s_add_u32 s85, s85, 16384
    s_waitcnt vmcnt(12)
    buffer_load_dwordx4 v3, s[32:35], s85 offen lds
    buffer_load_dwordx4 v4, s[32:35], s85 offen offset:1024 lds
    s_waitcnt vmcnt(12)
    buffer_load_dwordx4 v2, s[44:47], s84 offen offset:2048 sc1 lds
    buffer_load_dwordx4 v2, s[44:47], s84 offen offset:3072 sc1 lds
    s_mov_b32 m0, s48
    v_mov_b32 v12, 180
    global_load_lds_dword v12, s[88:89]
    s_waitcnt lgkmcnt(0)
    v_cmp_ge_u32 vcc, 37, v28
    s_cbranch_vccz L_fr68
    s_movk_i32 s81, 38
    s_call_b64 s[82:83], L_spin_d
L_fr68:
    ds_read_b32 v28, v7
    s_add_u32 m0, s78, 81920
    s_lshl_b32 s87, s86, 4
    v_readlane_b32 s84, v5, 46
    s_waitcnt vmcnt(13)
    buffer_load_dwordx4 v3, s[32:35], s87 offen lds
    buffer_load_dwordx4 v4, s[32:35], s87 offen offset:1024 lds
    s_waitcnt vmcnt(13)
    buffer_load_dwordx4 v2, s[44:47], s86 offen offset:2048 sc1 lds
    buffer_load_dwordx4 v2, s[44:47], s86 offen offset:3072 sc1 lds
    s_add_u32 m0, s78, 86016
    s_add_u32 s86, s86, 2048
    s_add_u32 s87, s87, 16384
    s_waitcnt vmcnt(12)
    buffer_load_dwordx4 v3, s[32:35], s87 offen lds
    buffer_load_dwordx4 v4, s[32:35], s87 offen offset:1024 lds
    s_waitcnt vmcnt(12)
    buffer_load_dwordx4 v2, s[44:47], s86 offen offset:2048 sc1 lds
    buffer_load_dwordx4 v2, s[44:47], s86 offen offset:3072 sc1 lds
    s_mov_b32 m0, s48
    v_mov_b32 v12, 184
    global_load_lds_dword v12, s[88:89]
    s_waitcnt lgkmcnt(0)
    v_cmp_ge_u32 vcc, 39, v28
    s_cbranch_vccz L_fr69
    s_movk_i32 s81, 40
    s_call_b64 s[82:83], L_spin_d
L_fr69:
    s_load_dword s55, s[44:45], s54 offset:384 glc
    s_add_u32 m0, s78, 98304
    s_lshl_b32 s85, s84, 4
    v_readlane_b32 s86, v5, 47
    s_waitcnt vmcnt(13)
    buffer_load_dwordx4 v3, s[32:35], s85 offen lds
    buffer_load_dwordx4 v4, s[32:35], s85 offen offset:1024 lds
    s_waitcnt vmcnt(13)
    buffer_load_dwordx4 v2, s[44:47], s84 offen offset:2048 sc1 lds
    buffer_load_dwordx4 v2, s[44:47], s84 offen offset:3072 sc1 lds
    s_add_u32 m0, s78, 102400
    s_add_u32 s84, s84, 2048
    s_add_u32 s85, s85, 16384
    s_waitcnt vmcnt(12)
    buffer_load_dwordx4 v3, s[32:35], s85 offen lds
    buffer_load_dwordx4 v4, s[32:35], s85 offen offset:1024 lds
    s_waitcnt vmcnt(12)
    buffer_load_dwordx4 v2, s[44:47], s84 offen offset:2048 sc1 lds
    buffer_load_dwordx4 v2, s[44:47], s84 offen offset:3072 sc1 lds
    s_mov_b32 m0, s48
    v_mov_b32 v12, 188
    global_load_lds_dword v12, s[88:89]
    s_add_u32 m0, s78, 131072
    s_lshl_b32 s87, s86, 4
    v_readlane_b32 s84, v5, 48
    s_waitcnt vmcnt(13)
    buffer_load_dwordx4 v3, s[32:35], s87 offen lds
    buffer_load_dwordx4 v4, s[32:35], s87 offen offset:1024 lds
    s_waitcnt vmcnt(13)
    buffer_load_dwordx4 v2, s[44:47], s86 offen offset:2048 sc1 lds
    buffer_load_dwordx4 v2, s[44:47], s86 offen offset:3072 sc1 lds
    s_add_u32 m0, s78, 135168
    s_add_u32 s86, s86, 2048
    s_add_u32 s87, s87, 16384
    s_waitcnt vmcnt(12)
    buffer_load_dwordx4 v3, s[32:35], s87 offen lds
    buffer_load_dwordx4 v4, s[32:35], s87 offen offset:1024 lds
    s_waitcnt vmcnt(12)
    buffer_load_dwordx4 v2, s[44:47], s86 offen offset:2048 sc1 lds
    buffer_load_dwordx4 v2, s[44:47], s86 offen offset:3072 sc1 lds
    s_mov_b32 m0, s48
    v_mov_b32 v12, 192
    global_load_lds_dword v12, s[88:89]
    s_waitcnt lgkmcnt(0)
    s_cmp_eq_u32 s55, 16
    s_cbranch_scc1 L_ok70
    s_mov_b32 s80, 0
L_spin70:
    s_sleep 4
    s_load_dword s55, s[44:45], s54 offset:384 glc
    s_add_u32 s80, s80, 1
    s_waitcnt lgkmcnt(0)
    s_cmp_eq_u32 s55, 16
    s_cbranch_scc1 L_ok70
    s_cmp_lt_u32 s80, 0x80000
    s_cbranch_scc1 L_spin70
L_ok70:
    ds_read_b32 v28, v7
    s_add_u32 m0, s78, 147456
    s_lshl_b32 s85, s84, 4
    v_readlane_b32 s86, v5, 49
    v_add_u32 v2, 114688, v2
    s_waitcnt vmcnt(13)
    buffer_load_dwordx4 v3, s[20:23], s85 offen lds
    buffer_load_dwordx4 v4, s[20:23], s85 offen offset:1024 lds
    s_waitcnt vmcnt(13)
    buffer_load_dwordx4 v2, s[44:47], s84 offen offset:2048 sc1 lds
    buffer_load_dwordx4 v2, s[44:47], s84 offen offset:3072 sc1 lds
    s_add_u32 m0, s78, 151552
    s_add_u32 s84, s84, 2048
    s_add_u32 s85, s85, 16384
    s_waitcnt vmcnt(12)
    buffer_load_dwordx4 v3, s[20:23], s85 offen lds
    buffer_load_dwordx4 v4, s[20:23], s85 offen offset:1024 lds
    s_waitcnt vmcnt(12)
    buffer_load_dwordx4 v2, s[44:47], s84 offen offset:2048 sc1 lds
    buffer_load_dwordx4 v2, s[44:47], s84 offen offset:3072 sc1 lds
    s_mov_b32 m0, s48
    v_mov_b32 v12, 196
    global_load_lds_dword v12, s[88:89]
    s_waitcnt lgkmcnt(0)
    v_cmp_ge_u32 vcc, 41, v28
    s_cbranch_vccz L_fr71
    s_movk_i32 s81, 42
    s_call_b64 s[82:83], L_spin_d
L_fr71:
    s_add_u32 m0, s78, 114688
    s_lshl_b32 s87, s86, 4
    v_readlane_b32 s84, v5, 50
    s_waitcnt vmcnt(13)
    buffer_load_dwordx4 v3, s[20:23], s87 offen lds
    buffer_load_dwordx4 v4, s[20:23], s87 offen offset:1024 lds
    s_waitcnt vmcnt(13)
    buffer_load_dwordx4 v2, s[44:47], s86 offen offset:2048 sc1 lds
    buffer_load_dwordx4 v2, s[44:47], s86 offen offset:3072 sc1 lds
    s_add_u32 m0, s78, 118784
    s_add_u32 s86, s86, 2048
    s_add_u32 s87, s87, 16384
    s_waitcnt vmcnt(12)
    buffer_load_dwordx4 v3, s[20:23], s87 offen lds
    buffer_load_dwordx4 v4, s[20:23], s87 offen offset:1024 lds
    s_waitcnt vmcnt(12)
    buffer_load_dwordx4 v2, s[44:47], s86 offen offset:2048 sc1 lds
    buffer_load_dwordx4 v2, s[44:47], s86 offen offset:3072 sc1 lds
    s_mov_b32 m0, s48
    v_mov_b32 v12, 200
    global_load_lds_dword v12, s[88:89]
    ds_read_b32 v28, v7
    s_add_u32 m0, s78, 0
    s_lshl_b32 s85, s84, 4
    v_readlane_b32 s86, v5, 51
    s_waitcnt vmcnt(13)
    buffer_load_dwordx4 v3, s[20:23], s85 offen lds
    buffer_load_dwordx4 v4, s[20:23], s85 offen offset:1024 lds
    s_waitcnt vmcnt(13)
    buffer_load_dwordx4 v2, s[44:47], s84 offen offset:2048 sc1 lds
    buffer_load_dwordx4 v2, s[44:47], s84 offen offset:3072 sc1 lds
    s_add_u32 m0, s78, 4096
    s_add_u32 s84, s84, 2048
    s_add_u32 s85, s85, 16384
    s_waitcnt vmcnt(12)
    buffer_load_dwordx4 v3, s[20:23], s85 offen lds
    buffer_load_dwordx4 v4, s[20:23], s85 offen offset:1024 lds
    s_waitcnt vmcnt(12)
    buffer_load_dwordx4 v2, s[44:47], s84 offen offset:2048 sc1 lds
    buffer_load_dwordx4 v2, s[44:47], s84 offen offset:3072 sc1 lds
    s_mov_b32 m0, s48
    v_mov_b32 v12, 204
    global_load_lds_dword v12, s[88:89]
    s_waitcnt lgkmcnt(0)
    v_cmp_ge_u32 vcc, 43, v28
    s_cbranch_vccz L_fr72
    s_movk_i32 s81, 44
    s_call_b64 s[82:83], L_spin_d
L_fr72:
    s_add_u32 m0, s78, 32768
    s_lshl_b32 s87, s86, 4
    v_readlane_b32 s84, v5, 52
    s_waitcnt vmcnt(13)
    buffer_load_dwordx4 v3, s[20:23], s87 offen lds
    buffer_load_dwordx4 v4, s[20:23], s87 offen offset:1024 lds
    s_waitcnt vmcnt(13)
    buffer_load_dwordx4 v2, s[44:47], s86 offen offset:2048 sc1 lds
    buffer_load_dwordx4 v2, s[44:47], s86 offen offset:3072 sc1 lds
    s_add_u32 m0, s78, 36864
    s_add_u32 s86, s86, 2048
    s_add_u32 s87, s87, 16384
    s_waitcnt vmcnt(12)
    buffer_load_dwordx4 v3, s[20:23], s87 offen lds
    buffer_load_dwordx4 v4, s[20:23], s87 offen offset:1024 lds
    s_waitcnt vmcnt(12)
    buffer_load_dwordx4 v2, s[44:47], s86 offen offset:2048 sc1 lds
    buffer_load_dwordx4 v2, s[44:47], s86 offen offset:3072 sc1 lds
    s_mov_b32 m0, s48
    v_mov_b32 v12, 208
    global_load_lds_dword v12, s[88:89]
    ds_read_b32 v28, v7
    s_add_u32 m0, s78, 49152
    s_lshl_b32 s85, s84, 4
    v_readlane_b32 s86, v5, 53
    s_waitcnt vmcnt(13)
    buffer_load_dwordx4 v3, s[20:23], s85 offen lds
    buffer_load_dwordx4 v4, s[20:23], s85 offen offset:1024 lds
    s_waitcnt vmcnt(13)
    buffer_load_dwordx4 v2, s[44:47], s84 offen offset:2048 sc1 lds
    buffer_load_dwordx4 v2, s[44:47], s84 offen offset:3072 sc1 lds
    s_add_u32 m0, s78, 53248
    s_add_u32 s84, s84, 2048
    s_add_u32 s85, s85, 16384
    s_waitcnt vmcnt(12)
    buffer_load_dwordx4 v3, s[20:23], s85 offen lds
    buffer_load_dwordx4 v4, s[20:23], s85 offen offset:1024 lds
    s_waitcnt vmcnt(12)
    buffer_load_dwordx4 v2, s[44:47], s84 offen offset:2048 sc1 lds
    buffer_load_dwordx4 v2, s[44:47], s84 offen offset:3072 sc1 lds
    s_mov_b32 m0, s48
    v_mov_b32 v12, 212
    global_load_lds_dword v12, s[88:89]
    s_waitcnt lgkmcnt(0)
    v_cmp_ge_u32 vcc, 45, v28
    s_cbranch_vccz L_fr73
    s_movk_i32 s81, 46
    s_call_b64 s[82:83], L_spin_d
L_fr73:
    s_add_u32 m0, s78, 65536
    s_lshl_b32 s87, s86, 4
    v_readlane_b32 s84, v5, 54
    s_waitcnt vmcnt(13)
    buffer_load_dwordx4 v3, s[20:23], s87 offen lds
    buffer_load_dwordx4 v4, s[20:23], s87 offen offset:1024 lds
    s_waitcnt vmcnt(13)
    buffer_load_dwordx4 v2, s[44:47], s86 offen offset:2048 sc1 lds
    buffer_load_dwordx4 v2, s[44:47], s86 offen offset:3072 sc1 lds
    s_add_u32 m0, s78, 69632
    s_add_u32 s86, s86, 2048
    s_add_u32 s87, s87, 16384
    s_waitcnt vmcnt(12)
    buffer_load_dwordx4 v3, s[20:23], s87 offen lds
    buffer_load_dwordx4 v4, s[20:23], s87 offen offset:1024 lds
    s_waitcnt vmcnt(12)
    buffer_load_dwordx4 v2, s[44:47], s86 offen offset:2048 sc1 lds
    buffer_load_dwordx4 v2, s[44:47], s86 offen offset:3072 sc1 lds
    s_mov_b32 m0, s48
    v_mov_b32 v12, 216
    global_load_lds_dword v12, s[88:89]
    ds_read_b32 v28, v7
    s_add_u32 m0, s78, 81920
    s_lshl_b32 s85, s84, 4
    v_readlane_b32 s86, v5, 55
    s_waitcnt vmcnt(13)
    buffer_load_dwordx4 v3, s[20:23], s85 offen lds
    buffer_load_dwordx4 v4, s[20:23], s85 offen offset:1024 lds
    s_waitcnt vmcnt(13)
    buffer_load_dwordx4 v2, s[44:47], s84 offen offset:2048 sc1 lds
    buffer_load_dwordx4 v2, s[44:47], s84 offen offset:3072 sc1 lds
    s_add_u32 m0, s78, 86016
    s_add_u32 s84, s84, 2048
    s_add_u32 s85, s85, 16384
    s_waitcnt vmcnt(12)
    buffer_load_dwordx4 v3, s[20:23], s85 offen lds
    buffer_load_dwordx4 v4, s[20:23], s85 offen offset:1024 lds
    s_waitcnt vmcnt(12)
    buffer_load_dwordx4 v2, s[44:47], s84 offen offset:2048 sc1 lds
    buffer_load_dwordx4 v2, s[44:47], s84 offen offset:3072 sc1 lds
    s_mov_b32 m0, s48
    v_mov_b32 v12, 220
    global_load_lds_dword v12, s[88:89]
    s_waitcnt lgkmcnt(0)
    v_cmp_ge_u32 vcc, 47, v28
    s_cbranch_vccz L_fr74
    s_movk_i32 s81, 48
    s_call_b64 s[82:83], L_spin_d
L_fr74:
    s_add_u32 m0, s78, 98304
    s_lshl_b32 s87, s86, 4
    s_waitcnt vmcnt(13)
    buffer_load_dwordx4 v3, s[20:23], s87 offen lds
    buffer_load_dwordx4 v4, s[20:23], s87 offen offset:1024 lds
    s_waitcnt vmcnt(13)
    buffer_load_dwordx4 v2, s[44:47], s86 offen offset:2048 sc1 lds
    buffer_load_dwordx4 v2, s[44:47], s86 offen offset:3072 sc1 lds
    s_add_u32 m0, s78, 102400
    s_add_u32 s86, s86, 2048
    s_add_u32 s87, s87, 16384
    s_waitcnt vmcnt(12)
    buffer_load_dwordx4 v3, s[20:23], s87 offen lds
    buffer_load_dwordx4 v4, s[20:23], s87 offen offset:1024 lds
    s_waitcnt vmcnt(12)
    buffer_load_dwordx4 v2, s[44:47], s86 offen offset:2048 sc1 lds
    buffer_load_dwordx4 v2, s[44:47], s86 offen offset:3072 sc1 lds
    s_mov_b32 m0, s48
    v_mov_b32 v12, 224
    global_load_lds_dword v12, s[88:89]
    s_endpgm
L_comp:
    s_cmp_eq_u32 s60, 1
    s_cbranch_scc1 L_comp1
    v_and_b32 v32, 15, v1
    v_lshrrev_b32 v33, 4, v1
    v_and_b32 v36, 1, v33
    v_lshrrev_b32 v37, 5, v1
    s_lshl_b32 s67, s56, 12
    s_add_u32 s67, s67, 32768
    v_lshlrev_b32 v38, 7, v32
    v_add_u32 v39, s67, v38
    v_lshrrev_b32 v40, 1, v32
    v_xor_b32 v40, v40, v33
    v_lshl_add_u32 v80, v40, 4, v39
    v_xor_b32 v81, 64, v80
    v_add_u32 v82, 0x10000, v80
    v_mov_b32 v84, 0x3f803f80
    v_add_u32 v83, 0x10000, v81
    v_mov_b32 v85, 0x3f803f80
    s_barrier
    ds_read_b128 v[128:131], v80 offset:0
    ds_read_b128 v[132:135], v80 offset:2048
    ds_read_b128 v[136:139], v81 offset:0
    ds_read_b128 v[140:143], v81 offset:2048
    ds_read_b128 v[144:147], v80 offset:16384
    ds_read_b128 v[148:151], v80 offset:18432
    ds_read_b128 v[152:155], v81 offset:16384
    ds_read_b128 v[156:159], v81 offset:18432
    s_waitcnt lgkmcnt(6)
    v_mfma_f32_4x4x4_16b_bf16 v[64:67], v[84:85], v[128:129], 0
    v_mfma_f32_4x4x4_16b_bf16 v[68:71], v[84:85], v[132:133], 0
    v_mfma_f32_4x4x4_16b_bf16 v[88:91], v[128:129], v[128:129], 0
    v_mfma_f32_4x4x4_16b_bf16 v[92:95], v[132:133], v[132:133], 0
    v_mfma_f32_4x4x4_16b_bf16 v[64:67], v[84:85], v[130:131], v[64:67]
    v_mfma_f32_4x4x4_16b_bf16 v[68:71], v[84:85], v[134:135], v[68:71]
    v_mfma_f32_4x4x4_16b_bf16 v[88:91], v[130:131], v[130:131], v[88:91]
    v_mfma_f32_4x4x4_16b_bf16 v[92:95], v[134:135], v[134:135], v[92:95]
    s_waitcnt lgkmcnt(4)
    v_mfma_f32_4x4x4_16b_bf16 v[64:67], v[84:85], v[136:137], v[64:67]
    v_mfma_f32_4x4x4_16b_bf16 v[68:71], v[84:85], v[140:141], v[68:71]
    v_mfma_f32_4x4x4_16b_bf16 v[88:91], v[136:137], v[136:137], v[88:91]
    v_mfma_f32_4x4x4_16b_bf16 v[92:95], v[140:141], v[140:141], v[92:95]
    v_mfma_f32_4x4x4_16b_bf16 v[64:67], v[84:85], v[138:139], v[64:67]
    v_mfma_f32_4x4x4_16b_bf16 v[68:71], v[84:85], v[142:143], v[68:71]
    v_mfma_f32_4x4x4_16b_bf16 v[88:91], v[138:139], v[138:139], v[88:91]
    v_mfma_f32_4x4x4_16b_bf16 v[92:95], v[142:143], v[142:143], v[92:95]
    s_waitcnt lgkmcnt(2)
    v_mfma_f32_4x4x4_16b_bf16 v[64:67], v[84:85], v[144:145], v[64:67]
    v_mfma_f32_4x4x4_16b_bf16 v[68:71], v[84:85], v[148:149], v[68:71]
    v_mfma_f32_4x4x4_16b_bf16 v[88:91], v[144:145], v[144:145], v[88:91]
    v_mfma_f32_4x4x4_16b_bf16 v[92:95], v[148:149], v[148:149], v[92:95]
    v_mfma_f32_4x4x4_16b_bf16 v[64:67], v[84:85], v[146:147], v[64:67]
    v_mfma_f32_4x4x4_16b_bf16 v[68:71], v[84:85], v[150:151], v[68:71]
    v_mfma_f32_4x4x4_16b_bf16 v[88:91], v[146:147], v[146:147], v[88:91]
    v_mfma_f32_4x4x4_16b_bf16 v[92:95], v[150:151], v[150:151], v[92:95]
    s_waitcnt lgkmcnt(0)
    v_mfma_f32_4x4x4_16b_bf16 v[64:67], v[84:85], v[152:153], v[64:67]
    v_mfma_f32_4x4x4_16b_bf16 v[68:71], v[84:85], v[156:157], v[68:71]
    v_mfma_f32_4x4x4_16b_bf16 v[88:91], v[152:153], v[152:153], v[88:91]
    v_mfma_f32_4x4x4_16b_bf16 v[92:95], v[156:157], v[156:157], v[92:95]
    v_mfma_f32_4x4x4_16b_bf16 v[64:67], v[84:85], v[154:155], v[64:67]
    v_mfma_f32_4x4x4_16b_bf16 v[68:71], v[84:85], v[158:159], v[68:71]
    v_mfma_f32_4x4x4_16b_bf16 v[88:91], v[154:155], v[154:155], v[88:91]
    v_mfma_f32_4x4x4_16b_bf16 v[92:95], v[158:159], v[158:159], v[92:95]
    v_and_b32 v45, 3, v1
    v_and_b32 v46, 1, v1
    v_lshlrev_b32 v46, 4, v46
    v_mov_b32 v47, 0x3f80
    v_lshlrev_b32 v46, v46, v47
    v_cmp_gt_u32 vcc, 2, v45
    s_nop 1
    v_cndmask_b32 v120, 0, v46, vcc
    v_sub_u32 v121, v46, v120
    v_cmp_eq_u32 s[94:95], 1, v45
    v_cmp_eq_u32 s[96:97], 2, v45
    v_cmp_eq_u32 s[98:99], 3, v45
    v_mov_b32 v21, 16384
    v_mov_b32 v22, 1
    s_lshl_b32 s70, s58, 1
    s_lshr_b32 s69, s56, 1
    s_add_u32 s70, s70, s69
    s_lshl_b32 s70, s70, 9
    v_mov_b32 v24, s70
    v_and_b32 v18, 1, v1
    v_lshlrev_b32 v18, 8, v18
    v_add_u32 v18, 16640, v18
    s_lshl_b32 s70, s56, 8
    s_add_u32 m0, s70, 17152
    s_lshl_b32 s70, s56, 5
    v_and_b32 v127, 31, v1
    v_add_u32 v127, s70, v127
    v_bfe_u32 v34, v1, 2, 2
    v_and_b32 v35, 3, v1
    v_lshlrev_b32 v35, 3, v35
    v_lshl_add_u32 v40, v33, 11, v35
    s_barrier
    ds_read_b128 v[160:163], v80 offset:32768
    ds_read_b128 v[164:167], v80 offset:34816
    ds_read_b128 v[168:171], v81 offset:32768
    ds_read_b128 v[172:175], v81 offset:34816
    ds_read_b128 v[176:179], v80 offset:49152
    ds_read_b128 v[180:183], v80 offset:51200
    ds_read_b128 v[184:187], v81 offset:49152
    ds_read_b128 v[188:191], v81 offset:51200
    s_waitcnt lgkmcnt(6)
    v_mfma_f32_4x4x4_16b_bf16 v[64:67], v[84:85], v[160:161], v[64:67]
    v_mfma_f32_4x4x4_16b_bf16 v[68:71], v[84:85], v[164:165], v[68:71]
    v_mfma_f32_4x4x4_16b_bf16 v[88:91], v[160:161], v[160:161], v[88:91]
    v_mfma_f32_4x4x4_16b_bf16 v[92:95], v[164:165], v[164:165], v[92:95]
    v_mfma_f32_4x4x4_16b_bf16 v[64:67], v[84:85], v[162:163], v[64:67]
    v_mfma_f32_4x4x4_16b_bf16 v[68:71], v[84:85], v[166:167], v[68:71]
    v_mfma_f32_4x4x4_16b_bf16 v[88:91], v[162:163], v[162:163], v[88:91]
    v_mfma_f32_4x4x4_16b_bf16 v[92:95], v[166:167], v[166:167], v[92:95]
    s_waitcnt lgkmcnt(4)
    v_mfma_f32_4x4x4_16b_bf16 v[64:67], v[84:85], v[168:169], v[64:67]
    v_mfma_f32_4x4x4_16b_bf16 v[68:71], v[84:85], v[172:173], v[68:71]
    v_mfma_f32_4x4x4_16b_bf16 v[88:91], v[168:169], v[168:169], v[88:91]
    v_mfma_f32_4x4x4_16b_bf16 v[92:95], v[172:173], v[172:173], v[92:95]
    v_mfma_f32_4x4x4_16b_bf16 v[64:67], v[84:85], v[170:171], v[64:67]
    v_mfma_f32_4x4x4_16b_bf16 v[68:71], v[84:85], v[174:175], v[68:71]
    v_mfma_f32_4x4x4_16b_bf16 v[88:91], v[170:171], v[170:171], v[88:91]
    v_mfma_f32_4x4x4_16b_bf16 v[92:95], v[174:175], v[174:175], v[92:95]
    s_waitcnt lgkmcnt(2)
    v_mfma_f32_4x4x4_16b_bf16 v[64:67], v[84:85], v[176:177], v[64:67]
    v_mfma_f32_4x4x4_16b_bf16 v[68:71], v[84:85], v[180:181], v[68:71]
    v_mfma_f32_4x4x4_16b_bf16 v[88:91], v[176:177], v[176:177], v[88:91]
    v_mfma_f32_4x4x4_16b_bf16 v[92:95], v[180:181], v[180:181], v[92:95]
    v_mfma_f32_4x4x4_16b_bf16 v[64:67], v[84:85], v[178:179], v[64:67]
    v_mfma_f32_4x4x4_16b_bf16 v[68:71], v[84:85], v[182:183], v[68:71]
    v_mfma_f32_4x4x4_16b_bf16 v[88:91], v[178:179], v[178:179], v[88:91]
    v_mfma_f32_4x4x4_16b_bf16 v[92:95], v[182:183], v[182:183], v[92:95]
    s_waitcnt lgkmcnt(0)
    v_mfma_f32_4x4x4_16b_bf16 v[64:67], v[84:85], v[184:185], v[64:67]
    v_mfma_f32_4x4x4_16b_bf16 v[68:71], v[84:85], v[188:189], v[68:71]
    v_mfma_f32_4x4x4_16b_bf16 v[88:91], v[184:185], v[184:185], v[88:91]
    v_mfma_f32_4x4x4_16b_bf16 v[92:95], v[188:189], v[188:189], v[92:95]
    v_mfma_f32_4x4x4_16b_bf16 v[64:67], v[84:85], v[186:187], v[64:67]
    v_mfma_f32_4x4x4_16b_bf16 v[68:71], v[84:85], v[190:191], v[68:71]
    v_mfma_f32_4x4x4_16b_bf16 v[88:91], v[186:187], v[186:187], v[88:91]
    v_mfma_f32_4x4x4_16b_bf16 v[92:95], v[190:191], v[190:191], v[92:95]
    v_lshl_add_u32 v40, v34, 7, v40
    v_and_b32 v41, 2, v34
    v_xor_b32 v41, v41, v36
    v_lshl_add_u32 v2, v41, 5, v40
    v_xor_b32 v3, 32, v2
    v_xor_b32 v4, 64, v2
    v_xor_b32 v5, 96, v2
    v_add_u32 v6, 0x10000, v2
    v_add_u32 v7, 0x10000, v3
    v_add_u32 v8, 0x10000, v4
    v_add_u32 v9, 0x10000, v5
    v_lshl_add_u32 v40, v37, 11, v35
    v_lshl_add_u32 v40, v34, 6, v40
    v_mul_u32_u24 v41, 544, v36
    v_add_u32 v10, v40, v41
    v_xor_b32 v11, 32, v10
    v_add_u32 v12, 0x10000, v10
    v_add_u32 v13, 0x10000, v11
    s_lshl_b32 s66, s56, 13
    s_add_u32 s66, s66, 131072
    v_lshlrev_b32 v15, 9, v36
    v_lshl_add_u32 v15, v32, 4, v15
    v_lshl_add_u32 v15, v37, 3, v15
    v_add_u32 v15, s66, v15
    v_lshlrev_b32 v43, 4, v1
    s_lshl_b32 s66, s58, 2
    s_add_u32 s66, s66, s56
    s_mul_i32 s66, s66, 147456
    s_add_u32 s66, s66, 2097152
    v_add_u32 v14, s66, v43
    s_lshl_b32 s76, s59, 7
    s_barrier
    ds_read_b128 v[192:195], v82 offset:0
    ds_read_b128 v[196:199], v82 offset:2048
    ds_read_b128 v[200:203], v83 offset:0
    ds_read_b128 v[204:207], v83 offset:2048
    ds_read_b128 v[208:211], v82 offset:16384
    ds_read_b128 v[212:215], v82 offset:18432
    ds_read_b128 v[216:219], v83 offset:16384
    ds_read_b128 v[220:223], v83 offset:18432
    s_waitcnt lgkmcnt(6)
    v_mfma_f32_4x4x4_16b_bf16 v[64:67], v[84:85], v[192:193], v[64:67]
    v_mfma_f32_4x4x4_16b_bf16 v[68:71], v[84:85], v[196:197], v[68:71]
    v_mfma_f32_4x4x4_16b_bf16 v[88:91], v[192:193], v[192:193], v[88:91]
    v_mfma_f32_4x4x4_16b_bf16 v[92:95], v[196:197], v[196:197], v[92:95]
    v_mfma_f32_4x4x4_16b_bf16 v[64:67], v[84:85], v[194:195], v[64:67]
    v_mfma_f32_4x4x4_16b_bf16 v[68:71], v[84:85], v[198:199], v[68:71]
    v_mfma_f32_4x4x4_16b_bf16 v[88:91], v[194:195], v[194:195], v[88:91]
    v_mfma_f32_4x4x4_16b_bf16 v[92:95], v[198:199], v[198:199], v[92:95]
    s_waitcnt lgkmcnt(4)
    v_mfma_f32_4x4x4_16b_bf16 v[64:67], v[84:85], v[200:201], v[64:67]
    v_mfma_f32_4x4x4_16b_bf16 v[68:71], v[84:85], v[204:205], v[68:71]
    v_mfma_f32_4x4x4_16b_bf16 v[88:91], v[200:201], v[200:201], v[88:91]
    v_mfma_f32_4x4x4_16b_bf16 v[92:95], v[204:205], v[204:205], v[92:95]
    v_mfma_f32_4x4x4_16b_bf16 v[64:67], v[84:85], v[202:203], v[64:67]
    v_mfma_f32_4x4x4_16b_bf16 v[68:71], v[84:85], v[206:207], v[68:71]
    v_mfma_f32_4x4x4_16b_bf16 v[88:91], v[202:203], v[202:203], v[88:91]
    v_mfma_f32_4x4x4_16b_bf16 v[92:95], v[206:207], v[206:207], v[92:95]
    s_waitcnt lgkmcnt(2)
    v_mfma_f32_4x4x4_16b_bf16 v[64:67], v[84:85], v[208:209], v[64:67]
    v_mfma_f32_4x4x4_16b_bf16 v[68:71], v[84:85], v[212:213], v[68:71]
    v_mfma_f32_4x4x4_16b_bf16 v[88:91], v[208:209], v[208:209], v[88:91]
    v_mfma_f32_4x4x4_16b_bf16 v[92:95], v[212:213], v[212:213], v[92:95]
    v_mfma_f32_4x4x4_16b_bf16 v[64:67], v[84:85], v[210:211], v[64:67]
    v_mfma_f32_4x4x4_16b_bf16 v[68:71], v[84:85], v[214:215], v[68:71]
    v_mfma_f32_4x4x4_16b_bf16 v[88:91], v[210:211], v[210:211], v[88:91]
    v_mfma_f32_4x4x4_16b_bf16 v[92:95], v[214:215], v[214:215], v[92:95]
    s_waitcnt lgkmcnt(0)
    v_mfma_f32_4x4x4_16b_bf16 v[64:67], v[84:85], v[216:217], v[64:67]
    v_mfma_f32_4x4x4_16b_bf16 v[68:71], v[84:85], v[220:221], v[68:71]
    v_mfma_f32_4x4x4_16b_bf16 v[88:91], v[216:217], v[216:217], v[88:91]
    v_mfma_f32_4x4x4_16b_bf16 v[92:95], v[220:221], v[220:221], v[92:95]
    v_mfma_f32_4x4x4_16b_bf16 v[64:67], v[84:85], v[218:219], v[64:67]
    v_mfma_f32_4x4x4_16b_bf16 v[68:71], v[84:85], v[222:223], v[68:71]
    v_mfma_f32_4x4x4_16b_bf16 v[88:91], v[218:219], v[218:219], v[88:91]
    v_mfma_f32_4x4x4_16b_bf16 v[92:95], v[222:223], v[222:223], v[92:95]
    s_add_u32 s77, s76, 64
    s_lshl_b32 s76, s76, 6
    s_lshl_b32 s77, s77, 6
    s_lshr_b32 s66, s56, 1
    s_lshl_b32 s68, s66, 13
    v_add_u32 v25, s68, v43
    v_add_u32 v26, 0x10000, v25
    v_add_u32 v27, 0x20000, v25
    v_bfe_u32 v44, v1, 3, 2
    s_lshl_b32 s70, s57, 1
    v_xor_b32 v44, s70, v44
    v_lshl_add_u32 v28, v44, 5, v35
    v_lshrrev_b32 v44, 2, v1
    v_lshl_add_u32 v28, v44, 7, v28
    v_add_u32 v29, 0x10000, v28
    v_add_u32 v30, 0x20000, v28
    s_lshl_b32 s69, s66, 5
    v_add_u32 v44, s69, v32
    v_lshlrev_b32 v0, 2, v44
    s_lshl_b32 s70, s57, 6
    v_lshlrev_b32 v17, 7, v44
    v_lshl_add_u32 v17, v33, 3, v17
    v_add_u32 v17, s70, v17
    s_lshl_b32 s68, s63, 16
    s_lshl_b32 s69, s64, 7
    s_add_u32 s69, s69, s70
    s_add_u32 s69, s69, s68
    v_lshlrev_b32 v44, 10, v44
    v_lshl_add_u32 v44, v36, 5, v44
    v_lshl_add_u32 v44, v37, 4, v44
    v_add_u32 v31, s69, v44
    s_barrier
    ds_read_b128 v[224:227], v82 offset:32768
    ds_read_b128 v[228:231], v82 offset:34816
    ds_read_b128 v[232:235], v83 offset:32768
    ds_read_b128 v[236:239], v83 offset:34816
    ds_read_b128 v[240:243], v82 offset:49152
    ds_read_b128 v[244:247], v82 offset:51200
    ds_read_b128 v[248:251], v83 offset:49152
    ds_read_b128 v[252:255], v83 offset:51200
    s_waitcnt lgkmcnt(6)
    v_mfma_f32_4x4x4_16b_bf16 v[64:67], v[84:85], v[224:225], v[64:67]
    v_mfma_f32_4x4x4_16b_bf16 v[68:71], v[84:85], v[228:229], v[68:71]
    v_mfma_f32_4x4x4_16b_bf16 v[88:91], v[224:225], v[224:225], v[88:91]
    v_mfma_f32_4x4x4_16b_bf16 v[92:95], v[228:229], v[228:229], v[92:95]
    v_mfma_f32_4x4x4_16b_bf16 v[64:67], v[84:85], v[226:227], v[64:67]
    v_mfma_f32_4x4x4_16b_bf16 v[68:71], v[84:85], v[230:231], v[68:71]
    v_mfma_f32_4x4x4_16b_bf16 v[88:91], v[226:227], v[226:227], v[88:91]
    v_mfma_f32_4x4x4_16b_bf16 v[92:95], v[230:231], v[230:231], v[92:95]
    s_waitcnt lgkmcnt(4)
    v_mfma_f32_4x4x4_16b_bf16 v[64:67], v[84:85], v[232:233], v[64:67]
    v_mfma_f32_4x4x4_16b_bf16 v[68:71], v[84:85], v[236:237], v[68:71]
    v_mfma_f32_4x4x4_16b_bf16 v[88:91], v[232:233], v[232:233], v[88:91]
    v_mfma_f32_4x4x4_16b_bf16 v[92:95], v[236:237], v[236:237], v[92:95]
    v_mfma_f32_4x4x4_16b_bf16 v[64:67], v[84:85], v[234:235], v[64:67]
    v_mfma_f32_4x4x4_16b_bf16 v[68:71], v[84:85], v[238:239], v[68:71]
    v_mfma_f32_4x4x4_16b_bf16 v[88:91], v[234:235], v[234:235], v[88:91]
    v_mfma_f32_4x4x4_16b_bf16 v[92:95], v[238:239], v[238:239], v[92:95]
    s_waitcnt lgkmcnt(2)
    v_mfma_f32_4x4x4_16b_bf16 v[64:67], v[84:85], v[240:241], v[64:67]
    v_mfma_f32_4x4x4_16b_bf16 v[68:71], v[84:85], v[244:245], v[68:71]
    v_mfma_f32_4x4x4_16b_bf16 v[88:91], v[240:241], v[240:241], v[88:91]
    v_mfma_f32_4x4x4_16b_bf16 v[92:95], v[244:245], v[244:245], v[92:95]
    v_mfma_f32_4x4x4_16b_bf16 v[64:67], v[84:85], v[242:243], v[64:67]
    v_mfma_f32_4x4x4_16b_bf16 v[68:71], v[84:85], v[246:247], v[68:71]
    v_mfma_f32_4x4x4_16b_bf16 v[88:91], v[242:243], v[242:243], v[88:91]
    v_mfma_f32_4x4x4_16b_bf16 v[92:95], v[246:247], v[246:247], v[92:95]
    s_waitcnt lgkmcnt(0)
    s_barrier
    v_mfma_f32_4x4x4_16b_bf16 v[64:67], v[84:85], v[248:249], v[64:67]
    v_mfma_f32_4x4x4_16b_bf16 v[68:71], v[84:85], v[252:253], v[68:71]
    v_mfma_f32_4x4x4_16b_bf16 v[88:91], v[248:249], v[248:249], v[88:91]
    v_mfma_f32_4x4x4_16b_bf16 v[92:95], v[252:253], v[252:253], v[92:95]
    v_mfma_f32_4x4x4_16b_bf16 v[64:67], v[84:85], v[250:251], v[64:67]
    v_mfma_f32_4x4x4_16b_bf16 v[68:71], v[84:85], v[254:255], v[68:71]
    v_mfma_f32_4x4x4_16b_bf16 v[88:91], v[250:251], v[250:251], v[88:91]
    v_mfma_f32_4x4x4_16b_bf16 v[92:95], v[254:255], v[254:255], v[92:95]
    s_waitcnt vmcnt(0)
    s_nop 1
    v_permlane16_swap_b32 v64, v68
    v_add_f32 v64, v64, v68
    v_mov_b32 v68, v64
    s_nop 1
    v_permlane32_swap_b32 v64, v68
    v_add_f32 v64, v64, v68
    v_mul_f32 v126, 0xbb000000, v64
    v_cvt_pk_bf16_f32 v64, v126, v126
    v_mov_b32 v65, v64
    s_nop 1
    v_permlane16_swap_b32 v64, v65
    v_and_b32 v112, 0xffff0000, v64
    v_and_b32 v113, 0xffff0000, v64
    v_and_b32 v114, 0xffff0000, v64
    v_and_b32 v115, 0xffff0000, v64
    v_and_b32 v116, 0xffff0000, v65
    v_and_b32 v117, 0xffff0000, v65
    v_and_b32 v118, 0xffff0000, v65
    v_and_b32 v119, 0xffff0000, v65
    v_mfma_f32_4x4x4_16b_bf16 v[96:99], v[120:121], v[128:129], v[112:115]
    v_mfma_f32_4x4x4_16b_bf16 v[100:103], v[120:121], v[130:131], v[112:115]
    v_mfma_f32_4x4x4_16b_bf16 v[104:107], v[120:121], v[132:133], v[116:119]
    v_mfma_f32_4x4x4_16b_bf16 v[108:111], v[120:121], v[134:135], v[116:119]
    s_nop 1
    v_cvt_pk_bf16_f32 v128, v96, v97
    v_cvt_pk_bf16_f32 v129, v98, v99
    v_mfma_f32_4x4x4_16b_bf16 v[96:99], v[120:121], v[136:137], v[112:115]
    v_cvt_pk_bf16_f32 v130, v100, v101
    v_cvt_pk_bf16_f32 v131, v102, v103
    v_mfma_f32_4x4x4_16b_bf16 v[100:103], v[120:121], v[138:139], v[112:115]
    v_cvt_pk_bf16_f32 v132, v104, v105
    v_cvt_pk_bf16_f32 v133, v106, v107
    v_mfma_f32_4x4x4_16b_bf16 v[104:107], v[120:121], v[140:141], v[116:119]
    v_cvt_pk_bf16_f32 v134, v108, v109
    v_cvt_pk_bf16_f32 v135, v110, v111
    v_mfma_f32_4x4x4_16b_bf16 v[108:111], v[120:121], v[142:143], v[116:119]
    v_cvt_pk_bf16_f32 v136, v96, v97
    v_cvt_pk_bf16_f32 v137, v98, v99
    v_mfma_f32_4x4x4_16b_bf16 v[96:99], v[120:121], v[144:145], v[112:115]
    v_cvt_pk_bf16_f32 v138, v100, v101
    v_cvt_pk_bf16_f32 v139, v102, v103
    v_mfma_f32_4x4x4_16b_bf16 v[100:103], v[120:121], v[146:147], v[112:115]
    v_cvt_pk_bf16_f32 v140, v104, v105
    v_cvt_pk_bf16_f32 v141, v106, v107
    v_mfma_f32_4x4x4_16b_bf16 v[104:107], v[120:121], v[148:149], v[116:119]
    v_cvt_pk_bf16_f32 v142, v108, v109
    v_cvt_pk_bf16_f32 v143, v110, v111
    v_mfma_f32_4x4x4_16b_bf16 v[108:111], v[120:121], v[150:151], v[116:119]
    v_cvt_pk_bf16_f32 v144, v96, v97
    v_cvt_pk_bf16_f32 v145, v98, v99
    v_mfma_f32_4x4x4_16b_bf16 v[96:99], v[120:121], v[152:153], v[112:115]
    v_cvt_pk_bf16_f32 v146, v100, v101
    v_cvt_pk_bf16_f32 v147, v102, v103
    v_mfma_f32_4x4x4_16b_bf16 v[100:103], v[120:121], v[154:155], v[112:115]
    v_cvt_pk_bf16_f32 v148, v104, v105
    v_cvt_pk_bf16_f32 v149, v106, v107
    v_mfma_f32_4x4x4_16b_bf16 v[104:107], v[120:121], v[156:157], v[116:119]
    v_cvt_pk_bf16_f32 v150, v108, v109
    v_cvt_pk_bf16_f32 v151, v110, v111
    v_mfma_f32_4x4x4_16b_bf16 v[108:111], v[120:121], v[158:159], v[116:119]
    v_cvt_pk_bf16_f32 v152, v96, v97
    v_cvt_pk_bf16_f32 v153, v98, v99
    v_mfma_f32_4x4x4_16b_bf16 v[96:99], v[120:121], v[160:161], v[112:115]
    v_cvt_pk_bf16_f32 v154, v100, v101
    v_cvt_pk_bf16_f32 v155, v102, v103
    v_mfma_f32_4x4x4_16b_bf16 v[100:103], v[120:121], v[162:163], v[112:115]
    v_cvt_pk_bf16_f32 v156, v104, v105
    v_cvt_pk_bf16_f32 v157, v106, v107
    v_mfma_f32_4x4x4_16b_bf16 v[104:107], v[120:121], v[164:165], v[116:119]
    v_cvt_pk_bf16_f32 v158, v108, v109
    v_cvt_pk_bf16_f32 v159, v110, v111
    v_mfma_f32_4x4x4_16b_bf16 v[108:111], v[120:121], v[166:167], v[116:119]
    v_cvt_pk_bf16_f32 v160, v96, v97
    v_cvt_pk_bf16_f32 v161, v98, v99
    v_mfma_f32_4x4x4_16b_bf16 v[96:99], v[120:121], v[168:169], v[112:115]
    v_cvt_pk_bf16_f32 v162, v100, v101
    v_cvt_pk_bf16_f32 v163, v102, v103
    v_mfma_f32_4x4x4_16b_bf16 v[100:103], v[120:121], v[170:171], v[112:115]
    v_cvt_pk_bf16_f32 v164, v104, v105
    v_cvt_pk_bf16_f32 v165, v106, v107
    v_mfma_f32_4x4x4_16b_bf16 v[104:107], v[120:121], v[172:173], v[116:119]
    v_cvt_pk_bf16_f32 v166, v108, v109
    v_cvt_pk_bf16_f32 v167, v110, v111
    v_mfma_f32_4x4x4_16b_bf16 v[108:111], v[120:121], v[174:175], v[116:119]
    v_cvt_pk_bf16_f32 v168, v96, v97
    v_cvt_pk_bf16_f32 v169, v98, v99
    v_mfma_f32_4x4x4_16b_bf16 v[96:99], v[120:121], v[176:177], v[112:115]
    v_cvt_pk_bf16_f32 v170, v100, v101
    v_cvt_pk_bf16_f32 v171, v102, v103
    v_mfma_f32_4x4x4_16b_bf16 v[100:103], v[120:121], v[178:179], v[112:115]
    v_cvt_pk_bf16_f32 v172, v104, v105
    v_cvt_pk_bf16_f32 v173, v106, v107
    v_mfma_f32_4x4x4_16b_bf16 v[104:107], v[120:121], v[180:181], v[116:119]
    v_cvt_pk_bf16_f32 v174, v108, v109
    v_cvt_pk_bf16_f32 v175, v110, v111
    v_mfma_f32_4x4x4_16b_bf16 v[108:111], v[120:121], v[182:183], v[116:119]
    v_cvt_pk_bf16_f32 v176, v96, v97
    v_cvt_pk_bf16_f32 v177, v98, v99
    v_mfma_f32_4x4x4_16b_bf16 v[96:99], v[120:121], v[184:185], v[112:115]
    v_cvt_pk_bf16_f32 v178, v100, v101
    v_cvt_pk_bf16_f32 v179, v102, v103
    v_mfma_f32_4x4x4_16b_bf16 v[100:103], v[120:121], v[186:187], v[112:115]
    v_cvt_pk_bf16_f32 v180, v104, v105
    v_cvt_pk_bf16_f32 v181, v106, v107
    v_mfma_f32_4x4x4_16b_bf16 v[104:107], v[120:121], v[188:189], v[116:119]
    v_cvt_pk_bf16_f32 v182, v108, v109
    v_cvt_pk_bf16_f32 v183, v110, v111
    v_mfma_f32_4x4x4_16b_bf16 v[108:111], v[120:121], v[190:191], v[116:119]
    v_cvt_pk_bf16_f32 v184, v96, v97
    v_cvt_pk_bf16_f32 v185, v98, v99
    v_mfma_f32_4x4x4_16b_bf16 v[96:99], v[120:121], v[192:193], v[112:115]
    v_cvt_pk_bf16_f32 v186, v100, v101
    v_cvt_pk_bf16_f32 v187, v102, v103
    v_mfma_f32_4x4x4_16b_bf16 v[100:103], v[120:121], v[194:195], v[112:115]
    v_cvt_pk_bf16_f32 v188, v104, v105
    v_cvt_pk_bf16_f32 v189, v106, v107
    v_mfma_f32_4x4x4_16b_bf16 v[104:107], v[120:121], v[196:197], v[116:119]
    v_cvt_pk_bf16_f32 v190, v108, v109
    v_cvt_pk_bf16_f32 v191, v110, v111
    v_mfma_f32_4x4x4_16b_bf16 v[108:111], v[120:121], v[198:199], v[116:119]
    v_cvt_pk_bf16_f32 v192, v96, v97
    v_cvt_pk_bf16_f32 v193, v98, v99
    v_mfma_f32_4x4x4_16b_bf16 v[96:99], v[120:121], v[200:201], v[112:115]
    v_cvt_pk_bf16_f32 v194, v100, v101
    v_cvt_pk_bf16_f32 v195, v102, v103
    v_mfma_f32_4x4x4_16b_bf16 v[100:103], v[120:121], v[202:203], v[112:115]
    v_cvt_pk_bf16_f32 v196, v104, v105
    v_cvt_pk_bf16_f32 v197, v106, v107
    v_mfma_f32_4x4x4_16b_bf16 v[104:107], v[120:121], v[204:205], v[116:119]
    v_cvt_pk_bf16_f32 v198, v108, v109
    v_cvt_pk_bf16_f32 v199, v110, v111
    v_mfma_f32_4x4x4_16b_bf16 v[108:111], v[120:121], v[206:207], v[116:119]
    v_cvt_pk_bf16_f32 v200, v96, v97
    v_cvt_pk_bf16_f32 v201, v98, v99
    v_mfma_f32_4x4x4_16b_bf16 v[96:99], v[120:121], v[208:209], v[112:115]
    v_cvt_pk_bf16_f32 v202, v100, v101
    v_cvt_pk_bf16_f32 v203, v102, v103
    v_mfma_f32_4x4x4_16b_bf16 v[100:103], v[120:121], v[210:211], v[112:115]
    v_cvt_pk_bf16_f32 v204, v104, v105
    v_cvt_pk_bf16_f32 v205, v106, v107
    v_mfma_f32_4x4x4_16b_bf16 v[104:107], v[120:121], v[212:213], v[116:119]
    v_cvt_pk_bf16_f32 v206, v108, v109
    v_cvt_pk_bf16_f32 v207, v110, v111
    v_mfma_f32_4x4x4_16b_bf16 v[108:111], v[120:121], v[214:215], v[116:119]
    v_cvt_pk_bf16_f32 v208, v96, v97
    v_cvt_pk_bf16_f32 v209, v98, v99
    v_mfma_f32_4x4x4_16b_bf16 v[96:99], v[120:121], v[216:217], v[112:115]
    v_cvt_pk_bf16_f32 v210, v100, v101
    v_cvt_pk_bf16_f32 v211, v102, v103
    v_mfma_f32_4x4x4_16b_bf16 v[100:103], v[120:121], v[218:219], v[112:115]
    v_cvt_pk_bf16_f32 v212, v104, v105
    v_cvt_pk_bf16_f32 v213, v106, v107
    v_mfma_f32_4x4x4_16b_bf16 v[104:107], v[120:121], v[220:221], v[116:119]
    v_cvt_pk_bf16_f32 v214, v108, v109
    v_cvt_pk_bf16_f32 v215, v110, v111
    v_mfma_f32_4x4x4_16b_bf16 v[108:111], v[120:121], v[222:223], v[116:119]
    v_cvt_pk_bf16_f32 v216, v96, v97
    v_cvt_pk_bf16_f32 v217, v98, v99
    v_cvt_pk_bf16_f32 v218, v100, v101
    v_cvt_pk_bf16_f32 v219, v102, v103
    v_cvt_pk_bf16_f32 v220, v104, v105
    v_cvt_pk_bf16_f32 v221, v106, v107
    v_cvt_pk_bf16_f32 v222, v108, v109
    v_cvt_pk_bf16_f32 v223, v110, v111
    ds_read_b32 v16, v18
    v_cndmask_b32 v122, v88, v89, s[94:95]
    v_cndmask_b32 v123, v92, v93, s[94:95]
    v_cndmask_b32 v122, v122, v90, s[96:97]
    v_cndmask_b32 v123, v123, v94, s[96:97]
    v_cndmask_b32 v122, v122, v91, s[98:99]
    v_cndmask_b32 v123, v123, v95, s[98:99]
    v_mfma_f32_4x4x4_16b_bf16 v[96:99], v[120:121], v[224:225], v[112:115]
    v_mfma_f32_4x4x4_16b_bf16 v[100:103], v[120:121], v[226:227], v[112:115]
    v_mfma_f32_4x4x4_16b_bf16 v[104:107], v[120:121], v[228:229], v[116:119]
    v_mfma_f32_4x4x4_16b_bf16 v[108:111], v[120:121], v[230:231], v[116:119]
    s_nop 1
    v_cvt_pk_bf16_f32 v224, v96, v97
    v_cvt_pk_bf16_f32 v225, v98, v99
    v_mfma_f32_4x4x4_16b_bf16 v[96:99], v[120:121], v[232:233], v[112:115]
    v_cvt_pk_bf16_f32 v226, v100, v101
    v_cvt_pk_bf16_f32 v227, v102, v103
    v_mfma_f32_4x4x4_16b_bf16 v[100:103], v[120:121], v[234:235], v[112:115]
    v_cvt_pk_bf16_f32 v228, v104, v105
    v_cvt_pk_bf16_f32 v229, v106, v107
    v_mfma_f32_4x4x4_16b_bf16 v[104:107], v[120:121], v[236:237], v[116:119]
    v_cvt_pk_bf16_f32 v230, v108, v109
    v_cvt_pk_bf16_f32 v231, v110, v111
    v_mfma_f32_4x4x4_16b_bf16 v[108:111], v[120:121], v[238:239], v[116:119]
    v_cvt_pk_bf16_f32 v232, v96, v97
    v_cvt_pk_bf16_f32 v233, v98, v99
    v_cvt_pk_bf16_f32 v234, v100, v101
    v_cvt_pk_bf16_f32 v235, v102, v103
    v_cvt_pk_bf16_f32 v236, v104, v105
    v_cvt_pk_bf16_f32 v237, v106, v107
    v_cvt_pk_bf16_f32 v238, v108, v109
    v_cvt_pk_bf16_f32 v239, v110, v111
    s_waitcnt lgkmcnt(0)
    v_cmp_ge_u32 vcc, 0, v16
    s_cbranch_vccz L_cb77
    s_movk_i32 s81, 1
    s_call_b64 s[82:83], L_spin_c
L_cb77:
    ds_read_b64_tr_b16 v[32:33], v10 offset:0
    ds_read_b64_tr_b16 v[34:35], v10 offset:256
    ds_read_b64_tr_b16 v[36:37], v10 offset:1024
    ds_read_b64_tr_b16 v[38:39], v10 offset:1280
    ds_read_b64_tr_b16 v[40:41], v10 offset:4096
    ds_read_b64_tr_b16 v[42:43], v10 offset:4352
    ds_read_b64_tr_b16 v[44:45], v10 offset:5120
    ds_read_b64_tr_b16 v[46:47], v10 offset:5376
    ds_read_b64_tr_b16 v[48:49], v10 offset:8192
    ds_read_b64_tr_b16 v[50:51], v10 offset:8448
    ds_read_b64_tr_b16 v[52:53], v10 offset:9216
    ds_read_b64_tr_b16 v[54:55], v10 offset:9472
    ds_read_b64_tr_b16 v[56:57], v10 offset:12288
    ds_read_b64_tr_b16 v[58:59], v10 offset:12544
    v_mfma_f32_4x4x4_16b_bf16 v[96:99], v[120:121], v[240:241], v[112:115]
    v_mfma_f32_4x4x4_16b_bf16 v[100:103], v[120:121], v[242:243], v[112:115]
    v_mfma_f32_4x4x4_16b_bf16 v[104:107], v[120:121], v[244:245], v[116:119]
    v_mfma_f32_4x4x4_16b_bf16 v[108:111], v[120:121], v[246:247], v[116:119]
    s_nop 1
    v_cvt_pk_bf16_f32 v240, v96, v97
    v_cvt_pk_bf16_f32 v241, v98, v99
    v_mfma_f32_4x4x4_16b_bf16 v[96:99], v[120:121], v[248:249], v[112:115]
    v_cvt_pk_bf16_f32 v242, v100, v101
    v_cvt_pk_bf16_f32 v243, v102, v103
    v_mfma_f32_4x4x4_16b_bf16 v[100:103], v[120:121], v[250:251], v[112:115]
    v_cvt_pk_bf16_f32 v244, v104, v105
    v_cvt_pk_bf16_f32 v245, v106, v107
    v_mfma_f32_4x4x4_16b_bf16 v[104:107], v[120:121], v[252:253], v[116:119]
    v_cvt_pk_bf16_f32 v246, v108, v109
    v_cvt_pk_bf16_f32 v247, v110, v111
    v_mfma_f32_4x4x4_16b_bf16 v[108:111], v[120:121], v[254:255], v[116:119]
    v_cvt_pk_bf16_f32 v248, v96, v97
    v_cvt_pk_bf16_f32 v249, v98, v99
    v_cvt_pk_bf16_f32 v250, v100, v101
    v_cvt_pk_bf16_f32 v251, v102, v103
    v_cvt_pk_bf16_f32 v252, v104, v105
    v_cvt_pk_bf16_f32 v253, v106, v107
    v_cvt_pk_bf16_f32 v254, v108, v109
    v_cvt_pk_bf16_f32 v255, v110, v111
    s_waitcnt lgkmcnt(10)
    v_mfma_f32_16x16x32_bf16 v[64:67], v[32:35], v[128:131], 0
    ds_read_b64_tr_b16 v[60:61], v10 offset:13312
    v_mfma_f32_16x16x32_bf16 v[68:71], v[32:35], v[132:135], 0
    ds_read_b64_tr_b16 v[62:63], v10 offset:13568
    v_mfma_f32_16x16x32_bf16 v[72:75], v[36:39], v[128:131], 0
    ds_read_b64_tr_b16 v[32:33], v11 offset:0
    v_mfma_f32_16x16x32_bf16 v[76:79], v[36:39], v[132:135], 0
    ds_read_b64_tr_b16 v[34:35], v11 offset:256
    s_waitcnt lgkmcnt(10)
    v_mfma_f32_16x16x32_bf16 v[64:67], v[40:43], v[136:139], v[64:67]
    ds_read_b64_tr_b16 v[36:37], v11 offset:1024
    v_mfma_f32_16x16x32_bf16 v[68:71], v[40:43], v[140:143], v[68:71]
    ds_read_b64_tr_b16 v[38:39], v11 offset:1280
    v_mfma_f32_16x16x32_bf16 v[72:75], v[44:47], v[136:139], v[72:75]
    ds_read_b64_tr_b16 v[40:41], v11 offset:4096
    v_mfma_f32_16x16x32_bf16 v[76:79], v[44:47], v[140:143], v[76:79]
    ds_read_b64_tr_b16 v[42:43], v11 offset:4352
    s_waitcnt lgkmcnt(10)
    v_mfma_f32_16x16x32_bf16 v[64:67], v[48:51], v[144:147], v[64:67]
    ds_read_b64_tr_b16 v[44:45], v11 offset:5120
    v_mfma_f32_16x16x32_bf16 v[68:71], v[48:51], v[148:151], v[68:71]
    ds_read_b64_tr_b16 v[46:47], v11 offset:5376
    v_mfma_f32_16x16x32_bf16 v[72:75], v[52:55], v[144:147], v[72:75]
    ds_read_b64_tr_b16 v[48:49], v11 offset:8192
    v_mfma_f32_16x16x32_bf16 v[76:79], v[52:55], v[148:151], v[76:79]
    ds_read_b64_tr_b16 v[50:51], v11 offset:8448
    s_waitcnt lgkmcnt(10)
    v_mfma_f32_16x16x32_bf16 v[64:67], v[56:59], v[152:155], v[64:67]
    ds_read_b64_tr_b16 v[52:53], v11 offset:9216
    ds_read_b64_tr_b16 v[54:55], v11 offset:9472
    v_mfma_f32_16x16x32_bf16 v[68:71], v[56:59], v[156:159], v[68:71]
    ds_read_b32 v16, v18
    v_mfma_f32_16x16x32_bf16 v[72:75], v[60:63], v[152:155], v[72:75]
    ds_read_b64_tr_b16 v[56:57], v11 offset:12288
    v_mfma_f32_16x16x32_bf16 v[76:79], v[60:63], v[156:159], v[76:79]
    ds_read_b64_tr_b16 v[58:59], v11 offset:12544
    s_waitcnt lgkmcnt(11)
    v_mfma_f32_16x16x32_bf16 v[80:83], v[32:35], v[128:131], 0
    ds_read_b64_tr_b16 v[60:61], v11 offset:13312
    ds_read_b64_tr_b16 v[62:63], v11 offset:13568
    v_mfma_f32_16x16x32_bf16 v[84:87], v[32:35], v[132:135], 0
    s_waitcnt lgkmcnt(4)
    v_cmp_ge_u32 vcc, 1, v16
    v_mfma_f32_16x16x32_bf16 v[88:91], v[36:39], v[128:131], 0
    v_mfma_f32_16x16x32_bf16 v[92:95], v[36:39], v[132:135], 0
    s_cbranch_vccz L_cb78
    s_movk_i32 s81, 2
    s_call_b64 s[82:83], L_spin_c
L_cb78:
    ds_read_b64_tr_b16 v[32:33], v10 offset:32768
    ds_read_b64_tr_b16 v[34:35], v10 offset:33024
    v_mfma_f32_16x16x32_bf16 v[80:83], v[40:43], v[136:139], v[80:83]
    ds_read_b64_tr_b16 v[36:37], v10 offset:33792
    v_mfma_f32_16x16x32_bf16 v[84:87], v[40:43], v[140:143], v[84:87]
    ds_read_b64_tr_b16 v[38:39], v10 offset:34048
    v_mfma_f32_16x16x32_bf16 v[88:91], v[44:47], v[136:139], v[88:91]
    ds_read_b64_tr_b16 v[40:41], v10 offset:36864
    v_mfma_f32_16x16x32_bf16 v[92:95], v[44:47], v[140:143], v[92:95]
    ds_read_b64_tr_b16 v[42:43], v10 offset:37120
    v_mfma_f32_16x16x32_bf16 v[80:83], v[48:51], v[144:147], v[80:83]
    ds_read_b64_tr_b16 v[44:45], v10 offset:37888
    ds_read_b64_tr_b16 v[46:47], v10 offset:38144
    v_mfma_f32_16x16x32_bf16 v[84:87], v[48:51], v[148:151], v[84:87]
    v_permlane16_swap_b32 v122, v123
    v_mfma_f32_16x16x32_bf16 v[88:91], v[52:55], v[144:147], v[88:91]
    ds_read_b64_tr_b16 v[48:49], v10 offset:40960
    ds_read_b64_tr_b16 v[50:51], v10 offset:41216
    v_mfma_f32_16x16x32_bf16 v[92:95], v[52:55], v[148:151], v[92:95]
    v_add_f32 v122, v122, v123
    s_waitcnt lgkmcnt(10)
    v_mfma_f32_16x16x32_bf16 v[80:83], v[56:59], v[152:155], v[80:83]
    ds_read_b64_tr_b16 v[52:53], v10 offset:41984
    ds_read_b64_tr_b16 v[54:55], v10 offset:42240
    v_mfma_f32_16x16x32_bf16 v[84:87], v[56:59], v[156:159], v[84:87]
    v_mov_b32 v123, v122
    v_mfma_f32_16x16x32_bf16 v[88:91], v[60:63], v[152:155], v[88:91]
    v_mov_b32 v23, 4
    global_load_lds_dword v23, s[88:89]
    ds_read_b64_tr_b16 v[56:57], v10 offset:45056
    v_mfma_f32_16x16x32_bf16 v[92:95], v[60:63], v[156:159], v[92:95]
    ds_read_b64_tr_b16 v[58:59], v10 offset:45312
    v_permlane32_swap_b32 v122, v123
    s_waitcnt lgkmcnt(10)
    v_mfma_f32_16x16x32_bf16 v[64:67], v[32:35], v[160:163], v[64:67]
    ds_read_b64_tr_b16 v[60:61], v10 offset:46080
    ds_read_b64_tr_b16 v[62:63], v10 offset:46336
    v_mfma_f32_16x16x32_bf16 v[68:71], v[32:35], v[164:167], v[68:71]
    v_add_f32 v122, v122, v123
    v_mfma_f32_16x16x32_bf16 v[72:75], v[36:39], v[160:163], v[72:75]
    ds_read_b64_tr_b16 v[32:33], v11 offset:32768
    ds_read_b64_tr_b16 v[34:35], v11 offset:33024
    v_mfma_f32_16x16x32_bf16 v[76:79], v[36:39], v[164:167], v[76:79]
    v_mul_f32 v122, 0x3b000000, v122
    s_waitcnt lgkmcnt(10)
    v_mfma_f32_16x16x32_bf16 v[64:67], v[40:43], v[168:171], v[64:67]
    ds_read_b64_tr_b16 v[36:37], v11 offset:33792
    ds_read_b64_tr_b16 v[38:39], v11 offset:34048
    v_mfma_f32_16x16x32_bf16 v[68:71], v[40:43], v[172:175], v[68:71]
    v_fma_f32 v122, -v126, v126, v122
    v_mfma_f32_16x16x32_bf16 v[72:75], v[44:47], v[168:171], v[72:75]
    ds_read_b64_tr_b16 v[40:41], v11 offset:36864
    ds_read_b64_tr_b16 v[42:43], v11 offset:37120
    v_mfma_f32_16x16x32_bf16 v[76:79], v[44:47], v[172:175], v[76:79]
    v_max_f32 v122, 0, v122
    s_waitcnt lgkmcnt(10)
    v_mfma_f32_16x16x32_bf16 v[64:67], v[48:51], v[176:179], v[64:67]
    ds_read_b64_tr_b16 v[44:45], v11 offset:37888
    ds_read_b64_tr_b16 v[46:47], v11 offset:38144
    v_mfma_f32_16x16x32_bf16 v[68:71], v[48:51], v[180:183], v[68:71]
    v_cvt_pk_bf16_f32 v123, v122, v122
    v_mfma_f32_16x16x32_bf16 v[72:75], v[52:55], v[176:179], v[72:75]
    ds_read_b64_tr_b16 v[48:49], v11 offset:40960
    ds_read_b64_tr_b16 v[50:51], v11 offset:41216
    v_mfma_f32_16x16x32_bf16 v[76:79], v[52:55], v[180:183], v[76:79]
    v_and_b32 v122, 0xffff0000, v123
    s_waitcnt lgkmcnt(10)
    v_mfma_f32_16x16x32_bf16 v[64:67], v[56:59], v[184:187], v[64:67]
    ds_read_b64_tr_b16 v[52:53], v11 offset:41984
    ds_read_b64_tr_b16 v[54:55], v11 offset:42240
    v_mfma_f32_16x16x32_bf16 v[68:71], v[56:59], v[188:191], v[68:71]
    ds_read_b32 v16, v18
    v_add_f32 v122, 0x3727c5ac, v122
    v_mfma_f32_16x16x32_bf16 v[72:75], v[60:63], v[184:187], v[72:75]
    ds_read_b64_tr_b16 v[56:57], v11 offset:45056
    ds_read_b64_tr_b16 v[58:59], v11 offset:45312
    v_mfma_f32_16x16x32_bf16 v[76:79], v[60:63], v[188:191], v[76:79]
    v_cvt_pk_bf16_f32 v123, v122, v122
    s_waitcnt lgkmcnt(11)
    v_mfma_f32_16x16x32_bf16 v[80:83], v[32:35], v[160:163], v[80:83]
    ds_read_b64_tr_b16 v[60:61], v11 offset:46080
    ds_read_b64_tr_b16 v[62:63], v11 offset:46336
    v_mfma_f32_16x16x32_bf16 v[84:87], v[32:35], v[164:167], v[84:87]
    s_waitcnt lgkmcnt(4)
    v_cmp_ge_u32 vcc, 2, v16
    v_and_b32 v122, 0xffff0000, v123
    v_mfma_f32_16x16x32_bf16 v[88:91], v[36:39], v[160:163], v[88:91]
    v_mfma_f32_16x16x32_bf16 v[92:95], v[36:39], v[164:167], v[92:95]
    s_cbranch_vccz L_cb79
    s_movk_i32 s81, 3
    s_call_b64 s[82:83], L_spin_c
L_cb79:
    ds_read_b64_tr_b16 v[32:33], v10 offset:49152
    ds_read_b64_tr_b16 v[34:35], v10 offset:49408
    v_sqrt_f32 v122, v122
    v_mfma_f32_16x16x32_bf16 v[80:83], v[40:43], v[168:171], v[80:83]
    ds_read_b64_tr_b16 v[36:37], v10 offset:50176
    ds_read_b64_tr_b16 v[38:39], v10 offset:50432
    v_mfma_f32_16x16x32_bf16 v[84:87], v[40:43], v[172:175], v[84:87]
    v_cvt_pk_bf16_f32 v123, v122, v122
    v_mfma_f32_16x16x32_bf16 v[88:91], v[44:47], v[168:171], v[88:91]
    ds_read_b64_tr_b16 v[40:41], v10 offset:53248
    ds_read_b64_tr_b16 v[42:43], v10 offset:53504
    v_mfma_f32_16x16x32_bf16 v[92:95], v[44:47], v[172:175], v[92:95]
    v_and_b32 v122, 0xffff0000, v123
    v_mfma_f32_16x16x32_bf16 v[80:83], v[48:51], v[176:179], v[80:83]
    ds_read_b64_tr_b16 v[44:45], v10 offset:54272
    ds_read_b64_tr_b16 v[46:47], v10 offset:54528
    v_mfma_f32_16x16x32_bf16 v[84:87], v[48:51], v[180:183], v[84:87]
    v_rcp_f32 v122, v122
    v_mfma_f32_16x16x32_bf16 v[88:91], v[52:55], v[176:179], v[88:91]
    ds_read_b64_tr_b16 v[48:49], v10 offset:57344
    ds_read_b64_tr_b16 v[50:51], v10 offset:57600
    v_mfma_f32_16x16x32_bf16 v[92:95], v[52:55], v[180:183], v[92:95]
    v_lshl_add_u32 v124, v127, 1, v21
    s_waitcnt lgkmcnt(10)
    v_mfma_f32_16x16x32_bf16 v[80:83], v[56:59], v[184:187], v[80:83]
    ds_read_b64_tr_b16 v[52:53], v10 offset:58368
    ds_read_b64_tr_b16 v[54:55], v10 offset:58624
    v_mfma_f32_16x16x32_bf16 v[84:87], v[56:59], v[188:191], v[84:87]
    v_lshl_add_u32 v125, v127, 2, v21
    v_mfma_f32_16x16x32_bf16 v[88:91], v[60:63], v[184:187], v[88:91]
    ds_read_b64_tr_b16 v[56:57], v10 offset:61440
    v_mfma_f32_16x16x32_bf16 v[92:95], v[60:63], v[188:191], v[92:95]
    ds_read_b64_tr_b16 v[58:59], v10 offset:61696
    s_waitcnt lgkmcnt(10)
    v_mfma_f32_16x16x32_bf16 v[64:67], v[32:35], v[192:195], v[64:67]
    ds_read_b64_tr_b16 v[60:61], v10 offset:62464
    v_mfma_f32_16x16x32_bf16 v[68:71], v[32:35], v[196:199], v[68:71]
    ds_read_b64_tr_b16 v[62:63], v10 offset:62720
    v_mfma_f32_16x16x32_bf16 v[72:75], v[36:39], v[192:195], v[72:75]
    ds_read_b64_tr_b16 v[32:33], v11 offset:49152
    v_mfma_f32_16x16x32_bf16 v[76:79], v[36:39], v[196:199], v[76:79]
    ds_read_b64_tr_b16 v[34:35], v11 offset:49408
    s_waitcnt lgkmcnt(10)
    v_mfma_f32_16x16x32_bf16 v[64:67], v[40:43], v[200:203], v[64:67]
    ds_read_b64_tr_b16 v[36:37], v11 offset:50176
    v_mfma_f32_16x16x32_bf16 v[68:71], v[40:43], v[204:207], v[68:71]
    ds_read_b64_tr_b16 v[38:39], v11 offset:50432
    v_mfma_f32_16x16x32_bf16 v[72:75], v[44:47], v[200:203], v[72:75]
    ds_read_b64_tr_b16 v[40:41], v11 offset:53248
    v_mfma_f32_16x16x32_bf16 v[76:79], v[44:47], v[204:207], v[76:79]
    ds_read_b64_tr_b16 v[42:43], v11 offset:53504
    s_waitcnt lgkmcnt(10)
    v_mfma_f32_16x16x32_bf16 v[64:67], v[48:51], v[208:211], v[64:67]
    ds_read_b64_tr_b16 v[44:45], v11 offset:54272
    v_mfma_f32_16x16x32_bf16 v[68:71], v[48:51], v[212:215], v[68:71]
    ds_read_b64_tr_b16 v[46:47], v11 offset:54528
    v_mfma_f32_16x16x32_bf16 v[72:75], v[52:55], v[208:211], v[72:75]
    ds_read_b64_tr_b16 v[48:49], v11 offset:57344
    v_mfma_f32_16x16x32_bf16 v[76:79], v[52:55], v[212:215], v[76:79]
    ds_read_b64_tr_b16 v[50:51], v11 offset:57600
    s_waitcnt lgkmcnt(10)
    v_mfma_f32_16x16x32_bf16 v[64:67], v[56:59], v[216:219], v[64:67]
    ds_read_b64_tr_b16 v[52:53], v11 offset:58368
    ds_read_b64_tr_b16 v[54:55], v11 offset:58624
    v_mfma_f32_16x16x32_bf16 v[68:71], v[56:59], v[220:223], v[68:71]
    ds_read_b32 v16, v18
    v_mfma_f32_16x16x32_bf16 v[72:75], v[60:63], v[216:219], v[72:75]
    ds_read_b64_tr_b16 v[56:57], v11 offset:61440
    v_mfma_f32_16x16x32_bf16 v[76:79], v[60:63], v[220:223], v[76:79]
    ds_read_b64_tr_b16 v[58:59], v11 offset:61696
    s_waitcnt lgkmcnt(11)
    v_mfma_f32_16x16x32_bf16 v[80:83], v[32:35], v[192:195], v[80:83]
    ds_read_b64_tr_b16 v[60:61], v11 offset:62464
    ds_read_b64_tr_b16 v[62:63], v11 offset:62720
    v_mfma_f32_16x16x32_bf16 v[84:87], v[32:35], v[196:199], v[84:87]
    s_waitcnt lgkmcnt(4)
    v_cmp_ge_u32 vcc, 3, v16
    v_mfma_f32_16x16x32_bf16 v[88:91], v[36:39], v[192:195], v[88:91]
    v_mfma_f32_16x16x32_bf16 v[92:95], v[36:39], v[196:199], v[92:95]
    s_cbranch_vccz L_cb80
    s_movk_i32 s81, 4
    s_call_b64 s[82:83], L_spin_c
L_cb80:
    ds_read_b64_tr_b16 v[32:33], v12 offset:0
    ds_read_b64_tr_b16 v[34:35], v12 offset:256
    v_mfma_f32_16x16x32_bf16 v[80:83], v[40:43], v[200:203], v[80:83]
    ds_read_b64_tr_b16 v[36:37], v12 offset:1024
    v_mfma_f32_16x16x32_bf16 v[84:87], v[40:43], v[204:207], v[84:87]
    ds_read_b64_tr_b16 v[38:39], v12 offset:1280
    v_mfma_f32_16x16x32_bf16 v[88:91], v[44:47], v[200:203], v[88:91]
    ds_read_b64_tr_b16 v[40:41], v12 offset:4096
    v_mfma_f32_16x16x32_bf16 v[92:95], v[44:47], v[204:207], v[92:95]
    ds_read_b64_tr_b16 v[42:43], v12 offset:4352
    v_mfma_f32_16x16x32_bf16 v[80:83], v[48:51], v[208:211], v[80:83]
    ds_read_b64_tr_b16 v[44:45], v12 offset:5120
    v_mfma_f32_16x16x32_bf16 v[84:87], v[48:51], v[212:215], v[84:87]
    ds_read_b64_tr_b16 v[46:47], v12 offset:5376
    v_mfma_f32_16x16x32_bf16 v[88:91], v[52:55], v[208:211], v[88:91]
    ds_read_b64_tr_b16 v[48:49], v12 offset:8192
    v_mfma_f32_16x16x32_bf16 v[92:95], v[52:55], v[212:215], v[92:95]
    ds_read_b64_tr_b16 v[50:51], v12 offset:8448
    s_waitcnt lgkmcnt(10)
    v_mfma_f32_16x16x32_bf16 v[80:83], v[56:59], v[216:219], v[80:83]
    ds_read_b64_tr_b16 v[52:53], v12 offset:9216
    ds_read_b64_tr_b16 v[54:55], v12 offset:9472
    v_mfma_f32_16x16x32_bf16 v[84:87], v[56:59], v[220:223], v[84:87]
    s_cmp_lg_u32 s59, 0
    s_cbranch_scc1 L_sk75
    s_lshl_b32 s70, s58, 9
    s_add_u32 s70, s70, 16384
    s_mov_b32 exec_hi, 0
    buffer_store_dword v122, v125, s[44:47], s70 offen sc1
    s_mov_b64 exec, -1
L_sk75:
    v_mfma_f32_16x16x32_bf16 v[88:91], v[60:63], v[216:219], v[88:91]
    v_mov_b32 v23, 12
    global_load_lds_dword v23, s[88:89]
    v_mfma_f32_16x16x32_bf16 v[92:95], v[60:63], v[220:223], v[92:95]
    ds_read_b64_tr_b16 v[56:57], v12 offset:12288
    ds_read_b64_tr_b16 v[58:59], v12 offset:12544
    s_waitcnt lgkmcnt(10)
    v_mfma_f32_16x16x32_bf16 v[64:67], v[32:35], v[224:227], v[64:67]
    ds_read_b64_tr_b16 v[60:61], v12 offset:13312
    v_mfma_f32_16x16x32_bf16 v[68:71], v[32:35], v[228:231], v[68:71]
    ds_read_b64_tr_b16 v[62:63], v12 offset:13568
    v_mfma_f32_16x16x32_bf16 v[72:75], v[36:39], v[224:227], v[72:75]
    ds_read_b64_tr_b16 v[32:33], v13 offset:0
    v_mfma_f32_16x16x32_bf16 v[76:79], v[36:39], v[228:231], v[76:79]
    ds_read_b64_tr_b16 v[34:35], v13 offset:256
    s_waitcnt lgkmcnt(10)
    v_mfma_f32_16x16x32_bf16 v[64:67], v[40:43], v[232:235], v[64:67]
    ds_read_b64_tr_b16 v[36:37], v13 offset:1024
    v_mfma_f32_16x16x32_bf16 v[68:71], v[40:43], v[236:239], v[68:71]
    ds_read_b64_tr_b16 v[38:39], v13 offset:1280
    v_mfma_f32_16x16x32_bf16 v[72:75], v[44:47], v[232:235], v[72:75]
    ds_read_b64_tr_b16 v[40:41], v13 offset:4096
    v_mfma_f32_16x16x32_bf16 v[76:79], v[44:47], v[236:239], v[76:79]
    ds_read_b64_tr_b16 v[42:43], v13 offset:4352
    s_waitcnt lgkmcnt(10)
    v_mfma_f32_16x16x32_bf16 v[64:67], v[48:51], v[240:243], v[64:67]
    ds_read_b64_tr_b16 v[44:45], v13 offset:5120
    v_mfma_f32_16x16x32_bf16 v[68:71], v[48:51], v[244:247], v[68:71]
    ds_read_b64_tr_b16 v[46:47], v13 offset:5376
    v_mfma_f32_16x16x32_bf16 v[72:75], v[52:55], v[240:243], v[72:75]
    ds_read_b64_tr_b16 v[48:49], v13 offset:8192
    v_mfma_f32_16x16x32_bf16 v[76:79], v[52:55], v[244:247], v[76:79]
    ds_read_b64_tr_b16 v[50:51], v13 offset:8448
    s_waitcnt lgkmcnt(10)
    v_mfma_f32_16x16x32_bf16 v[64:67], v[56:59], v[248:251], v[64:67]
    ds_read_b64_tr_b16 v[52:53], v13 offset:9216
    ds_read_b64_tr_b16 v[54:55], v13 offset:9472
    v_mfma_f32_16x16x32_bf16 v[68:71], v[56:59], v[252:255], v[68:71]
    ds_read_b32 v16, v18
    v_mfma_f32_16x16x32_bf16 v[72:75], v[60:63], v[248:251], v[72:75]
    ds_read_b64_tr_b16 v[56:57], v13 offset:12288
    v_mfma_f32_16x16x32_bf16 v[76:79], v[60:63], v[252:255], v[76:79]
    ds_read_b64_tr_b16 v[58:59], v13 offset:12544
    s_waitcnt lgkmcnt(11)
    v_mfma_f32_16x16x32_bf16 v[80:83], v[32:35], v[224:227], v[80:83]
    ds_read_b64_tr_b16 v[60:61], v13 offset:13312
    ds_read_b64_tr_b16 v[62:63], v13 offset:13568
    v_mfma_f32_16x16x32_bf16 v[84:87], v[32:35], v[228:231], v[84:87]
    s_waitcnt lgkmcnt(4)
    v_cmp_ge_u32 vcc, 4, v16
    v_cvt_pk_bf16_f32 v64, v64, v65
    v_cvt_pk_bf16_f32 v65, v66, v67
    v_cvt_pk_bf16_f32 v68, v68, v69
    v_mfma_f32_16x16x32_bf16 v[88:91], v[36:39], v[224:227], v[88:91]
    v_mfma_f32_16x16x32_bf16 v[92:95], v[36:39], v[228:231], v[92:95]
    s_cbranch_vccz L_cb81
    s_movk_i32 s81, 5
    s_call_b64 s[82:83], L_spin_c
L_cb81:
    ds_read_b64_tr_b16 v[32:33], v8 offset:16384
    ds_read_b64_tr_b16 v[34:35], v8 offset:16896
    v_cvt_pk_bf16_f32 v69, v70, v71
    v_cvt_pk_bf16_f32 v72, v72, v73
    v_cvt_pk_bf16_f32 v73, v74, v75
    v_mfma_f32_16x16x32_bf16 v[80:83], v[40:43], v[232:235], v[80:83]
    ds_read_b64_tr_b16 v[36:37], v8 offset:17408
    ds_read_b64_tr_b16 v[38:39], v8 offset:17920
    v_mfma_f32_16x16x32_bf16 v[84:87], v[40:43], v[236:239], v[84:87]
    v_cvt_pk_bf16_f32 v76, v76, v77
    v_cvt_pk_bf16_f32 v77, v78, v79
    v_mfma_f32_16x16x32_bf16 v[88:91], v[44:47], v[232:235], v[88:91]
    ds_read_b64_tr_b16 v[40:41], v8 offset:24576
    v_mfma_f32_16x16x32_bf16 v[92:95], v[44:47], v[236:239], v[92:95]
    ds_read_b64_tr_b16 v[42:43], v8 offset:25088
    v_mfma_f32_16x16x32_bf16 v[80:83], v[48:51], v[240:243], v[80:83]
    ds_read_b64_tr_b16 v[44:45], v8 offset:25600
    v_mfma_f32_16x16x32_bf16 v[84:87], v[48:51], v[244:247], v[84:87]
    ds_read_b64_tr_b16 v[46:47], v8 offset:26112
    v_mfma_f32_16x16x32_bf16 v[88:91], v[52:55], v[240:243], v[88:91]
    ds_read_b64_tr_b16 v[48:49], v9 offset:16384
    v_mfma_f32_16x16x32_bf16 v[92:95], v[52:55], v[244:247], v[92:95]
    ds_read_b64_tr_b16 v[50:51], v9 offset:16896
    s_waitcnt lgkmcnt(10)
    v_mfma_f32_16x16x32_bf16 v[80:83], v[56:59], v[248:251], v[80:83]
    ds_read_b64_tr_b16 v[52:53], v9 offset:17408
    v_mfma_f32_16x16x32_bf16 v[84:87], v[56:59], v[252:255], v[84:87]
    ds_read_b64_tr_b16 v[54:55], v9 offset:17920
    v_mfma_f32_16x16x32_bf16 v[88:91], v[60:63], v[248:251], v[88:91]
    ds_read_b64_tr_b16 v[56:57], v9 offset:24576
    v_mfma_f32_16x16x32_bf16 v[92:95], v[60:63], v[252:255], v[92:95]
    ds_read_b64_tr_b16 v[58:59], v9 offset:25088
    s_waitcnt lgkmcnt(10)
    v_mfma_f32_16x16x32_bf16 v[96:99], v[32:35], v[128:131], 0
    ds_read_b64_tr_b16 v[60:61], v9 offset:25600
    ds_read_b64_tr_b16 v[62:63], v9 offset:26112
    v_cvt_pk_bf16_f32 v80, v80, v81
    v_mfma_f32_16x16x32_bf16 v[100:103], v[32:35], v[132:135], 0
    v_cvt_pk_bf16_f32 v81, v82, v83
    v_cvt_pk_bf16_f32 v84, v84, v85
    v_mfma_f32_16x16x32_bf16 v[104:107], v[36:39], v[128:131], 0
    ds_read_b64_tr_b16 v[32:33], v6 offset:16384
    ds_read_b64_tr_b16 v[34:35], v6 offset:16896
    v_cvt_pk_bf16_f32 v85, v86, v87
    v_mfma_f32_16x16x32_bf16 v[108:111], v[36:39], v[132:135], 0
    v_cvt_pk_bf16_f32 v88, v88, v89
    v_cvt_pk_bf16_f32 v89, v90, v91
    s_waitcnt lgkmcnt(10)
    v_mfma_f32_16x16x32_bf16 v[96:99], v[40:43], v[136:139], v[96:99]
    ds_read_b64_tr_b16 v[36:37], v6 offset:17408
    ds_read_b64_tr_b16 v[38:39], v6 offset:17920
    v_cvt_pk_bf16_f32 v92, v92, v93
    v_mfma_f32_16x16x32_bf16 v[100:103], v[40:43], v[140:143], v[100:103]
    v_cvt_pk_bf16_f32 v93, v94, v95
    ds_write_b16 v124, v123 offset:2560
    v_mfma_f32_16x16x32_bf16 v[104:107], v[44:47], v[136:139], v[104:107]
    ds_read_b64_tr_b16 v[40:41], v6 offset:24576
    ds_read_b64_tr_b16 v[42:43], v6 offset:25088
    ds_write_b32 v125, v122 offset:2048
    ds_write_b64 v15, v[64:65] offset:0
    v_mfma_f32_16x16x32_bf16 v[108:111], v[44:47], v[140:143], v[108:111]
    ds_write_b64 v15, v[68:69] offset:256
    ds_write_b64 v15, v[72:73] offset:1024
    ds_write_b64 v15, v[76:77] offset:1280
    s_waitcnt lgkmcnt(15)
    v_mfma_f32_16x16x32_bf16 v[112:115], v[48:51], v[128:131], 0
    ds_read_b64_tr_b16 v[44:45], v6 offset:25600
    ds_read_b64_tr_b16 v[46:47], v6 offset:26112
    ds_write_b64 v15, v[80:81] offset:2048
    ds_write_b64 v15, v[84:85] offset:2304
    ds_write_b64 v15, v[88:89] offset:3072
    v_mfma_f32_16x16x32_bf16 v[116:119], v[48:51], v[132:135], 0
    ds_write_b64 v15, v[92:93] offset:3328
    s_mov_b64 exec, 1
    ds_add_u32 v21, v22 offset:32
    s_mov_b64 exec, -1
    v_mfma_f32_16x16x32_bf16 v[120:123], v[52:55], v[128:131], 0
    ds_read_b64_tr_b16 v[48:49], v7 offset:16384
    v_mfma_f32_16x16x32_bf16 v[124:127], v[52:55], v[132:135], 0
    ds_read_b64_tr_b16 v[50:51], v7 offset:16896
    s_waitcnt lgkmcnt(15)
    v_mfma_f32_16x16x32_bf16 v[112:115], v[56:59], v[136:139], v[112:115]
    ds_read_b64_tr_b16 v[52:53], v7 offset:17408
    ds_read_b64_tr_b16 v[54:55], v7 offset:17920
    v_mfma_f32_16x16x32_bf16 v[116:119], v[56:59], v[140:143], v[116:119]
    ds_read_b32 v16, v18
    v_mfma_f32_16x16x32_bf16 v[120:123], v[60:63], v[136:139], v[120:123]
    ds_read_b64_tr_b16 v[56:57], v7 offset:24576
    v_mfma_f32_16x16x32_bf16 v[124:127], v[60:63], v[140:143], v[124:127]
    ds_read_b64_tr_b16 v[58:59], v7 offset:25088
    s_waitcnt lgkmcnt(15)
    v_mfma_f32_16x16x32_bf16 v[64:67], v[32:35], v[128:131], 0
    ds_read_b64_tr_b16 v[60:61], v7 offset:25600
    ds_read_b64_tr_b16 v[62:63], v7 offset:26112
    v_mfma_f32_16x16x32_bf16 v[68:71], v[32:35], v[132:135], 0
    s_waitcnt lgkmcnt(4)
    v_cmp_ge_u32 vcc, 5, v16
    v_mfma_f32_16x16x32_bf16 v[72:75], v[36:39], v[128:131], 0
    v_mfma_f32_16x16x32_bf16 v[76:79], v[36:39], v[132:135], 0
    s_cbranch_vccz L_cb82
    s_movk_i32 s81, 6
    s_call_b64 s[82:83], L_spin_c
L_cb82:
    ds_read_b64_tr_b16 v[32:33], v6 offset:32768
    ds_read_b64_tr_b16 v[34:35], v6 offset:33280
    v_mfma_f32_16x16x32_bf16 v[64:67], v[40:43], v[136:139], v[64:67]
    ds_read_b64_tr_b16 v[36:37], v6 offset:33792
    v_mfma_f32_16x16x32_bf16 v[68:71], v[40:43], v[140:143], v[68:71]
    ds_read_b64_tr_b16 v[38:39], v6 offset:34304
    v_mfma_f32_16x16x32_bf16 v[72:75], v[44:47], v[136:139], v[72:75]
    ds_read_b64_tr_b16 v[40:41], v6 offset:40960
    v_mfma_f32_16x16x32_bf16 v[76:79], v[44:47], v[140:143], v[76:79]
    ds_read_b64_tr_b16 v[42:43], v6 offset:41472
    v_mfma_f32_16x16x32_bf16 v[80:83], v[48:51], v[128:131], 0
    ds_read_b64_tr_b16 v[44:45], v6 offset:41984
    v_mfma_f32_16x16x32_bf16 v[84:87], v[48:51], v[132:135], 0
    ds_read_b64_tr_b16 v[46:47], v6 offset:42496
    v_mfma_f32_16x16x32_bf16 v[88:91], v[52:55], v[128:131], 0
    ds_read_b64_tr_b16 v[48:49], v7 offset:32768
    v_mfma_f32_16x16x32_bf16 v[92:95], v[52:55], v[132:135], 0
    ds_read_b64_tr_b16 v[50:51], v7 offset:33280
    s_waitcnt lgkmcnt(10)
    v_mfma_f32_16x16x32_bf16 v[80:83], v[56:59], v[136:139], v[80:83]
    ds_read_b64_tr_b16 v[52:53], v7 offset:33792
    v_mfma_f32_16x16x32_bf16 v[84:87], v[56:59], v[140:143], v[84:87]
    ds_read_b64_tr_b16 v[54:55], v7 offset:34304
    v_mfma_f32_16x16x32_bf16 v[88:91], v[60:63], v[136:139], v[88:91]
    v_mov_b32 v23, 20
    global_load_lds_dword v23, s[88:89]
    v_mfma_f32_16x16x32_bf16 v[92:95], v[60:63], v[140:143], v[92:95]
    ds_read_b64_tr_b16 v[56:57], v7 offset:40960
    ds_read_b64_tr_b16 v[58:59], v7 offset:41472
    s_waitcnt lgkmcnt(10)
    v_mfma_f32_16x16x32_bf16 v[64:67], v[32:35], v[144:147], v[64:67]
    ds_read_b64_tr_b16 v[60:61], v7 offset:41984
    v_mfma_f32_16x16x32_bf16 v[68:71], v[32:35], v[148:151], v[68:71]
    ds_read_b64_tr_b16 v[62:63], v7 offset:42496
    v_mfma_f32_16x16x32_bf16 v[72:75], v[36:39], v[144:147], v[72:75]
    ds_read_b64_tr_b16 v[32:33], v8 offset:32768
    v_mfma_f32_16x16x32_bf16 v[76:79], v[36:39], v[148:151], v[76:79]
    ds_read_b64_tr_b16 v[34:35], v8 offset:33280
    s_waitcnt lgkmcnt(10)
    v_mfma_f32_16x16x32_bf16 v[64:67], v[40:43], v[152:155], v[64:67]
    ds_read_b64_tr_b16 v[36:37], v8 offset:33792
    v_mfma_f32_16x16x32_bf16 v[68:71], v[40:43], v[156:159], v[68:71]
    ds_read_b64_tr_b16 v[38:39], v8 offset:34304
    v_mfma_f32_16x16x32_bf16 v[72:75], v[44:47], v[152:155], v[72:75]
    ds_read_b64_tr_b16 v[40:41], v8 offset:40960
    v_mfma_f32_16x16x32_bf16 v[76:79], v[44:47], v[156:159], v[76:79]
    ds_read_b64_tr_b16 v[42:43], v8 offset:41472
    s_waitcnt lgkmcnt(10)
    v_mfma_f32_16x16x32_bf16 v[80:83], v[48:51], v[144:147], v[80:83]
    ds_read_b64_tr_b16 v[44:45], v8 offset:41984
    v_mfma_f32_16x16x32_bf16 v[84:87], v[48:51], v[148:151], v[84:87]
    ds_read_b64_tr_b16 v[46:47], v8 offset:42496
    v_mfma_f32_16x16x32_bf16 v[88:91], v[52:55], v[144:147], v[88:91]
    ds_read_b64_tr_b16 v[48:49], v9 offset:32768
    v_mfma_f32_16x16x32_bf16 v[92:95], v[52:55], v[148:151], v[92:95]
    ds_read_b64_tr_b16 v[50:51], v9 offset:33280
    s_waitcnt lgkmcnt(10)
    v_mfma_f32_16x16x32_bf16 v[80:83], v[56:59], v[152:155], v[80:83]
    ds_read_b64_tr_b16 v[52:53], v9 offset:33792
    ds_read_b64_tr_b16 v[54:55], v9 offset:34304
    v_mfma_f32_16x16x32_bf16 v[84:87], v[56:59], v[156:159], v[84:87]
    ds_read_b32 v16, v18
    v_mfma_f32_16x16x32_bf16 v[88:91], v[60:63], v[152:155], v[88:91]
    ds_read_b64_tr_b16 v[56:57], v9 offset:40960
    v_mfma_f32_16x16x32_bf16 v[92:95], v[60:63], v[156:159], v[92:95]
    ds_read_b64_tr_b16 v[58:59], v9 offset:41472
    s_waitcnt lgkmcnt(11)
    v_mfma_f32_16x16x32_bf16 v[96:99], v[32:35], v[144:147], v[96:99]
    ds_read_b64_tr_b16 v[60:61], v9 offset:41984
    ds_read_b64_tr_b16 v[62:63], v9 offset:42496
    v_mfma_f32_16x16x32_bf16 v[100:103], v[32:35], v[148:151], v[100:103]
    s_waitcnt lgkmcnt(4)
    v_cmp_ge_u32 vcc, 7, v16
    v_mfma_f32_16x16x32_bf16 v[104:107], v[36:39], v[144:147], v[104:107]
    v_mfma_f32_16x16x32_bf16 v[108:111], v[36:39], v[148:151], v[108:111]
    s_cbranch_vccz L_cb83
    s_movk_i32 s81, 8
    s_call_b64 s[82:83], L_spin_c
L_cb83:
    ds_read_b64_tr_b16 v[32:33], v6 offset:49152
    ds_read_b64_tr_b16 v[34:35], v6 offset:49664
    v_mfma_f32_16x16x32_bf16 v[96:99], v[40:43], v[152:155], v[96:99]
    ds_read_b64_tr_b16 v[36:37], v6 offset:50176
    v_mfma_f32_16x16x32_bf16 v[100:103], v[40:43], v[156:159], v[100:103]
    ds_read_b64_tr_b16 v[38:39], v6 offset:50688
    v_mfma_f32_16x16x32_bf16 v[104:107], v[44:47], v[152:155], v[104:107]
    ds_read_b64_tr_b16 v[40:41], v6 offset:57344
    v_mfma_f32_16x16x32_bf16 v[108:111], v[44:47], v[156:159], v[108:111]
    ds_read_b64_tr_b16 v[42:43], v6 offset:57856
    v_mfma_f32_16x16x32_bf16 v[112:115], v[48:51], v[144:147], v[112:115]
    ds_read_b64_tr_b16 v[44:45], v6 offset:58368
    v_mfma_f32_16x16x32_bf16 v[116:119], v[48:51], v[148:151], v[116:119]
    ds_read_b64_tr_b16 v[46:47], v6 offset:58880
    v_mfma_f32_16x16x32_bf16 v[120:123], v[52:55], v[144:147], v[120:123]
    ds_read_b64_tr_b16 v[48:49], v7 offset:49152
    v_mfma_f32_16x16x32_bf16 v[124:127], v[52:55], v[148:151], v[124:127]
    ds_read_b64_tr_b16 v[50:51], v7 offset:49664
    s_waitcnt lgkmcnt(10)
    v_mfma_f32_16x16x32_bf16 v[112:115], v[56:59], v[152:155], v[112:115]
    ds_read_b64_tr_b16 v[52:53], v7 offset:50176
    ds_read_b64_tr_b16 v[54:55], v7 offset:50688
    v_mfma_f32_16x16x32_bf16 v[116:119], v[56:59], v[156:159], v[116:119]
    ds_read_b32 v20, v21 offset:1792
    v_mfma_f32_16x16x32_bf16 v[120:123], v[60:63], v[152:155], v[120:123]
    ds_read_b64_tr_b16 v[56:57], v7 offset:57344
    v_mfma_f32_16x16x32_bf16 v[124:127], v[60:63], v[156:159], v[124:127]
    ds_read_b64_tr_b16 v[58:59], v7 offset:57856
    s_waitcnt lgkmcnt(11)
    v_mfma_f32_16x16x32_bf16 v[64:67], v[32:35], v[160:163], v[64:67]
    ds_read_b64_tr_b16 v[60:61], v7 offset:58368
    v_mfma_f32_16x16x32_bf16 v[68:71], v[32:35], v[164:167], v[68:71]
    ds_read_b64_tr_b16 v[62:63], v7 offset:58880
    v_mfma_f32_16x16x32_bf16 v[72:75], v[36:39], v[160:163], v[72:75]
    ds_read_b64_tr_b16 v[32:33], v8 offset:49152
    v_mfma_f32_16x16x32_bf16 v[76:79], v[36:39], v[164:167], v[76:79]
    ds_read_b64_tr_b16 v[34:35], v8 offset:49664
    s_waitcnt lgkmcnt(11)
    v_mfma_f32_16x16x32_bf16 v[64:67], v[40:43], v[168:171], v[64:67]
    ds_read_b64_tr_b16 v[36:37], v8 offset:50176
    v_mfma_f32_16x16x32_bf16 v[68:71], v[40:43], v[172:175], v[68:71]
    ds_read_b64_tr_b16 v[38:39], v8 offset:50688
    v_mfma_f32_16x16x32_bf16 v[72:75], v[44:47], v[168:171], v[72:75]
    ds_read_b64_tr_b16 v[40:41], v8 offset:57344
    v_mfma_f32_16x16x32_bf16 v[76:79], v[44:47], v[172:175], v[76:79]
    ds_read_b64_tr_b16 v[42:43], v8 offset:57856
    s_waitcnt lgkmcnt(11)
    v_mfma_f32_16x16x32_bf16 v[80:83], v[48:51], v[160:163], v[80:83]
    ds_read_b64_tr_b16 v[44:45], v8 offset:58368
    ds_read_b64_tr_b16 v[46:47], v8 offset:58880
    v_mfma_f32_16x16x32_bf16 v[84:87], v[48:51], v[164:167], v[84:87]
    s_waitcnt lgkmcnt(12)
    v_cmp_eq_u32 vcc, 1, v20
    s_cbranch_vccnz L_ok76
    v_mov_b32 v23, 0
    s_mov_b32 s80, 0
L_spin76:
    s_sleep 4
    buffer_load_dword v20, v23, s[40:43], 0 offen offset:0 sc1
    s_add_u32 s80, s80, 1
    s_waitcnt vmcnt(0)
    v_cmp_eq_u32 vcc, 1, v20
    s_cbranch_vccnz L_ok76
    s_cmp_lt_u32 s80, 0x80000
    s_cbranch_scc1 L_spin76
L_ok76:
    v_mfma_f32_16x16x32_bf16 v[88:91], v[52:55], v[160:163], v[88:91]
    ds_read_b64_tr_b16 v[48:49], v9 offset:49152
    v_mfma_f32_16x16x32_bf16 v[92:95], v[52:55], v[164:167], v[92:95]
    ds_read_b64_tr_b16 v[50:51], v9 offset:49664
    s_waitcnt lgkmcnt(10)
    v_mfma_f32_16x16x32_bf16 v[80:83], v[56:59], v[168:171], v[80:83]
    ds_read_b64_tr_b16 v[52:53], v9 offset:50176
    v_mfma_f32_16x16x32_bf16 v[84:87], v[56:59], v[172:175], v[84:87]
    ds_read_b64_tr_b16 v[54:55], v9 offset:50688
    v_mfma_f32_16x16x32_bf16 v[88:91], v[60:63], v[168:171], v[88:91]
    ds_read_b64_tr_b16 v[56:57], v9 offset:57344
    v_mfma_f32_16x16x32_bf16 v[92:95], v[60:63], v[172:175], v[92:95]
    ds_read_b64_tr_b16 v[58:59], v9 offset:57856
    s_waitcnt lgkmcnt(10)
    v_mfma_f32_16x16x32_bf16 v[96:99], v[32:35], v[160:163], v[96:99]
    ds_read_b64_tr_b16 v[60:61], v9 offset:58368
    v_mfma_f32_16x16x32_bf16 v[100:103], v[32:35], v[164:167], v[100:103]
    ds_read_b64_tr_b16 v[62:63], v9 offset:58880
    v_mfma_f32_16x16x32_bf16 v[104:107], v[36:39], v[160:163], v[104:107]
    ds_read_b64_tr_b16 v[32:33], v2 offset:0
    v_mfma_f32_16x16x32_bf16 v[108:111], v[36:39], v[164:167], v[108:111]
    ds_read_b64_tr_b16 v[34:35], v2 offset:512
    s_waitcnt lgkmcnt(10)
    v_mfma_f32_16x16x32_bf16 v[96:99], v[40:43], v[168:171], v[96:99]
    ds_read_b64_tr_b16 v[36:37], v2 offset:1024
    v_mfma_f32_16x16x32_bf16 v[100:103], v[40:43], v[172:175], v[100:103]
    ds_read_b64_tr_b16 v[38:39], v2 offset:1536
    v_mfma_f32_16x16x32_bf16 v[104:107], v[44:47], v[168:171], v[104:107]
    ds_read_b64_tr_b16 v[40:41], v2 offset:8192
    v_mfma_f32_16x16x32_bf16 v[108:111], v[44:47], v[172:175], v[108:111]
    ds_read_b64_tr_b16 v[42:43], v2 offset:8704
    s_waitcnt lgkmcnt(10)
    v_mfma_f32_16x16x32_bf16 v[112:115], v[48:51], v[160:163], v[112:115]
    ds_read_b64_tr_b16 v[44:45], v2 offset:9216
    v_mfma_f32_16x16x32_bf16 v[116:119], v[48:51], v[164:167], v[116:119]
    ds_read_b64_tr_b16 v[46:47], v2 offset:9728
    v_mfma_f32_16x16x32_bf16 v[120:123], v[52:55], v[160:163], v[120:123]
    ds_read_b64_tr_b16 v[48:49], v3 offset:0
    v_mfma_f32_16x16x32_bf16 v[124:127], v[52:55], v[164:167], v[124:127]
    ds_read_b64_tr_b16 v[50:51], v3 offset:512
    s_waitcnt lgkmcnt(10)
    v_mfma_f32_16x16x32_bf16 v[112:115], v[56:59], v[168:171], v[112:115]
    ds_read_b64_tr_b16 v[52:53], v3 offset:1024
    v_mfma_f32_16x16x32_bf16 v[116:119], v[56:59], v[172:175], v[116:119]
    ds_read_b64_tr_b16 v[54:55], v3 offset:1536
    v_mfma_f32_16x16x32_bf16 v[120:123], v[60:63], v[168:171], v[120:123]
    v_mov_b32 v23, 28
    global_load_lds_dword v23, s[88:89]
    v_mfma_f32_16x16x32_bf16 v[124:127], v[60:63], v[172:175], v[124:127]
    ds_read_b64_tr_b16 v[56:57], v3 offset:8192
    ds_read_b64_tr_b16 v[58:59], v3 offset:8704
    s_waitcnt lgkmcnt(10)
    v_mfma_f32_16x16x32_bf16 v[64:67], v[32:35], v[176:179], v[64:67]
    ds_read_b64_tr_b16 v[60:61], v3 offset:9216
    v_mfma_f32_16x16x32_bf16 v[68:71], v[32:35], v[180:183], v[68:71]
    ds_read_b64_tr_b16 v[62:63], v3 offset:9728
    v_mfma_f32_16x16x32_bf16 v[72:75], v[36:39], v[176:179], v[72:75]
    ds_read_b64_tr_b16 v[32:33], v4 offset:0
    v_mfma_f32_16x16x32_bf16 v[76:79], v[36:39], v[180:183], v[76:79]
    ds_read_b64_tr_b16 v[34:35], v4 offset:512
    s_waitcnt lgkmcnt(10)
    v_mfma_f32_16x16x32_bf16 v[64:67], v[40:43], v[184:187], v[64:67]
    ds_read_b64_tr_b16 v[36:37], v4 offset:1024
    v_mfma_f32_16x16x32_bf16 v[68:71], v[40:43], v[188:191], v[68:71]
    ds_read_b64_tr_b16 v[38:39], v4 offset:1536
    v_mfma_f32_16x16x32_bf16 v[72:75], v[44:47], v[184:187], v[72:75]
    ds_read_b64_tr_b16 v[40:41], v4 offset:8192
    v_mfma_f32_16x16x32_bf16 v[76:79], v[44:47], v[188:191], v[76:79]
    ds_read_b64_tr_b16 v[42:43], v4 offset:8704
    s_waitcnt lgkmcnt(10)
    v_mfma_f32_16x16x32_bf16 v[80:83], v[48:51], v[176:179], v[80:83]
    ds_read_b64_tr_b16 v[44:45], v4 offset:9216
    v_mfma_f32_16x16x32_bf16 v[84:87], v[48:51], v[180:183], v[84:87]
    ds_read_b64_tr_b16 v[46:47], v4 offset:9728
    v_mfma_f32_16x16x32_bf16 v[88:91], v[52:55], v[176:179], v[88:91]
    ds_read_b64_tr_b16 v[48:49], v5 offset:0
    v_mfma_f32_16x16x32_bf16 v[92:95], v[52:55], v[180:183], v[92:95]
    ds_read_b64_tr_b16 v[50:51], v5 offset:512
    s_waitcnt lgkmcnt(10)
    v_mfma_f32_16x16x32_bf16 v[80:83], v[56:59], v[184:187], v[80:83]
    ds_read_b64_tr_b16 v[52:53], v5 offset:1024
    ds_read_b64_tr_b16 v[54:55], v5 offset:1536
    v_mfma_f32_16x16x32_bf16 v[84:87], v[56:59], v[188:191], v[84:87]
    ds_read_b32 v16, v18
    v_mfma_f32_16x16x32_bf16 v[88:91], v[60:63], v[184:187], v[88:91]
    ds_read_b64_tr_b16 v[56:57], v5 offset:8192
    v_mfma_f32_16x16x32_bf16 v[92:95], v[60:63], v[188:191], v[92:95]
    ds_read_b64_tr_b16 v[58:59], v5 offset:8704
    s_waitcnt lgkmcnt(11)
    v_mfma_f32_16x16x32_bf16 v[96:99], v[32:35], v[176:179], v[96:99]
    ds_read_b64_tr_b16 v[60:61], v5 offset:9216
    ds_read_b64_tr_b16 v[62:63], v5 offset:9728
    v_mfma_f32_16x16x32_bf16 v[100:103], v[32:35], v[180:183], v[100:103]
    s_waitcnt lgkmcnt(4)
    v_cmp_ge_u32 vcc, 9, v16
    v_mfma_f32_16x16x32_bf16 v[104:107], v[36:39], v[176:179], v[104:107]
    v_mfma_f32_16x16x32_bf16 v[108:111], v[36:39], v[180:183], v[108:111]
    s_cbranch_vccz L_cb84
    s_movk_i32 s81, 10
    s_call_b64 s[82:83], L_spin_c
L_cb84:
    ds_read_b64_tr_b16 v[32:33], v2 offset:32768
    ds_read_b64_tr_b16 v[34:35], v2 offset:33280
    v_mfma_f32_16x16x32_bf16 v[96:99], v[40:43], v[184:187], v[96:99]
    ds_read_b64_tr_b16 v[36:37], v2 offset:33792
    v_mfma_f32_16x16x32_bf16 v[100:103], v[40:43], v[188:191], v[100:103]
    ds_read_b64_tr_b16 v[38:39], v2 offset:34304
    v_mfma_f32_16x16x32_bf16 v[104:107], v[44:47], v[184:187], v[104:107]
    ds_read_b64_tr_b16 v[40:41], v2 offset:40960
    v_mfma_f32_16x16x32_bf16 v[108:111], v[44:47], v[188:191], v[108:111]
    ds_read_b64_tr_b16 v[42:43], v2 offset:41472
    v_mfma_f32_16x16x32_bf16 v[112:115], v[48:51], v[176:179], v[112:115]
    ds_read_b64_tr_b16 v[44:45], v2 offset:41984
    v_mfma_f32_16x16x32_bf16 v[116:119], v[48:51], v[180:183], v[116:119]
    ds_read_b64_tr_b16 v[46:47], v2 offset:42496
    v_mfma_f32_16x16x32_bf16 v[120:123], v[52:55], v[176:179], v[120:123]
    ds_read_b64_tr_b16 v[48:49], v3 offset:32768
    v_mfma_f32_16x16x32_bf16 v[124:127], v[52:55], v[180:183], v[124:127]
    ds_read_b64_tr_b16 v[50:51], v3 offset:33280
    s_waitcnt lgkmcnt(10)
    v_mfma_f32_16x16x32_bf16 v[112:115], v[56:59], v[184:187], v[112:115]
    ds_read_b64_tr_b16 v[52:53], v3 offset:33792
    v_mfma_f32_16x16x32_bf16 v[116:119], v[56:59], v[188:191], v[116:119]
    ds_read_b64_tr_b16 v[54:55], v3 offset:34304
    v_mfma_f32_16x16x32_bf16 v[120:123], v[60:63], v[184:187], v[120:123]
    ds_read_b64_tr_b16 v[56:57], v3 offset:40960
    v_mfma_f32_16x16x32_bf16 v[124:127], v[60:63], v[188:191], v[124:127]
    ds_read_b64_tr_b16 v[58:59], v3 offset:41472
    s_waitcnt lgkmcnt(10)
    v_mfma_f32_16x16x32_bf16 v[64:67], v[32:35], v[192:195], v[64:67]
    ds_read_b64_tr_b16 v[60:61], v3 offset:41984
    v_mfma_f32_16x16x32_bf16 v[68:71], v[32:35], v[196:199], v[68:71]
    ds_read_b64_tr_b16 v[62:63], v3 offset:42496
    v_mfma_f32_16x16x32_bf16 v[72:75], v[36:39], v[192:195], v[72:75]
    ds_read_b64_tr_b16 v[32:33], v4 offset:32768
    v_mfma_f32_16x16x32_bf16 v[76:79], v[36:39], v[196:199], v[76:79]
    ds_read_b64_tr_b16 v[34:35], v4 offset:33280
    s_waitcnt lgkmcnt(10)
    v_mfma_f32_16x16x32_bf16 v[64:67], v[40:43], v[200:203], v[64:67]
    ds_read_b64_tr_b16 v[36:37], v4 offset:33792
    v_mfma_f32_16x16x32_bf16 v[68:71], v[40:43], v[204:207], v[68:71]
    ds_read_b64_tr_b16 v[38:39], v4 offset:34304
    v_mfma_f32_16x16x32_bf16 v[72:75], v[44:47], v[200:203], v[72:75]
    ds_read_b64_tr_b16 v[40:41], v4 offset:40960
    v_mfma_f32_16x16x32_bf16 v[76:79], v[44:47], v[204:207], v[76:79]
    ds_read_b64_tr_b16 v[42:43], v4 offset:41472
    s_waitcnt lgkmcnt(10)
    v_mfma_f32_16x16x32_bf16 v[80:83], v[48:51], v[192:195], v[80:83]
    ds_read_b64_tr_b16 v[44:45], v4 offset:41984
    v_mfma_f32_16x16x32_bf16 v[84:87], v[48:51], v[196:199], v[84:87]
    ds_read_b64_tr_b16 v[46:47], v4 offset:42496
    v_mfma_f32_16x16x32_bf16 v[88:91], v[52:55], v[192:195], v[88:91]
    ds_read_b64_tr_b16 v[48:49], v5 offset:32768
    v_mfma_f32_16x16x32_bf16 v[92:95], v[52:55], v[196:199], v[92:95]
    ds_read_b64_tr_b16 v[50:51], v5 offset:33280
    s_waitcnt lgkmcnt(10)
    v_mfma_f32_16x16x32_bf16 v[80:83], v[56:59], v[200:203], v[80:83]
    ds_read_b64_tr_b16 v[52:53], v5 offset:33792
    v_mfma_f32_16x16x32_bf16 v[84:87], v[56:59], v[204:207], v[84:87]
    ds_read_b64_tr_b16 v[54:55], v5 offset:34304
    v_mfma_f32_16x16x32_bf16 v[88:91], v[60:63], v[200:203], v[88:91]
    ds_read_b64_tr_b16 v[56:57], v5 offset:40960
    v_mfma_f32_16x16x32_bf16 v[92:95], v[60:63], v[204:207], v[92:95]
    ds_read_b64_tr_b16 v[58:59], v5 offset:41472
    s_waitcnt lgkmcnt(10)
    v_mfma_f32_16x16x32_bf16 v[96:99], v[32:35], v[192:195], v[96:99]
    ds_read_b64_tr_b16 v[60:61], v5 offset:41984
    v_mfma_f32_16x16x32_bf16 v[100:103], v[32:35], v[196:199], v[100:103]
    ds_read_b64_tr_b16 v[62:63], v5 offset:42496
    v_mfma_f32_16x16x32_bf16 v[104:107], v[36:39], v[192:195], v[104:107]
    ds_read_b64_tr_b16 v[32:33], v2 offset:49152
    v_mfma_f32_16x16x32_bf16 v[108:111], v[36:39], v[196:199], v[108:111]
    ds_read_b64_tr_b16 v[34:35], v2 offset:49664
    s_waitcnt lgkmcnt(10)
    v_mfma_f32_16x16x32_bf16 v[96:99], v[40:43], v[200:203], v[96:99]
    ds_read_b64_tr_b16 v[36:37], v2 offset:50176
    v_mfma_f32_16x16x32_bf16 v[100:103], v[40:43], v[204:207], v[100:103]
    ds_read_b64_tr_b16 v[38:39], v2 offset:50688
    v_mfma_f32_16x16x32_bf16 v[104:107], v[44:47], v[200:203], v[104:107]
    ds_read_b64_tr_b16 v[40:41], v2 offset:57344
    v_mfma_f32_16x16x32_bf16 v[108:111], v[44:47], v[204:207], v[108:111]
    ds_read_b64_tr_b16 v[42:43], v2 offset:57856
    s_waitcnt lgkmcnt(10)
    v_mfma_f32_16x16x32_bf16 v[112:115], v[48:51], v[192:195], v[112:115]
    ds_read_b64_tr_b16 v[44:45], v2 offset:58368
    v_mfma_f32_16x16x32_bf16 v[116:119], v[48:51], v[196:199], v[116:119]
    ds_read_b64_tr_b16 v[46:47], v2 offset:58880
    v_mfma_f32_16x16x32_bf16 v[120:123], v[52:55], v[192:195], v[120:123]
    ds_read_b64_tr_b16 v[48:49], v3 offset:49152
    v_mfma_f32_16x16x32_bf16 v[124:127], v[52:55], v[196:199], v[124:127]
    ds_read_b64_tr_b16 v[50:51], v3 offset:49664
    s_waitcnt lgkmcnt(10)
    v_mfma_f32_16x16x32_bf16 v[112:115], v[56:59], v[200:203], v[112:115]
    ds_read_b64_tr_b16 v[52:53], v3 offset:50176
    v_mfma_f32_16x16x32_bf16 v[116:119], v[56:59], v[204:207], v[116:119]
    ds_read_b64_tr_b16 v[54:55], v3 offset:50688
    v_mfma_f32_16x16x32_bf16 v[120:123], v[60:63], v[200:203], v[120:123]
    v_mov_b32 v23, 36
    global_load_lds_dword v23, s[88:89]
    v_mfma_f32_16x16x32_bf16 v[124:127], v[60:63], v[204:207], v[124:127]
    ds_read_b64_tr_b16 v[56:57], v3 offset:57344
    ds_read_b64_tr_b16 v[58:59], v3 offset:57856
    s_waitcnt lgkmcnt(10)
    v_mfma_f32_16x16x32_bf16 v[64:67], v[32:35], v[208:211], v[64:67]
    ds_read_b64_tr_b16 v[60:61], v3 offset:58368
    v_mfma_f32_16x16x32_bf16 v[68:71], v[32:35], v[212:215], v[68:71]
    ds_read_b64_tr_b16 v[62:63], v3 offset:58880
    v_mfma_f32_16x16x32_bf16 v[72:75], v[36:39], v[208:211], v[72:75]
    ds_read_b64_tr_b16 v[32:33], v4 offset:49152
    v_mfma_f32_16x16x32_bf16 v[76:79], v[36:39], v[212:215], v[76:79]
    ds_read_b64_tr_b16 v[34:35], v4 offset:49664
    s_waitcnt lgkmcnt(10)
    v_mfma_f32_16x16x32_bf16 v[64:67], v[40:43], v[216:219], v[64:67]
    ds_read_b64_tr_b16 v[36:37], v4 offset:50176
    v_mfma_f32_16x16x32_bf16 v[68:71], v[40:43], v[220:223], v[68:71]
    ds_read_b64_tr_b16 v[38:39], v4 offset:50688
    v_mfma_f32_16x16x32_bf16 v[72:75], v[44:47], v[216:219], v[72:75]
    ds_read_b64_tr_b16 v[40:41], v4 offset:57344
    v_mfma_f32_16x16x32_bf16 v[76:79], v[44:47], v[220:223], v[76:79]
    ds_read_b64_tr_b16 v[42:43], v4 offset:57856
    s_waitcnt lgkmcnt(10)
    v_mfma_f32_16x16x32_bf16 v[80:83], v[48:51], v[208:211], v[80:83]
    ds_read_b64_tr_b16 v[44:45], v4 offset:58368
    v_mfma_f32_16x16x32_bf16 v[84:87], v[48:51], v[212:215], v[84:87]
    ds_read_b64_tr_b16 v[46:47], v4 offset:58880
    v_mfma_f32_16x16x32_bf16 v[88:91], v[52:55], v[208:211], v[88:91]
    ds_read_b64_tr_b16 v[48:49], v5 offset:49152
    v_mfma_f32_16x16x32_bf16 v[92:95], v[52:55], v[212:215], v[92:95]
    ds_read_b64_tr_b16 v[50:51], v5 offset:49664
    s_waitcnt lgkmcnt(10)
    v_mfma_f32_16x16x32_bf16 v[80:83], v[56:59], v[216:219], v[80:83]
    ds_read_b64_tr_b16 v[52:53], v5 offset:50176
    ds_read_b64_tr_b16 v[54:55], v5 offset:50688
    v_mfma_f32_16x16x32_bf16 v[84:87], v[56:59], v[220:223], v[84:87]
    ds_read_b32 v16, v18
    v_mfma_f32_16x16x32_bf16 v[88:91], v[60:63], v[216:219], v[88:91]
    ds_read_b64_tr_b16 v[56:57], v5 offset:57344
    v_mfma_f32_16x16x32_bf16 v[92:95], v[60:63], v[220:223], v[92:95]
    ds_read_b64_tr_b16 v[58:59], v5 offset:57856
    s_waitcnt lgkmcnt(11)
    v_mfma_f32_16x16x32_bf16 v[96:99], v[32:35], v[208:211], v[96:99]
    ds_read_b64_tr_b16 v[60:61], v5 offset:58368
    ds_read_b64_tr_b16 v[62:63], v5 offset:58880
    v_mfma_f32_16x16x32_bf16 v[100:103], v[32:35], v[212:215], v[100:103]
    s_waitcnt lgkmcnt(4)
    v_cmp_ge_u32 vcc, 11, v16
    v_mfma_f32_16x16x32_bf16 v[104:107], v[36:39], v[208:211], v[104:107]
    v_mfma_f32_16x16x32_bf16 v[108:111], v[36:39], v[212:215], v[108:111]
    s_cbranch_vccz L_cb85
    s_movk_i32 s81, 12
    s_call_b64 s[82:83], L_spin_c
L_cb85:
    ds_read_b64_tr_b16 v[32:33], v6 offset:0
    ds_read_b64_tr_b16 v[34:35], v6 offset:512
    v_mfma_f32_16x16x32_bf16 v[96:99], v[40:43], v[216:219], v[96:99]
    ds_read_b64_tr_b16 v[36:37], v6 offset:1024
    v_mfma_f32_16x16x32_bf16 v[100:103], v[40:43], v[220:223], v[100:103]
    ds_read_b64_tr_b16 v[38:39], v6 offset:1536
    v_mfma_f32_16x16x32_bf16 v[104:107], v[44:47], v[216:219], v[104:107]
    ds_read_b64_tr_b16 v[40:41], v6 offset:8192
    v_mfma_f32_16x16x32_bf16 v[108:111], v[44:47], v[220:223], v[108:111]
    ds_read_b64_tr_b16 v[42:43], v6 offset:8704
    v_mfma_f32_16x16x32_bf16 v[112:115], v[48:51], v[208:211], v[112:115]
    ds_read_b64_tr_b16 v[44:45], v6 offset:9216
    v_mfma_f32_16x16x32_bf16 v[116:119], v[48:51], v[212:215], v[116:119]
    ds_read_b64_tr_b16 v[46:47], v6 offset:9728
    v_mfma_f32_16x16x32_bf16 v[120:123], v[52:55], v[208:211], v[120:123]
    ds_read_b64_tr_b16 v[48:49], v7 offset:0
    v_mfma_f32_16x16x32_bf16 v[124:127], v[52:55], v[212:215], v[124:127]
    ds_read_b64_tr_b16 v[50:51], v7 offset:512
    s_waitcnt lgkmcnt(10)
    v_mfma_f32_16x16x32_bf16 v[112:115], v[56:59], v[216:219], v[112:115]
    ds_read_b64_tr_b16 v[52:53], v7 offset:1024
    v_mfma_f32_16x16x32_bf16 v[116:119], v[56:59], v[220:223], v[116:119]
    ds_read_b64_tr_b16 v[54:55], v7 offset:1536
    v_mfma_f32_16x16x32_bf16 v[120:123], v[60:63], v[216:219], v[120:123]
    ds_read_b64_tr_b16 v[56:57], v7 offset:8192
    v_mfma_f32_16x16x32_bf16 v[124:127], v[60:63], v[220:223], v[124:127]
    ds_read_b64_tr_b16 v[58:59], v7 offset:8704
    s_waitcnt lgkmcnt(10)
    v_mfma_f32_16x16x32_bf16 v[64:67], v[32:35], v[224:227], v[64:67]
    ds_read_b64_tr_b16 v[60:61], v7 offset:9216
    v_mfma_f32_16x16x32_bf16 v[68:71], v[32:35], v[228:231], v[68:71]
    ds_read_b64_tr_b16 v[62:63], v7 offset:9728
    v_mfma_f32_16x16x32_bf16 v[72:75], v[36:39], v[224:227], v[72:75]
    ds_read_b64_tr_b16 v[32:33], v8 offset:0
    v_mfma_f32_16x16x32_bf16 v[76:79], v[36:39], v[228:231], v[76:79]
    ds_read_b64_tr_b16 v[34:35], v8 offset:512
    s_waitcnt lgkmcnt(10)
    v_mfma_f32_16x16x32_bf16 v[64:67], v[40:43], v[232:235], v[64:67]
    ds_read_b64_tr_b16 v[36:37], v8 offset:1024
    v_mfma_f32_16x16x32_bf16 v[68:71], v[40:43], v[236:239], v[68:71]
    ds_read_b64_tr_b16 v[38:39], v8 offset:1536
    v_mfma_f32_16x16x32_bf16 v[72:75], v[44:47], v[232:235], v[72:75]
    ds_read_b64_tr_b16 v[40:41], v8 offset:8192
    v_mfma_f32_16x16x32_bf16 v[76:79], v[44:47], v[236:239], v[76:79]
    ds_read_b64_tr_b16 v[42:43], v8 offset:8704
    s_waitcnt lgkmcnt(10)
    v_mfma_f32_16x16x32_bf16 v[80:83], v[48:51], v[224:227], v[80:83]
    ds_read_b64_tr_b16 v[44:45], v8 offset:9216
    v_mfma_f32_16x16x32_bf16 v[84:87], v[48:51], v[228:231], v[84:87]
    ds_read_b64_tr_b16 v[46:47], v8 offset:9728
    v_mfma_f32_16x16x32_bf16 v[88:91], v[52:55], v[224:227], v[88:91]
    ds_read_b64_tr_b16 v[48:49], v9 offset:0
    v_mfma_f32_16x16x32_bf16 v[92:95], v[52:55], v[228:231], v[92:95]
    ds_read_b64_tr_b16 v[50:51], v9 offset:512
    s_waitcnt lgkmcnt(10)
    v_mfma_f32_16x16x32_bf16 v[80:83], v[56:59], v[232:235], v[80:83]
    ds_read_b64_tr_b16 v[52:53], v9 offset:1024
    v_mfma_f32_16x16x32_bf16 v[84:87], v[56:59], v[236:239], v[84:87]
    ds_read_b64_tr_b16 v[54:55], v9 offset:1536
    v_mfma_f32_16x16x32_bf16 v[88:91], v[60:63], v[232:235], v[88:91]
    ds_read_b64_tr_b16 v[56:57], v9 offset:8192
    v_mfma_f32_16x16x32_bf16 v[92:95], v[60:63], v[236:239], v[92:95]
    ds_read_b64_tr_b16 v[58:59], v9 offset:8704
    s_waitcnt lgkmcnt(10)
    v_mfma_f32_16x16x32_bf16 v[96:99], v[32:35], v[224:227], v[96:99]
    ds_read_b64_tr_b16 v[60:61], v9 offset:9216
    v_mfma_f32_16x16x32_bf16 v[100:103], v[32:35], v[228:231], v[100:103]
    ds_read_b64_tr_b16 v[62:63], v9 offset:9728
    v_mfma_f32_16x16x32_bf16 v[104:107], v[36:39], v[224:227], v[104:107]
    ds_read_b64_tr_b16 v[32:33], v6 offset:16384
    v_mfma_f32_16x16x32_bf16 v[108:111], v[36:39], v[228:231], v[108:111]
    ds_read_b64_tr_b16 v[34:35], v6 offset:16896
    s_waitcnt lgkmcnt(10)
    v_mfma_f32_16x16x32_bf16 v[96:99], v[40:43], v[232:235], v[96:99]
    ds_read_b64_tr_b16 v[36:37], v6 offset:17408
    v_mfma_f32_16x16x32_bf16 v[100:103], v[40:43], v[236:239], v[100:103]
    ds_read_b64_tr_b16 v[38:39], v6 offset:17920
    v_mfma_f32_16x16x32_bf16 v[104:107], v[44:47], v[232:235], v[104:107]
    ds_read_b64_tr_b16 v[40:41], v6 offset:24576
    v_mfma_f32_16x16x32_bf16 v[108:111], v[44:47], v[236:239], v[108:111]
    ds_read_b64_tr_b16 v[42:43], v6 offset:25088
    s_waitcnt lgkmcnt(10)
    v_mfma_f32_16x16x32_bf16 v[112:115], v[48:51], v[224:227], v[112:115]
    ds_read_b64_tr_b16 v[44:45], v6 offset:25600
    v_mfma_f32_16x16x32_bf16 v[116:119], v[48:51], v[228:231], v[116:119]
    ds_read_b64_tr_b16 v[46:47], v6 offset:26112
    v_mfma_f32_16x16x32_bf16 v[120:123], v[52:55], v[224:227], v[120:123]
    ds_read_b64_tr_b16 v[48:49], v7 offset:16384
    v_mfma_f32_16x16x32_bf16 v[124:127], v[52:55], v[228:231], v[124:127]
    ds_read_b64_tr_b16 v[50:51], v7 offset:16896
    s_waitcnt lgkmcnt(10)
    v_mfma_f32_16x16x32_bf16 v[112:115], v[56:59], v[232:235], v[112:115]
    ds_read_b64_tr_b16 v[52:53], v7 offset:17408
    v_mfma_f32_16x16x32_bf16 v[116:119], v[56:59], v[236:239], v[116:119]
    ds_read_b64_tr_b16 v[54:55], v7 offset:17920
    v_mfma_f32_16x16x32_bf16 v[120:123], v[60:63], v[232:235], v[120:123]
    v_mov_b32 v23, 44
    global_load_lds_dword v23, s[88:89]
    v_mfma_f32_16x16x32_bf16 v[124:127], v[60:63], v[236:239], v[124:127]
    ds_read_b64_tr_b16 v[56:57], v7 offset:24576
    ds_read_b64_tr_b16 v[58:59], v7 offset:25088
    s_waitcnt lgkmcnt(10)
    v_mfma_f32_16x16x32_bf16 v[64:67], v[32:35], v[240:243], v[64:67]
    ds_read_b64_tr_b16 v[60:61], v7 offset:25600
    v_mfma_f32_16x16x32_bf16 v[68:71], v[32:35], v[244:247], v[68:71]
    ds_read_b64_tr_b16 v[62:63], v7 offset:26112
    v_mfma_f32_16x16x32_bf16 v[72:75], v[36:39], v[240:243], v[72:75]
    ds_read_b64_tr_b16 v[32:33], v8 offset:16384
    v_mfma_f32_16x16x32_bf16 v[76:79], v[36:39], v[244:247], v[76:79]
    ds_read_b64_tr_b16 v[34:35], v8 offset:16896
    s_waitcnt lgkmcnt(10)
    v_mfma_f32_16x16x32_bf16 v[64:67], v[40:43], v[248:251], v[64:67]
    ds_read_b64_tr_b16 v[36:37], v8 offset:17408
    v_mfma_f32_16x16x32_bf16 v[68:71], v[40:43], v[252:255], v[68:71]
    ds_read_b64_tr_b16 v[38:39], v8 offset:17920
    v_mfma_f32_16x16x32_bf16 v[72:75], v[44:47], v[248:251], v[72:75]
    ds_read_b64_tr_b16 v[40:41], v8 offset:24576
    v_mfma_f32_16x16x32_bf16 v[76:79], v[44:47], v[252:255], v[76:79]
    ds_read_b64_tr_b16 v[42:43], v8 offset:25088
    s_waitcnt lgkmcnt(10)
    v_mfma_f32_16x16x32_bf16 v[80:83], v[48:51], v[240:243], v[80:83]
    ds_read_b64_tr_b16 v[44:45], v8 offset:25600
    ds_read_b64_tr_b16 v[46:47], v8 offset:26112
    s_nop 0
    v_mul_f32 v64, v64, v72
    v_mfma_f32_16x16x32_bf16 v[84:87], v[48:51], v[244:247], v[84:87]
    v_mul_f32 v65, v65, v73
    v_mul_f32 v66, v66, v74
    v_mfma_f32_16x16x32_bf16 v[88:91], v[52:55], v[240:243], v[88:91]
    ds_read_b64_tr_b16 v[48:49], v9 offset:16384
    ds_read_b64_tr_b16 v[50:51], v9 offset:16896
    v_mul_f32 v67, v67, v75
    v_mfma_f32_16x16x32_bf16 v[92:95], v[52:55], v[244:247], v[92:95]
    v_mul_f32 v68, v68, v76
    v_mul_f32 v69, v69, v77
    s_waitcnt lgkmcnt(10)
    v_mfma_f32_16x16x32_bf16 v[80:83], v[56:59], v[248:251], v[80:83]
    ds_read_b64_tr_b16 v[52:53], v9 offset:17408
    ds_read_b64_tr_b16 v[54:55], v9 offset:17920
    ds_read_b32 v16, v18
    v_mfma_f32_16x16x32_bf16 v[84:87], v[56:59], v[252:255], v[84:87]
    v_mul_f32 v70, v70, v78
    v_mul_f32 v71, v71, v79
    v_cvt_pk_bf16_f32 v72, v64, v65
    v_mfma_f32_16x16x32_bf16 v[88:91], v[60:63], v[248:251], v[88:91]
    ds_read_b64_tr_b16 v[56:57], v9 offset:24576
    ds_read_b64_tr_b16 v[58:59], v9 offset:25088
    v_cvt_pk_bf16_f32 v73, v66, v67
    v_mfma_f32_16x16x32_bf16 v[92:95], v[60:63], v[252:255], v[92:95]
    v_cvt_pk_bf16_f32 v76, v68, v69
    v_cvt_pk_bf16_f32 v77, v70, v71
    s_waitcnt lgkmcnt(11)
    v_mfma_f32_16x16x32_bf16 v[96:99], v[32:35], v[240:243], v[96:99]
    ds_read_b64_tr_b16 v[60:61], v9 offset:25600
    ds_read_b64_tr_b16 v[62:63], v9 offset:26112
    v_mfma_f32_16x16x32_bf16 v[100:103], v[32:35], v[244:247], v[100:103]
    s_waitcnt lgkmcnt(4)
    v_cmp_ge_u32 vcc, 12, v16
    v_mul_f32 v80, v80, v88
    v_mul_f32 v81, v81, v89
    v_mul_f32 v82, v82, v90
    v_mfma_f32_16x16x32_bf16 v[104:107], v[36:39], v[240:243], v[104:107]
    v_mfma_f32_16x16x32_bf16 v[108:111], v[36:39], v[244:247], v[108:111]
    s_cbranch_vccz L_cb86
    s_movk_i32 s81, 13
    s_call_b64 s[82:83], L_spin_c
L_cb86:
    ds_read_b64_tr_b16 v[32:33], v6 offset:32768
    ds_read_b64_tr_b16 v[34:35], v6 offset:33280
    v_mul_f32 v83, v83, v91
    v_mul_f32 v84, v84, v92
    v_mul_f32 v85, v85, v93
    v_mfma_f32_16x16x32_bf16 v[96:99], v[40:43], v[248:251], v[96:99]
    ds_read_b64_tr_b16 v[36:37], v6 offset:33792
    ds_read_b64_tr_b16 v[38:39], v6 offset:34304
    v_mul_f32 v86, v86, v94
    v_mfma_f32_16x16x32_bf16 v[100:103], v[40:43], v[252:255], v[100:103]
    v_mul_f32 v87, v87, v95
    v_cvt_pk_bf16_f32 v74, v80, v81
    v_mfma_f32_16x16x32_bf16 v[104:107], v[44:47], v[248:251], v[104:107]
    ds_read_b64_tr_b16 v[40:41], v6 offset:40960
    ds_read_b64_tr_b16 v[42:43], v6 offset:41472
    v_cvt_pk_bf16_f32 v75, v82, v83
    v_mfma_f32_16x16x32_bf16 v[108:111], v[44:47], v[252:255], v[108:111]
    buffer_store_dwordx4 v[72:75], v14, s[44:47], s76 offen offset:0 sc1
    v_cvt_pk_bf16_f32 v78, v84, v85
    v_mfma_f32_16x16x32_bf16 v[112:115], v[48:51], v[240:243], v[112:115]
    ds_read_b64_tr_b16 v[44:45], v6 offset:41984
    ds_read_b64_tr_b16 v[46:47], v6 offset:42496
    v_cvt_pk_bf16_f32 v79, v86, v87
    v_mfma_f32_16x16x32_bf16 v[116:119], v[48:51], v[244:247], v[116:119]
    buffer_store_dwordx4 v[76:79], v14, s[44:47], s76 offen offset:1024 sc1
    v_mul_f32 v96, v96, v104
    v_mfma_f32_16x16x32_bf16 v[120:123], v[52:55], v[240:243], v[120:123]
    ds_read_b64_tr_b16 v[48:49], v7 offset:32768
    ds_read_b64_tr_b16 v[50:51], v7 offset:33280
    v_mul_f32 v97, v97, v105
    v_mfma_f32_16x16x32_bf16 v[124:127], v[52:55], v[244:247], v[124:127]
    v_mul_f32 v98, v98, v106
    v_mul_f32 v99, v99, v107
    s_waitcnt lgkmcnt(10)
    v_mfma_f32_16x16x32_bf16 v[112:115], v[56:59], v[248:251], v[112:115]
    ds_read_b64_tr_b16 v[52:53], v7 offset:33792
    ds_read_b64_tr_b16 v[54:55], v7 offset:34304
    v_mul_f32 v100, v100, v108
    v_mfma_f32_16x16x32_bf16 v[116:119], v[56:59], v[252:255], v[116:119]
    v_mul_f32 v101, v101, v109
    v_mul_f32 v102, v102, v110
    v_mfma_f32_16x16x32_bf16 v[120:123], v[60:63], v[248:251], v[120:123]
    ds_read_b64_tr_b16 v[56:57], v7 offset:40960
    ds_read_b64_tr_b16 v[58:59], v7 offset:41472
    v_mul_f32 v103, v103, v111
    v_mfma_f32_16x16x32_bf16 v[124:127], v[60:63], v[252:255], v[124:127]
    v_cvt_pk_bf16_f32 v104, v96, v97
    v_cvt_pk_bf16_f32 v105, v98, v99
    s_waitcnt lgkmcnt(10)
    v_mfma_f32_16x16x32_bf16 v[64:67], v[32:35], v[128:131], 0
    ds_read_b64_tr_b16 v[60:61], v7 offset:41984
    ds_read_b64_tr_b16 v[62:63], v7 offset:42496
    v_cvt_pk_bf16_f32 v108, v100, v101
    v_mfma_f32_16x16x32_bf16 v[68:71], v[32:35], v[132:135], 0
    v_cvt_pk_bf16_f32 v109, v102, v103
    v_mul_f32 v112, v112, v120
    v_mfma_f32_16x16x32_bf16 v[72:75], v[36:39], v[128:131], 0
    ds_read_b64_tr_b16 v[32:33], v8 offset:32768
    ds_read_b64_tr_b16 v[34:35], v8 offset:33280
    v_mul_f32 v113, v113, v121
    v_mfma_f32_16x16x32_bf16 v[76:79], v[36:39], v[132:135], 0
    v_mul_f32 v114, v114, v122
    v_mul_f32 v115, v115, v123
    s_waitcnt lgkmcnt(10)
    v_mfma_f32_16x16x32_bf16 v[64:67], v[40:43], v[136:139], v[64:67]
    ds_read_b64_tr_b16 v[36:37], v8 offset:33792
    ds_read_b64_tr_b16 v[38:39], v8 offset:34304
    v_mul_f32 v116, v116, v124
    v_mfma_f32_16x16x32_bf16 v[68:71], v[40:43], v[140:143], v[68:71]
    v_mul_f32 v117, v117, v125
    v_mul_f32 v118, v118, v126
    v_mfma_f32_16x16x32_bf16 v[72:75], v[44:47], v[136:139], v[72:75]
    ds_read_b64_tr_b16 v[40:41], v8 offset:40960
    ds_read_b64_tr_b16 v[42:43], v8 offset:41472
    v_mul_f32 v119, v119, v127
    v_mfma_f32_16x16x32_bf16 v[76:79], v[44:47], v[140:143], v[76:79]
    v_cvt_pk_bf16_f32 v106, v112, v113
    v_cvt_pk_bf16_f32 v107, v114, v115
    s_waitcnt lgkmcnt(10)
    v_mfma_f32_16x16x32_bf16 v[80:83], v[48:51], v[128:131], 0
    ds_read_b64_tr_b16 v[44:45], v8 offset:41984
    ds_read_b64_tr_b16 v[46:47], v8 offset:42496
    buffer_store_dwordx4 v[104:107], v14, s[44:47], s76 offen offset:2048 sc1
    v_mfma_f32_16x16x32_bf16 v[84:87], v[48:51], v[132:135], 0
    v_cvt_pk_bf16_f32 v110, v116, v117
    v_cvt_pk_bf16_f32 v111, v118, v119
    v_mfma_f32_16x16x32_bf16 v[88:91], v[52:55], v[128:131], 0
    ds_read_b64_tr_b16 v[48:49], v9 offset:32768
    ds_read_b64_tr_b16 v[50:51], v9 offset:33280
    v_mfma_f32_16x16x32_bf16 v[92:95], v[52:55], v[132:135], 0
    buffer_store_dwordx4 v[108:111], v14, s[44:47], s76 offen offset:3072 sc1
    s_waitcnt lgkmcnt(10)
    v_mfma_f32_16x16x32_bf16 v[80:83], v[56:59], v[136:139], v[80:83]
    ds_read_b64_tr_b16 v[52:53], v9 offset:33792
    ds_read_b64_tr_b16 v[54:55], v9 offset:34304
    v_mfma_f32_16x16x32_bf16 v[84:87], v[56:59], v[140:143], v[84:87]
    ds_read_b32 v16, v18
    v_mfma_f32_16x16x32_bf16 v[88:91], v[60:63], v[136:139], v[88:91]
    ds_read_b64_tr_b16 v[56:57], v9 offset:40960
    v_mfma_f32_16x16x32_bf16 v[92:95], v[60:63], v[140:143], v[92:95]
    ds_read_b64_tr_b16 v[58:59], v9 offset:41472
    s_waitcnt lgkmcnt(11)
    v_mfma_f32_16x16x32_bf16 v[96:99], v[32:35], v[128:131], 0
    ds_read_b64_tr_b16 v[60:61], v9 offset:41984
    ds_read_b64_tr_b16 v[62:63], v9 offset:42496
    v_mfma_f32_16x16x32_bf16 v[100:103], v[32:35], v[132:135], 0
    s_waitcnt lgkmcnt(4)
    v_cmp_ge_u32 vcc, 13, v16
    v_mfma_f32_16x16x32_bf16 v[104:107], v[36:39], v[128:131], 0
    v_mfma_f32_16x16x32_bf16 v[108:111], v[36:39], v[132:135], 0
    s_cbranch_vccz L_cb87
    s_movk_i32 s81, 14
    s_call_b64 s[82:83], L_spin_c
L_cb87:
    ds_read_b64_tr_b16 v[32:33], v6 offset:49152
    ds_read_b64_tr_b16 v[34:35], v6 offset:49664
    v_mfma_f32_16x16x32_bf16 v[96:99], v[40:43], v[136:139], v[96:99]
    ds_read_b64_tr_b16 v[36:37], v6 offset:50176
    v_mfma_f32_16x16x32_bf16 v[100:103], v[40:43], v[140:143], v[100:103]
    ds_read_b64_tr_b16 v[38:39], v6 offset:50688
    v_mfma_f32_16x16x32_bf16 v[104:107], v[44:47], v[136:139], v[104:107]
    ds_read_b64_tr_b16 v[40:41], v6 offset:57344
    v_mfma_f32_16x16x32_bf16 v[108:111], v[44:47], v[140:143], v[108:111]
    ds_read_b64_tr_b16 v[42:43], v6 offset:57856
    v_mfma_f32_16x16x32_bf16 v[112:115], v[48:51], v[128:131], 0
    ds_read_b64_tr_b16 v[44:45], v6 offset:58368
    v_mfma_f32_16x16x32_bf16 v[116:119], v[48:51], v[132:135], 0
    ds_read_b64_tr_b16 v[46:47], v6 offset:58880
    v_mfma_f32_16x16x32_bf16 v[120:123], v[52:55], v[128:131], 0
    ds_read_b64_tr_b16 v[48:49], v7 offset:49152
    v_mfma_f32_16x16x32_bf16 v[124:127], v[52:55], v[132:135], 0
    ds_read_b64_tr_b16 v[50:51], v7 offset:49664
    s_waitcnt lgkmcnt(10)
    v_mfma_f32_16x16x32_bf16 v[112:115], v[56:59], v[136:139], v[112:115]
    ds_read_b64_tr_b16 v[52:53], v7 offset:50176
    v_mfma_f32_16x16x32_bf16 v[116:119], v[56:59], v[140:143], v[116:119]
    ds_read_b64_tr_b16 v[54:55], v7 offset:50688
    v_mfma_f32_16x16x32_bf16 v[120:123], v[60:63], v[136:139], v[120:123]
    v_mov_b32 v23, 52
    global_load_lds_dword v23, s[88:89]
    v_mfma_f32_16x16x32_bf16 v[124:127], v[60:63], v[140:143], v[124:127]
    ds_read_b64_tr_b16 v[56:57], v7 offset:57344
    ds_read_b64_tr_b16 v[58:59], v7 offset:57856
    s_waitcnt lgkmcnt(10)
    v_mfma_f32_16x16x32_bf16 v[64:67], v[32:35], v[144:147], v[64:67]
    ds_read_b64_tr_b16 v[60:61], v7 offset:58368
    v_mfma_f32_16x16x32_bf16 v[68:71], v[32:35], v[148:151], v[68:71]
    ds_read_b64_tr_b16 v[62:63], v7 offset:58880
    v_mfma_f32_16x16x32_bf16 v[72:75], v[36:39], v[144:147], v[72:75]
    ds_read_b64_tr_b16 v[32:33], v8 offset:49152
    v_mfma_f32_16x16x32_bf16 v[76:79], v[36:39], v[148:151], v[76:79]
    ds_read_b64_tr_b16 v[34:35], v8 offset:49664
    s_waitcnt lgkmcnt(10)
    v_mfma_f32_16x16x32_bf16 v[64:67], v[40:43], v[152:155], v[64:67]
    ds_read_b64_tr_b16 v[36:37], v8 offset:50176
    v_mfma_f32_16x16x32_bf16 v[68:71], v[40:43], v[156:159], v[68:71]
    ds_read_b64_tr_b16 v[38:39], v8 offset:50688
    v_mfma_f32_16x16x32_bf16 v[72:75], v[44:47], v[152:155], v[72:75]
    ds_read_b64_tr_b16 v[40:41], v8 offset:57344
    v_mfma_f32_16x16x32_bf16 v[76:79], v[44:47], v[156:159], v[76:79]
    ds_read_b64_tr_b16 v[42:43], v8 offset:57856
    s_waitcnt lgkmcnt(10)
    v_mfma_f32_16x16x32_bf16 v[80:83], v[48:51], v[144:147], v[80:83]
    ds_read_b64_tr_b16 v[44:45], v8 offset:58368
    v_mfma_f32_16x16x32_bf16 v[84:87], v[48:51], v[148:151], v[84:87]
    ds_read_b64_tr_b16 v[46:47], v8 offset:58880
    v_mfma_f32_16x16x32_bf16 v[88:91], v[52:55], v[144:147], v[88:91]
    ds_read_b64_tr_b16 v[48:49], v9 offset:49152
    v_mfma_f32_16x16x32_bf16 v[92:95], v[52:55], v[148:151], v[92:95]
    ds_read_b64_tr_b16 v[50:51], v9 offset:49664
    s_waitcnt lgkmcnt(10)
    v_mfma_f32_16x16x32_bf16 v[80:83], v[56:59], v[152:155], v[80:83]
    ds_read_b64_tr_b16 v[52:53], v9 offset:50176
    ds_read_b64_tr_b16 v[54:55], v9 offset:50688
    ds_read_b32 v16, v18
    v_mfma_f32_16x16x32_bf16 v[84:87], v[56:59], v[156:159], v[84:87]
    s_waitcnt vmcnt(1)
    s_mov_b64 exec, 1
    buffer_atomic_add v22, v24, s[44:47], 0 offen offset:0 sc1
    s_mov_b64 exec, -1
    v_mfma_f32_16x16x32_bf16 v[88:91], v[60:63], v[152:155], v[88:91]
    ds_read_b64_tr_b16 v[56:57], v9 offset:57344
    v_mfma_f32_16x16x32_bf16 v[92:95], v[60:63], v[156:159], v[92:95]
    ds_read_b64_tr_b16 v[58:59], v9 offset:57856
    s_waitcnt lgkmcnt(11)
    v_mfma_f32_16x16x32_bf16 v[96:99], v[32:35], v[144:147], v[96:99]
    ds_read_b64_tr_b16 v[60:61], v9 offset:58368
    ds_read_b64_tr_b16 v[62:63], v9 offset:58880
    v_mfma_f32_16x16x32_bf16 v[100:103], v[32:35], v[148:151], v[100:103]
    s_waitcnt lgkmcnt(4)
    v_cmp_ge_u32 vcc, 15, v16
    v_mfma_f32_16x16x32_bf16 v[104:107], v[36:39], v[144:147], v[104:107]
    v_mfma_f32_16x16x32_bf16 v[108:111], v[36:39], v[148:151], v[108:111]
    s_cbranch_vccz L_cb88
    s_movk_i32 s81, 16
    s_call_b64 s[82:83], L_spin_c
L_cb88:
    ds_read_b64_tr_b16 v[32:33], v2 offset:0
    ds_read_b64_tr_b16 v[34:35], v2 offset:512
    v_mfma_f32_16x16x32_bf16 v[96:99], v[40:43], v[152:155], v[96:99]
    ds_read_b64_tr_b16 v[36:37], v2 offset:1024
    v_mfma_f32_16x16x32_bf16 v[100:103], v[40:43], v[156:159], v[100:103]
    ds_read_b64_tr_b16 v[38:39], v2 offset:1536
    v_mfma_f32_16x16x32_bf16 v[104:107], v[44:47], v[152:155], v[104:107]
    ds_read_b64_tr_b16 v[40:41], v2 offset:8192
    v_mfma_f32_16x16x32_bf16 v[108:111], v[44:47], v[156:159], v[108:111]
    ds_read_b64_tr_b16 v[42:43], v2 offset:8704
    v_mfma_f32_16x16x32_bf16 v[112:115], v[48:51], v[144:147], v[112:115]
    ds_read_b64_tr_b16 v[44:45], v2 offset:9216
    v_mfma_f32_16x16x32_bf16 v[116:119], v[48:51], v[148:151], v[116:119]
    ds_read_b64_tr_b16 v[46:47], v2 offset:9728
    v_mfma_f32_16x16x32_bf16 v[120:123], v[52:55], v[144:147], v[120:123]
    ds_read_b64_tr_b16 v[48:49], v3 offset:0
    v_mfma_f32_16x16x32_bf16 v[124:127], v[52:55], v[148:151], v[124:127]
    ds_read_b64_tr_b16 v[50:51], v3 offset:512
    s_waitcnt lgkmcnt(10)
    v_mfma_f32_16x16x32_bf16 v[112:115], v[56:59], v[152:155], v[112:115]
    ds_read_b64_tr_b16 v[52:53], v3 offset:1024
    v_mfma_f32_16x16x32_bf16 v[116:119], v[56:59], v[156:159], v[116:119]
    ds_read_b64_tr_b16 v[54:55], v3 offset:1536
    v_mfma_f32_16x16x32_bf16 v[120:123], v[60:63], v[152:155], v[120:123]
    v_mov_b32 v23, 56
    global_load_lds_dword v23, s[88:89]
    v_mfma_f32_16x16x32_bf16 v[124:127], v[60:63], v[156:159], v[124:127]
    ds_read_b64_tr_b16 v[56:57], v3 offset:8192
    ds_read_b64_tr_b16 v[58:59], v3 offset:8704
    s_waitcnt lgkmcnt(10)
    v_mfma_f32_16x16x32_bf16 v[64:67], v[32:35], v[160:163], v[64:67]
    ds_read_b64_tr_b16 v[60:61], v3 offset:9216
    v_mfma_f32_16x16x32_bf16 v[68:71], v[32:35], v[164:167], v[68:71]
    ds_read_b64_tr_b16 v[62:63], v3 offset:9728
    v_mfma_f32_16x16x32_bf16 v[72:75], v[36:39], v[160:163], v[72:75]
    ds_read_b64_tr_b16 v[32:33], v4 offset:0
    v_mfma_f32_16x16x32_bf16 v[76:79], v[36:39], v[164:167], v[76:79]
    ds_read_b64_tr_b16 v[34:35], v4 offset:512
    s_waitcnt lgkmcnt(10)
    v_mfma_f32_16x16x32_bf16 v[64:67], v[40:43], v[168:171], v[64:67]
    ds_read_b64_tr_b16 v[36:37], v4 offset:1024
    v_mfma_f32_16x16x32_bf16 v[68:71], v[40:43], v[172:175], v[68:71]
    ds_read_b64_tr_b16 v[38:39], v4 offset:1536
    v_mfma_f32_16x16x32_bf16 v[72:75], v[44:47], v[168:171], v[72:75]
    ds_read_b64_tr_b16 v[40:41], v4 offset:8192
    v_mfma_f32_16x16x32_bf16 v[76:79], v[44:47], v[172:175], v[76:79]
    ds_read_b64_tr_b16 v[42:43], v4 offset:8704
    s_waitcnt lgkmcnt(10)
    v_mfma_f32_16x16x32_bf16 v[80:83], v[48:51], v[160:163], v[80:83]
    ds_read_b64_tr_b16 v[44:45], v4 offset:9216
    v_mfma_f32_16x16x32_bf16 v[84:87], v[48:51], v[164:167], v[84:87]
    ds_read_b64_tr_b16 v[46:47], v4 offset:9728
    v_mfma_f32_16x16x32_bf16 v[88:91], v[52:55], v[160:163], v[88:91]
    ds_read_b64_tr_b16 v[48:49], v5 offset:0
    v_mfma_f32_16x16x32_bf16 v[92:95], v[52:55], v[164:167], v[92:95]
    ds_read_b64_tr_b16 v[50:51], v5 offset:512
    s_waitcnt lgkmcnt(10)
    v_mfma_f32_16x16x32_bf16 v[80:83], v[56:59], v[168:171], v[80:83]
    ds_read_b64_tr_b16 v[52:53], v5 offset:1024
    v_mfma_f32_16x16x32_bf16 v[84:87], v[56:59], v[172:175], v[84:87]
    ds_read_b64_tr_b16 v[54:55], v5 offset:1536
    v_mfma_f32_16x16x32_bf16 v[88:91], v[60:63], v[168:171], v[88:91]
    ds_read_b64_tr_b16 v[56:57], v5 offset:8192
    v_mfma_f32_16x16x32_bf16 v[92:95], v[60:63], v[172:175], v[92:95]
    ds_read_b64_tr_b16 v[58:59], v5 offset:8704
    s_waitcnt lgkmcnt(10)
    v_mfma_f32_16x16x32_bf16 v[96:99], v[32:35], v[160:163], v[96:99]
    ds_read_b64_tr_b16 v[60:61], v5 offset:9216
    v_mfma_f32_16x16x32_bf16 v[100:103], v[32:35], v[164:167], v[100:103]
    ds_read_b64_tr_b16 v[62:63], v5 offset:9728
    v_mfma_f32_16x16x32_bf16 v[104:107], v[36:39], v[160:163], v[104:107]
    ds_read_b64_tr_b16 v[32:33], v2 offset:32768
    v_mfma_f32_16x16x32_bf16 v[108:111], v[36:39], v[164:167], v[108:111]
    ds_read_b64_tr_b16 v[34:35], v2 offset:33280
    s_waitcnt lgkmcnt(10)
    v_mfma_f32_16x16x32_bf16 v[96:99], v[40:43], v[168:171], v[96:99]
    ds_read_b64_tr_b16 v[36:37], v2 offset:33792
    v_mfma_f32_16x16x32_bf16 v[100:103], v[40:43], v[172:175], v[100:103]
    ds_read_b64_tr_b16 v[38:39], v2 offset:34304
    v_mfma_f32_16x16x32_bf16 v[104:107], v[44:47], v[168:171], v[104:107]
    ds_read_b64_tr_b16 v[40:41], v2 offset:40960
    v_mfma_f32_16x16x32_bf16 v[108:111], v[44:47], v[172:175], v[108:111]
    ds_read_b64_tr_b16 v[42:43], v2 offset:41472
    s_waitcnt lgkmcnt(10)
    v_mfma_f32_16x16x32_bf16 v[112:115], v[48:51], v[160:163], v[112:115]
    ds_read_b64_tr_b16 v[44:45], v2 offset:41984
    v_mfma_f32_16x16x32_bf16 v[116:119], v[48:51], v[164:167], v[116:119]
    ds_read_b64_tr_b16 v[46:47], v2 offset:42496
    v_mfma_f32_16x16x32_bf16 v[120:123], v[52:55], v[160:163], v[120:123]
    ds_read_b64_tr_b16 v[48:49], v3 offset:32768
    v_mfma_f32_16x16x32_bf16 v[124:127], v[52:55], v[164:167], v[124:127]
    ds_read_b64_tr_b16 v[50:51], v3 offset:33280
    s_waitcnt lgkmcnt(10)
    v_mfma_f32_16x16x32_bf16 v[112:115], v[56:59], v[168:171], v[112:115]
    ds_read_b64_tr_b16 v[52:53], v3 offset:33792
    v_mfma_f32_16x16x32_bf16 v[116:119], v[56:59], v[172:175], v[116:119]
    ds_read_b64_tr_b16 v[54:55], v3 offset:34304
    v_mfma_f32_16x16x32_bf16 v[120:123], v[60:63], v[168:171], v[120:123]
    v_mov_b32 v23, 60
    global_load_lds_dword v23, s[88:89]
    v_mfma_f32_16x16x32_bf16 v[124:127], v[60:63], v[172:175], v[124:127]
    ds_read_b64_tr_b16 v[56:57], v3 offset:40960
    ds_read_b64_tr_b16 v[58:59], v3 offset:41472
    s_waitcnt lgkmcnt(10)
    v_mfma_f32_16x16x32_bf16 v[64:67], v[32:35], v[176:179], v[64:67]
    ds_read_b64_tr_b16 v[60:61], v3 offset:41984
    v_mfma_f32_16x16x32_bf16 v[68:71], v[32:35], v[180:183], v[68:71]
    ds_read_b64_tr_b16 v[62:63], v3 offset:42496
    v_mfma_f32_16x16x32_bf16 v[72:75], v[36:39], v[176:179], v[72:75]
    ds_read_b64_tr_b16 v[32:33], v4 offset:32768
    v_mfma_f32_16x16x32_bf16 v[76:79], v[36:39], v[180:183], v[76:79]
    ds_read_b64_tr_b16 v[34:35], v4 offset:33280
    s_waitcnt lgkmcnt(10)
    v_mfma_f32_16x16x32_bf16 v[64:67], v[40:43], v[184:187], v[64:67]
    ds_read_b64_tr_b16 v[36:37], v4 offset:33792
    v_mfma_f32_16x16x32_bf16 v[68:71], v[40:43], v[188:191], v[68:71]
    ds_read_b64_tr_b16 v[38:39], v4 offset:34304
    v_mfma_f32_16x16x32_bf16 v[72:75], v[44:47], v[184:187], v[72:75]
    ds_read_b64_tr_b16 v[40:41], v4 offset:40960
    v_mfma_f32_16x16x32_bf16 v[76:79], v[44:47], v[188:191], v[76:79]
    ds_read_b64_tr_b16 v[42:43], v4 offset:41472
    s_waitcnt lgkmcnt(10)
    v_mfma_f32_16x16x32_bf16 v[80:83], v[48:51], v[176:179], v[80:83]
    ds_read_b64_tr_b16 v[44:45], v4 offset:41984
    v_mfma_f32_16x16x32_bf16 v[84:87], v[48:51], v[180:183], v[84:87]
    ds_read_b64_tr_b16 v[46:47], v4 offset:42496
    v_mfma_f32_16x16x32_bf16 v[88:91], v[52:55], v[176:179], v[88:91]
    ds_read_b64_tr_b16 v[48:49], v5 offset:32768
    v_mfma_f32_16x16x32_bf16 v[92:95], v[52:55], v[180:183], v[92:95]
    ds_read_b64_tr_b16 v[50:51], v5 offset:33280
    s_waitcnt lgkmcnt(10)
    v_mfma_f32_16x16x32_bf16 v[80:83], v[56:59], v[184:187], v[80:83]
    ds_read_b64_tr_b16 v[52:53], v5 offset:33792
    ds_read_b64_tr_b16 v[54:55], v5 offset:34304
    v_mfma_f32_16x16x32_bf16 v[84:87], v[56:59], v[188:191], v[84:87]
    ds_read_b32 v16, v18
    v_mfma_f32_16x16x32_bf16 v[88:91], v[60:63], v[184:187], v[88:91]
    ds_read_b64_tr_b16 v[56:57], v5 offset:40960
    v_mfma_f32_16x16x32_bf16 v[92:95], v[60:63], v[188:191], v[92:95]
    ds_read_b64_tr_b16 v[58:59], v5 offset:41472
    s_waitcnt lgkmcnt(11)
    v_mfma_f32_16x16x32_bf16 v[96:99], v[32:35], v[176:179], v[96:99]
    ds_read_b64_tr_b16 v[60:61], v5 offset:41984
    ds_read_b64_tr_b16 v[62:63], v5 offset:42496
    v_mfma_f32_16x16x32_bf16 v[100:103], v[32:35], v[180:183], v[100:103]
    s_waitcnt lgkmcnt(4)
    v_cmp_ge_u32 vcc, 17, v16
    v_mfma_f32_16x16x32_bf16 v[104:107], v[36:39], v[176:179], v[104:107]
    v_mfma_f32_16x16x32_bf16 v[108:111], v[36:39], v[180:183], v[108:111]
    s_cbranch_vccz L_cb89
    s_movk_i32 s81, 18
    s_call_b64 s[82:83], L_spin_c
L_cb89:
    ds_read_b64_tr_b16 v[32:33], v2 offset:49152
    ds_read_b64_tr_b16 v[34:35], v2 offset:49664
    v_mfma_f32_16x16x32_bf16 v[96:99], v[40:43], v[184:187], v[96:99]
    ds_read_b64_tr_b16 v[36:37], v2 offset:50176
    v_mfma_f32_16x16x32_bf16 v[100:103], v[40:43], v[188:191], v[100:103]
    ds_read_b64_tr_b16 v[38:39], v2 offset:50688
    v_mfma_f32_16x16x32_bf16 v[104:107], v[44:47], v[184:187], v[104:107]
    ds_read_b64_tr_b16 v[40:41], v2 offset:57344
    v_mfma_f32_16x16x32_bf16 v[108:111], v[44:47], v[188:191], v[108:111]
    ds_read_b64_tr_b16 v[42:43], v2 offset:57856
    v_mfma_f32_16x16x32_bf16 v[112:115], v[48:51], v[176:179], v[112:115]
    ds_read_b64_tr_b16 v[44:45], v2 offset:58368
    v_mfma_f32_16x16x32_bf16 v[116:119], v[48:51], v[180:183], v[116:119]
    ds_read_b64_tr_b16 v[46:47], v2 offset:58880
    v_mfma_f32_16x16x32_bf16 v[120:123], v[52:55], v[176:179], v[120:123]
    ds_read_b64_tr_b16 v[48:49], v3 offset:49152
    v_mfma_f32_16x16x32_bf16 v[124:127], v[52:55], v[180:183], v[124:127]
    ds_read_b64_tr_b16 v[50:51], v3 offset:49664
    s_waitcnt lgkmcnt(10)
    v_mfma_f32_16x16x32_bf16 v[112:115], v[56:59], v[184:187], v[112:115]
    ds_read_b64_tr_b16 v[52:53], v3 offset:50176
    v_mfma_f32_16x16x32_bf16 v[116:119], v[56:59], v[188:191], v[116:119]
    ds_read_b64_tr_b16 v[54:55], v3 offset:50688
    v_mfma_f32_16x16x32_bf16 v[120:123], v[60:63], v[184:187], v[120:123]
    v_mov_b32 v23, 64
    global_load_lds_dword v23, s[88:89]
    v_mfma_f32_16x16x32_bf16 v[124:127], v[60:63], v[188:191], v[124:127]
    ds_read_b64_tr_b16 v[56:57], v3 offset:57344
    ds_read_b64_tr_b16 v[58:59], v3 offset:57856
    s_waitcnt lgkmcnt(10)
    v_mfma_f32_16x16x32_bf16 v[64:67], v[32:35], v[192:195], v[64:67]
    ds_read_b64_tr_b16 v[60:61], v3 offset:58368
    v_mfma_f32_16x16x32_bf16 v[68:71], v[32:35], v[196:199], v[68:71]
    ds_read_b64_tr_b16 v[62:63], v3 offset:58880
    v_mfma_f32_16x16x32_bf16 v[72:75], v[36:39], v[192:195], v[72:75]
    ds_read_b64_tr_b16 v[32:33], v4 offset:49152
    v_mfma_f32_16x16x32_bf16 v[76:79], v[36:39], v[196:199], v[76:79]
    ds_read_b64_tr_b16 v[34:35], v4 offset:49664
    s_waitcnt lgkmcnt(10)
    v_mfma_f32_16x16x32_bf16 v[64:67], v[40:43], v[200:203], v[64:67]
    ds_read_b64_tr_b16 v[36:37], v4 offset:50176
    v_mfma_f32_16x16x32_bf16 v[68:71], v[40:43], v[204:207], v[68:71]
    ds_read_b64_tr_b16 v[38:39], v4 offset:50688
    v_mfma_f32_16x16x32_bf16 v[72:75], v[44:47], v[200:203], v[72:75]
    ds_read_b64_tr_b16 v[40:41], v4 offset:57344
    v_mfma_f32_16x16x32_bf16 v[76:79], v[44:47], v[204:207], v[76:79]
    ds_read_b64_tr_b16 v[42:43], v4 offset:57856
    s_waitcnt lgkmcnt(10)
    v_mfma_f32_16x16x32_bf16 v[80:83], v[48:51], v[192:195], v[80:83]
    ds_read_b64_tr_b16 v[44:45], v4 offset:58368
    v_mfma_f32_16x16x32_bf16 v[84:87], v[48:51], v[196:199], v[84:87]
    ds_read_b64_tr_b16 v[46:47], v4 offset:58880
    v_mfma_f32_16x16x32_bf16 v[88:91], v[52:55], v[192:195], v[88:91]
    ds_read_b64_tr_b16 v[48:49], v5 offset:49152
    v_mfma_f32_16x16x32_bf16 v[92:95], v[52:55], v[196:199], v[92:95]
    ds_read_b64_tr_b16 v[50:51], v5 offset:49664
    s_waitcnt lgkmcnt(10)
    v_mfma_f32_16x16x32_bf16 v[80:83], v[56:59], v[200:203], v[80:83]
    ds_read_b64_tr_b16 v[52:53], v5 offset:50176
    v_mfma_f32_16x16x32_bf16 v[84:87], v[56:59], v[204:207], v[84:87]
    ds_read_b64_tr_b16 v[54:55], v5 offset:50688
    v_mfma_f32_16x16x32_bf16 v[88:91], v[60:63], v[200:203], v[88:91]
    ds_read_b64_tr_b16 v[56:57], v5 offset:57344
    v_mfma_f32_16x16x32_bf16 v[92:95], v[60:63], v[204:207], v[92:95]
    ds_read_b64_tr_b16 v[58:59], v5 offset:57856
    s_waitcnt lgkmcnt(10)
    v_mfma_f32_16x16x32_bf16 v[96:99], v[32:35], v[192:195], v[96:99]
    ds_read_b64_tr_b16 v[60:61], v5 offset:58368
    v_mfma_f32_16x16x32_bf16 v[100:103], v[32:35], v[196:199], v[100:103]
    ds_read_b64_tr_b16 v[62:63], v5 offset:58880
    v_mfma_f32_16x16x32_bf16 v[104:107], v[36:39], v[192:195], v[104:107]
    ds_read_b64_tr_b16 v[32:33], v6 offset:0
    v_mfma_f32_16x16x32_bf16 v[108:111], v[36:39], v[196:199], v[108:111]
    ds_read_b64_tr_b16 v[34:35], v6 offset:512
    s_waitcnt lgkmcnt(10)
    v_mfma_f32_16x16x32_bf16 v[96:99], v[40:43], v[200:203], v[96:99]
    ds_read_b64_tr_b16 v[36:37], v6 offset:1024
    v_mfma_f32_16x16x32_bf16 v[100:103], v[40:43], v[204:207], v[100:103]
    ds_read_b64_tr_b16 v[38:39], v6 offset:1536
    v_mfma_f32_16x16x32_bf16 v[104:107], v[44:47], v[200:203], v[104:107]
    ds_read_b64_tr_b16 v[40:41], v6 offset:8192
    v_mfma_f32_16x16x32_bf16 v[108:111], v[44:47], v[204:207], v[108:111]
    ds_read_b64_tr_b16 v[42:43], v6 offset:8704
    s_waitcnt lgkmcnt(10)
    v_mfma_f32_16x16x32_bf16 v[112:115], v[48:51], v[192:195], v[112:115]
    ds_read_b64_tr_b16 v[44:45], v6 offset:9216
    v_mfma_f32_16x16x32_bf16 v[116:119], v[48:51], v[196:199], v[116:119]
    ds_read_b64_tr_b16 v[46:47], v6 offset:9728
    v_mfma_f32_16x16x32_bf16 v[120:123], v[52:55], v[192:195], v[120:123]
    ds_read_b64_tr_b16 v[48:49], v7 offset:0
    v_mfma_f32_16x16x32_bf16 v[124:127], v[52:55], v[196:199], v[124:127]
    ds_read_b64_tr_b16 v[50:51], v7 offset:512
    s_waitcnt lgkmcnt(10)
    v_mfma_f32_16x16x32_bf16 v[112:115], v[56:59], v[200:203], v[112:115]
    ds_read_b64_tr_b16 v[52:53], v7 offset:1024
    v_mfma_f32_16x16x32_bf16 v[116:119], v[56:59], v[204:207], v[116:119]
    ds_read_b64_tr_b16 v[54:55], v7 offset:1536
    v_mfma_f32_16x16x32_bf16 v[120:123], v[60:63], v[200:203], v[120:123]
    v_mov_b32 v23, 68
    global_load_lds_dword v23, s[88:89]
    v_mfma_f32_16x16x32_bf16 v[124:127], v[60:63], v[204:207], v[124:127]
    ds_read_b64_tr_b16 v[56:57], v7 offset:8192
    ds_read_b64_tr_b16 v[58:59], v7 offset:8704
    s_waitcnt lgkmcnt(10)
    v_mfma_f32_16x16x32_bf16 v[64:67], v[32:35], v[208:211], v[64:67]
    ds_read_b64_tr_b16 v[60:61], v7 offset:9216
    v_mfma_f32_16x16x32_bf16 v[68:71], v[32:35], v[212:215], v[68:71]
    ds_read_b64_tr_b16 v[62:63], v7 offset:9728
    v_mfma_f32_16x16x32_bf16 v[72:75], v[36:39], v[208:211], v[72:75]
    ds_read_b64_tr_b16 v[32:33], v8 offset:0
    v_mfma_f32_16x16x32_bf16 v[76:79], v[36:39], v[212:215], v[76:79]
    ds_read_b64_tr_b16 v[34:35], v8 offset:512
    s_waitcnt lgkmcnt(10)
    v_mfma_f32_16x16x32_bf16 v[64:67], v[40:43], v[216:219], v[64:67]
    ds_read_b64_tr_b16 v[36:37], v8 offset:1024
    v_mfma_f32_16x16x32_bf16 v[68:71], v[40:43], v[220:223], v[68:71]
    ds_read_b64_tr_b16 v[38:39], v8 offset:1536
    v_mfma_f32_16x16x32_bf16 v[72:75], v[44:47], v[216:219], v[72:75]
    ds_read_b64_tr_b16 v[40:41], v8 offset:8192
    v_mfma_f32_16x16x32_bf16 v[76:79], v[44:47], v[220:223], v[76:79]
    ds_read_b64_tr_b16 v[42:43], v8 offset:8704
    s_waitcnt lgkmcnt(10)
    v_mfma_f32_16x16x32_bf16 v[80:83], v[48:51], v[208:211], v[80:83]
    ds_read_b64_tr_b16 v[44:45], v8 offset:9216
    v_mfma_f32_16x16x32_bf16 v[84:87], v[48:51], v[212:215], v[84:87]
    ds_read_b64_tr_b16 v[46:47], v8 offset:9728
    v_mfma_f32_16x16x32_bf16 v[88:91], v[52:55], v[208:211], v[88:91]
    ds_read_b64_tr_b16 v[48:49], v9 offset:0
    v_mfma_f32_16x16x32_bf16 v[92:95], v[52:55], v[212:215], v[92:95]
    ds_read_b64_tr_b16 v[50:51], v9 offset:512
    s_waitcnt lgkmcnt(10)
    v_mfma_f32_16x16x32_bf16 v[80:83], v[56:59], v[216:219], v[80:83]
    ds_read_b64_tr_b16 v[52:53], v9 offset:1024
    ds_read_b64_tr_b16 v[54:55], v9 offset:1536
    v_mfma_f32_16x16x32_bf16 v[84:87], v[56:59], v[220:223], v[84:87]
    ds_read_b32 v16, v18
    v_mfma_f32_16x16x32_bf16 v[88:91], v[60:63], v[216:219], v[88:91]
    ds_read_b64_tr_b16 v[56:57], v9 offset:8192
    v_mfma_f32_16x16x32_bf16 v[92:95], v[60:63], v[220:223], v[92:95]
    ds_read_b64_tr_b16 v[58:59], v9 offset:8704
    s_waitcnt lgkmcnt(11)
    v_mfma_f32_16x16x32_bf16 v[96:99], v[32:35], v[208:211], v[96:99]
    ds_read_b64_tr_b16 v[60:61], v9 offset:9216
    ds_read_b64_tr_b16 v[62:63], v9 offset:9728
    v_mfma_f32_16x16x32_bf16 v[100:103], v[32:35], v[212:215], v[100:103]
    s_waitcnt lgkmcnt(4)
    v_cmp_ge_u32 vcc, 19, v16
    v_mfma_f32_16x16x32_bf16 v[104:107], v[36:39], v[208:211], v[104:107]
    v_mfma_f32_16x16x32_bf16 v[108:111], v[36:39], v[212:215], v[108:111]
    s_cbranch_vccz L_cb90
    s_movk_i32 s81, 20
    s_call_b64 s[82:83], L_spin_c
L_cb90:
    ds_read_b64_tr_b16 v[32:33], v6 offset:16384
    ds_read_b64_tr_b16 v[34:35], v6 offset:16896
    v_mfma_f32_16x16x32_bf16 v[96:99], v[40:43], v[216:219], v[96:99]
    ds_read_b64_tr_b16 v[36:37], v6 offset:17408
    v_mfma_f32_16x16x32_bf16 v[100:103], v[40:43], v[220:223], v[100:103]
    ds_read_b64_tr_b16 v[38:39], v6 offset:17920
    v_mfma_f32_16x16x32_bf16 v[104:107], v[44:47], v[216:219], v[104:107]
    ds_read_b64_tr_b16 v[40:41], v6 offset:24576
    v_mfma_f32_16x16x32_bf16 v[108:111], v[44:47], v[220:223], v[108:111]
    ds_read_b64_tr_b16 v[42:43], v6 offset:25088
    v_mfma_f32_16x16x32_bf16 v[112:115], v[48:51], v[208:211], v[112:115]
    ds_read_b64_tr_b16 v[44:45], v6 offset:25600
    v_mfma_f32_16x16x32_bf16 v[116:119], v[48:51], v[212:215], v[116:119]
    ds_read_b64_tr_b16 v[46:47], v6 offset:26112
    v_mfma_f32_16x16x32_bf16 v[120:123], v[52:55], v[208:211], v[120:123]
    ds_read_b64_tr_b16 v[48:49], v7 offset:16384
    v_mfma_f32_16x16x32_bf16 v[124:127], v[52:55], v[212:215], v[124:127]
    ds_read_b64_tr_b16 v[50:51], v7 offset:16896
    s_waitcnt lgkmcnt(10)
    v_mfma_f32_16x16x32_bf16 v[112:115], v[56:59], v[216:219], v[112:115]
    ds_read_b64_tr_b16 v[52:53], v7 offset:17408
    v_mfma_f32_16x16x32_bf16 v[116:119], v[56:59], v[220:223], v[116:119]
    ds_read_b64_tr_b16 v[54:55], v7 offset:17920
    v_mfma_f32_16x16x32_bf16 v[120:123], v[60:63], v[216:219], v[120:123]
    v_mov_b32 v23, 72
    global_load_lds_dword v23, s[88:89]
    v_mfma_f32_16x16x32_bf16 v[124:127], v[60:63], v[220:223], v[124:127]
    ds_read_b64_tr_b16 v[56:57], v7 offset:24576
    ds_read_b64_tr_b16 v[58:59], v7 offset:25088
    s_waitcnt lgkmcnt(10)
    v_mfma_f32_16x16x32_bf16 v[64:67], v[32:35], v[224:227], v[64:67]
    ds_read_b64_tr_b16 v[60:61], v7 offset:25600
    v_mfma_f32_16x16x32_bf16 v[68:71], v[32:35], v[228:231], v[68:71]
    ds_read_b64_tr_b16 v[62:63], v7 offset:26112
    v_mfma_f32_16x16x32_bf16 v[72:75], v[36:39], v[224:227], v[72:75]
    ds_read_b64_tr_b16 v[32:33], v8 offset:16384
    v_mfma_f32_16x16x32_bf16 v[76:79], v[36:39], v[228:231], v[76:79]
    ds_read_b64_tr_b16 v[34:35], v8 offset:16896
    s_waitcnt lgkmcnt(10)
    v_mfma_f32_16x16x32_bf16 v[64:67], v[40:43], v[232:235], v[64:67]
    ds_read_b64_tr_b16 v[36:37], v8 offset:17408
    v_mfma_f32_16x16x32_bf16 v[68:71], v[40:43], v[236:239], v[68:71]
    ds_read_b64_tr_b16 v[38:39], v8 offset:17920
    v_mfma_f32_16x16x32_bf16 v[72:75], v[44:47], v[232:235], v[72:75]
    ds_read_b64_tr_b16 v[40:41], v8 offset:24576
    v_mfma_f32_16x16x32_bf16 v[76:79], v[44:47], v[236:239], v[76:79]
    ds_read_b64_tr_b16 v[42:43], v8 offset:25088
    s_waitcnt lgkmcnt(10)
    v_mfma_f32_16x16x32_bf16 v[80:83], v[48:51], v[224:227], v[80:83]
    ds_read_b64_tr_b16 v[44:45], v8 offset:25600
    v_mfma_f32_16x16x32_bf16 v[84:87], v[48:51], v[228:231], v[84:87]
    ds_read_b64_tr_b16 v[46:47], v8 offset:26112
    v_mfma_f32_16x16x32_bf16 v[88:91], v[52:55], v[224:227], v[88:91]
    ds_read_b64_tr_b16 v[48:49], v9 offset:16384
    v_mfma_f32_16x16x32_bf16 v[92:95], v[52:55], v[228:231], v[92:95]
    ds_read_b64_tr_b16 v[50:51], v9 offset:16896
    s_waitcnt lgkmcnt(10)
    v_mfma_f32_16x16x32_bf16 v[80:83], v[56:59], v[232:235], v[80:83]
    ds_read_b64_tr_b16 v[52:53], v9 offset:17408
    v_mfma_f32_16x16x32_bf16 v[84:87], v[56:59], v[236:239], v[84:87]
    ds_read_b64_tr_b16 v[54:55], v9 offset:17920
    v_mfma_f32_16x16x32_bf16 v[88:91], v[60:63], v[232:235], v[88:91]
    ds_read_b64_tr_b16 v[56:57], v9 offset:24576
    v_mfma_f32_16x16x32_bf16 v[92:95], v[60:63], v[236:239], v[92:95]
    ds_read_b64_tr_b16 v[58:59], v9 offset:25088
    s_waitcnt lgkmcnt(10)
    v_mfma_f32_16x16x32_bf16 v[96:99], v[32:35], v[224:227], v[96:99]
    ds_read_b64_tr_b16 v[60:61], v9 offset:25600
    v_mfma_f32_16x16x32_bf16 v[100:103], v[32:35], v[228:231], v[100:103]
    ds_read_b64_tr_b16 v[62:63], v9 offset:26112
    v_mfma_f32_16x16x32_bf16 v[104:107], v[36:39], v[224:227], v[104:107]
    ds_read_b64_tr_b16 v[32:33], v6 offset:32768
    v_mfma_f32_16x16x32_bf16 v[108:111], v[36:39], v[228:231], v[108:111]
    ds_read_b64_tr_b16 v[34:35], v6 offset:33280
    s_waitcnt lgkmcnt(10)
    v_mfma_f32_16x16x32_bf16 v[96:99], v[40:43], v[232:235], v[96:99]
    ds_read_b64_tr_b16 v[36:37], v6 offset:33792
    v_mfma_f32_16x16x32_bf16 v[100:103], v[40:43], v[236:239], v[100:103]
    ds_read_b64_tr_b16 v[38:39], v6 offset:34304
    v_mfma_f32_16x16x32_bf16 v[104:107], v[44:47], v[232:235], v[104:107]
    ds_read_b64_tr_b16 v[40:41], v6 offset:40960
    v_mfma_f32_16x16x32_bf16 v[108:111], v[44:47], v[236:239], v[108:111]
    ds_read_b64_tr_b16 v[42:43], v6 offset:41472
    s_waitcnt lgkmcnt(10)
    v_mfma_f32_16x16x32_bf16 v[112:115], v[48:51], v[224:227], v[112:115]
    ds_read_b64_tr_b16 v[44:45], v6 offset:41984
    v_mfma_f32_16x16x32_bf16 v[116:119], v[48:51], v[228:231], v[116:119]
    ds_read_b64_tr_b16 v[46:47], v6 offset:42496
    v_mfma_f32_16x16x32_bf16 v[120:123], v[52:55], v[224:227], v[120:123]
    ds_read_b64_tr_b16 v[48:49], v7 offset:32768
    v_mfma_f32_16x16x32_bf16 v[124:127], v[52:55], v[228:231], v[124:127]
    ds_read_b64_tr_b16 v[50:51], v7 offset:33280
    s_waitcnt lgkmcnt(10)
    v_mfma_f32_16x16x32_bf16 v[112:115], v[56:59], v[232:235], v[112:115]
    ds_read_b64_tr_b16 v[52:53], v7 offset:33792
    v_mfma_f32_16x16x32_bf16 v[116:119], v[56:59], v[236:239], v[116:119]
    ds_read_b64_tr_b16 v[54:55], v7 offset:34304
    v_mfma_f32_16x16x32_bf16 v[120:123], v[60:63], v[232:235], v[120:123]
    v_mov_b32 v23, 76
    global_load_lds_dword v23, s[88:89]
    v_mfma_f32_16x16x32_bf16 v[124:127], v[60:63], v[236:239], v[124:127]
    ds_read_b64_tr_b16 v[56:57], v7 offset:40960
    ds_read_b64_tr_b16 v[58:59], v7 offset:41472
    s_waitcnt lgkmcnt(10)
    v_mfma_f32_16x16x32_bf16 v[64:67], v[32:35], v[240:243], v[64:67]
    ds_read_b64_tr_b16 v[60:61], v7 offset:41984
    v_mfma_f32_16x16x32_bf16 v[68:71], v[32:35], v[244:247], v[68:71]
    ds_read_b64_tr_b16 v[62:63], v7 offset:42496
    v_mfma_f32_16x16x32_bf16 v[72:75], v[36:39], v[240:243], v[72:75]
    ds_read_b64_tr_b16 v[32:33], v8 offset:32768
    v_mfma_f32_16x16x32_bf16 v[76:79], v[36:39], v[244:247], v[76:79]
    ds_read_b64_tr_b16 v[34:35], v8 offset:33280
    s_waitcnt lgkmcnt(10)
    v_mfma_f32_16x16x32_bf16 v[64:67], v[40:43], v[248:251], v[64:67]
    ds_read_b64_tr_b16 v[36:37], v8 offset:33792
    v_mfma_f32_16x16x32_bf16 v[68:71], v[40:43], v[252:255], v[68:71]
    ds_read_b64_tr_b16 v[38:39], v8 offset:34304
    v_mfma_f32_16x16x32_bf16 v[72:75], v[44:47], v[248:251], v[72:75]
    ds_read_b64_tr_b16 v[40:41], v8 offset:40960
    v_mfma_f32_16x16x32_bf16 v[76:79], v[44:47], v[252:255], v[76:79]
    ds_read_b64_tr_b16 v[42:43], v8 offset:41472
    s_waitcnt lgkmcnt(10)
    v_mfma_f32_16x16x32_bf16 v[80:83], v[48:51], v[240:243], v[80:83]
    ds_read_b64_tr_b16 v[44:45], v8 offset:41984
    ds_read_b64_tr_b16 v[46:47], v8 offset:42496
    s_nop 0
    v_mul_f32 v64, v64, v72
    v_mfma_f32_16x16x32_bf16 v[84:87], v[48:51], v[244:247], v[84:87]
    v_mul_f32 v65, v65, v73
    v_mul_f32 v66, v66, v74
    v_mfma_f32_16x16x32_bf16 v[88:91], v[52:55], v[240:243], v[88:91]
    ds_read_b64_tr_b16 v[48:49], v9 offset:32768
    ds_read_b64_tr_b16 v[50:51], v9 offset:33280
    v_mul_f32 v67, v67, v75
    v_mfma_f32_16x16x32_bf16 v[92:95], v[52:55], v[244:247], v[92:95]
    v_mul_f32 v68, v68, v76
    v_mul_f32 v69, v69, v77
    s_waitcnt lgkmcnt(10)
    v_mfma_f32_16x16x32_bf16 v[80:83], v[56:59], v[248:251], v[80:83]
    ds_read_b64_tr_b16 v[52:53], v9 offset:33792
    ds_read_b64_tr_b16 v[54:55], v9 offset:34304
    v_mul_f32 v70, v70, v78
    v_mfma_f32_16x16x32_bf16 v[84:87], v[56:59], v[252:255], v[84:87]
    v_mul_f32 v71, v71, v79
    v_cvt_pk_bf16_f32 v72, v64, v65
    v_mfma_f32_16x16x32_bf16 v[88:91], v[60:63], v[248:251], v[88:91]
    ds_read_b64_tr_b16 v[56:57], v9 offset:40960
    ds_read_b64_tr_b16 v[58:59], v9 offset:41472
    v_cvt_pk_bf16_f32 v73, v66, v67
    v_mfma_f32_16x16x32_bf16 v[92:95], v[60:63], v[252:255], v[92:95]
    v_cvt_pk_bf16_f32 v76, v68, v69
    v_cvt_pk_bf16_f32 v77, v70, v71
    s_waitcnt lgkmcnt(10)
    v_mfma_f32_16x16x32_bf16 v[96:99], v[32:35], v[240:243], v[96:99]
    ds_read_b64_tr_b16 v[60:61], v9 offset:41984
    ds_read_b64_tr_b16 v[62:63], v9 offset:42496
    v_mul_f32 v80, v80, v88
    v_mfma_f32_16x16x32_bf16 v[100:103], v[32:35], v[244:247], v[100:103]
    v_mul_f32 v81, v81, v89
    v_mul_f32 v82, v82, v90
    v_mfma_f32_16x16x32_bf16 v[104:107], v[36:39], v[240:243], v[104:107]
    v_mul_f32 v83, v83, v91
    v_mul_f32 v84, v84, v92
    v_mfma_f32_16x16x32_bf16 v[108:111], v[36:39], v[244:247], v[108:111]
    v_mul_f32 v85, v85, v93
    s_waitcnt lgkmcnt(8)
    v_mfma_f32_16x16x32_bf16 v[96:99], v[40:43], v[248:251], v[96:99]
    v_mul_f32 v86, v86, v94
    v_mul_f32 v87, v87, v95
    v_mfma_f32_16x16x32_bf16 v[100:103], v[40:43], v[252:255], v[100:103]
    v_cvt_pk_bf16_f32 v74, v80, v81
    v_mfma_f32_16x16x32_bf16 v[104:107], v[44:47], v[248:251], v[104:107]
    v_cvt_pk_bf16_f32 v75, v82, v83
    buffer_store_dwordx4 v[72:75], v14, s[44:47], s77 offen offset:0 sc1
    v_mfma_f32_16x16x32_bf16 v[108:111], v[44:47], v[252:255], v[108:111]
    v_cvt_pk_bf16_f32 v78, v84, v85
    s_waitcnt lgkmcnt(4)
    v_mfma_f32_16x16x32_bf16 v[112:115], v[48:51], v[240:243], v[112:115]
    ds_read_b32 v16, v18
    v_cvt_pk_bf16_f32 v79, v86, v87
    v_mfma_f32_16x16x32_bf16 v[116:119], v[48:51], v[244:247], v[116:119]
    buffer_store_dwordx4 v[76:79], v14, s[44:47], s77 offen offset:1024 sc1
    v_mul_f32 v96, v96, v104
    v_mfma_f32_16x16x32_bf16 v[120:123], v[52:55], v[240:243], v[120:123]
    ds_read_b32 v16, v18
    v_mul_f32 v97, v97, v105
    v_mfma_f32_16x16x32_bf16 v[124:127], v[52:55], v[244:247], v[124:127]
    v_mul_f32 v98, v98, v106
    v_mul_f32 v99, v99, v107
    s_waitcnt lgkmcnt(2)
    v_mfma_f32_16x16x32_bf16 v[112:115], v[56:59], v[248:251], v[112:115]
    v_mfma_f32_16x16x32_bf16 v[116:119], v[56:59], v[252:255], v[116:119]
    s_waitcnt lgkmcnt(1)
    v_cmp_ge_u32 vcc, 20, v16
    v_mul_f32 v100, v100, v108
    v_mul_f32 v101, v101, v109
    v_mul_f32 v102, v102, v110
    v_mfma_f32_16x16x32_bf16 v[120:123], v[60:63], v[248:251], v[120:123]
    v_mfma_f32_16x16x32_bf16 v[124:127], v[60:63], v[252:255], v[124:127]
    v_mov_b32 v23, 80
    global_load_lds_dword v23, s[88:89]
    v_mul_f32 v103, v103, v111
    v_cvt_pk_bf16_f32 v104, v96, v97
    v_cvt_pk_bf16_f32 v105, v98, v99
    v_cvt_pk_bf16_f32 v108, v100, v101
    v_cvt_pk_bf16_f32 v109, v102, v103
    v_xor_b32 v2, 32, v28
    v_xor_b32 v3, 32, v29
    v_xor_b32 v4, 32, v30
    v_mul_f32 v112, v112, v120
    v_mul_f32 v113, v113, v121
    v_mul_f32 v114, v114, v122
    v_mul_f32 v115, v115, v123
    v_mul_f32 v116, v116, v124
    v_mul_f32 v117, v117, v125
    v_mul_f32 v118, v118, v126
    v_mul_f32 v119, v119, v127
    v_cvt_pk_bf16_f32 v106, v112, v113
    v_cvt_pk_bf16_f32 v107, v114, v115
    buffer_store_dwordx4 v[104:107], v14, s[44:47], s77 offen offset:2048 sc1
    v_cvt_pk_bf16_f32 v110, v116, v117
    v_cvt_pk_bf16_f32 v111, v118, v119
    buffer_store_dwordx4 v[108:111], v14, s[44:47], s77 offen offset:3072 sc1
    s_branch L_compj
L_comp1:
    v_and_b32 v32, 15, v1
    v_lshrrev_b32 v33, 4, v1
    v_and_b32 v36, 1, v33
    v_lshrrev_b32 v37, 5, v1
    s_lshl_b32 s67, s56, 12
    s_add_u32 s67, s67, 32768
    v_lshlrev_b32 v38, 7, v32
    v_add_u32 v39, s67, v38
    v_lshrrev_b32 v40, 1, v32
    v_xor_b32 v40, v40, v33
    v_lshl_add_u32 v80, v40, 4, v39
    v_xor_b32 v81, 64, v80
    v_add_u32 v82, 0x10000, v80
    v_mov_b32 v84, 0x3f803f80
    v_add_u32 v83, 0x10000, v81
    v_mov_b32 v85, 0x3f803f80
    s_barrier
    ds_read_b128 v[128:131], v80 offset:0
    ds_read_b128 v[132:135], v80 offset:2048
    ds_read_b128 v[136:139], v81 offset:0
    ds_read_b128 v[140:143], v81 offset:2048
    ds_read_b128 v[144:147], v80 offset:16384
    ds_read_b128 v[148:151], v80 offset:18432
    ds_read_b128 v[152:155], v81 offset:16384
    ds_read_b128 v[156:159], v81 offset:18432
    s_waitcnt lgkmcnt(6)
    v_mfma_f32_4x4x4_16b_bf16 v[64:67], v[84:85], v[128:129], 0
    v_mfma_f32_4x4x4_16b_bf16 v[68:71], v[84:85], v[132:133], 0
    v_mfma_f32_4x4x4_16b_bf16 v[88:91], v[128:129], v[128:129], 0
    v_mfma_f32_4x4x4_16b_bf16 v[92:95], v[132:133], v[132:133], 0
    v_mfma_f32_4x4x4_16b_bf16 v[64:67], v[84:85], v[130:131], v[64:67]
    v_mfma_f32_4x4x4_16b_bf16 v[68:71], v[84:85], v[134:135], v[68:71]
    v_mfma_f32_4x4x4_16b_bf16 v[88:91], v[130:131], v[130:131], v[88:91]
    v_mfma_f32_4x4x4_16b_bf16 v[92:95], v[134:135], v[134:135], v[92:95]
    s_waitcnt lgkmcnt(4)
    v_mfma_f32_4x4x4_16b_bf16 v[64:67], v[84:85], v[136:137], v[64:67]
    v_mfma_f32_4x4x4_16b_bf16 v[68:71], v[84:85], v[140:141], v[68:71]
    v_mfma_f32_4x4x4_16b_bf16 v[88:91], v[136:137], v[136:137], v[88:91]
    v_mfma_f32_4x4x4_16b_bf16 v[92:95], v[140:141], v[140:141], v[92:95]
    v_mfma_f32_4x4x4_16b_bf16 v[64:67], v[84:85], v[138:139], v[64:67]
    v_mfma_f32_4x4x4_16b_bf16 v[68:71], v[84:85], v[142:143], v[68:71]
    v_mfma_f32_4x4x4_16b_bf16 v[88:91], v[138:139], v[138:139], v[88:91]
    v_mfma_f32_4x4x4_16b_bf16 v[92:95], v[142:143], v[142:143], v[92:95]
    s_waitcnt lgkmcnt(2)
    v_mfma_f32_4x4x4_16b_bf16 v[64:67], v[84:85], v[144:145], v[64:67]
    v_mfma_f32_4x4x4_16b_bf16 v[68:71], v[84:85], v[148:149], v[68:71]
    v_mfma_f32_4x4x4_16b_bf16 v[88:91], v[144:145], v[144:145], v[88:91]
    v_mfma_f32_4x4x4_16b_bf16 v[92:95], v[148:149], v[148:149], v[92:95]
    v_mfma_f32_4x4x4_16b_bf16 v[64:67], v[84:85], v[146:147], v[64:67]
    v_mfma_f32_4x4x4_16b_bf16 v[68:71], v[84:85], v[150:151], v[68:71]
    v_mfma_f32_4x4x4_16b_bf16 v[88:91], v[146:147], v[146:147], v[88:91]
    v_mfma_f32_4x4x4_16b_bf16 v[92:95], v[150:151], v[150:151], v[92:95]
    s_waitcnt lgkmcnt(0)
    v_mfma_f32_4x4x4_16b_bf16 v[64:67], v[84:85], v[152:153], v[64:67]
    v_mfma_f32_4x4x4_16b_bf16 v[68:71], v[84:85], v[156:157], v[68:71]
    v_mfma_f32_4x4x4_16b_bf16 v[88:91], v[152:153], v[152:153], v[88:91]
    v_mfma_f32_4x4x4_16b_bf16 v[92:95], v[156:157], v[156:157], v[92:95]
    v_mfma_f32_4x4x4_16b_bf16 v[64:67], v[84:85], v[154:155], v[64:67]
    v_mfma_f32_4x4x4_16b_bf16 v[68:71], v[84:85], v[158:159], v[68:71]
    v_mfma_f32_4x4x4_16b_bf16 v[88:91], v[154:155], v[154:155], v[88:91]
    v_mfma_f32_4x4x4_16b_bf16 v[92:95], v[158:159], v[158:159], v[92:95]
    v_and_b32 v45, 3, v1
    v_and_b32 v46, 1, v1
    v_lshlrev_b32 v46, 4, v46
    v_mov_b32 v47, 0x3f80
    v_lshlrev_b32 v46, v46, v47
    v_cmp_gt_u32 vcc, 2, v45
    s_nop 1
    v_cndmask_b32 v120, 0, v46, vcc
    v_sub_u32 v121, v46, v120
    v_cmp_eq_u32 s[94:95], 1, v45
    v_cmp_eq_u32 s[96:97], 2, v45
    v_cmp_eq_u32 s[98:99], 3, v45
    v_mov_b32 v21, 16384
    v_mov_b32 v22, 1
    s_lshl_b32 s70, s58, 1
    s_lshr_b32 s69, s56, 1
    s_add_u32 s70, s70, s69
    s_lshl_b32 s70, s70, 9
    v_mov_b32 v24, s70
    v_and_b32 v18, 1, v1
    v_lshlrev_b32 v18, 8, v18
    v_add_u32 v18, 16640, v18
    s_lshl_b32 s70, s56, 8
    s_add_u32 m0, s70, 17152
    s_lshl_b32 s70, s56, 5
    v_and_b32 v127, 31, v1
    v_add_u32 v127, s70, v127
    v_bfe_u32 v34, v1, 2, 2
    v_and_b32 v35, 3, v1
    v_lshlrev_b32 v35, 3, v35
    v_lshl_add_u32 v40, v33, 11, v35
    v_lshl_add_u32 v40, v34, 7, v40
    v_and_b32 v41, 2, v34
    s_barrier
    ds_read_b128 v[160:163], v80 offset:32768
    ds_read_b128 v[164:167], v80 offset:34816
    ds_read_b128 v[168:171], v81 offset:32768
    ds_read_b128 v[172:175], v81 offset:34816
    ds_read_b128 v[176:179], v80 offset:49152
    ds_read_b128 v[180:183], v80 offset:51200
    ds_read_b128 v[184:187], v81 offset:49152
    ds_read_b128 v[188:191], v81 offset:51200
    s_waitcnt lgkmcnt(6)
    v_mfma_f32_4x4x4_16b_bf16 v[64:67], v[84:85], v[160:161], v[64:67]
    v_mfma_f32_4x4x4_16b_bf16 v[68:71], v[84:85], v[164:165], v[68:71]
    v_mfma_f32_4x4x4_16b_bf16 v[88:91], v[160:161], v[160:161], v[88:91]
    v_mfma_f32_4x4x4_16b_bf16 v[92:95], v[164:165], v[164:165], v[92:95]
    v_mfma_f32_4x4x4_16b_bf16 v[64:67], v[84:85], v[162:163], v[64:67]
    v_mfma_f32_4x4x4_16b_bf16 v[68:71], v[84:85], v[166:167], v[68:71]
    v_mfma_f32_4x4x4_16b_bf16 v[88:91], v[162:163], v[162:163], v[88:91]
    v_mfma_f32_4x4x4_16b_bf16 v[92:95], v[166:167], v[166:167], v[92:95]
    s_waitcnt lgkmcnt(4)
    v_mfma_f32_4x4x4_16b_bf16 v[64:67], v[84:85], v[168:169], v[64:67]
    v_mfma_f32_4x4x4_16b_bf16 v[68:71], v[84:85], v[172:173], v[68:71]
    v_mfma_f32_4x4x4_16b_bf16 v[88:91], v[168:169], v[168:169], v[88:91]
    v_mfma_f32_4x4x4_16b_bf16 v[92:95], v[172:173], v[172:173], v[92:95]
    v_mfma_f32_4x4x4_16b_bf16 v[64:67], v[84:85], v[170:171], v[64:67]
    v_mfma_f32_4x4x4_16b_bf16 v[68:71], v[84:85], v[174:175], v[68:71]
    v_mfma_f32_4x4x4_16b_bf16 v[88:91], v[170:171], v[170:171], v[88:91]
    v_mfma_f32_4x4x4_16b_bf16 v[92:95], v[174:175], v[174:175], v[92:95]
    s_waitcnt lgkmcnt(2)
    v_mfma_f32_4x4x4_16b_bf16 v[64:67], v[84:85], v[176:177], v[64:67]
    v_mfma_f32_4x4x4_16b_bf16 v[68:71], v[84:85], v[180:181], v[68:71]
    v_mfma_f32_4x4x4_16b_bf16 v[88:91], v[176:177], v[176:177], v[88:91]
    v_mfma_f32_4x4x4_16b_bf16 v[92:95], v[180:181], v[180:181], v[92:95]
    v_mfma_f32_4x4x4_16b_bf16 v[64:67], v[84:85], v[178:179], v[64:67]
    v_mfma_f32_4x4x4_16b_bf16 v[68:71], v[84:85], v[182:183], v[68:71]
    v_mfma_f32_4x4x4_16b_bf16 v[88:91], v[178:179], v[178:179], v[88:91]
    v_mfma_f32_4x4x4_16b_bf16 v[92:95], v[182:183], v[182:183], v[92:95]
    s_waitcnt lgkmcnt(0)
    v_mfma_f32_4x4x4_16b_bf16 v[64:67], v[84:85], v[184:185], v[64:67]
    v_mfma_f32_4x4x4_16b_bf16 v[68:71], v[84:85], v[188:189], v[68:71]
    v_mfma_f32_4x4x4_16b_bf16 v[88:91], v[184:185], v[184:185], v[88:91]
    v_mfma_f32_4x4x4_16b_bf16 v[92:95], v[188:189], v[188:189], v[92:95]
    v_mfma_f32_4x4x4_16b_bf16 v[64:67], v[84:85], v[186:187], v[64:67]
    v_mfma_f32_4x4x4_16b_bf16 v[68:71], v[84:85], v[190:191], v[68:71]
    v_mfma_f32_4x4x4_16b_bf16 v[88:91], v[186:187], v[186:187], v[88:91]
    v_mfma_f32_4x4x4_16b_bf16 v[92:95], v[190:191], v[190:191], v[92:95]
    v_xor_b32 v41, v41, v36
    v_lshl_add_u32 v2, v41, 5, v40
    v_xor_b32 v3, 32, v2
    v_xor_b32 v4, 64, v2
    v_xor_b32 v5, 96, v2
    v_add_u32 v6, 0x10000, v2
    v_add_u32 v7, 0x10000, v3
    v_add_u32 v8, 0x10000, v4
    v_add_u32 v9, 0x10000, v5
    v_lshl_add_u32 v40, v37, 11, v35
    v_lshl_add_u32 v40, v34, 6, v40
    v_mul_u32_u24 v41, 544, v36
    v_add_u32 v10, v40, v41
    v_xor_b32 v11, 32, v10
    v_add_u32 v12, 0x10000, v10
    v_add_u32 v13, 0x10000, v11
    s_lshl_b32 s66, s56, 13
    s_add_u32 s66, s66, 131072
    v_lshlrev_b32 v15, 9, v36
    v_lshl_add_u32 v15, v32, 4, v15
    v_lshl_add_u32 v15, v37, 3, v15
    v_add_u32 v15, s66, v15
    v_lshlrev_b32 v43, 4, v1
    s_lshl_b32 s66, s58, 2
    s_add_u32 s66, s66, s56
    s_mul_i32 s66, s66, 147456
    s_add_u32 s66, s66, 2097152
    v_add_u32 v14, s66, v43
    s_mul_i32 s66, s59, 96
    s_add_u32 s66, s66, 1024
    s_and_b32 s67, s59, 1
    s_lshl_b32 s68, s67, 5
    s_add_u32 s76, s66, s68
    s_barrier
    ds_read_b128 v[192:195], v82 offset:0
    ds_read_b128 v[196:199], v82 offset:2048
    ds_read_b128 v[200:203], v83 offset:0
    ds_read_b128 v[204:207], v83 offset:2048
    ds_read_b128 v[208:211], v82 offset:16384
    ds_read_b128 v[212:215], v82 offset:18432
    ds_read_b128 v[216:219], v83 offset:16384
    ds_read_b128 v[220:223], v83 offset:18432
    s_waitcnt lgkmcnt(6)
    v_mfma_f32_4x4x4_16b_bf16 v[64:67], v[84:85], v[192:193], v[64:67]
    v_mfma_f32_4x4x4_16b_bf16 v[68:71], v[84:85], v[196:197], v[68:71]
    v_mfma_f32_4x4x4_16b_bf16 v[88:91], v[192:193], v[192:193], v[88:91]
    v_mfma_f32_4x4x4_16b_bf16 v[92:95], v[196:197], v[196:197], v[92:95]
    v_mfma_f32_4x4x4_16b_bf16 v[64:67], v[84:85], v[194:195], v[64:67]
    v_mfma_f32_4x4x4_16b_bf16 v[68:71], v[84:85], v[198:199], v[68:71]
    v_mfma_f32_4x4x4_16b_bf16 v[88:91], v[194:195], v[194:195], v[88:91]
    v_mfma_f32_4x4x4_16b_bf16 v[92:95], v[198:199], v[198:199], v[92:95]
    s_waitcnt lgkmcnt(4)
    v_mfma_f32_4x4x4_16b_bf16 v[64:67], v[84:85], v[200:201], v[64:67]
    v_mfma_f32_4x4x4_16b_bf16 v[68:71], v[84:85], v[204:205], v[68:71]
    v_mfma_f32_4x4x4_16b_bf16 v[88:91], v[200:201], v[200:201], v[88:91]
    v_mfma_f32_4x4x4_16b_bf16 v[92:95], v[204:205], v[204:205], v[92:95]
    v_mfma_f32_4x4x4_16b_bf16 v[64:67], v[84:85], v[202:203], v[64:67]
    v_mfma_f32_4x4x4_16b_bf16 v[68:71], v[84:85], v[206:207], v[68:71]
    v_mfma_f32_4x4x4_16b_bf16 v[88:91], v[202:203], v[202:203], v[88:91]
    v_mfma_f32_4x4x4_16b_bf16 v[92:95], v[206:207], v[206:207], v[92:95]
    s_waitcnt lgkmcnt(2)
    v_mfma_f32_4x4x4_16b_bf16 v[64:67], v[84:85], v[208:209], v[64:67]
    v_mfma_f32_4x4x4_16b_bf16 v[68:71], v[84:85], v[212:213], v[68:71]
    v_mfma_f32_4x4x4_16b_bf16 v[88:91], v[208:209], v[208:209], v[88:91]
    v_mfma_f32_4x4x4_16b_bf16 v[92:95], v[212:213], v[212:213], v[92:95]
    v_mfma_f32_4x4x4_16b_bf16 v[64:67], v[84:85], v[210:211], v[64:67]
    v_mfma_f32_4x4x4_16b_bf16 v[68:71], v[84:85], v[214:215], v[68:71]
    v_mfma_f32_4x4x4_16b_bf16 v[88:91], v[210:211], v[210:211], v[88:91]
    v_mfma_f32_4x4x4_16b_bf16 v[92:95], v[214:215], v[214:215], v[92:95]
    s_waitcnt lgkmcnt(0)
    v_mfma_f32_4x4x4_16b_bf16 v[64:67], v[84:85], v[216:217], v[64:67]
    v_mfma_f32_4x4x4_16b_bf16 v[68:71], v[84:85], v[220:221], v[68:71]
    v_mfma_f32_4x4x4_16b_bf16 v[88:91], v[216:217], v[216:217], v[88:91]
    v_mfma_f32_4x4x4_16b_bf16 v[92:95], v[220:221], v[220:221], v[92:95]
    v_mfma_f32_4x4x4_16b_bf16 v[64:67], v[84:85], v[218:219], v[64:67]
    v_mfma_f32_4x4x4_16b_bf16 v[68:71], v[84:85], v[222:223], v[68:71]
    v_mfma_f32_4x4x4_16b_bf16 v[88:91], v[218:219], v[218:219], v[88:91]
    v_mfma_f32_4x4x4_16b_bf16 v[92:95], v[222:223], v[222:223], v[92:95]
    s_xor_b32 s67, s67, 1
    s_lshl_b32 s67, s67, 6
    s_add_u32 s77, s66, s67
    s_lshl_b32 s76, s76, 6
    s_lshl_b32 s77, s77, 6
    s_lshr_b32 s66, s56, 1
    s_lshl_b32 s68, s66, 13
    v_add_u32 v25, s68, v43
    v_add_u32 v26, 0x10000, v25
    v_add_u32 v27, 0x20000, v25
    v_bfe_u32 v44, v1, 3, 2
    s_lshl_b32 s70, s57, 1
    v_xor_b32 v44, s70, v44
    v_lshl_add_u32 v28, v44, 5, v35
    v_lshrrev_b32 v44, 2, v1
    v_lshl_add_u32 v28, v44, 7, v28
    v_add_u32 v29, 0x10000, v28
    v_add_u32 v30, 0x20000, v28
    s_lshl_b32 s69, s66, 5
    v_add_u32 v44, s69, v32
    v_lshlrev_b32 v0, 2, v44
    s_lshl_b32 s70, s57, 6
    v_lshlrev_b32 v17, 7, v44
    v_lshl_add_u32 v17, v33, 3, v17
    v_add_u32 v17, s70, v17
    s_lshl_b32 s68, s63, 16
    s_lshl_b32 s69, s64, 7
    s_add_u32 s69, s69, s70
    s_add_u32 s69, s69, s68
    v_lshlrev_b32 v44, 10, v44
    v_lshl_add_u32 v44, v36, 5, v44
    v_lshl_add_u32 v44, v37, 4, v44
    v_add_u32 v31, s69, v44
    s_barrier
    ds_read_b128 v[224:227], v82 offset:32768
    ds_read_b128 v[228:231], v82 offset:34816
    ds_read_b128 v[232:235], v83 offset:32768
    ds_read_b128 v[236:239], v83 offset:34816
    ds_read_b128 v[240:243], v82 offset:49152
    ds_read_b128 v[244:247], v82 offset:51200
    ds_read_b128 v[248:251], v83 offset:49152
    ds_read_b128 v[252:255], v83 offset:51200
    s_waitcnt lgkmcnt(6)
    v_mfma_f32_4x4x4_16b_bf16 v[64:67], v[84:85], v[224:225], v[64:67]
    v_mfma_f32_4x4x4_16b_bf16 v[68:71], v[84:85], v[228:229], v[68:71]
    v_mfma_f32_4x4x4_16b_bf16 v[88:91], v[224:225], v[224:225], v[88:91]
    v_mfma_f32_4x4x4_16b_bf16 v[92:95], v[228:229], v[228:229], v[92:95]
    v_mfma_f32_4x4x4_16b_bf16 v[64:67], v[84:85], v[226:227], v[64:67]
    v_mfma_f32_4x4x4_16b_bf16 v[68:71], v[84:85], v[230:231], v[68:71]
    v_mfma_f32_4x4x4_16b_bf16 v[88:91], v[226:227], v[226:227], v[88:91]
    v_mfma_f32_4x4x4_16b_bf16 v[92:95], v[230:231], v[230:231], v[92:95]
    s_waitcnt lgkmcnt(4)
    v_mfma_f32_4x4x4_16b_bf16 v[64:67], v[84:85], v[232:233], v[64:67]
    v_mfma_f32_4x4x4_16b_bf16 v[68:71], v[84:85], v[236:237], v[68:71]
    v_mfma_f32_4x4x4_16b_bf16 v[88:91], v[232:233], v[232:233], v[88:91]
    v_mfma_f32_4x4x4_16b_bf16 v[92:95], v[236:237], v[236:237], v[92:95]
    v_mfma_f32_4x4x4_16b_bf16 v[64:67], v[84:85], v[234:235], v[64:67]
    v_mfma_f32_4x4x4_16b_bf16 v[68:71], v[84:85], v[238:239], v[68:71]
    v_mfma_f32_4x4x4_16b_bf16 v[88:91], v[234:235], v[234:235], v[88:91]
    v_mfma_f32_4x4x4_16b_bf16 v[92:95], v[238:239], v[238:239], v[92:95]
    s_waitcnt lgkmcnt(2)
    v_mfma_f32_4x4x4_16b_bf16 v[64:67], v[84:85], v[240:241], v[64:67]
    v_mfma_f32_4x4x4_16b_bf16 v[68:71], v[84:85], v[244:245], v[68:71]
    v_mfma_f32_4x4x4_16b_bf16 v[88:91], v[240:241], v[240:241], v[88:91]
    v_mfma_f32_4x4x4_16b_bf16 v[92:95], v[244:245], v[244:245], v[92:95]
    v_mfma_f32_4x4x4_16b_bf16 v[64:67], v[84:85], v[242:243], v[64:67]
    v_mfma_f32_4x4x4_16b_bf16 v[68:71], v[84:85], v[246:247], v[68:71]
    v_mfma_f32_4x4x4_16b_bf16 v[88:91], v[242:243], v[242:243], v[88:91]
    v_mfma_f32_4x4x4_16b_bf16 v[92:95], v[246:247], v[246:247], v[92:95]
    s_waitcnt lgkmcnt(0)
    s_barrier
    v_mfma_f32_4x4x4_16b_bf16 v[64:67], v[84:85], v[248:249], v[64:67]
    v_mfma_f32_4x4x4_16b_bf16 v[68:71], v[84:85], v[252:253], v[68:71]
    v_mfma_f32_4x4x4_16b_bf16 v[88:91], v[248:249], v[248:249], v[88:91]
    v_mfma_f32_4x4x4_16b_bf16 v[92:95], v[252:253], v[252:253], v[92:95]
    v_mfma_f32_4x4x4_16b_bf16 v[64:67], v[84:85], v[250:251], v[64:67]
    v_mfma_f32_4x4x4_16b_bf16 v[68:71], v[84:85], v[254:255], v[68:71]
    v_mfma_f32_4x4x4_16b_bf16 v[88:91], v[250:251], v[250:251], v[88:91]
    v_mfma_f32_4x4x4_16b_bf16 v[92:95], v[254:255], v[254:255], v[92:95]
    s_waitcnt vmcnt(0)
    s_nop 1
    v_permlane16_swap_b32 v64, v68
    v_add_f32 v64, v64, v68
    v_mov_b32 v68, v64
    s_nop 1
    v_permlane32_swap_b32 v64, v68
    v_add_f32 v64, v64, v68
    v_mul_f32 v126, 0xbb000000, v64
    v_cvt_pk_bf16_f32 v64, v126, v126
    v_mov_b32 v65, v64
    s_nop 1
    v_permlane16_swap_b32 v64, v65
    v_and_b32 v112, 0xffff0000, v64
    v_and_b32 v113, 0xffff0000, v64
    v_and_b32 v114, 0xffff0000, v64
    v_and_b32 v115, 0xffff0000, v64
    v_and_b32 v116, 0xffff0000, v65
    v_and_b32 v117, 0xffff0000, v65
    v_and_b32 v118, 0xffff0000, v65
    v_and_b32 v119, 0xffff0000, v65
    v_mfma_f32_4x4x4_16b_bf16 v[96:99], v[120:121], v[128:129], v[112:115]
    v_mfma_f32_4x4x4_16b_bf16 v[100:103], v[120:121], v[130:131], v[112:115]
    v_mfma_f32_4x4x4_16b_bf16 v[104:107], v[120:121], v[132:133], v[116:119]
    v_mfma_f32_4x4x4_16b_bf16 v[108:111], v[120:121], v[134:135], v[116:119]
    s_nop 1
    v_cvt_pk_bf16_f32 v128, v96, v97
    v_cvt_pk_bf16_f32 v129, v98, v99
    v_mfma_f32_4x4x4_16b_bf16 v[96:99], v[120:121], v[136:137], v[112:115]
    v_cvt_pk_bf16_f32 v130, v100, v101
    v_cvt_pk_bf16_f32 v131, v102, v103
    v_mfma_f32_4x4x4_16b_bf16 v[100:103], v[120:121], v[138:139], v[112:115]
    v_cvt_pk_bf16_f32 v132, v104, v105
    v_cvt_pk_bf16_f32 v133, v106, v107
    v_mfma_f32_4x4x4_16b_bf16 v[104:107], v[120:121], v[140:141], v[116:119]
    v_cvt_pk_bf16_f32 v134, v108, v109
    v_cvt_pk_bf16_f32 v135, v110, v111
    v_mfma_f32_4x4x4_16b_bf16 v[108:111], v[120:121], v[142:143], v[116:119]
    v_cvt_pk_bf16_f32 v136, v96, v97
    v_cvt_pk_bf16_f32 v137, v98, v99
    v_mfma_f32_4x4x4_16b_bf16 v[96:99], v[120:121], v[144:145], v[112:115]
    v_cvt_pk_bf16_f32 v138, v100, v101
    v_cvt_pk_bf16_f32 v139, v102, v103
    v_mfma_f32_4x4x4_16b_bf16 v[100:103], v[120:121], v[146:147], v[112:115]
    v_cvt_pk_bf16_f32 v140, v104, v105
    v_cvt_pk_bf16_f32 v141, v106, v107
    v_mfma_f32_4x4x4_16b_bf16 v[104:107], v[120:121], v[148:149], v[116:119]
    v_cvt_pk_bf16_f32 v142, v108, v109
    v_cvt_pk_bf16_f32 v143, v110, v111
    v_mfma_f32_4x4x4_16b_bf16 v[108:111], v[120:121], v[150:151], v[116:119]
    v_cvt_pk_bf16_f32 v144, v96, v97
    v_cvt_pk_bf16_f32 v145, v98, v99
    v_mfma_f32_4x4x4_16b_bf16 v[96:99], v[120:121], v[152:153], v[112:115]
    v_cvt_pk_bf16_f32 v146, v100, v101
    v_cvt_pk_bf16_f32 v147, v102, v103
    v_mfma_f32_4x4x4_16b_bf16 v[100:103], v[120:121], v[154:155], v[112:115]
    v_cvt_pk_bf16_f32 v148, v104, v105
    v_cvt_pk_bf16_f32 v149, v106, v107
    v_mfma_f32_4x4x4_16b_bf16 v[104:107], v[120:121], v[156:157], v[116:119]
    v_cvt_pk_bf16_f32 v150, v108, v109
    v_cvt_pk_bf16_f32 v151, v110, v111
    v_mfma_f32_4x4x4_16b_bf16 v[108:111], v[120:121], v[158:159], v[116:119]
    v_cvt_pk_bf16_f32 v152, v96, v97
    v_cvt_pk_bf16_f32 v153, v98, v99
    v_mfma_f32_4x4x4_16b_bf16 v[96:99], v[120:121], v[160:161], v[112:115]
    v_cvt_pk_bf16_f32 v154, v100, v101
    v_cvt_pk_bf16_f32 v155, v102, v103
    v_mfma_f32_4x4x4_16b_bf16 v[100:103], v[120:121], v[162:163], v[112:115]
    v_cvt_pk_bf16_f32 v156, v104, v105
    v_cvt_pk_bf16_f32 v157, v106, v107
    v_mfma_f32_4x4x4_16b_bf16 v[104:107], v[120:121], v[164:165], v[116:119]
    v_cvt_pk_bf16_f32 v158, v108, v109
    v_cvt_pk_bf16_f32 v159, v110, v111
    v_mfma_f32_4x4x4_16b_bf16 v[108:111], v[120:121], v[166:167], v[116:119]
    v_cvt_pk_bf16_f32 v160, v96, v97
    v_cvt_pk_bf16_f32 v161, v98, v99
    v_mfma_f32_4x4x4_16b_bf16 v[96:99], v[120:121], v[168:169], v[112:115]
    v_cvt_pk_bf16_f32 v162, v100, v101
    v_cvt_pk_bf16_f32 v163, v102, v103
    v_mfma_f32_4x4x4_16b_bf16 v[100:103], v[120:121], v[170:171], v[112:115]
    v_cvt_pk_bf16_f32 v164, v104, v105
    v_cvt_pk_bf16_f32 v165, v106, v107
    v_mfma_f32_4x4x4_16b_bf16 v[104:107], v[120:121], v[172:173], v[116:119]
    v_cvt_pk_bf16_f32 v166, v108, v109
    v_cvt_pk_bf16_f32 v167, v110, v111
    v_mfma_f32_4x4x4_16b_bf16 v[108:111], v[120:121], v[174:175], v[116:119]
    v_cvt_pk_bf16_f32 v168, v96, v97
    v_cvt_pk_bf16_f32 v169, v98, v99
    v_mfma_f32_4x4x4_16b_bf16 v[96:99], v[120:121], v[176:177], v[112:115]
    v_cvt_pk_bf16_f32 v170, v100, v101
    v_cvt_pk_bf16_f32 v171, v102, v103
    v_mfma_f32_4x4x4_16b_bf16 v[100:103], v[120:121], v[178:179], v[112:115]
    v_cvt_pk_bf16_f32 v172, v104, v105
    v_cvt_pk_bf16_f32 v173, v106, v107
    v_mfma_f32_4x4x4_16b_bf16 v[104:107], v[120:121], v[180:181], v[116:119]
    v_cvt_pk_bf16_f32 v174, v108, v109
    v_cvt_pk_bf16_f32 v175, v110, v111
    v_mfma_f32_4x4x4_16b_bf16 v[108:111], v[120:121], v[182:183], v[116:119]
    v_cvt_pk_bf16_f32 v176, v96, v97
    v_cvt_pk_bf16_f32 v177, v98, v99
    v_mfma_f32_4x4x4_16b_bf16 v[96:99], v[120:121], v[184:185], v[112:115]
    v_cvt_pk_bf16_f32 v178, v100, v101
    v_cvt_pk_bf16_f32 v179, v102, v103
    v_mfma_f32_4x4x4_16b_bf16 v[100:103], v[120:121], v[186:187], v[112:115]
    v_cvt_pk_bf16_f32 v180, v104, v105
    v_cvt_pk_bf16_f32 v181, v106, v107
    v_mfma_f32_4x4x4_16b_bf16 v[104:107], v[120:121], v[188:189], v[116:119]
    v_cvt_pk_bf16_f32 v182, v108, v109
    v_cvt_pk_bf16_f32 v183, v110, v111
    v_mfma_f32_4x4x4_16b_bf16 v[108:111], v[120:121], v[190:191], v[116:119]
    v_cvt_pk_bf16_f32 v184, v96, v97
    v_cvt_pk_bf16_f32 v185, v98, v99
    v_mfma_f32_4x4x4_16b_bf16 v[96:99], v[120:121], v[192:193], v[112:115]
    v_cvt_pk_bf16_f32 v186, v100, v101
    v_cvt_pk_bf16_f32 v187, v102, v103
    v_mfma_f32_4x4x4_16b_bf16 v[100:103], v[120:121], v[194:195], v[112:115]
    v_cvt_pk_bf16_f32 v188, v104, v105
    v_cvt_pk_bf16_f32 v189, v106, v107
    v_mfma_f32_4x4x4_16b_bf16 v[104:107], v[120:121], v[196:197], v[116:119]
    v_cvt_pk_bf16_f32 v190, v108, v109
    v_cvt_pk_bf16_f32 v191, v110, v111
    v_mfma_f32_4x4x4_16b_bf16 v[108:111], v[120:121], v[198:199], v[116:119]
    v_cvt_pk_bf16_f32 v192, v96, v97
    v_cvt_pk_bf16_f32 v193, v98, v99
    v_mfma_f32_4x4x4_16b_bf16 v[96:99], v[120:121], v[200:201], v[112:115]
    v_cvt_pk_bf16_f32 v194, v100, v101
    v_cvt_pk_bf16_f32 v195, v102, v103
    v_mfma_f32_4x4x4_16b_bf16 v[100:103], v[120:121], v[202:203], v[112:115]
    v_cvt_pk_bf16_f32 v196, v104, v105
    v_cvt_pk_bf16_f32 v197, v106, v107
    v_mfma_f32_4x4x4_16b_bf16 v[104:107], v[120:121], v[204:205], v[116:119]
    v_cvt_pk_bf16_f32 v198, v108, v109
    v_cvt_pk_bf16_f32 v199, v110, v111
    v_mfma_f32_4x4x4_16b_bf16 v[108:111], v[120:121], v[206:207], v[116:119]
    v_cvt_pk_bf16_f32 v200, v96, v97
    v_cvt_pk_bf16_f32 v201, v98, v99
    v_mfma_f32_4x4x4_16b_bf16 v[96:99], v[120:121], v[208:209], v[112:115]
    v_cvt_pk_bf16_f32 v202, v100, v101
    v_cvt_pk_bf16_f32 v203, v102, v103
    v_mfma_f32_4x4x4_16b_bf16 v[100:103], v[120:121], v[210:211], v[112:115]
    v_cvt_pk_bf16_f32 v204, v104, v105
    v_cvt_pk_bf16_f32 v205, v106, v107
    v_mfma_f32_4x4x4_16b_bf16 v[104:107], v[120:121], v[212:213], v[116:119]
    v_cvt_pk_bf16_f32 v206, v108, v109
    v_cvt_pk_bf16_f32 v207, v110, v111
    v_mfma_f32_4x4x4_16b_bf16 v[108:111], v[120:121], v[214:215], v[116:119]
    v_cvt_pk_bf16_f32 v208, v96, v97
    v_cvt_pk_bf16_f32 v209, v98, v99
    v_mfma_f32_4x4x4_16b_bf16 v[96:99], v[120:121], v[216:217], v[112:115]
    v_cvt_pk_bf16_f32 v210, v100, v101
    v_cvt_pk_bf16_f32 v211, v102, v103
    v_mfma_f32_4x4x4_16b_bf16 v[100:103], v[120:121], v[218:219], v[112:115]
    v_cvt_pk_bf16_f32 v212, v104, v105
    v_cvt_pk_bf16_f32 v213, v106, v107
    v_mfma_f32_4x4x4_16b_bf16 v[104:107], v[120:121], v[220:221], v[116:119]
    v_cvt_pk_bf16_f32 v214, v108, v109
    v_cvt_pk_bf16_f32 v215, v110, v111
    v_mfma_f32_4x4x4_16b_bf16 v[108:111], v[120:121], v[222:223], v[116:119]
    v_cvt_pk_bf16_f32 v216, v96, v97
    v_cvt_pk_bf16_f32 v217, v98, v99
    v_cvt_pk_bf16_f32 v218, v100, v101
    v_cvt_pk_bf16_f32 v219, v102, v103
    v_cvt_pk_bf16_f32 v220, v104, v105
    v_cvt_pk_bf16_f32 v221, v106, v107
    v_cvt_pk_bf16_f32 v222, v108, v109
    v_cvt_pk_bf16_f32 v223, v110, v111
    ds_read_b32 v16, v18
    v_cndmask_b32 v122, v88, v89, s[94:95]
    v_cndmask_b32 v123, v92, v93, s[94:95]
    v_cndmask_b32 v122, v122, v90, s[96:97]
    v_cndmask_b32 v123, v123, v94, s[96:97]
    v_cndmask_b32 v122, v122, v91, s[98:99]
    v_cndmask_b32 v123, v123, v95, s[98:99]
    v_mfma_f32_4x4x4_16b_bf16 v[96:99], v[120:121], v[224:225], v[112:115]
    v_mfma_f32_4x4x4_16b_bf16 v[100:103], v[120:121], v[226:227], v[112:115]
    v_mfma_f32_4x4x4_16b_bf16 v[104:107], v[120:121], v[228:229], v[116:119]
    v_mfma_f32_4x4x4_16b_bf16 v[108:111], v[120:121], v[230:231], v[116:119]
    s_nop 1
    v_cvt_pk_bf16_f32 v224, v96, v97
    v_cvt_pk_bf16_f32 v225, v98, v99
    v_mfma_f32_4x4x4_16b_bf16 v[96:99], v[120:121], v[232:233], v[112:115]
    v_cvt_pk_bf16_f32 v226, v100, v101
    v_cvt_pk_bf16_f32 v227, v102, v103
    v_mfma_f32_4x4x4_16b_bf16 v[100:103], v[120:121], v[234:235], v[112:115]
    v_cvt_pk_bf16_f32 v228, v104, v105
    v_cvt_pk_bf16_f32 v229, v106, v107
    v_mfma_f32_4x4x4_16b_bf16 v[104:107], v[120:121], v[236:237], v[116:119]
    v_cvt_pk_bf16_f32 v230, v108, v109
    v_cvt_pk_bf16_f32 v231, v110, v111
    v_mfma_f32_4x4x4_16b_bf16 v[108:111], v[120:121], v[238:239], v[116:119]
    v_cvt_pk_bf16_f32 v232, v96, v97
    v_cvt_pk_bf16_f32 v233, v98, v99
    v_cvt_pk_bf16_f32 v234, v100, v101
    v_cvt_pk_bf16_f32 v235, v102, v103
    v_cvt_pk_bf16_f32 v236, v104, v105
    v_cvt_pk_bf16_f32 v237, v106, v107
    v_cvt_pk_bf16_f32 v238, v108, v109
    v_cvt_pk_bf16_f32 v239, v110, v111
    s_waitcnt lgkmcnt(0)
    v_cmp_ge_u32 vcc, 0, v16
    s_cbranch_vccz L_cb128
    s_movk_i32 s81, 1
    s_call_b64 s[82:83], L_spin_c
L_cb128:
    ds_read_b64_tr_b16 v[32:33], v10 offset:0
    ds_read_b64_tr_b16 v[34:35], v10 offset:256
    ds_read_b64_tr_b16 v[36:37], v10 offset:1024
    ds_read_b64_tr_b16 v[38:39], v10 offset:1280
    ds_read_b64_tr_b16 v[40:41], v10 offset:4096
    ds_read_b64_tr_b16 v[42:43], v10 offset:4352
    ds_read_b64_tr_b16 v[44:45], v10 offset:5120
    ds_read_b64_tr_b16 v[46:47], v10 offset:5376
    ds_read_b64_tr_b16 v[48:49], v10 offset:8192
    ds_read_b64_tr_b16 v[50:51], v10 offset:8448
    ds_read_b64_tr_b16 v[52:53], v10 offset:9216
    ds_read_b64_tr_b16 v[54:55], v10 offset:9472
    ds_read_b64_tr_b16 v[56:57], v10 offset:12288
    ds_read_b64_tr_b16 v[58:59], v10 offset:12544
    v_mfma_f32_4x4x4_16b_bf16 v[96:99], v[120:121], v[240:241], v[112:115]
    v_mfma_f32_4x4x4_16b_bf16 v[100:103], v[120:121], v[242:243], v[112:115]
    v_mfma_f32_4x4x4_16b_bf16 v[104:107], v[120:121], v[244:245], v[116:119]
    v_mfma_f32_4x4x4_16b_bf16 v[108:111], v[120:121], v[246:247], v[116:119]
    s_nop 1
    v_cvt_pk_bf16_f32 v240, v96, v97
    v_cvt_pk_bf16_f32 v241, v98, v99
    v_mfma_f32_4x4x4_16b_bf16 v[96:99], v[120:121], v[248:249], v[112:115]
    v_cvt_pk_bf16_f32 v242, v100, v101
    v_cvt_pk_bf16_f32 v243, v102, v103
    v_mfma_f32_4x4x4_16b_bf16 v[100:103], v[120:121], v[250:251], v[112:115]
    v_cvt_pk_bf16_f32 v244, v104, v105
    v_cvt_pk_bf16_f32 v245, v106, v107
    v_mfma_f32_4x4x4_16b_bf16 v[104:107], v[120:121], v[252:253], v[116:119]
    v_cvt_pk_bf16_f32 v246, v108, v109
    v_cvt_pk_bf16_f32 v247, v110, v111
    v_mfma_f32_4x4x4_16b_bf16 v[108:111], v[120:121], v[254:255], v[116:119]
    v_cvt_pk_bf16_f32 v248, v96, v97
    v_cvt_pk_bf16_f32 v249, v98, v99
    v_cvt_pk_bf16_f32 v250, v100, v101
    v_cvt_pk_bf16_f32 v251, v102, v103
    v_cvt_pk_bf16_f32 v252, v104, v105
    v_cvt_pk_bf16_f32 v253, v106, v107
    v_cvt_pk_bf16_f32 v254, v108, v109
    v_cvt_pk_bf16_f32 v255, v110, v111
    s_waitcnt lgkmcnt(10)
    v_mfma_f32_16x16x32_bf16 v[64:67], v[32:35], v[128:131], 0
    ds_read_b64_tr_b16 v[60:61], v10 offset:13312
    v_mfma_f32_16x16x32_bf16 v[68:71], v[32:35], v[132:135], 0
    ds_read_b64_tr_b16 v[62:63], v10 offset:13568
    v_mfma_f32_16x16x32_bf16 v[72:75], v[36:39], v[128:131], 0
    ds_read_b64_tr_b16 v[32:33], v11 offset:0
    v_mfma_f32_16x16x32_bf16 v[76:79], v[36:39], v[132:135], 0
    ds_read_b64_tr_b16 v[34:35], v11 offset:256
    s_waitcnt lgkmcnt(10)
    v_mfma_f32_16x16x32_bf16 v[64:67], v[40:43], v[136:139], v[64:67]
    ds_read_b64_tr_b16 v[36:37], v11 offset:1024
    v_mfma_f32_16x16x32_bf16 v[68:71], v[40:43], v[140:143], v[68:71]
    ds_read_b64_tr_b16 v[38:39], v11 offset:1280
    v_mfma_f32_16x16x32_bf16 v[72:75], v[44:47], v[136:139], v[72:75]
    ds_read_b64_tr_b16 v[40:41], v11 offset:4096
    v_mfma_f32_16x16x32_bf16 v[76:79], v[44:47], v[140:143], v[76:79]
    ds_read_b64_tr_b16 v[42:43], v11 offset:4352
    s_waitcnt lgkmcnt(10)
    v_mfma_f32_16x16x32_bf16 v[64:67], v[48:51], v[144:147], v[64:67]
    ds_read_b64_tr_b16 v[44:45], v11 offset:5120
    v_mfma_f32_16x16x32_bf16 v[68:71], v[48:51], v[148:151], v[68:71]
    ds_read_b64_tr_b16 v[46:47], v11 offset:5376
    v_mfma_f32_16x16x32_bf16 v[72:75], v[52:55], v[144:147], v[72:75]
    ds_read_b64_tr_b16 v[48:49], v11 offset:8192
    v_mfma_f32_16x16x32_bf16 v[76:79], v[52:55], v[148:151], v[76:79]
    ds_read_b64_tr_b16 v[50:51], v11 offset:8448
    s_waitcnt lgkmcnt(10)
    v_mfma_f32_16x16x32_bf16 v[64:67], v[56:59], v[152:155], v[64:67]
    ds_read_b64_tr_b16 v[52:53], v11 offset:9216
    ds_read_b64_tr_b16 v[54:55], v11 offset:9472
    v_mfma_f32_16x16x32_bf16 v[68:71], v[56:59], v[156:159], v[68:71]
    ds_read_b32 v16, v18
    v_mfma_f32_16x16x32_bf16 v[72:75], v[60:63], v[152:155], v[72:75]
    ds_read_b64_tr_b16 v[56:57], v11 offset:12288
    v_mfma_f32_16x16x32_bf16 v[76:79], v[60:63], v[156:159], v[76:79]
    ds_read_b64_tr_b16 v[58:59], v11 offset:12544
    s_waitcnt lgkmcnt(11)
    v_mfma_f32_16x16x32_bf16 v[80:83], v[32:35], v[128:131], 0
    ds_read_b64_tr_b16 v[60:61], v11 offset:13312
    ds_read_b64_tr_b16 v[62:63], v11 offset:13568
    v_mfma_f32_16x16x32_bf16 v[84:87], v[32:35], v[132:135], 0
    s_waitcnt lgkmcnt(4)
    v_cmp_ge_u32 vcc, 1, v16
    v_mfma_f32_16x16x32_bf16 v[88:91], v[36:39], v[128:131], 0
    v_mfma_f32_16x16x32_bf16 v[92:95], v[36:39], v[132:135], 0
    s_cbranch_vccz L_cb129
    s_movk_i32 s81, 2
    s_call_b64 s[82:83], L_spin_c
L_cb129:
    ds_read_b64_tr_b16 v[32:33], v10 offset:32768
    ds_read_b64_tr_b16 v[34:35], v10 offset:33024
    v_mfma_f32_16x16x32_bf16 v[80:83], v[40:43], v[136:139], v[80:83]
    ds_read_b64_tr_b16 v[36:37], v10 offset:33792
    v_mfma_f32_16x16x32_bf16 v[84:87], v[40:43], v[140:143], v[84:87]
    ds_read_b64_tr_b16 v[38:39], v10 offset:34048
    v_mfma_f32_16x16x32_bf16 v[88:91], v[44:47], v[136:139], v[88:91]
    ds_read_b64_tr_b16 v[40:41], v10 offset:36864
    v_mfma_f32_16x16x32_bf16 v[92:95], v[44:47], v[140:143], v[92:95]
    ds_read_b64_tr_b16 v[42:43], v10 offset:37120
    v_mfma_f32_16x16x32_bf16 v[80:83], v[48:51], v[144:147], v[80:83]
    ds_read_b64_tr_b16 v[44:45], v10 offset:37888
    ds_read_b64_tr_b16 v[46:47], v10 offset:38144
    v_mfma_f32_16x16x32_bf16 v[84:87], v[48:51], v[148:151], v[84:87]
    v_permlane16_swap_b32 v122, v123
    v_mfma_f32_16x16x32_bf16 v[88:91], v[52:55], v[144:147], v[88:91]
    ds_read_b64_tr_b16 v[48:49], v10 offset:40960
    ds_read_b64_tr_b16 v[50:51], v10 offset:41216
    v_mfma_f32_16x16x32_bf16 v[92:95], v[52:55], v[148:151], v[92:95]
    v_add_f32 v122, v122, v123
    s_waitcnt lgkmcnt(10)
    v_mfma_f32_16x16x32_bf16 v[80:83], v[56:59], v[152:155], v[80:83]
    ds_read_b64_tr_b16 v[52:53], v10 offset:41984
    ds_read_b64_tr_b16 v[54:55], v10 offset:42240
    v_mfma_f32_16x16x32_bf16 v[84:87], v[56:59], v[156:159], v[84:87]
    v_mov_b32 v123, v122
    v_mfma_f32_16x16x32_bf16 v[88:91], v[60:63], v[152:155], v[88:91]
    v_mov_b32 v23, 4
    global_load_lds_dword v23, s[88:89]
    ds_read_b64_tr_b16 v[56:57], v10 offset:45056
    v_mfma_f32_16x16x32_bf16 v[92:95], v[60:63], v[156:159], v[92:95]
    ds_read_b64_tr_b16 v[58:59], v10 offset:45312
    v_permlane32_swap_b32 v122, v123
    s_waitcnt lgkmcnt(10)
    v_mfma_f32_16x16x32_bf16 v[64:67], v[32:35], v[160:163], v[64:67]
    ds_read_b64_tr_b16 v[60:61], v10 offset:46080
    ds_read_b64_tr_b16 v[62:63], v10 offset:46336
    v_mfma_f32_16x16x32_bf16 v[68:71], v[32:35], v[164:167], v[68:71]
    v_add_f32 v122, v122, v123
    v_mfma_f32_16x16x32_bf16 v[72:75], v[36:39], v[160:163], v[72:75]
    ds_read_b64_tr_b16 v[32:33], v11 offset:32768
    ds_read_b64_tr_b16 v[34:35], v11 offset:33024
    v_mfma_f32_16x16x32_bf16 v[76:79], v[36:39], v[164:167], v[76:79]
    v_mul_f32 v122, 0x3b000000, v122
    s_waitcnt lgkmcnt(10)
    v_mfma_f32_16x16x32_bf16 v[64:67], v[40:43], v[168:171], v[64:67]
    ds_read_b64_tr_b16 v[36:37], v11 offset:33792
    ds_read_b64_tr_b16 v[38:39], v11 offset:34048
    v_mfma_f32_16x16x32_bf16 v[68:71], v[40:43], v[172:175], v[68:71]
    v_fma_f32 v122, -v126, v126, v122
    v_mfma_f32_16x16x32_bf16 v[72:75], v[44:47], v[168:171], v[72:75]
    ds_read_b64_tr_b16 v[40:41], v11 offset:36864
    ds_read_b64_tr_b16 v[42:43], v11 offset:37120
    v_mfma_f32_16x16x32_bf16 v[76:79], v[44:47], v[172:175], v[76:79]
    v_max_f32 v122, 0, v122
    s_waitcnt lgkmcnt(10)
    v_mfma_f32_16x16x32_bf16 v[64:67], v[48:51], v[176:179], v[64:67]
    ds_read_b64_tr_b16 v[44:45], v11 offset:37888
    ds_read_b64_tr_b16 v[46:47], v11 offset:38144
    v_mfma_f32_16x16x32_bf16 v[68:71], v[48:51], v[180:183], v[68:71]
    v_cvt_pk_bf16_f32 v123, v122, v122
    v_mfma_f32_16x16x32_bf16 v[72:75], v[52:55], v[176:179], v[72:75]
    ds_read_b64_tr_b16 v[48:49], v11 offset:40960
    ds_read_b64_tr_b16 v[50:51], v11 offset:41216
    v_mfma_f32_16x16x32_bf16 v[76:79], v[52:55], v[180:183], v[76:79]
    v_and_b32 v122, 0xffff0000, v123
    s_waitcnt lgkmcnt(10)
    v_mfma_f32_16x16x32_bf16 v[64:67], v[56:59], v[184:187], v[64:67]
    ds_read_b64_tr_b16 v[52:53], v11 offset:41984
    ds_read_b64_tr_b16 v[54:55], v11 offset:42240
    v_mfma_f32_16x16x32_bf16 v[68:71], v[56:59], v[188:191], v[68:71]
    ds_read_b32 v16, v18
    v_add_f32 v122, 0x3727c5ac, v122
    v_mfma_f32_16x16x32_bf16 v[72:75], v[60:63], v[184:187], v[72:75]
    ds_read_b64_tr_b16 v[56:57], v11 offset:45056
    ds_read_b64_tr_b16 v[58:59], v11 offset:45312
    v_mfma_f32_16x16x32_bf16 v[76:79], v[60:63], v[188:191], v[76:79]
    v_cvt_pk_bf16_f32 v123, v122, v122
    s_waitcnt lgkmcnt(11)
    v_mfma_f32_16x16x32_bf16 v[80:83], v[32:35], v[160:163], v[80:83]
    ds_read_b64_tr_b16 v[60:61], v11 offset:46080
    ds_read_b64_tr_b16 v[62:63], v11 offset:46336
    v_mfma_f32_16x16x32_bf16 v[84:87], v[32:35], v[164:167], v[84:87]
    s_waitcnt lgkmcnt(4)
    v_cmp_ge_u32 vcc, 2, v16
    v_and_b32 v122, 0xffff0000, v123
    v_mfma_f32_16x16x32_bf16 v[88:91], v[36:39], v[160:163], v[88:91]
    v_mfma_f32_16x16x32_bf16 v[92:95], v[36:39], v[164:167], v[92:95]
    s_cbranch_vccz L_cb130
    s_movk_i32 s81, 3
    s_call_b64 s[82:83], L_spin_c
L_cb130:
    ds_read_b64_tr_b16 v[32:33], v10 offset:49152
    ds_read_b64_tr_b16 v[34:35], v10 offset:49408
    v_sqrt_f32 v122, v122
    v_mfma_f32_16x16x32_bf16 v[80:83], v[40:43], v[168:171], v[80:83]
    ds_read_b64_tr_b16 v[36:37], v10 offset:50176
    ds_read_b64_tr_b16 v[38:39], v10 offset:50432
    v_mfma_f32_16x16x32_bf16 v[84:87], v[40:43], v[172:175], v[84:87]
    v_cvt_pk_bf16_f32 v123, v122, v122
    v_mfma_f32_16x16x32_bf16 v[88:91], v[44:47], v[168:171], v[88:91]
    ds_read_b64_tr_b16 v[40:41], v10 offset:53248
    ds_read_b64_tr_b16 v[42:43], v10 offset:53504
    v_mfma_f32_16x16x32_bf16 v[92:95], v[44:47], v[172:175], v[92:95]
    v_and_b32 v122, 0xffff0000, v123
    v_mfma_f32_16x16x32_bf16 v[80:83], v[48:51], v[176:179], v[80:83]
    ds_read_b64_tr_b16 v[44:45], v10 offset:54272
    ds_read_b64_tr_b16 v[46:47], v10 offset:54528
    v_mfma_f32_16x16x32_bf16 v[84:87], v[48:51], v[180:183], v[84:87]
    v_rcp_f32 v122, v122
    v_mfma_f32_16x16x32_bf16 v[88:91], v[52:55], v[176:179], v[88:91]
    ds_read_b64_tr_b16 v[48:49], v10 offset:57344
    ds_read_b64_tr_b16 v[50:51], v10 offset:57600
    v_mfma_f32_16x16x32_bf16 v[92:95], v[52:55], v[180:183], v[92:95]
    v_lshl_add_u32 v124, v127, 1, v21
    s_waitcnt lgkmcnt(10)
    v_mfma_f32_16x16x32_bf16 v[80:83], v[56:59], v[184:187], v[80:83]
    ds_read_b64_tr_b16 v[52:53], v10 offset:58368
    ds_read_b64_tr_b16 v[54:55], v10 offset:58624
    v_mfma_f32_16x16x32_bf16 v[84:87], v[56:59], v[188:191], v[84:87]
    v_lshl_add_u32 v125, v127, 2, v21
    v_mfma_f32_16x16x32_bf16 v[88:91], v[60:63], v[184:187], v[88:91]
    ds_read_b64_tr_b16 v[56:57], v10 offset:61440
    v_mfma_f32_16x16x32_bf16 v[92:95], v[60:63], v[188:191], v[92:95]
    ds_read_b64_tr_b16 v[58:59], v10 offset:61696
    s_waitcnt lgkmcnt(10)
    v_mfma_f32_16x16x32_bf16 v[64:67], v[32:35], v[192:195], v[64:67]
    ds_read_b64_tr_b16 v[60:61], v10 offset:62464
    v_mfma_f32_16x16x32_bf16 v[68:71], v[32:35], v[196:199], v[68:71]
    ds_read_b64_tr_b16 v[62:63], v10 offset:62720
    v_mfma_f32_16x16x32_bf16 v[72:75], v[36:39], v[192:195], v[72:75]
    ds_read_b64_tr_b16 v[32:33], v11 offset:49152
    v_mfma_f32_16x16x32_bf16 v[76:79], v[36:39], v[196:199], v[76:79]
    ds_read_b64_tr_b16 v[34:35], v11 offset:49408
    s_waitcnt lgkmcnt(10)
    v_mfma_f32_16x16x32_bf16 v[64:67], v[40:43], v[200:203], v[64:67]
    ds_read_b64_tr_b16 v[36:37], v11 offset:50176
    v_mfma_f32_16x16x32_bf16 v[68:71], v[40:43], v[204:207], v[68:71]
    ds_read_b64_tr_b16 v[38:39], v11 offset:50432
    v_mfma_f32_16x16x32_bf16 v[72:75], v[44:47], v[200:203], v[72:75]
    ds_read_b64_tr_b16 v[40:41], v11 offset:53248
    v_mfma_f32_16x16x32_bf16 v[76:79], v[44:47], v[204:207], v[76:79]
    ds_read_b64_tr_b16 v[42:43], v11 offset:53504
    s_waitcnt lgkmcnt(10)
    v_mfma_f32_16x16x32_bf16 v[64:67], v[48:51], v[208:211], v[64:67]
    ds_read_b64_tr_b16 v[44:45], v11 offset:54272
    v_mfma_f32_16x16x32_bf16 v[68:71], v[48:51], v[212:215], v[68:71]
    ds_read_b64_tr_b16 v[46:47], v11 offset:54528
    v_mfma_f32_16x16x32_bf16 v[72:75], v[52:55], v[208:211], v[72:75]
    ds_read_b64_tr_b16 v[48:49], v11 offset:57344
    v_mfma_f32_16x16x32_bf16 v[76:79], v[52:55], v[212:215], v[76:79]
    ds_read_b64_tr_b16 v[50:51], v11 offset:57600
    s_waitcnt lgkmcnt(10)
    v_mfma_f32_16x16x32_bf16 v[64:67], v[56:59], v[216:219], v[64:67]
    ds_read_b64_tr_b16 v[52:53], v11 offset:58368
    ds_read_b64_tr_b16 v[54:55], v11 offset:58624
    v_mfma_f32_16x16x32_bf16 v[68:71], v[56:59], v[220:223], v[68:71]
    ds_read_b32 v16, v18
    v_mfma_f32_16x16x32_bf16 v[72:75], v[60:63], v[216:219], v[72:75]
    ds_read_b64_tr_b16 v[56:57], v11 offset:61440
    v_mfma_f32_16x16x32_bf16 v[76:79], v[60:63], v[220:223], v[76:79]
    ds_read_b64_tr_b16 v[58:59], v11 offset:61696
    s_waitcnt lgkmcnt(11)
    v_mfma_f32_16x16x32_bf16 v[80:83], v[32:35], v[192:195], v[80:83]
    ds_read_b64_tr_b16 v[60:61], v11 offset:62464
    ds_read_b64_tr_b16 v[62:63], v11 offset:62720
    v_mfma_f32_16x16x32_bf16 v[84:87], v[32:35], v[196:199], v[84:87]
    s_waitcnt lgkmcnt(4)
    v_cmp_ge_u32 vcc, 3, v16
    v_mfma_f32_16x16x32_bf16 v[88:91], v[36:39], v[192:195], v[88:91]
    v_mfma_f32_16x16x32_bf16 v[92:95], v[36:39], v[196:199], v[92:95]
    s_cbranch_vccz L_cb131
    s_movk_i32 s81, 4
    s_call_b64 s[82:83], L_spin_c
L_cb131:
    ds_read_b64_tr_b16 v[32:33], v12 offset:0
    ds_read_b64_tr_b16 v[34:35], v12 offset:256
    v_mfma_f32_16x16x32_bf16 v[80:83], v[40:43], v[200:203], v[80:83]
    ds_read_b64_tr_b16 v[36:37], v12 offset:1024
    v_mfma_f32_16x16x32_bf16 v[84:87], v[40:43], v[204:207], v[84:87]
    ds_read_b64_tr_b16 v[38:39], v12 offset:1280
    v_mfma_f32_16x16x32_bf16 v[88:91], v[44:47], v[200:203], v[88:91]
    ds_read_b64_tr_b16 v[40:41], v12 offset:4096
    v_mfma_f32_16x16x32_bf16 v[92:95], v[44:47], v[204:207], v[92:95]
    ds_read_b64_tr_b16 v[42:43], v12 offset:4352
    v_mfma_f32_16x16x32_bf16 v[80:83], v[48:51], v[208:211], v[80:83]
    ds_read_b64_tr_b16 v[44:45], v12 offset:5120
    v_mfma_f32_16x16x32_bf16 v[84:87], v[48:51], v[212:215], v[84:87]
    ds_read_b64_tr_b16 v[46:47], v12 offset:5376
    v_mfma_f32_16x16x32_bf16 v[88:91], v[52:55], v[208:211], v[88:91]
    ds_read_b64_tr_b16 v[48:49], v12 offset:8192
    v_mfma_f32_16x16x32_bf16 v[92:95], v[52:55], v[212:215], v[92:95]
    ds_read_b64_tr_b16 v[50:51], v12 offset:8448
    s_waitcnt lgkmcnt(10)
    v_mfma_f32_16x16x32_bf16 v[80:83], v[56:59], v[216:219], v[80:83]
    ds_read_b64_tr_b16 v[52:53], v12 offset:9216
    v_mfma_f32_16x16x32_bf16 v[84:87], v[56:59], v[220:223], v[84:87]
    ds_read_b64_tr_b16 v[54:55], v12 offset:9472
    v_mfma_f32_16x16x32_bf16 v[88:91], v[60:63], v[216:219], v[88:91]
    v_mov_b32 v23, 12
    global_load_lds_dword v23, s[88:89]
    v_mfma_f32_16x16x32_bf16 v[92:95], v[60:63], v[220:223], v[92:95]
    ds_read_b64_tr_b16 v[56:57], v12 offset:12288
    ds_read_b64_tr_b16 v[58:59], v12 offset:12544
    s_waitcnt lgkmcnt(10)
    v_mfma_f32_16x16x32_bf16 v[64:67], v[32:35], v[224:227], v[64:67]
    ds_read_b64_tr_b16 v[60:61], v12 offset:13312
    v_mfma_f32_16x16x32_bf16 v[68:71], v[32:35], v[228:231], v[68:71]
    ds_read_b64_tr_b16 v[62:63], v12 offset:13568
    v_mfma_f32_16x16x32_bf16 v[72:75], v[36:39], v[224:227], v[72:75]
    ds_read_b64_tr_b16 v[32:33], v13 offset:0
    v_mfma_f32_16x16x32_bf16 v[76:79], v[36:39], v[228:231], v[76:79]
    ds_read_b64_tr_b16 v[34:35], v13 offset:256
    s_waitcnt lgkmcnt(10)
    v_mfma_f32_16x16x32_bf16 v[64:67], v[40:43], v[232:235], v[64:67]
    ds_read_b64_tr_b16 v[36:37], v13 offset:1024
    v_mfma_f32_16x16x32_bf16 v[68:71], v[40:43], v[236:239], v[68:71]
    ds_read_b64_tr_b16 v[38:39], v13 offset:1280
    v_mfma_f32_16x16x32_bf16 v[72:75], v[44:47], v[232:235], v[72:75]
    ds_read_b64_tr_b16 v[40:41], v13 offset:4096
    v_mfma_f32_16x16x32_bf16 v[76:79], v[44:47], v[236:239], v[76:79]
    ds_read_b64_tr_b16 v[42:43], v13 offset:4352
    s_waitcnt lgkmcnt(10)
    v_mfma_f32_16x16x32_bf16 v[64:67], v[48:51], v[240:243], v[64:67]
    ds_read_b64_tr_b16 v[44:45], v13 offset:5120
    v_mfma_f32_16x16x32_bf16 v[68:71], v[48:51], v[244:247], v[68:71]
    ds_read_b64_tr_b16 v[46:47], v13 offset:5376
    v_mfma_f32_16x16x32_bf16 v[72:75], v[52:55], v[240:243], v[72:75]
    ds_read_b64_tr_b16 v[48:49], v13 offset:8192
    v_mfma_f32_16x16x32_bf16 v[76:79], v[52:55], v[244:247], v[76:79]
    ds_read_b64_tr_b16 v[50:51], v13 offset:8448
    s_waitcnt lgkmcnt(10)
    v_mfma_f32_16x16x32_bf16 v[64:67], v[56:59], v[248:251], v[64:67]
    ds_read_b64_tr_b16 v[52:53], v13 offset:9216
    ds_read_b64_tr_b16 v[54:55], v13 offset:9472
    v_mfma_f32_16x16x32_bf16 v[68:71], v[56:59], v[252:255], v[68:71]
    ds_read_b32 v16, v18
    v_mfma_f32_16x16x32_bf16 v[72:75], v[60:63], v[248:251], v[72:75]
    ds_read_b64_tr_b16 v[56:57], v13 offset:12288
    v_mfma_f32_16x16x32_bf16 v[76:79], v[60:63], v[252:255], v[76:79]
    ds_read_b64_tr_b16 v[58:59], v13 offset:12544
    s_waitcnt lgkmcnt(11)
    v_mfma_f32_16x16x32_bf16 v[80:83], v[32:35], v[224:227], v[80:83]
    ds_read_b64_tr_b16 v[60:61], v13 offset:13312
    ds_read_b64_tr_b16 v[62:63], v13 offset:13568
    v_mfma_f32_16x16x32_bf16 v[84:87], v[32:35], v[228:231], v[84:87]
    s_waitcnt lgkmcnt(4)
    v_cmp_ge_u32 vcc, 4, v16
    v_cvt_pk_bf16_f32 v64, v64, v65
    v_cvt_pk_bf16_f32 v65, v66, v67
    v_cvt_pk_bf16_f32 v68, v68, v69
    v_mfma_f32_16x16x32_bf16 v[88:91], v[36:39], v[224:227], v[88:91]
    v_mfma_f32_16x16x32_bf16 v[92:95], v[36:39], v[228:231], v[92:95]
    s_cbranch_vccz L_cb132
    s_movk_i32 s81, 5
    s_call_b64 s[82:83], L_spin_c
L_cb132:
    ds_read_b64_tr_b16 v[32:33], v12 offset:16384
    ds_read_b64_tr_b16 v[34:35], v12 offset:16640
    v_cvt_pk_bf16_f32 v69, v70, v71
    v_cvt_pk_bf16_f32 v72, v72, v73
    v_cvt_pk_bf16_f32 v73, v74, v75
    v_mfma_f32_16x16x32_bf16 v[80:83], v[40:43], v[232:235], v[80:83]
    ds_read_b64_tr_b16 v[36:37], v12 offset:17408
    ds_read_b64_tr_b16 v[38:39], v12 offset:17664
    v_mfma_f32_16x16x32_bf16 v[84:87], v[40:43], v[236:239], v[84:87]
    v_cvt_pk_bf16_f32 v76, v76, v77
    v_cvt_pk_bf16_f32 v77, v78, v79
    v_mfma_f32_16x16x32_bf16 v[88:91], v[44:47], v[232:235], v[88:91]
    ds_read_b64_tr_b16 v[40:41], v12 offset:20480
    v_mfma_f32_16x16x32_bf16 v[92:95], v[44:47], v[236:239], v[92:95]
    ds_read_b64_tr_b16 v[42:43], v12 offset:20736
    v_mfma_f32_16x16x32_bf16 v[80:83], v[48:51], v[240:243], v[80:83]
    ds_read_b64_tr_b16 v[44:45], v12 offset:21504
    v_mfma_f32_16x16x32_bf16 v[84:87], v[48:51], v[244:247], v[84:87]
    ds_read_b64_tr_b16 v[46:47], v12 offset:21760
    v_mfma_f32_16x16x32_bf16 v[88:91], v[52:55], v[240:243], v[88:91]
    ds_read_b64_tr_b16 v[48:49], v12 offset:24576
    v_mfma_f32_16x16x32_bf16 v[92:95], v[52:55], v[244:247], v[92:95]
    ds_read_b64_tr_b16 v[50:51], v12 offset:24832
    s_waitcnt lgkmcnt(10)
    v_mfma_f32_16x16x32_bf16 v[80:83], v[56:59], v[248:251], v[80:83]
    ds_read_b64_tr_b16 v[52:53], v12 offset:25600
    v_mfma_f32_16x16x32_bf16 v[84:87], v[56:59], v[252:255], v[84:87]
    ds_read_b64_tr_b16 v[54:55], v12 offset:25856
    v_mfma_f32_16x16x32_bf16 v[88:91], v[60:63], v[248:251], v[88:91]
    ds_read_b64_tr_b16 v[56:57], v12 offset:28672
    v_mfma_f32_16x16x32_bf16 v[92:95], v[60:63], v[252:255], v[92:95]
    ds_read_b64_tr_b16 v[58:59], v12 offset:28928
    s_waitcnt lgkmcnt(10)
    v_mfma_f32_16x16x32_bf16 v[96:99], v[32:35], v[128:131], 0
    ds_read_b64_tr_b16 v[60:61], v12 offset:29696
    ds_read_b64_tr_b16 v[62:63], v12 offset:29952
    v_cvt_pk_bf16_f32 v80, v80, v81
    v_mfma_f32_16x16x32_bf16 v[100:103], v[32:35], v[132:135], 0
    v_cvt_pk_bf16_f32 v81, v82, v83
    v_cvt_pk_bf16_f32 v84, v84, v85
    v_mfma_f32_16x16x32_bf16 v[104:107], v[36:39], v[128:131], 0
    ds_read_b64_tr_b16 v[32:33], v13 offset:16384
    ds_read_b64_tr_b16 v[34:35], v13 offset:16640
    v_cvt_pk_bf16_f32 v85, v86, v87
    v_mfma_f32_16x16x32_bf16 v[108:111], v[36:39], v[132:135], 0
    v_cvt_pk_bf16_f32 v88, v88, v89
    v_cvt_pk_bf16_f32 v89, v90, v91
    s_waitcnt lgkmcnt(10)
    v_mfma_f32_16x16x32_bf16 v[96:99], v[40:43], v[136:139], v[96:99]
    ds_read_b64_tr_b16 v[36:37], v13 offset:17408
    ds_read_b64_tr_b16 v[38:39], v13 offset:17664
    v_cvt_pk_bf16_f32 v92, v92, v93
    v_mfma_f32_16x16x32_bf16 v[100:103], v[40:43], v[140:143], v[100:103]
    v_cvt_pk_bf16_f32 v93, v94, v95
    ds_write_b16 v124, v123 offset:2560
    v_mfma_f32_16x16x32_bf16 v[104:107], v[44:47], v[136:139], v[104:107]
    ds_read_b64_tr_b16 v[40:41], v13 offset:20480
    ds_read_b64_tr_b16 v[42:43], v13 offset:20736
    ds_write_b32 v125, v122 offset:2048
    ds_write_b64 v15, v[64:65] offset:0
    v_mfma_f32_16x16x32_bf16 v[108:111], v[44:47], v[140:143], v[108:111]
    ds_write_b64 v15, v[68:69] offset:256
    ds_write_b64 v15, v[72:73] offset:1024
    ds_write_b64 v15, v[76:77] offset:1280
    s_waitcnt lgkmcnt(15)
    v_mfma_f32_16x16x32_bf16 v[96:99], v[48:51], v[144:147], v[96:99]
    ds_read_b64_tr_b16 v[44:45], v13 offset:21504
    ds_read_b64_tr_b16 v[46:47], v13 offset:21760
    ds_write_b64 v15, v[80:81] offset:2048
    ds_write_b64 v15, v[84:85] offset:2304
    ds_write_b64 v15, v[88:89] offset:3072
    v_mfma_f32_16x16x32_bf16 v[100:103], v[48:51], v[148:151], v[100:103]
    ds_write_b64 v15, v[92:93] offset:3328
    s_mov_b64 exec, 1
    ds_add_u32 v21, v22 offset:32
    s_mov_b64 exec, -1
    v_mfma_f32_16x16x32_bf16 v[104:107], v[52:55], v[144:147], v[104:107]
    ds_read_b64_tr_b16 v[48:49], v13 offset:24576
    v_mfma_f32_16x16x32_bf16 v[108:111], v[52:55], v[148:151], v[108:111]
    ds_read_b64_tr_b16 v[50:51], v13 offset:24832
    s_waitcnt lgkmcnt(15)
    v_mfma_f32_16x16x32_bf16 v[96:99], v[56:59], v[152:155], v[96:99]
    ds_read_b64_tr_b16 v[52:53], v13 offset:25600
    ds_read_b64_tr_b16 v[54:55], v13 offset:25856
    v_mfma_f32_16x16x32_bf16 v[100:103], v[56:59], v[156:159], v[100:103]
    ds_read_b32 v16, v18
    v_mfma_f32_16x16x32_bf16 v[104:107], v[60:63], v[152:155], v[104:107]
    ds_read_b64_tr_b16 v[56:57], v13 offset:28672
    v_mfma_f32_16x16x32_bf16 v[108:111], v[60:63], v[156:159], v[108:111]
    ds_read_b64_tr_b16 v[58:59], v13 offset:28928
    s_waitcnt lgkmcnt(15)
    v_mfma_f32_16x16x32_bf16 v[112:115], v[32:35], v[128:131], 0
    ds_read_b64_tr_b16 v[60:61], v13 offset:29696
    ds_read_b64_tr_b16 v[62:63], v13 offset:29952
    v_mfma_f32_16x16x32_bf16 v[116:119], v[32:35], v[132:135], 0
    s_waitcnt lgkmcnt(4)
    v_cmp_ge_u32 vcc, 5, v16
    v_mfma_f32_16x16x32_bf16 v[120:123], v[36:39], v[128:131], 0
    v_mfma_f32_16x16x32_bf16 v[124:127], v[36:39], v[132:135], 0
    s_cbranch_vccz L_cb133
    s_movk_i32 s81, 6
    s_call_b64 s[82:83], L_spin_c
L_cb133:
    ds_read_b64_tr_b16 v[32:33], v12 offset:32768
    ds_read_b64_tr_b16 v[34:35], v12 offset:33024
    v_mfma_f32_16x16x32_bf16 v[112:115], v[40:43], v[136:139], v[112:115]
    ds_read_b64_tr_b16 v[36:37], v12 offset:33792
    v_mfma_f32_16x16x32_bf16 v[116:119], v[40:43], v[140:143], v[116:119]
    ds_read_b64_tr_b16 v[38:39], v12 offset:34048
    v_mfma_f32_16x16x32_bf16 v[120:123], v[44:47], v[136:139], v[120:123]
    ds_read_b64_tr_b16 v[40:41], v12 offset:36864
    v_mfma_f32_16x16x32_bf16 v[124:127], v[44:47], v[140:143], v[124:127]
    ds_read_b64_tr_b16 v[42:43], v12 offset:37120
    v_mfma_f32_16x16x32_bf16 v[112:115], v[48:51], v[144:147], v[112:115]
    ds_read_b64_tr_b16 v[44:45], v12 offset:37888
    v_mfma_f32_16x16x32_bf16 v[116:119], v[48:51], v[148:151], v[116:119]
    ds_read_b64_tr_b16 v[46:47], v12 offset:38144
    v_mfma_f32_16x16x32_bf16 v[120:123], v[52:55], v[144:147], v[120:123]
    ds_read_b64_tr_b16 v[48:49], v12 offset:40960
    v_mfma_f32_16x16x32_bf16 v[124:127], v[52:55], v[148:151], v[124:127]
    ds_read_b64_tr_b16 v[50:51], v12 offset:41216
    s_waitcnt lgkmcnt(10)
    v_mfma_f32_16x16x32_bf16 v[112:115], v[56:59], v[152:155], v[112:115]
    ds_read_b64_tr_b16 v[52:53], v12 offset:41984
    v_mfma_f32_16x16x32_bf16 v[116:119], v[56:59], v[156:159], v[116:119]
    ds_read_b64_tr_b16 v[54:55], v12 offset:42240
    v_mfma_f32_16x16x32_bf16 v[120:123], v[60:63], v[152:155], v[120:123]
    v_mov_b32 v23, 20
    global_load_lds_dword v23, s[88:89]
    v_mfma_f32_16x16x32_bf16 v[124:127], v[60:63], v[156:159], v[124:127]
    ds_read_b64_tr_b16 v[56:57], v12 offset:45056
    ds_read_b64_tr_b16 v[58:59], v12 offset:45312
    s_waitcnt lgkmcnt(10)
    v_mfma_f32_16x16x32_bf16 v[96:99], v[32:35], v[160:163], v[96:99]
    ds_read_b64_tr_b16 v[60:61], v12 offset:46080
    v_mfma_f32_16x16x32_bf16 v[100:103], v[32:35], v[164:167], v[100:103]
    ds_read_b64_tr_b16 v[62:63], v12 offset:46336
    v_mfma_f32_16x16x32_bf16 v[104:107], v[36:39], v[160:163], v[104:107]
    ds_read_b64_tr_b16 v[32:33], v13 offset:32768
    v_mfma_f32_16x16x32_bf16 v[108:111], v[36:39], v[164:167], v[108:111]
    ds_read_b64_tr_b16 v[34:35], v13 offset:33024
    s_waitcnt lgkmcnt(10)
    v_mfma_f32_16x16x32_bf16 v[96:99], v[40:43], v[168:171], v[96:99]
    ds_read_b64_tr_b16 v[36:37], v13 offset:33792
    v_mfma_f32_16x16x32_bf16 v[100:103], v[40:43], v[172:175], v[100:103]
    ds_read_b64_tr_b16 v[38:39], v13 offset:34048
    v_mfma_f32_16x16x32_bf16 v[104:107], v[44:47], v[168:171], v[104:107]
    ds_read_b64_tr_b16 v[40:41], v13 offset:36864
    v_mfma_f32_16x16x32_bf16 v[108:111], v[44:47], v[172:175], v[108:111]
    ds_read_b64_tr_b16 v[42:43], v13 offset:37120
    s_waitcnt lgkmcnt(10)
    v_mfma_f32_16x16x32_bf16 v[96:99], v[48:51], v[176:179], v[96:99]
    ds_read_b64_tr_b16 v[44:45], v13 offset:37888
    v_mfma_f32_16x16x32_bf16 v[100:103], v[48:51], v[180:183], v[100:103]
    ds_read_b64_tr_b16 v[46:47], v13 offset:38144
    v_mfma_f32_16x16x32_bf16 v[104:107], v[52:55], v[176:179], v[104:107]
    ds_read_b64_tr_b16 v[48:49], v13 offset:40960
    v_mfma_f32_16x16x32_bf16 v[108:111], v[52:55], v[180:183], v[108:111]
    ds_read_b64_tr_b16 v[50:51], v13 offset:41216
    s_waitcnt lgkmcnt(10)
    v_mfma_f32_16x16x32_bf16 v[96:99], v[56:59], v[184:187], v[96:99]
    ds_read_b64_tr_b16 v[52:53], v13 offset:41984
    ds_read_b64_tr_b16 v[54:55], v13 offset:42240
    v_mfma_f32_16x16x32_bf16 v[100:103], v[56:59], v[188:191], v[100:103]
    ds_read_b32 v16, v18
    v_mfma_f32_16x16x32_bf16 v[104:107], v[60:63], v[184:187], v[104:107]
    ds_read_b64_tr_b16 v[56:57], v13 offset:45056
    v_mfma_f32_16x16x32_bf16 v[108:111], v[60:63], v[188:191], v[108:111]
    ds_read_b64_tr_b16 v[58:59], v13 offset:45312
    s_waitcnt lgkmcnt(11)
    v_mfma_f32_16x16x32_bf16 v[112:115], v[32:35], v[160:163], v[112:115]
    ds_read_b64_tr_b16 v[60:61], v13 offset:46080
    ds_read_b64_tr_b16 v[62:63], v13 offset:46336
    v_mfma_f32_16x16x32_bf16 v[116:119], v[32:35], v[164:167], v[116:119]
    s_waitcnt lgkmcnt(4)
    v_cmp_ge_u32 vcc, 6, v16
    v_mfma_f32_16x16x32_bf16 v[120:123], v[36:39], v[160:163], v[120:123]
    v_mfma_f32_16x16x32_bf16 v[124:127], v[36:39], v[164:167], v[124:127]
    s_cbranch_vccz L_cb134
    s_movk_i32 s81, 7
    s_call_b64 s[82:83], L_spin_c
L_cb134:
    ds_read_b64_tr_b16 v[32:33], v12 offset:49152
    ds_read_b64_tr_b16 v[34:35], v12 offset:49408
    v_mfma_f32_16x16x32_bf16 v[112:115], v[40:43], v[168:171], v[112:115]
    ds_read_b64_tr_b16 v[36:37], v12 offset:50176
    v_mfma_f32_16x16x32_bf16 v[116:119], v[40:43], v[172:175], v[116:119]
    ds_read_b64_tr_b16 v[38:39], v12 offset:50432
    v_mfma_f32_16x16x32_bf16 v[120:123], v[44:47], v[168:171], v[120:123]
    ds_read_b64_tr_b16 v[40:41], v12 offset:53248
    v_mfma_f32_16x16x32_bf16 v[124:127], v[44:47], v[172:175], v[124:127]
    ds_read_b64_tr_b16 v[42:43], v12 offset:53504
    v_mfma_f32_16x16x32_bf16 v[112:115], v[48:51], v[176:179], v[112:115]
    ds_read_b64_tr_b16 v[44:45], v12 offset:54272
    v_mfma_f32_16x16x32_bf16 v[116:119], v[48:51], v[180:183], v[116:119]
    ds_read_b64_tr_b16 v[46:47], v12 offset:54528
    v_mfma_f32_16x16x32_bf16 v[120:123], v[52:55], v[176:179], v[120:123]
    ds_read_b64_tr_b16 v[48:49], v12 offset:57344
    v_mfma_f32_16x16x32_bf16 v[124:127], v[52:55], v[180:183], v[124:127]
    ds_read_b64_tr_b16 v[50:51], v12 offset:57600
    s_waitcnt lgkmcnt(10)
    v_mfma_f32_16x16x32_bf16 v[112:115], v[56:59], v[184:187], v[112:115]
    ds_read_b64_tr_b16 v[52:53], v12 offset:58368
    ds_read_b64_tr_b16 v[54:55], v12 offset:58624
    v_mfma_f32_16x16x32_bf16 v[116:119], v[56:59], v[188:191], v[116:119]
    ds_read_b32 v20, v21 offset:1792
    v_mfma_f32_16x16x32_bf16 v[120:123], v[60:63], v[184:187], v[120:123]
    ds_read_b64_tr_b16 v[56:57], v12 offset:61440
    v_mfma_f32_16x16x32_bf16 v[124:127], v[60:63], v[188:191], v[124:127]
    ds_read_b64_tr_b16 v[58:59], v12 offset:61696
    s_waitcnt lgkmcnt(11)
    v_mfma_f32_16x16x32_bf16 v[96:99], v[32:35], v[192:195], v[96:99]
    ds_read_b64_tr_b16 v[60:61], v12 offset:62464
    v_mfma_f32_16x16x32_bf16 v[100:103], v[32:35], v[196:199], v[100:103]
    ds_read_b64_tr_b16 v[62:63], v12 offset:62720
    v_mfma_f32_16x16x32_bf16 v[104:107], v[36:39], v[192:195], v[104:107]
    ds_read_b64_tr_b16 v[32:33], v13 offset:49152
    v_mfma_f32_16x16x32_bf16 v[108:111], v[36:39], v[196:199], v[108:111]
    ds_read_b64_tr_b16 v[34:35], v13 offset:49408
    s_waitcnt lgkmcnt(11)
    v_mfma_f32_16x16x32_bf16 v[96:99], v[40:43], v[200:203], v[96:99]
    ds_read_b64_tr_b16 v[36:37], v13 offset:50176
    v_mfma_f32_16x16x32_bf16 v[100:103], v[40:43], v[204:207], v[100:103]
    ds_read_b64_tr_b16 v[38:39], v13 offset:50432
    v_mfma_f32_16x16x32_bf16 v[104:107], v[44:47], v[200:203], v[104:107]
    ds_read_b64_tr_b16 v[40:41], v13 offset:53248
    v_mfma_f32_16x16x32_bf16 v[108:111], v[44:47], v[204:207], v[108:111]
    ds_read_b64_tr_b16 v[42:43], v13 offset:53504
    s_waitcnt lgkmcnt(11)
    v_mfma_f32_16x16x32_bf16 v[96:99], v[48:51], v[208:211], v[96:99]
    ds_read_b64_tr_b16 v[44:45], v13 offset:54272
    ds_read_b64_tr_b16 v[46:47], v13 offset:54528
    v_mfma_f32_16x16x32_bf16 v[100:103], v[48:51], v[212:215], v[100:103]
    s_waitcnt lgkmcnt(12)
    v_cmp_eq_u32 vcc, 1, v20
    s_cbranch_vccnz L_ok127
    v_mov_b32 v23, 0
    s_mov_b32 s80, 0
L_spin127:
    s_sleep 4
    buffer_load_dword v20, v23, s[40:43], 0 offen offset:0 sc1
    s_add_u32 s80, s80, 1
    s_waitcnt vmcnt(0)
    v_cmp_eq_u32 vcc, 1, v20
    s_cbranch_vccnz L_ok127
    s_cmp_lt_u32 s80, 0x80000
    s_cbranch_scc1 L_spin127
L_ok127:
    v_mfma_f32_16x16x32_bf16 v[104:107], v[52:55], v[208:211], v[104:107]
    ds_read_b64_tr_b16 v[48:49], v13 offset:57344
    v_mfma_f32_16x16x32_bf16 v[108:111], v[52:55], v[212:215], v[108:111]
    ds_read_b64_tr_b16 v[50:51], v13 offset:57600
    s_waitcnt lgkmcnt(10)
    v_mfma_f32_16x16x32_bf16 v[96:99], v[56:59], v[216:219], v[96:99]
    ds_read_b64_tr_b16 v[52:53], v13 offset:58368
    ds_read_b64_tr_b16 v[54:55], v13 offset:58624
    v_mfma_f32_16x16x32_bf16 v[100:103], v[56:59], v[220:223], v[100:103]
    ds_read_b32 v16, v18
    v_mfma_f32_16x16x32_bf16 v[104:107], v[60:63], v[216:219], v[104:107]
    ds_read_b64_tr_b16 v[56:57], v13 offset:61440
    v_mfma_f32_16x16x32_bf16 v[108:111], v[60:63], v[220:223], v[108:111]
    ds_read_b64_tr_b16 v[58:59], v13 offset:61696
    s_waitcnt lgkmcnt(11)
    v_mfma_f32_16x16x32_bf16 v[112:115], v[32:35], v[192:195], v[112:115]
    ds_read_b64_tr_b16 v[60:61], v13 offset:62464
    ds_read_b64_tr_b16 v[62:63], v13 offset:62720
    v_mfma_f32_16x16x32_bf16 v[116:119], v[32:35], v[196:199], v[116:119]
    s_waitcnt lgkmcnt(4)
    v_cmp_ge_u32 vcc, 7, v16
    v_mfma_f32_16x16x32_bf16 v[120:123], v[36:39], v[192:195], v[120:123]
    v_mfma_f32_16x16x32_bf16 v[124:127], v[36:39], v[196:199], v[124:127]
    s_cbranch_vccz L_cb135
    s_movk_i32 s81, 8
    s_call_b64 s[82:83], L_spin_c
L_cb135:
    ds_read_b64_tr_b16 v[32:33], v10 offset:0
    ds_read_b64_tr_b16 v[34:35], v10 offset:256
    v_mfma_f32_16x16x32_bf16 v[112:115], v[40:43], v[200:203], v[112:115]
    ds_read_b64_tr_b16 v[36:37], v10 offset:1024
    v_mfma_f32_16x16x32_bf16 v[116:119], v[40:43], v[204:207], v[116:119]
    ds_read_b64_tr_b16 v[38:39], v10 offset:1280
    v_mfma_f32_16x16x32_bf16 v[120:123], v[44:47], v[200:203], v[120:123]
    ds_read_b64_tr_b16 v[40:41], v10 offset:4096
    v_mfma_f32_16x16x32_bf16 v[124:127], v[44:47], v[204:207], v[124:127]
    ds_read_b64_tr_b16 v[42:43], v10 offset:4352
    v_mfma_f32_16x16x32_bf16 v[112:115], v[48:51], v[208:211], v[112:115]
    ds_read_b64_tr_b16 v[44:45], v10 offset:5120
    v_mfma_f32_16x16x32_bf16 v[116:119], v[48:51], v[212:215], v[116:119]
    ds_read_b64_tr_b16 v[46:47], v10 offset:5376
    v_mfma_f32_16x16x32_bf16 v[120:123], v[52:55], v[208:211], v[120:123]
    ds_read_b64_tr_b16 v[48:49], v10 offset:8192
    v_mfma_f32_16x16x32_bf16 v[124:127], v[52:55], v[212:215], v[124:127]
    ds_read_b64_tr_b16 v[50:51], v10 offset:8448
    s_waitcnt lgkmcnt(10)
    v_mfma_f32_16x16x32_bf16 v[112:115], v[56:59], v[216:219], v[112:115]
    ds_read_b64_tr_b16 v[52:53], v10 offset:9216
    v_mfma_f32_16x16x32_bf16 v[116:119], v[56:59], v[220:223], v[116:119]
    ds_read_b64_tr_b16 v[54:55], v10 offset:9472
    v_mfma_f32_16x16x32_bf16 v[120:123], v[60:63], v[216:219], v[120:123]
    v_mov_b32 v23, 28
    global_load_lds_dword v23, s[88:89]
    v_mfma_f32_16x16x32_bf16 v[124:127], v[60:63], v[220:223], v[124:127]
    ds_read_b64_tr_b16 v[56:57], v10 offset:12288
    ds_read_b64_tr_b16 v[58:59], v10 offset:12544
    s_waitcnt lgkmcnt(10)
    v_mfma_f32_16x16x32_bf16 v[96:99], v[32:35], v[224:227], v[96:99]
    ds_read_b64_tr_b16 v[60:61], v10 offset:13312
    v_mfma_f32_16x16x32_bf16 v[100:103], v[32:35], v[228:231], v[100:103]
    ds_read_b64_tr_b16 v[62:63], v10 offset:13568
    v_mfma_f32_16x16x32_bf16 v[104:107], v[36:39], v[224:227], v[104:107]
    ds_read_b64_tr_b16 v[32:33], v11 offset:0
    v_mfma_f32_16x16x32_bf16 v[108:111], v[36:39], v[228:231], v[108:111]
    ds_read_b64_tr_b16 v[34:35], v11 offset:256
    s_waitcnt lgkmcnt(10)
    v_mfma_f32_16x16x32_bf16 v[96:99], v[40:43], v[232:235], v[96:99]
    ds_read_b64_tr_b16 v[36:37], v11 offset:1024
    v_mfma_f32_16x16x32_bf16 v[100:103], v[40:43], v[236:239], v[100:103]
    ds_read_b64_tr_b16 v[38:39], v11 offset:1280
    v_mfma_f32_16x16x32_bf16 v[104:107], v[44:47], v[232:235], v[104:107]
    ds_read_b64_tr_b16 v[40:41], v11 offset:4096
    v_mfma_f32_16x16x32_bf16 v[108:111], v[44:47], v[236:239], v[108:111]
    ds_read_b64_tr_b16 v[42:43], v11 offset:4352
    s_waitcnt lgkmcnt(10)
    v_mfma_f32_16x16x32_bf16 v[96:99], v[48:51], v[240:243], v[96:99]
    ds_read_b64_tr_b16 v[44:45], v11 offset:5120
    v_mfma_f32_16x16x32_bf16 v[100:103], v[48:51], v[244:247], v[100:103]
    ds_read_b64_tr_b16 v[46:47], v11 offset:5376
    v_mfma_f32_16x16x32_bf16 v[104:107], v[52:55], v[240:243], v[104:107]
    ds_read_b64_tr_b16 v[48:49], v11 offset:8192
    v_mfma_f32_16x16x32_bf16 v[108:111], v[52:55], v[244:247], v[108:111]
    ds_read_b64_tr_b16 v[50:51], v11 offset:8448
    s_waitcnt lgkmcnt(10)
    v_mfma_f32_16x16x32_bf16 v[96:99], v[56:59], v[248:251], v[96:99]
    ds_read_b64_tr_b16 v[52:53], v11 offset:9216
    ds_read_b64_tr_b16 v[54:55], v11 offset:9472
    v_mfma_f32_16x16x32_bf16 v[100:103], v[56:59], v[252:255], v[100:103]
    ds_read_b32 v16, v18
    v_mfma_f32_16x16x32_bf16 v[104:107], v[60:63], v[248:251], v[104:107]
    ds_read_b64_tr_b16 v[56:57], v11 offset:12288
    v_mfma_f32_16x16x32_bf16 v[108:111], v[60:63], v[252:255], v[108:111]
    ds_read_b64_tr_b16 v[58:59], v11 offset:12544
    s_waitcnt lgkmcnt(11)
    v_mfma_f32_16x16x32_bf16 v[112:115], v[32:35], v[224:227], v[112:115]
    ds_read_b64_tr_b16 v[60:61], v11 offset:13312
    ds_read_b64_tr_b16 v[62:63], v11 offset:13568
    v_mfma_f32_16x16x32_bf16 v[116:119], v[32:35], v[228:231], v[116:119]
    s_waitcnt lgkmcnt(4)
    v_cmp_ge_u32 vcc, 8, v16
    v_cvt_pk_bf16_f32 v96, v96, v97
    v_cvt_pk_bf16_f32 v97, v98, v99
    v_cvt_pk_bf16_f32 v100, v100, v101
    v_mfma_f32_16x16x32_bf16 v[120:123], v[36:39], v[224:227], v[120:123]
    v_mfma_f32_16x16x32_bf16 v[124:127], v[36:39], v[228:231], v[124:127]
    s_cbranch_vccz L_cb136
    s_movk_i32 s81, 9
    s_call_b64 s[82:83], L_spin_c
L_cb136:
    ds_read_b64_tr_b16 v[32:33], v2 offset:32768
    ds_read_b64_tr_b16 v[34:35], v2 offset:33280
    v_cvt_pk_bf16_f32 v101, v102, v103
    v_cvt_pk_bf16_f32 v104, v104, v105
    v_cvt_pk_bf16_f32 v105, v106, v107
    v_mfma_f32_16x16x32_bf16 v[112:115], v[40:43], v[232:235], v[112:115]
    ds_read_b64_tr_b16 v[36:37], v2 offset:33792
    ds_read_b64_tr_b16 v[38:39], v2 offset:34304
    v_mfma_f32_16x16x32_bf16 v[116:119], v[40:43], v[236:239], v[116:119]
    v_cvt_pk_bf16_f32 v108, v108, v109
    v_cvt_pk_bf16_f32 v109, v110, v111
    v_mfma_f32_16x16x32_bf16 v[120:123], v[44:47], v[232:235], v[120:123]
    ds_read_b64_tr_b16 v[40:41], v2 offset:40960
    v_mfma_f32_16x16x32_bf16 v[124:127], v[44:47], v[236:239], v[124:127]
    ds_read_b64_tr_b16 v[42:43], v2 offset:41472
    v_mfma_f32_16x16x32_bf16 v[112:115], v[48:51], v[240:243], v[112:115]
    ds_read_b64_tr_b16 v[44:45], v2 offset:41984
    v_mfma_f32_16x16x32_bf16 v[116:119], v[48:51], v[244:247], v[116:119]
    ds_read_b64_tr_b16 v[46:47], v2 offset:42496
    v_mfma_f32_16x16x32_bf16 v[120:123], v[52:55], v[240:243], v[120:123]
    ds_read_b64_tr_b16 v[48:49], v3 offset:32768
    v_mfma_f32_16x16x32_bf16 v[124:127], v[52:55], v[244:247], v[124:127]
    ds_read_b64_tr_b16 v[50:51], v3 offset:33280
    s_waitcnt lgkmcnt(10)
    v_mfma_f32_16x16x32_bf16 v[112:115], v[56:59], v[248:251], v[112:115]
    ds_read_b64_tr_b16 v[52:53], v3 offset:33792
    v_mfma_f32_16x16x32_bf16 v[116:119], v[56:59], v[252:255], v[116:119]
    ds_read_b64_tr_b16 v[54:55], v3 offset:34304
    v_mfma_f32_16x16x32_bf16 v[120:123], v[60:63], v[248:251], v[120:123]
    ds_read_b64_tr_b16 v[56:57], v3 offset:40960
    v_mfma_f32_16x16x32_bf16 v[124:127], v[60:63], v[252:255], v[124:127]
    ds_read_b64_tr_b16 v[58:59], v3 offset:41472
    s_waitcnt lgkmcnt(10)
    v_mfma_f32_16x16x32_bf16 v[64:67], v[32:35], v[128:131], 0
    ds_read_b64_tr_b16 v[60:61], v3 offset:41984
    ds_read_b64_tr_b16 v[62:63], v3 offset:42496
    v_cvt_pk_bf16_f32 v112, v112, v113
    v_mfma_f32_16x16x32_bf16 v[68:71], v[32:35], v[132:135], 0
    v_cvt_pk_bf16_f32 v113, v114, v115
    v_cvt_pk_bf16_f32 v116, v116, v117
    v_mfma_f32_16x16x32_bf16 v[72:75], v[36:39], v[128:131], 0
    ds_read_b64_tr_b16 v[32:33], v4 offset:32768
    ds_read_b64_tr_b16 v[34:35], v4 offset:33280
    v_cvt_pk_bf16_f32 v117, v118, v119
    v_mfma_f32_16x16x32_bf16 v[76:79], v[36:39], v[132:135], 0
    v_cvt_pk_bf16_f32 v120, v120, v121
    v_cvt_pk_bf16_f32 v121, v122, v123
    s_waitcnt lgkmcnt(10)
    v_mfma_f32_16x16x32_bf16 v[64:67], v[40:43], v[136:139], v[64:67]
    ds_read_b64_tr_b16 v[36:37], v4 offset:33792
    ds_read_b64_tr_b16 v[38:39], v4 offset:34304
    v_mfma_f32_16x16x32_bf16 v[68:71], v[40:43], v[140:143], v[68:71]
    v_cvt_pk_bf16_f32 v124, v124, v125
    v_cvt_pk_bf16_f32 v125, v126, v127
    v_mfma_f32_16x16x32_bf16 v[72:75], v[44:47], v[136:139], v[72:75]
    ds_read_b64_tr_b16 v[40:41], v4 offset:40960
    ds_read_b64_tr_b16 v[42:43], v4 offset:41472
    ds_write_b64 v15, v[96:97] offset:4096
    v_mfma_f32_16x16x32_bf16 v[76:79], v[44:47], v[140:143], v[76:79]
    ds_write_b64 v15, v[100:101] offset:4352
    ds_write_b64 v15, v[104:105] offset:5120
    ds_write_b64 v15, v[108:109] offset:5376
    s_waitcnt lgkmcnt(14)
    v_mfma_f32_16x16x32_bf16 v[80:83], v[48:51], v[128:131], 0
    ds_read_b64_tr_b16 v[44:45], v4 offset:41984
    ds_read_b64_tr_b16 v[46:47], v4 offset:42496
    ds_write_b64 v15, v[112:113] offset:6144
    ds_write_b64 v15, v[116:117] offset:6400
    ds_write_b64 v15, v[120:121] offset:7168
    v_mfma_f32_16x16x32_bf16 v[84:87], v[48:51], v[132:135], 0
    ds_write_b64 v15, v[124:125] offset:7424
    s_mov_b64 exec, 1
    ds_add_u32 v21, v22 offset:36
    s_mov_b64 exec, -1
    v_mfma_f32_16x16x32_bf16 v[88:91], v[52:55], v[128:131], 0
    ds_read_b64_tr_b16 v[48:49], v5 offset:32768
    v_mfma_f32_16x16x32_bf16 v[92:95], v[52:55], v[132:135], 0
    ds_read_b64_tr_b16 v[50:51], v5 offset:33280
    s_waitcnt lgkmcnt(15)
    v_mfma_f32_16x16x32_bf16 v[80:83], v[56:59], v[136:139], v[80:83]
    ds_read_b64_tr_b16 v[52:53], v5 offset:33792
    ds_read_b64_tr_b16 v[54:55], v5 offset:34304
    v_mfma_f32_16x16x32_bf16 v[84:87], v[56:59], v[140:143], v[84:87]
    ds_read_b32 v16, v18
    v_mfma_f32_16x16x32_bf16 v[88:91], v[60:63], v[136:139], v[88:91]
    ds_read_b64_tr_b16 v[56:57], v5 offset:40960
    v_mfma_f32_16x16x32_bf16 v[92:95], v[60:63], v[140:143], v[92:95]
    ds_read_b64_tr_b16 v[58:59], v5 offset:41472
    s_waitcnt lgkmcnt(15)
    v_mfma_f32_16x16x32_bf16 v[96:99], v[32:35], v[128:131], 0
    ds_read_b64_tr_b16 v[60:61], v5 offset:41984
    ds_read_b64_tr_b16 v[62:63], v5 offset:42496
    v_mfma_f32_16x16x32_bf16 v[100:103], v[32:35], v[132:135], 0
    s_waitcnt lgkmcnt(4)
    v_cmp_ge_u32 vcc, 9, v16
    v_mfma_f32_16x16x32_bf16 v[104:107], v[36:39], v[128:131], 0
    v_mfma_f32_16x16x32_bf16 v[108:111], v[36:39], v[132:135], 0
    s_cbranch_vccz L_cb137
    s_movk_i32 s81, 10
    s_call_b64 s[82:83], L_spin_c
L_cb137:
    ds_read_b64_tr_b16 v[32:33], v2 offset:49152
    ds_read_b64_tr_b16 v[34:35], v2 offset:49664
    v_mfma_f32_16x16x32_bf16 v[96:99], v[40:43], v[136:139], v[96:99]
    ds_read_b64_tr_b16 v[36:37], v2 offset:50176
    v_mfma_f32_16x16x32_bf16 v[100:103], v[40:43], v[140:143], v[100:103]
    ds_read_b64_tr_b16 v[38:39], v2 offset:50688
    v_mfma_f32_16x16x32_bf16 v[104:107], v[44:47], v[136:139], v[104:107]
    ds_read_b64_tr_b16 v[40:41], v2 offset:57344
    v_mfma_f32_16x16x32_bf16 v[108:111], v[44:47], v[140:143], v[108:111]
    ds_read_b64_tr_b16 v[42:43], v2 offset:57856
    v_mfma_f32_16x16x32_bf16 v[112:115], v[48:51], v[128:131], 0
    ds_read_b64_tr_b16 v[44:45], v2 offset:58368
    v_mfma_f32_16x16x32_bf16 v[116:119], v[48:51], v[132:135], 0
    ds_read_b64_tr_b16 v[46:47], v2 offset:58880
    v_mfma_f32_16x16x32_bf16 v[120:123], v[52:55], v[128:131], 0
    ds_read_b64_tr_b16 v[48:49], v3 offset:49152
    v_mfma_f32_16x16x32_bf16 v[124:127], v[52:55], v[132:135], 0
    ds_read_b64_tr_b16 v[50:51], v3 offset:49664
    s_waitcnt lgkmcnt(10)
    v_mfma_f32_16x16x32_bf16 v[112:115], v[56:59], v[136:139], v[112:115]
    ds_read_b64_tr_b16 v[52:53], v3 offset:50176
    v_mfma_f32_16x16x32_bf16 v[116:119], v[56:59], v[140:143], v[116:119]
    ds_read_b64_tr_b16 v[54:55], v3 offset:50688
    v_mfma_f32_16x16x32_bf16 v[120:123], v[60:63], v[136:139], v[120:123]
    v_mov_b32 v23, 36
    global_load_lds_dword v23, s[88:89]
    v_mfma_f32_16x16x32_bf16 v[124:127], v[60:63], v[140:143], v[124:127]
    ds_read_b64_tr_b16 v[56:57], v3 offset:57344
    ds_read_b64_tr_b16 v[58:59], v3 offset:57856
    s_waitcnt lgkmcnt(10)
    v_mfma_f32_16x16x32_bf16 v[64:67], v[32:35], v[144:147], v[64:67]
    ds_read_b64_tr_b16 v[60:61], v3 offset:58368
    v_mfma_f32_16x16x32_bf16 v[68:71], v[32:35], v[148:151], v[68:71]
    ds_read_b64_tr_b16 v[62:63], v3 offset:58880
    v_mfma_f32_16x16x32_bf16 v[72:75], v[36:39], v[144:147], v[72:75]
    ds_read_b64_tr_b16 v[32:33], v4 offset:49152
    v_mfma_f32_16x16x32_bf16 v[76:79], v[36:39], v[148:151], v[76:79]
    ds_read_b64_tr_b16 v[34:35], v4 offset:49664
    s_waitcnt lgkmcnt(10)
    v_mfma_f32_16x16x32_bf16 v[64:67], v[40:43], v[152:155], v[64:67]
    ds_read_b64_tr_b16 v[36:37], v4 offset:50176
    v_mfma_f32_16x16x32_bf16 v[68:71], v[40:43], v[156:159], v[68:71]
    ds_read_b64_tr_b16 v[38:39], v4 offset:50688
    v_mfma_f32_16x16x32_bf16 v[72:75], v[44:47], v[152:155], v[72:75]
    ds_read_b64_tr_b16 v[40:41], v4 offset:57344
    v_mfma_f32_16x16x32_bf16 v[76:79], v[44:47], v[156:159], v[76:79]
    ds_read_b64_tr_b16 v[42:43], v4 offset:57856
    s_waitcnt lgkmcnt(10)
    v_mfma_f32_16x16x32_bf16 v[80:83], v[48:51], v[144:147], v[80:83]
    ds_read_b64_tr_b16 v[44:45], v4 offset:58368
    v_mfma_f32_16x16x32_bf16 v[84:87], v[48:51], v[148:151], v[84:87]
    ds_read_b64_tr_b16 v[46:47], v4 offset:58880
    v_mfma_f32_16x16x32_bf16 v[88:91], v[52:55], v[144:147], v[88:91]
    ds_read_b64_tr_b16 v[48:49], v5 offset:49152
    v_mfma_f32_16x16x32_bf16 v[92:95], v[52:55], v[148:151], v[92:95]
    ds_read_b64_tr_b16 v[50:51], v5 offset:49664
    s_waitcnt lgkmcnt(10)
    v_mfma_f32_16x16x32_bf16 v[80:83], v[56:59], v[152:155], v[80:83]
    ds_read_b64_tr_b16 v[52:53], v5 offset:50176
    ds_read_b64_tr_b16 v[54:55], v5 offset:50688
    v_mfma_f32_16x16x32_bf16 v[84:87], v[56:59], v[156:159], v[84:87]
    ds_read_b32 v16, v18
    v_mfma_f32_16x16x32_bf16 v[88:91], v[60:63], v[152:155], v[88:91]
    ds_read_b64_tr_b16 v[56:57], v5 offset:57344
    v_mfma_f32_16x16x32_bf16 v[92:95], v[60:63], v[156:159], v[92:95]
    ds_read_b64_tr_b16 v[58:59], v5 offset:57856
    s_waitcnt lgkmcnt(11)
    v_mfma_f32_16x16x32_bf16 v[96:99], v[32:35], v[144:147], v[96:99]
    ds_read_b64_tr_b16 v[60:61], v5 offset:58368
    ds_read_b64_tr_b16 v[62:63], v5 offset:58880
    v_mfma_f32_16x16x32_bf16 v[100:103], v[32:35], v[148:151], v[100:103]
    s_waitcnt lgkmcnt(4)
    v_cmp_ge_u32 vcc, 11, v16
    v_mfma_f32_16x16x32_bf16 v[104:107], v[36:39], v[144:147], v[104:107]
    v_mfma_f32_16x16x32_bf16 v[108:111], v[36:39], v[148:151], v[108:111]
    s_cbranch_vccz L_cb138
    s_movk_i32 s81, 12
    s_call_b64 s[82:83], L_spin_c
L_cb138:
    ds_read_b64_tr_b16 v[32:33], v6 offset:0
    ds_read_b64_tr_b16 v[34:35], v6 offset:512
    v_mfma_f32_16x16x32_bf16 v[96:99], v[40:43], v[152:155], v[96:99]
    ds_read_b64_tr_b16 v[36:37], v6 offset:1024
    v_mfma_f32_16x16x32_bf16 v[100:103], v[40:43], v[156:159], v[100:103]
    ds_read_b64_tr_b16 v[38:39], v6 offset:1536
    v_mfma_f32_16x16x32_bf16 v[104:107], v[44:47], v[152:155], v[104:107]
    ds_read_b64_tr_b16 v[40:41], v6 offset:8192
    v_mfma_f32_16x16x32_bf16 v[108:111], v[44:47], v[156:159], v[108:111]
    ds_read_b64_tr_b16 v[42:43], v6 offset:8704
    v_mfma_f32_16x16x32_bf16 v[112:115], v[48:51], v[144:147], v[112:115]
    ds_read_b64_tr_b16 v[44:45], v6 offset:9216
    v_mfma_f32_16x16x32_bf16 v[116:119], v[48:51], v[148:151], v[116:119]
    ds_read_b64_tr_b16 v[46:47], v6 offset:9728
    v_mfma_f32_16x16x32_bf16 v[120:123], v[52:55], v[144:147], v[120:123]
    ds_read_b64_tr_b16 v[48:49], v7 offset:0
    v_mfma_f32_16x16x32_bf16 v[124:127], v[52:55], v[148:151], v[124:127]
    ds_read_b64_tr_b16 v[50:51], v7 offset:512
    s_waitcnt lgkmcnt(10)
    v_mfma_f32_16x16x32_bf16 v[112:115], v[56:59], v[152:155], v[112:115]
    ds_read_b64_tr_b16 v[52:53], v7 offset:1024
    v_mfma_f32_16x16x32_bf16 v[116:119], v[56:59], v[156:159], v[116:119]
    ds_read_b64_tr_b16 v[54:55], v7 offset:1536
    v_mfma_f32_16x16x32_bf16 v[120:123], v[60:63], v[152:155], v[120:123]
    ds_read_b64_tr_b16 v[56:57], v7 offset:8192
    v_mfma_f32_16x16x32_bf16 v[124:127], v[60:63], v[156:159], v[124:127]
    ds_read_b64_tr_b16 v[58:59], v7 offset:8704
    s_waitcnt lgkmcnt(10)
    v_mfma_f32_16x16x32_bf16 v[64:67], v[32:35], v[160:163], v[64:67]
    ds_read_b64_tr_b16 v[60:61], v7 offset:9216
    v_mfma_f32_16x16x32_bf16 v[68:71], v[32:35], v[164:167], v[68:71]
    ds_read_b64_tr_b16 v[62:63], v7 offset:9728
    v_mfma_f32_16x16x32_bf16 v[72:75], v[36:39], v[160:163], v[72:75]
    ds_read_b64_tr_b16 v[32:33], v8 offset:0
    v_mfma_f32_16x16x32_bf16 v[76:79], v[36:39], v[164:167], v[76:79]
    ds_read_b64_tr_b16 v[34:35], v8 offset:512
    s_waitcnt lgkmcnt(10)
    v_mfma_f32_16x16x32_bf16 v[64:67], v[40:43], v[168:171], v[64:67]
    ds_read_b64_tr_b16 v[36:37], v8 offset:1024
    v_mfma_f32_16x16x32_bf16 v[68:71], v[40:43], v[172:175], v[68:71]
    ds_read_b64_tr_b16 v[38:39], v8 offset:1536
    v_mfma_f32_16x16x32_bf16 v[72:75], v[44:47], v[168:171], v[72:75]
    ds_read_b64_tr_b16 v[40:41], v8 offset:8192
    v_mfma_f32_16x16x32_bf16 v[76:79], v[44:47], v[172:175], v[76:79]
    ds_read_b64_tr_b16 v[42:43], v8 offset:8704
    s_waitcnt lgkmcnt(10)
    v_mfma_f32_16x16x32_bf16 v[80:83], v[48:51], v[160:163], v[80:83]
    ds_read_b64_tr_b16 v[44:45], v8 offset:9216
    v_mfma_f32_16x16x32_bf16 v[84:87], v[48:51], v[164:167], v[84:87]
    ds_read_b64_tr_b16 v[46:47], v8 offset:9728
    v_mfma_f32_16x16x32_bf16 v[88:91], v[52:55], v[160:163], v[88:91]
    ds_read_b64_tr_b16 v[48:49], v9 offset:0
    v_mfma_f32_16x16x32_bf16 v[92:95], v[52:55], v[164:167], v[92:95]
    ds_read_b64_tr_b16 v[50:51], v9 offset:512
    s_waitcnt lgkmcnt(10)
    v_mfma_f32_16x16x32_bf16 v[80:83], v[56:59], v[168:171], v[80:83]
    ds_read_b64_tr_b16 v[52:53], v9 offset:1024
    v_mfma_f32_16x16x32_bf16 v[84:87], v[56:59], v[172:175], v[84:87]
    ds_read_b64_tr_b16 v[54:55], v9 offset:1536
    v_mfma_f32_16x16x32_bf16 v[88:91], v[60:63], v[168:171], v[88:91]
    ds_read_b64_tr_b16 v[56:57], v9 offset:8192
    v_mfma_f32_16x16x32_bf16 v[92:95], v[60:63], v[172:175], v[92:95]
    ds_read_b64_tr_b16 v[58:59], v9 offset:8704
    s_waitcnt lgkmcnt(10)
    v_mfma_f32_16x16x32_bf16 v[96:99], v[32:35], v[160:163], v[96:99]
    ds_read_b64_tr_b16 v[60:61], v9 offset:9216
    v_mfma_f32_16x16x32_bf16 v[100:103], v[32:35], v[164:167], v[100:103]
    ds_read_b64_tr_b16 v[62:63], v9 offset:9728
    v_mfma_f32_16x16x32_bf16 v[104:107], v[36:39], v[160:163], v[104:107]
    ds_read_b64_tr_b16 v[32:33], v6 offset:16384
    v_mfma_f32_16x16x32_bf16 v[108:111], v[36:39], v[164:167], v[108:111]
    ds_read_b64_tr_b16 v[34:35], v6 offset:16896
    s_waitcnt lgkmcnt(10)
    v_mfma_f32_16x16x32_bf16 v[96:99], v[40:43], v[168:171], v[96:99]
    ds_read_b64_tr_b16 v[36:37], v6 offset:17408
    v_mfma_f32_16x16x32_bf16 v[100:103], v[40:43], v[172:175], v[100:103]
    ds_read_b64_tr_b16 v[38:39], v6 offset:17920
    v_mfma_f32_16x16x32_bf16 v[104:107], v[44:47], v[168:171], v[104:107]
    ds_read_b64_tr_b16 v[40:41], v6 offset:24576
    v_mfma_f32_16x16x32_bf16 v[108:111], v[44:47], v[172:175], v[108:111]
    ds_read_b64_tr_b16 v[42:43], v6 offset:25088
    s_waitcnt lgkmcnt(10)
    v_mfma_f32_16x16x32_bf16 v[112:115], v[48:51], v[160:163], v[112:115]
    ds_read_b64_tr_b16 v[44:45], v6 offset:25600
    v_mfma_f32_16x16x32_bf16 v[116:119], v[48:51], v[164:167], v[116:119]
    ds_read_b64_tr_b16 v[46:47], v6 offset:26112
    v_mfma_f32_16x16x32_bf16 v[120:123], v[52:55], v[160:163], v[120:123]
    ds_read_b64_tr_b16 v[48:49], v7 offset:16384
    v_mfma_f32_16x16x32_bf16 v[124:127], v[52:55], v[164:167], v[124:127]
    ds_read_b64_tr_b16 v[50:51], v7 offset:16896
    s_waitcnt lgkmcnt(10)
    v_mfma_f32_16x16x32_bf16 v[112:115], v[56:59], v[168:171], v[112:115]
    ds_read_b64_tr_b16 v[52:53], v7 offset:17408
    v_mfma_f32_16x16x32_bf16 v[116:119], v[56:59], v[172:175], v[116:119]
    ds_read_b64_tr_b16 v[54:55], v7 offset:17920
    v_mfma_f32_16x16x32_bf16 v[120:123], v[60:63], v[168:171], v[120:123]
    v_mov_b32 v23, 44
    global_load_lds_dword v23, s[88:89]
    v_mfma_f32_16x16x32_bf16 v[124:127], v[60:63], v[172:175], v[124:127]
    ds_read_b64_tr_b16 v[56:57], v7 offset:24576
    ds_read_b64_tr_b16 v[58:59], v7 offset:25088
    s_waitcnt lgkmcnt(10)
    v_mfma_f32_16x16x32_bf16 v[64:67], v[32:35], v[176:179], v[64:67]
    ds_read_b64_tr_b16 v[60:61], v7 offset:25600
    v_mfma_f32_16x16x32_bf16 v[68:71], v[32:35], v[180:183], v[68:71]
    ds_read_b64_tr_b16 v[62:63], v7 offset:26112
    v_mfma_f32_16x16x32_bf16 v[72:75], v[36:39], v[176:179], v[72:75]
    ds_read_b64_tr_b16 v[32:33], v8 offset:16384
    v_mfma_f32_16x16x32_bf16 v[76:79], v[36:39], v[180:183], v[76:79]
    ds_read_b64_tr_b16 v[34:35], v8 offset:16896
    s_waitcnt lgkmcnt(10)
    v_mfma_f32_16x16x32_bf16 v[64:67], v[40:43], v[184:187], v[64:67]
    ds_read_b64_tr_b16 v[36:37], v8 offset:17408
    v_mfma_f32_16x16x32_bf16 v[68:71], v[40:43], v[188:191], v[68:71]
    ds_read_b64_tr_b16 v[38:39], v8 offset:17920
    v_mfma_f32_16x16x32_bf16 v[72:75], v[44:47], v[184:187], v[72:75]
    ds_read_b64_tr_b16 v[40:41], v8 offset:24576
    v_mfma_f32_16x16x32_bf16 v[76:79], v[44:47], v[188:191], v[76:79]
    ds_read_b64_tr_b16 v[42:43], v8 offset:25088
    s_waitcnt lgkmcnt(10)
    v_mfma_f32_16x16x32_bf16 v[80:83], v[48:51], v[176:179], v[80:83]
    ds_read_b64_tr_b16 v[44:45], v8 offset:25600
    v_mfma_f32_16x16x32_bf16 v[84:87], v[48:51], v[180:183], v[84:87]
    ds_read_b64_tr_b16 v[46:47], v8 offset:26112
    v_mfma_f32_16x16x32_bf16 v[88:91], v[52:55], v[176:179], v[88:91]
    ds_read_b64_tr_b16 v[48:49], v9 offset:16384
    v_mfma_f32_16x16x32_bf16 v[92:95], v[52:55], v[180:183], v[92:95]
    ds_read_b64_tr_b16 v[50:51], v9 offset:16896
    s_waitcnt lgkmcnt(10)
    v_mfma_f32_16x16x32_bf16 v[80:83], v[56:59], v[184:187], v[80:83]
    ds_read_b64_tr_b16 v[52:53], v9 offset:17408
    ds_read_b64_tr_b16 v[54:55], v9 offset:17920
    v_mfma_f32_16x16x32_bf16 v[84:87], v[56:59], v[188:191], v[84:87]
    ds_read_b32 v16, v18
    v_mfma_f32_16x16x32_bf16 v[88:91], v[60:63], v[184:187], v[88:91]
    ds_read_b64_tr_b16 v[56:57], v9 offset:24576
    v_mfma_f32_16x16x32_bf16 v[92:95], v[60:63], v[188:191], v[92:95]
    ds_read_b64_tr_b16 v[58:59], v9 offset:25088
    s_waitcnt lgkmcnt(11)
    v_mfma_f32_16x16x32_bf16 v[96:99], v[32:35], v[176:179], v[96:99]
    ds_read_b64_tr_b16 v[60:61], v9 offset:25600
    ds_read_b64_tr_b16 v[62:63], v9 offset:26112
    v_mfma_f32_16x16x32_bf16 v[100:103], v[32:35], v[180:183], v[100:103]
    s_waitcnt lgkmcnt(4)
    v_cmp_ge_u32 vcc, 13, v16
    v_mfma_f32_16x16x32_bf16 v[104:107], v[36:39], v[176:179], v[104:107]
    v_mfma_f32_16x16x32_bf16 v[108:111], v[36:39], v[180:183], v[108:111]
    s_cbranch_vccz L_cb139
    s_movk_i32 s81, 14
    s_call_b64 s[82:83], L_spin_c
L_cb139:
    ds_read_b64_tr_b16 v[32:33], v6 offset:32768
    ds_read_b64_tr_b16 v[34:35], v6 offset:33280
    v_mfma_f32_16x16x32_bf16 v[96:99], v[40:43], v[184:187], v[96:99]
    ds_read_b64_tr_b16 v[36:37], v6 offset:33792
    v_mfma_f32_16x16x32_bf16 v[100:103], v[40:43], v[188:191], v[100:103]
    ds_read_b64_tr_b16 v[38:39], v6 offset:34304
    v_mfma_f32_16x16x32_bf16 v[104:107], v[44:47], v[184:187], v[104:107]
    ds_read_b64_tr_b16 v[40:41], v6 offset:40960
    v_mfma_f32_16x16x32_bf16 v[108:111], v[44:47], v[188:191], v[108:111]
    ds_read_b64_tr_b16 v[42:43], v6 offset:41472
    v_mfma_f32_16x16x32_bf16 v[112:115], v[48:51], v[176:179], v[112:115]
    ds_read_b64_tr_b16 v[44:45], v6 offset:41984
    v_mfma_f32_16x16x32_bf16 v[116:119], v[48:51], v[180:183], v[116:119]
    ds_read_b64_tr_b16 v[46:47], v6 offset:42496
    v_mfma_f32_16x16x32_bf16 v[120:123], v[52:55], v[176:179], v[120:123]
    ds_read_b64_tr_b16 v[48:49], v7 offset:32768
    v_mfma_f32_16x16x32_bf16 v[124:127], v[52:55], v[180:183], v[124:127]
    ds_read_b64_tr_b16 v[50:51], v7 offset:33280
    s_waitcnt lgkmcnt(10)
    v_mfma_f32_16x16x32_bf16 v[112:115], v[56:59], v[184:187], v[112:115]
    ds_read_b64_tr_b16 v[52:53], v7 offset:33792
    v_mfma_f32_16x16x32_bf16 v[116:119], v[56:59], v[188:191], v[116:119]
    ds_read_b64_tr_b16 v[54:55], v7 offset:34304
    v_mfma_f32_16x16x32_bf16 v[120:123], v[60:63], v[184:187], v[120:123]
    ds_read_b64_tr_b16 v[56:57], v7 offset:40960
    v_mfma_f32_16x16x32_bf16 v[124:127], v[60:63], v[188:191], v[124:127]
    ds_read_b64_tr_b16 v[58:59], v7 offset:41472
    s_waitcnt lgkmcnt(10)
    v_mfma_f32_16x16x32_bf16 v[64:67], v[32:35], v[192:195], v[64:67]
    ds_read_b64_tr_b16 v[60:61], v7 offset:41984
    v_mfma_f32_16x16x32_bf16 v[68:71], v[32:35], v[196:199], v[68:71]
    ds_read_b64_tr_b16 v[62:63], v7 offset:42496
    v_mfma_f32_16x16x32_bf16 v[72:75], v[36:39], v[192:195], v[72:75]
    ds_read_b64_tr_b16 v[32:33], v8 offset:32768
    v_mfma_f32_16x16x32_bf16 v[76:79], v[36:39], v[196:199], v[76:79]
    ds_read_b64_tr_b16 v[34:35], v8 offset:33280
    s_waitcnt lgkmcnt(10)
    v_mfma_f32_16x16x32_bf16 v[64:67], v[40:43], v[200:203], v[64:67]
    ds_read_b64_tr_b16 v[36:37], v8 offset:33792
    v_mfma_f32_16x16x32_bf16 v[68:71], v[40:43], v[204:207], v[68:71]
    ds_read_b64_tr_b16 v[38:39], v8 offset:34304
    v_mfma_f32_16x16x32_bf16 v[72:75], v[44:47], v[200:203], v[72:75]
    ds_read_b64_tr_b16 v[40:41], v8 offset:40960
    v_mfma_f32_16x16x32_bf16 v[76:79], v[44:47], v[204:207], v[76:79]
    ds_read_b64_tr_b16 v[42:43], v8 offset:41472
    s_waitcnt lgkmcnt(10)
    v_mfma_f32_16x16x32_bf16 v[80:83], v[48:51], v[192:195], v[80:83]
    ds_read_b64_tr_b16 v[44:45], v8 offset:41984
    v_mfma_f32_16x16x32_bf16 v[84:87], v[48:51], v[196:199], v[84:87]
    ds_read_b64_tr_b16 v[46:47], v8 offset:42496
    v_mfma_f32_16x16x32_bf16 v[88:91], v[52:55], v[192:195], v[88:91]
    ds_read_b64_tr_b16 v[48:49], v9 offset:32768
    v_mfma_f32_16x16x32_bf16 v[92:95], v[52:55], v[196:199], v[92:95]
    ds_read_b64_tr_b16 v[50:51], v9 offset:33280
    s_waitcnt lgkmcnt(10)
    v_mfma_f32_16x16x32_bf16 v[80:83], v[56:59], v[200:203], v[80:83]
    ds_read_b64_tr_b16 v[52:53], v9 offset:33792
    v_mfma_f32_16x16x32_bf16 v[84:87], v[56:59], v[204:207], v[84:87]
    ds_read_b64_tr_b16 v[54:55], v9 offset:34304
    v_mfma_f32_16x16x32_bf16 v[88:91], v[60:63], v[200:203], v[88:91]
    ds_read_b64_tr_b16 v[56:57], v9 offset:40960
    v_mfma_f32_16x16x32_bf16 v[92:95], v[60:63], v[204:207], v[92:95]
    ds_read_b64_tr_b16 v[58:59], v9 offset:41472
    s_waitcnt lgkmcnt(10)
    v_mfma_f32_16x16x32_bf16 v[96:99], v[32:35], v[192:195], v[96:99]
    ds_read_b64_tr_b16 v[60:61], v9 offset:41984
    v_mfma_f32_16x16x32_bf16 v[100:103], v[32:35], v[196:199], v[100:103]
    ds_read_b64_tr_b16 v[62:63], v9 offset:42496
    v_mfma_f32_16x16x32_bf16 v[104:107], v[36:39], v[192:195], v[104:107]
    ds_read_b64_tr_b16 v[32:33], v6 offset:49152
    v_mfma_f32_16x16x32_bf16 v[108:111], v[36:39], v[196:199], v[108:111]
    ds_read_b64_tr_b16 v[34:35], v6 offset:49664
    s_waitcnt lgkmcnt(10)
    v_mfma_f32_16x16x32_bf16 v[96:99], v[40:43], v[200:203], v[96:99]
    ds_read_b64_tr_b16 v[36:37], v6 offset:50176
    v_mfma_f32_16x16x32_bf16 v[100:103], v[40:43], v[204:207], v[100:103]
    ds_read_b64_tr_b16 v[38:39], v6 offset:50688
    v_mfma_f32_16x16x32_bf16 v[104:107], v[44:47], v[200:203], v[104:107]
    ds_read_b64_tr_b16 v[40:41], v6 offset:57344
    v_mfma_f32_16x16x32_bf16 v[108:111], v[44:47], v[204:207], v[108:111]
    ds_read_b64_tr_b16 v[42:43], v6 offset:57856
    s_waitcnt lgkmcnt(10)
    v_mfma_f32_16x16x32_bf16 v[112:115], v[48:51], v[192:195], v[112:115]
    ds_read_b64_tr_b16 v[44:45], v6 offset:58368
    v_mfma_f32_16x16x32_bf16 v[116:119], v[48:51], v[196:199], v[116:119]
    ds_read_b64_tr_b16 v[46:47], v6 offset:58880
    v_mfma_f32_16x16x32_bf16 v[120:123], v[52:55], v[192:195], v[120:123]
    ds_read_b64_tr_b16 v[48:49], v7 offset:49152
    v_mfma_f32_16x16x32_bf16 v[124:127], v[52:55], v[196:199], v[124:127]
    ds_read_b64_tr_b16 v[50:51], v7 offset:49664
    s_waitcnt lgkmcnt(10)
    v_mfma_f32_16x16x32_bf16 v[112:115], v[56:59], v[200:203], v[112:115]
    ds_read_b64_tr_b16 v[52:53], v7 offset:50176
    v_mfma_f32_16x16x32_bf16 v[116:119], v[56:59], v[204:207], v[116:119]
    ds_read_b64_tr_b16 v[54:55], v7 offset:50688
    v_mfma_f32_16x16x32_bf16 v[120:123], v[60:63], v[200:203], v[120:123]
    v_mov_b32 v23, 52
    global_load_lds_dword v23, s[88:89]
    v_mfma_f32_16x16x32_bf16 v[124:127], v[60:63], v[204:207], v[124:127]
    ds_read_b64_tr_b16 v[56:57], v7 offset:57344
    ds_read_b64_tr_b16 v[58:59], v7 offset:57856
    s_waitcnt lgkmcnt(10)
    v_mfma_f32_16x16x32_bf16 v[64:67], v[32:35], v[208:211], v[64:67]
    ds_read_b64_tr_b16 v[60:61], v7 offset:58368
    v_mfma_f32_16x16x32_bf16 v[68:71], v[32:35], v[212:215], v[68:71]
    ds_read_b64_tr_b16 v[62:63], v7 offset:58880
    v_mfma_f32_16x16x32_bf16 v[72:75], v[36:39], v[208:211], v[72:75]
    ds_read_b64_tr_b16 v[32:33], v8 offset:49152
    v_mfma_f32_16x16x32_bf16 v[76:79], v[36:39], v[212:215], v[76:79]
    ds_read_b64_tr_b16 v[34:35], v8 offset:49664
    s_waitcnt lgkmcnt(10)
    v_mfma_f32_16x16x32_bf16 v[64:67], v[40:43], v[216:219], v[64:67]
    ds_read_b64_tr_b16 v[36:37], v8 offset:50176
    v_mfma_f32_16x16x32_bf16 v[68:71], v[40:43], v[220:223], v[68:71]
    ds_read_b64_tr_b16 v[38:39], v8 offset:50688
    v_mfma_f32_16x16x32_bf16 v[72:75], v[44:47], v[216:219], v[72:75]
    ds_read_b64_tr_b16 v[40:41], v8 offset:57344
    v_mfma_f32_16x16x32_bf16 v[76:79], v[44:47], v[220:223], v[76:79]
    ds_read_b64_tr_b16 v[42:43], v8 offset:57856
    s_waitcnt lgkmcnt(10)
    v_mfma_f32_16x16x32_bf16 v[80:83], v[48:51], v[208:211], v[80:83]
    ds_read_b64_tr_b16 v[44:45], v8 offset:58368
    v_mfma_f32_16x16x32_bf16 v[84:87], v[48:51], v[212:215], v[84:87]
    ds_read_b64_tr_b16 v[46:47], v8 offset:58880
    v_mfma_f32_16x16x32_bf16 v[88:91], v[52:55], v[208:211], v[88:91]
    ds_read_b64_tr_b16 v[48:49], v9 offset:49152
    v_mfma_f32_16x16x32_bf16 v[92:95], v[52:55], v[212:215], v[92:95]
    ds_read_b64_tr_b16 v[50:51], v9 offset:49664
    s_waitcnt lgkmcnt(10)
    v_mfma_f32_16x16x32_bf16 v[80:83], v[56:59], v[216:219], v[80:83]
    ds_read_b64_tr_b16 v[52:53], v9 offset:50176
    ds_read_b64_tr_b16 v[54:55], v9 offset:50688
    v_mfma_f32_16x16x32_bf16 v[84:87], v[56:59], v[220:223], v[84:87]
    ds_read_b32 v16, v18
    v_mfma_f32_16x16x32_bf16 v[88:91], v[60:63], v[216:219], v[88:91]
    ds_read_b64_tr_b16 v[56:57], v9 offset:57344
    v_mfma_f32_16x16x32_bf16 v[92:95], v[60:63], v[220:223], v[92:95]
    ds_read_b64_tr_b16 v[58:59], v9 offset:57856
    s_waitcnt lgkmcnt(11)
    v_mfma_f32_16x16x32_bf16 v[96:99], v[32:35], v[208:211], v[96:99]
    ds_read_b64_tr_b16 v[60:61], v9 offset:58368
    ds_read_b64_tr_b16 v[62:63], v9 offset:58880
    v_mfma_f32_16x16x32_bf16 v[100:103], v[32:35], v[212:215], v[100:103]
    s_waitcnt lgkmcnt(4)
    v_cmp_ge_u32 vcc, 15, v16
    v_mfma_f32_16x16x32_bf16 v[104:107], v[36:39], v[208:211], v[104:107]
    v_mfma_f32_16x16x32_bf16 v[108:111], v[36:39], v[212:215], v[108:111]
    s_cbranch_vccz L_cb140
    s_movk_i32 s81, 16
    s_call_b64 s[82:83], L_spin_c
L_cb140:
    ds_read_b64_tr_b16 v[32:33], v2 offset:0
    ds_read_b64_tr_b16 v[34:35], v2 offset:512
    v_mfma_f32_16x16x32_bf16 v[96:99], v[40:43], v[216:219], v[96:99]
    ds_read_b64_tr_b16 v[36:37], v2 offset:1024
    v_mfma_f32_16x16x32_bf16 v[100:103], v[40:43], v[220:223], v[100:103]
    ds_read_b64_tr_b16 v[38:39], v2 offset:1536
    v_mfma_f32_16x16x32_bf16 v[104:107], v[44:47], v[216:219], v[104:107]
    ds_read_b64_tr_b16 v[40:41], v2 offset:8192
    v_mfma_f32_16x16x32_bf16 v[108:111], v[44:47], v[220:223], v[108:111]
    ds_read_b64_tr_b16 v[42:43], v2 offset:8704
    v_mfma_f32_16x16x32_bf16 v[112:115], v[48:51], v[208:211], v[112:115]
    ds_read_b64_tr_b16 v[44:45], v2 offset:9216
    v_mfma_f32_16x16x32_bf16 v[116:119], v[48:51], v[212:215], v[116:119]
    ds_read_b64_tr_b16 v[46:47], v2 offset:9728
    v_mfma_f32_16x16x32_bf16 v[120:123], v[52:55], v[208:211], v[120:123]
    ds_read_b64_tr_b16 v[48:49], v3 offset:0
    v_mfma_f32_16x16x32_bf16 v[124:127], v[52:55], v[212:215], v[124:127]
    ds_read_b64_tr_b16 v[50:51], v3 offset:512
    s_waitcnt lgkmcnt(10)
    v_mfma_f32_16x16x32_bf16 v[112:115], v[56:59], v[216:219], v[112:115]
    ds_read_b64_tr_b16 v[52:53], v3 offset:1024
    v_mfma_f32_16x16x32_bf16 v[116:119], v[56:59], v[220:223], v[116:119]
    ds_read_b64_tr_b16 v[54:55], v3 offset:1536
    v_mfma_f32_16x16x32_bf16 v[120:123], v[60:63], v[216:219], v[120:123]
    v_mov_b32 v23, 56
    global_load_lds_dword v23, s[88:89]
    v_mfma_f32_16x16x32_bf16 v[124:127], v[60:63], v[220:223], v[124:127]
    ds_read_b64_tr_b16 v[56:57], v3 offset:8192
    ds_read_b64_tr_b16 v[58:59], v3 offset:8704
    s_waitcnt lgkmcnt(10)
    v_mfma_f32_16x16x32_bf16 v[64:67], v[32:35], v[224:227], v[64:67]
    ds_read_b64_tr_b16 v[60:61], v3 offset:9216
    v_mfma_f32_16x16x32_bf16 v[68:71], v[32:35], v[228:231], v[68:71]
    ds_read_b64_tr_b16 v[62:63], v3 offset:9728
    v_mfma_f32_16x16x32_bf16 v[72:75], v[36:39], v[224:227], v[72:75]
    ds_read_b64_tr_b16 v[32:33], v4 offset:0
    v_mfma_f32_16x16x32_bf16 v[76:79], v[36:39], v[228:231], v[76:79]
    ds_read_b64_tr_b16 v[34:35], v4 offset:512
    s_waitcnt lgkmcnt(10)
    v_mfma_f32_16x16x32_bf16 v[64:67], v[40:43], v[232:235], v[64:67]
    ds_read_b64_tr_b16 v[36:37], v4 offset:1024
    v_mfma_f32_16x16x32_bf16 v[68:71], v[40:43], v[236:239], v[68:71]
    ds_read_b64_tr_b16 v[38:39], v4 offset:1536
    v_mfma_f32_16x16x32_bf16 v[72:75], v[44:47], v[232:235], v[72:75]
    ds_read_b64_tr_b16 v[40:41], v4 offset:8192
    v_mfma_f32_16x16x32_bf16 v[76:79], v[44:47], v[236:239], v[76:79]
    ds_read_b64_tr_b16 v[42:43], v4 offset:8704
    s_waitcnt lgkmcnt(10)
    v_mfma_f32_16x16x32_bf16 v[80:83], v[48:51], v[224:227], v[80:83]
    ds_read_b64_tr_b16 v[44:45], v4 offset:9216
    v_mfma_f32_16x16x32_bf16 v[84:87], v[48:51], v[228:231], v[84:87]
    ds_read_b64_tr_b16 v[46:47], v4 offset:9728
    v_mfma_f32_16x16x32_bf16 v[88:91], v[52:55], v[224:227], v[88:91]
    ds_read_b64_tr_b16 v[48:49], v5 offset:0
    v_mfma_f32_16x16x32_bf16 v[92:95], v[52:55], v[228:231], v[92:95]
    ds_read_b64_tr_b16 v[50:51], v5 offset:512
    s_waitcnt lgkmcnt(10)
    v_mfma_f32_16x16x32_bf16 v[80:83], v[56:59], v[232:235], v[80:83]
    ds_read_b64_tr_b16 v[52:53], v5 offset:1024
    v_mfma_f32_16x16x32_bf16 v[84:87], v[56:59], v[236:239], v[84:87]
    ds_read_b64_tr_b16 v[54:55], v5 offset:1536
    v_mfma_f32_16x16x32_bf16 v[88:91], v[60:63], v[232:235], v[88:91]
    ds_read_b64_tr_b16 v[56:57], v5 offset:8192
    v_mfma_f32_16x16x32_bf16 v[92:95], v[60:63], v[236:239], v[92:95]
    ds_read_b64_tr_b16 v[58:59], v5 offset:8704
    s_waitcnt lgkmcnt(10)
    v_mfma_f32_16x16x32_bf16 v[96:99], v[32:35], v[224:227], v[96:99]
    ds_read_b64_tr_b16 v[60:61], v5 offset:9216
    v_mfma_f32_16x16x32_bf16 v[100:103], v[32:35], v[228:231], v[100:103]
    ds_read_b64_tr_b16 v[62:63], v5 offset:9728
    v_mfma_f32_16x16x32_bf16 v[104:107], v[36:39], v[224:227], v[104:107]
    ds_read_b64_tr_b16 v[32:33], v2 offset:32768
    v_mfma_f32_16x16x32_bf16 v[108:111], v[36:39], v[228:231], v[108:111]
    ds_read_b64_tr_b16 v[34:35], v2 offset:33280
    s_waitcnt lgkmcnt(10)
    v_mfma_f32_16x16x32_bf16 v[96:99], v[40:43], v[232:235], v[96:99]
    ds_read_b64_tr_b16 v[36:37], v2 offset:33792
    v_mfma_f32_16x16x32_bf16 v[100:103], v[40:43], v[236:239], v[100:103]
    ds_read_b64_tr_b16 v[38:39], v2 offset:34304
    v_mfma_f32_16x16x32_bf16 v[104:107], v[44:47], v[232:235], v[104:107]
    ds_read_b64_tr_b16 v[40:41], v2 offset:40960
    v_mfma_f32_16x16x32_bf16 v[108:111], v[44:47], v[236:239], v[108:111]
    ds_read_b64_tr_b16 v[42:43], v2 offset:41472
    s_waitcnt lgkmcnt(10)
    v_mfma_f32_16x16x32_bf16 v[112:115], v[48:51], v[224:227], v[112:115]
    ds_read_b64_tr_b16 v[44:45], v2 offset:41984
    v_mfma_f32_16x16x32_bf16 v[116:119], v[48:51], v[228:231], v[116:119]
    ds_read_b64_tr_b16 v[46:47], v2 offset:42496
    v_mfma_f32_16x16x32_bf16 v[120:123], v[52:55], v[224:227], v[120:123]
    ds_read_b64_tr_b16 v[48:49], v3 offset:32768
    v_mfma_f32_16x16x32_bf16 v[124:127], v[52:55], v[228:231], v[124:127]
    ds_read_b64_tr_b16 v[50:51], v3 offset:33280
    s_waitcnt lgkmcnt(10)
    v_mfma_f32_16x16x32_bf16 v[112:115], v[56:59], v[232:235], v[112:115]
    ds_read_b64_tr_b16 v[52:53], v3 offset:33792
    v_mfma_f32_16x16x32_bf16 v[116:119], v[56:59], v[236:239], v[116:119]
    ds_read_b64_tr_b16 v[54:55], v3 offset:34304
    v_mfma_f32_16x16x32_bf16 v[120:123], v[60:63], v[232:235], v[120:123]
    v_mov_b32 v23, 60
    global_load_lds_dword v23, s[88:89]
    v_mfma_f32_16x16x32_bf16 v[124:127], v[60:63], v[236:239], v[124:127]
    ds_read_b64_tr_b16 v[56:57], v3 offset:40960
    ds_read_b64_tr_b16 v[58:59], v3 offset:41472
    s_waitcnt lgkmcnt(10)
    v_mfma_f32_16x16x32_bf16 v[64:67], v[32:35], v[240:243], v[64:67]
    ds_read_b64_tr_b16 v[60:61], v3 offset:41984
    v_mfma_f32_16x16x32_bf16 v[68:71], v[32:35], v[244:247], v[68:71]
    ds_read_b64_tr_b16 v[62:63], v3 offset:42496
    v_mfma_f32_16x16x32_bf16 v[72:75], v[36:39], v[240:243], v[72:75]
    ds_read_b64_tr_b16 v[32:33], v4 offset:32768
    v_mfma_f32_16x16x32_bf16 v[76:79], v[36:39], v[244:247], v[76:79]
    ds_read_b64_tr_b16 v[34:35], v4 offset:33280
    s_waitcnt lgkmcnt(10)
    v_mfma_f32_16x16x32_bf16 v[64:67], v[40:43], v[248:251], v[64:67]
    ds_read_b64_tr_b16 v[36:37], v4 offset:33792
    v_mfma_f32_16x16x32_bf16 v[68:71], v[40:43], v[252:255], v[68:71]
    ds_read_b64_tr_b16 v[38:39], v4 offset:34304
    v_mfma_f32_16x16x32_bf16 v[72:75], v[44:47], v[248:251], v[72:75]
    ds_read_b64_tr_b16 v[40:41], v4 offset:40960
    v_mfma_f32_16x16x32_bf16 v[76:79], v[44:47], v[252:255], v[76:79]
    ds_read_b64_tr_b16 v[42:43], v4 offset:41472
    s_waitcnt lgkmcnt(10)
    v_mfma_f32_16x16x32_bf16 v[80:83], v[48:51], v[240:243], v[80:83]
    ds_read_b64_tr_b16 v[44:45], v4 offset:41984
    ds_read_b64_tr_b16 v[46:47], v4 offset:42496
    s_nop 0
    v_mul_f32 v64, v64, v72
    v_mfma_f32_16x16x32_bf16 v[84:87], v[48:51], v[244:247], v[84:87]
    v_mul_f32 v65, v65, v73
    v_mul_f32 v66, v66, v74
    v_mfma_f32_16x16x32_bf16 v[88:91], v[52:55], v[240:243], v[88:91]
    ds_read_b64_tr_b16 v[48:49], v5 offset:32768
    ds_read_b64_tr_b16 v[50:51], v5 offset:33280
    v_mul_f32 v67, v67, v75
    v_mfma_f32_16x16x32_bf16 v[92:95], v[52:55], v[244:247], v[92:95]
    v_mul_f32 v68, v68, v76
    v_mul_f32 v69, v69, v77
    s_waitcnt lgkmcnt(10)
    v_mfma_f32_16x16x32_bf16 v[80:83], v[56:59], v[248:251], v[80:83]
    ds_read_b64_tr_b16 v[52:53], v5 offset:33792
    ds_read_b64_tr_b16 v[54:55], v5 offset:34304
    ds_read_b32 v16, v18
    v_mfma_f32_16x16x32_bf16 v[84:87], v[56:59], v[252:255], v[84:87]
    v_mul_f32 v70, v70, v78
    v_mul_f32 v71, v71, v79
    v_cvt_pk_bf16_f32 v72, v64, v65
    v_mfma_f32_16x16x32_bf16 v[88:91], v[60:63], v[248:251], v[88:91]
    ds_read_b64_tr_b16 v[56:57], v5 offset:40960
    ds_read_b64_tr_b16 v[58:59], v5 offset:41472
    v_cvt_pk_bf16_f32 v73, v66, v67
    v_mfma_f32_16x16x32_bf16 v[92:95], v[60:63], v[252:255], v[92:95]
    v_cvt_pk_bf16_f32 v76, v68, v69
    v_cvt_pk_bf16_f32 v77, v70, v71
    s_waitcnt lgkmcnt(11)
    v_mfma_f32_16x16x32_bf16 v[96:99], v[32:35], v[240:243], v[96:99]
    ds_read_b64_tr_b16 v[60:61], v5 offset:41984
    ds_read_b64_tr_b16 v[62:63], v5 offset:42496
    v_mfma_f32_16x16x32_bf16 v[100:103], v[32:35], v[244:247], v[100:103]
    s_waitcnt lgkmcnt(4)
    v_cmp_ge_u32 vcc, 16, v16
    v_mul_f32 v80, v80, v88
    v_mul_f32 v81, v81, v89
    v_mul_f32 v82, v82, v90
    v_mfma_f32_16x16x32_bf16 v[104:107], v[36:39], v[240:243], v[104:107]
    v_mfma_f32_16x16x32_bf16 v[108:111], v[36:39], v[244:247], v[108:111]
    s_cbranch_vccz L_cb141
    s_movk_i32 s81, 17
    s_call_b64 s[82:83], L_spin_c
L_cb141:
    ds_read_b64_tr_b16 v[32:33], v10 offset:49152
    ds_read_b64_tr_b16 v[34:35], v10 offset:49408
    v_mul_f32 v83, v83, v91
    v_mul_f32 v84, v84, v92
    v_mul_f32 v85, v85, v93
    v_mfma_f32_16x16x32_bf16 v[96:99], v[40:43], v[248:251], v[96:99]
    ds_read_b64_tr_b16 v[36:37], v10 offset:50176
    ds_read_b64_tr_b16 v[38:39], v10 offset:50432
    v_mul_f32 v86, v86, v94
    v_mfma_f32_16x16x32_bf16 v[100:103], v[40:43], v[252:255], v[100:103]
    v_mul_f32 v87, v87, v95
    v_cvt_pk_bf16_f32 v74, v80, v81
    v_mfma_f32_16x16x32_bf16 v[104:107], v[44:47], v[248:251], v[104:107]
    ds_read_b64_tr_b16 v[40:41], v10 offset:53248
    ds_read_b64_tr_b16 v[42:43], v10 offset:53504
    v_cvt_pk_bf16_f32 v75, v82, v83
    v_mfma_f32_16x16x32_bf16 v[108:111], v[44:47], v[252:255], v[108:111]
    buffer_store_dwordx4 v[72:75], v14, s[44:47], s76 offen offset:0 sc1
    v_cvt_pk_bf16_f32 v78, v84, v85
    v_mfma_f32_16x16x32_bf16 v[112:115], v[48:51], v[240:243], v[112:115]
    ds_read_b64_tr_b16 v[44:45], v10 offset:54272
    ds_read_b64_tr_b16 v[46:47], v10 offset:54528
    v_cvt_pk_bf16_f32 v79, v86, v87
    v_mfma_f32_16x16x32_bf16 v[116:119], v[48:51], v[244:247], v[116:119]
    buffer_store_dwordx4 v[76:79], v14, s[44:47], s76 offen offset:1024 sc1
    v_mul_f32 v96, v96, v104
    v_mfma_f32_16x16x32_bf16 v[120:123], v[52:55], v[240:243], v[120:123]
    ds_read_b64_tr_b16 v[48:49], v10 offset:57344
    ds_read_b64_tr_b16 v[50:51], v10 offset:57600
    v_mul_f32 v97, v97, v105
    v_mfma_f32_16x16x32_bf16 v[124:127], v[52:55], v[244:247], v[124:127]
    v_mul_f32 v98, v98, v106
    v_mul_f32 v99, v99, v107
    s_waitcnt lgkmcnt(10)
    v_mfma_f32_16x16x32_bf16 v[112:115], v[56:59], v[248:251], v[112:115]
    ds_read_b64_tr_b16 v[52:53], v10 offset:58368
    ds_read_b64_tr_b16 v[54:55], v10 offset:58624
    v_mul_f32 v100, v100, v108
    v_mfma_f32_16x16x32_bf16 v[116:119], v[56:59], v[252:255], v[116:119]
    v_mul_f32 v101, v101, v109
    v_mul_f32 v102, v102, v110
    v_mfma_f32_16x16x32_bf16 v[120:123], v[60:63], v[248:251], v[120:123]
    v_mov_b32 v23, 64
    global_load_lds_dword v23, s[88:89]
    ds_read_b64_tr_b16 v[56:57], v10 offset:61440
    ds_read_b64_tr_b16 v[58:59], v10 offset:61696
    v_mfma_f32_16x16x32_bf16 v[124:127], v[60:63], v[252:255], v[124:127]
    v_mul_f32 v103, v103, v111
    v_cvt_pk_bf16_f32 v104, v96, v97
    v_cvt_pk_bf16_f32 v105, v98, v99
    s_waitcnt lgkmcnt(10)
    v_mfma_f32_16x16x32_bf16 v[64:67], v[32:35], v[128:131], 0
    ds_read_b64_tr_b16 v[60:61], v10 offset:62464
    ds_read_b64_tr_b16 v[62:63], v10 offset:62720
    v_cvt_pk_bf16_f32 v108, v100, v101
    v_mfma_f32_16x16x32_bf16 v[68:71], v[32:35], v[132:135], 0
    v_cvt_pk_bf16_f32 v109, v102, v103
    v_mul_f32 v112, v112, v120
    v_mfma_f32_16x16x32_bf16 v[72:75], v[36:39], v[128:131], 0
    ds_read_b64_tr_b16 v[32:33], v11 offset:49152
    ds_read_b64_tr_b16 v[34:35], v11 offset:49408
    v_mul_f32 v113, v113, v121
    v_mfma_f32_16x16x32_bf16 v[76:79], v[36:39], v[132:135], 0
    v_mul_f32 v114, v114, v122
    v_mul_f32 v115, v115, v123
    s_waitcnt lgkmcnt(10)
    v_mfma_f32_16x16x32_bf16 v[64:67], v[40:43], v[136:139], v[64:67]
    ds_read_b64_tr_b16 v[36:37], v11 offset:50176
    ds_read_b64_tr_b16 v[38:39], v11 offset:50432
    v_mul_f32 v116, v116, v124
    v_mfma_f32_16x16x32_bf16 v[68:71], v[40:43], v[140:143], v[68:71]
    v_mul_f32 v117, v117, v125
    v_mul_f32 v118, v118, v126
    v_mfma_f32_16x16x32_bf16 v[72:75], v[44:47], v[136:139], v[72:75]
    ds_read_b64_tr_b16 v[40:41], v11 offset:53248
    ds_read_b64_tr_b16 v[42:43], v11 offset:53504
    v_mul_f32 v119, v119, v127
    v_mfma_f32_16x16x32_bf16 v[76:79], v[44:47], v[140:143], v[76:79]
    v_cvt_pk_bf16_f32 v106, v112, v113
    v_cvt_pk_bf16_f32 v107, v114, v115
    s_waitcnt lgkmcnt(10)
    v_mfma_f32_16x16x32_bf16 v[64:67], v[48:51], v[144:147], v[64:67]
    ds_read_b64_tr_b16 v[44:45], v11 offset:54272
    ds_read_b64_tr_b16 v[46:47], v11 offset:54528
    buffer_store_dwordx4 v[104:107], v14, s[44:47], s76 offen offset:2048 sc1
    v_mfma_f32_16x16x32_bf16 v[68:71], v[48:51], v[148:151], v[68:71]
    v_cvt_pk_bf16_f32 v110, v116, v117
    v_cvt_pk_bf16_f32 v111, v118, v119
    v_mfma_f32_16x16x32_bf16 v[72:75], v[52:55], v[144:147], v[72:75]
    ds_read_b64_tr_b16 v[48:49], v11 offset:57344
    ds_read_b64_tr_b16 v[50:51], v11 offset:57600
    v_mfma_f32_16x16x32_bf16 v[76:79], v[52:55], v[148:151], v[76:79]
    buffer_store_dwordx4 v[108:111], v14, s[44:47], s76 offen offset:3072 sc1
    s_waitcnt lgkmcnt(10)
    v_mfma_f32_16x16x32_bf16 v[64:67], v[56:59], v[152:155], v[64:67]
    ds_read_b64_tr_b16 v[52:53], v11 offset:58368
    ds_read_b64_tr_b16 v[54:55], v11 offset:58624
    v_mfma_f32_16x16x32_bf16 v[68:71], v[56:59], v[156:159], v[68:71]
    ds_read_b32 v16, v18
    v_mfma_f32_16x16x32_bf16 v[72:75], v[60:63], v[152:155], v[72:75]
    ds_read_b64_tr_b16 v[56:57], v11 offset:61440
    v_mfma_f32_16x16x32_bf16 v[76:79], v[60:63], v[156:159], v[76:79]
    ds_read_b64_tr_b16 v[58:59], v11 offset:61696
    s_waitcnt lgkmcnt(11)
    v_mfma_f32_16x16x32_bf16 v[80:83], v[32:35], v[128:131], 0
    ds_read_b64_tr_b16 v[60:61], v11 offset:62464
    ds_read_b64_tr_b16 v[62:63], v11 offset:62720
    v_mfma_f32_16x16x32_bf16 v[84:87], v[32:35], v[132:135], 0
    s_waitcnt lgkmcnt(4)
    v_cmp_ge_u32 vcc, 17, v16
    v_mfma_f32_16x16x32_bf16 v[88:91], v[36:39], v[128:131], 0
    v_mfma_f32_16x16x32_bf16 v[92:95], v[36:39], v[132:135], 0
    s_cbranch_vccz L_cb142
    s_movk_i32 s81, 18
    s_call_b64 s[82:83], L_spin_c
L_cb142:
    ds_read_b64_tr_b16 v[32:33], v12 offset:0
    ds_read_b64_tr_b16 v[34:35], v12 offset:256
    v_mfma_f32_16x16x32_bf16 v[80:83], v[40:43], v[136:139], v[80:83]
    ds_read_b64_tr_b16 v[36:37], v12 offset:1024
    v_mfma_f32_16x16x32_bf16 v[84:87], v[40:43], v[140:143], v[84:87]
    ds_read_b64_tr_b16 v[38:39], v12 offset:1280
    v_mfma_f32_16x16x32_bf16 v[88:91], v[44:47], v[136:139], v[88:91]
    ds_read_b64_tr_b16 v[40:41], v12 offset:4096
    v_mfma_f32_16x16x32_bf16 v[92:95], v[44:47], v[140:143], v[92:95]
    ds_read_b64_tr_b16 v[42:43], v12 offset:4352
    v_mfma_f32_16x16x32_bf16 v[80:83], v[48:51], v[144:147], v[80:83]
    ds_read_b64_tr_b16 v[44:45], v12 offset:5120
    v_mfma_f32_16x16x32_bf16 v[84:87], v[48:51], v[148:151], v[84:87]
    ds_read_b64_tr_b16 v[46:47], v12 offset:5376
    v_mfma_f32_16x16x32_bf16 v[88:91], v[52:55], v[144:147], v[88:91]
    ds_read_b64_tr_b16 v[48:49], v12 offset:8192
    v_mfma_f32_16x16x32_bf16 v[92:95], v[52:55], v[148:151], v[92:95]
    ds_read_b64_tr_b16 v[50:51], v12 offset:8448
    s_waitcnt lgkmcnt(10)
    v_mfma_f32_16x16x32_bf16 v[80:83], v[56:59], v[152:155], v[80:83]
    ds_read_b64_tr_b16 v[52:53], v12 offset:9216
    v_mfma_f32_16x16x32_bf16 v[84:87], v[56:59], v[156:159], v[84:87]
    ds_read_b64_tr_b16 v[54:55], v12 offset:9472
    v_mfma_f32_16x16x32_bf16 v[88:91], v[60:63], v[152:155], v[88:91]
    v_mov_b32 v23, 68
    global_load_lds_dword v23, s[88:89]
    v_mfma_f32_16x16x32_bf16 v[92:95], v[60:63], v[156:159], v[92:95]
    ds_read_b64_tr_b16 v[56:57], v12 offset:12288
    ds_read_b64_tr_b16 v[58:59], v12 offset:12544
    s_waitcnt lgkmcnt(10)
    v_mfma_f32_16x16x32_bf16 v[64:67], v[32:35], v[160:163], v[64:67]
    ds_read_b64_tr_b16 v[60:61], v12 offset:13312
    v_mfma_f32_16x16x32_bf16 v[68:71], v[32:35], v[164:167], v[68:71]
    ds_read_b64_tr_b16 v[62:63], v12 offset:13568
    v_mfma_f32_16x16x32_bf16 v[72:75], v[36:39], v[160:163], v[72:75]
    ds_read_b64_tr_b16 v[32:33], v13 offset:0
    v_mfma_f32_16x16x32_bf16 v[76:79], v[36:39], v[164:167], v[76:79]
    ds_read_b64_tr_b16 v[34:35], v13 offset:256
    s_waitcnt lgkmcnt(10)
    v_mfma_f32_16x16x32_bf16 v[64:67], v[40:43], v[168:171], v[64:67]
    ds_read_b64_tr_b16 v[36:37], v13 offset:1024
    v_mfma_f32_16x16x32_bf16 v[68:71], v[40:43], v[172:175], v[68:71]
    ds_read_b64_tr_b16 v[38:39], v13 offset:1280
    v_mfma_f32_16x16x32_bf16 v[72:75], v[44:47], v[168:171], v[72:75]
    ds_read_b64_tr_b16 v[40:41], v13 offset:4096
    v_mfma_f32_16x16x32_bf16 v[76:79], v[44:47], v[172:175], v[76:79]
    ds_read_b64_tr_b16 v[42:43], v13 offset:4352
    s_waitcnt lgkmcnt(10)
    v_mfma_f32_16x16x32_bf16 v[64:67], v[48:51], v[176:179], v[64:67]
    ds_read_b64_tr_b16 v[44:45], v13 offset:5120
    v_mfma_f32_16x16x32_bf16 v[68:71], v[48:51], v[180:183], v[68:71]
    ds_read_b64_tr_b16 v[46:47], v13 offset:5376
    v_mfma_f32_16x16x32_bf16 v[72:75], v[52:55], v[176:179], v[72:75]
    ds_read_b64_tr_b16 v[48:49], v13 offset:8192
    v_mfma_f32_16x16x32_bf16 v[76:79], v[52:55], v[180:183], v[76:79]
    ds_read_b64_tr_b16 v[50:51], v13 offset:8448
    s_waitcnt lgkmcnt(10)
    v_mfma_f32_16x16x32_bf16 v[64:67], v[56:59], v[184:187], v[64:67]
    ds_read_b64_tr_b16 v[52:53], v13 offset:9216
    ds_read_b64_tr_b16 v[54:55], v13 offset:9472
    ds_read_b32 v16, v18
    v_mfma_f32_16x16x32_bf16 v[68:71], v[56:59], v[188:191], v[68:71]
    s_waitcnt vmcnt(1)
    s_mov_b64 exec, 1
    buffer_atomic_add v22, v24, s[44:47], 0 offen offset:128 sc1
    s_mov_b64 exec, -1
    v_mfma_f32_16x16x32_bf16 v[72:75], v[60:63], v[184:187], v[72:75]
    ds_read_b64_tr_b16 v[56:57], v13 offset:12288
    v_mfma_f32_16x16x32_bf16 v[76:79], v[60:63], v[188:191], v[76:79]
    ds_read_b64_tr_b16 v[58:59], v13 offset:12544
    s_waitcnt lgkmcnt(11)
    v_mfma_f32_16x16x32_bf16 v[80:83], v[32:35], v[160:163], v[80:83]
    ds_read_b64_tr_b16 v[60:61], v13 offset:13312
    ds_read_b64_tr_b16 v[62:63], v13 offset:13568
    v_mfma_f32_16x16x32_bf16 v[84:87], v[32:35], v[164:167], v[84:87]
    s_waitcnt lgkmcnt(4)
    v_cmp_ge_u32 vcc, 18, v16
    v_mfma_f32_16x16x32_bf16 v[88:91], v[36:39], v[160:163], v[88:91]
    v_mfma_f32_16x16x32_bf16 v[92:95], v[36:39], v[164:167], v[92:95]
    s_cbranch_vccz L_cb143
    s_movk_i32 s81, 19
    s_call_b64 s[82:83], L_spin_c
L_cb143:
    ds_read_b64_tr_b16 v[32:33], v12 offset:16384
    ds_read_b64_tr_b16 v[34:35], v12 offset:16640
    v_mfma_f32_16x16x32_bf16 v[80:83], v[40:43], v[168:171], v[80:83]
    ds_read_b64_tr_b16 v[36:37], v12 offset:17408
    v_mfma_f32_16x16x32_bf16 v[84:87], v[40:43], v[172:175], v[84:87]
    ds_read_b64_tr_b16 v[38:39], v12 offset:17664
    v_mfma_f32_16x16x32_bf16 v[88:91], v[44:47], v[168:171], v[88:91]
    ds_read_b64_tr_b16 v[40:41], v12 offset:20480
    v_mfma_f32_16x16x32_bf16 v[92:95], v[44:47], v[172:175], v[92:95]
    ds_read_b64_tr_b16 v[42:43], v12 offset:20736
    v_mfma_f32_16x16x32_bf16 v[80:83], v[48:51], v[176:179], v[80:83]
    ds_read_b64_tr_b16 v[44:45], v12 offset:21504
    v_mfma_f32_16x16x32_bf16 v[84:87], v[48:51], v[180:183], v[84:87]
    ds_read_b64_tr_b16 v[46:47], v12 offset:21760
    v_mfma_f32_16x16x32_bf16 v[88:91], v[52:55], v[176:179], v[88:91]
    ds_read_b64_tr_b16 v[48:49], v12 offset:24576
    v_mfma_f32_16x16x32_bf16 v[92:95], v[52:55], v[180:183], v[92:95]
    ds_read_b64_tr_b16 v[50:51], v12 offset:24832
    s_waitcnt lgkmcnt(10)
    v_mfma_f32_16x16x32_bf16 v[80:83], v[56:59], v[184:187], v[80:83]
    ds_read_b64_tr_b16 v[52:53], v12 offset:25600
    v_mfma_f32_16x16x32_bf16 v[84:87], v[56:59], v[188:191], v[84:87]
    ds_read_b64_tr_b16 v[54:55], v12 offset:25856
    v_mfma_f32_16x16x32_bf16 v[88:91], v[60:63], v[184:187], v[88:91]
    v_mov_b32 v23, 72
    global_load_lds_dword v23, s[88:89]
    v_mfma_f32_16x16x32_bf16 v[92:95], v[60:63], v[188:191], v[92:95]
    ds_read_b64_tr_b16 v[56:57], v12 offset:28672
    ds_read_b64_tr_b16 v[58:59], v12 offset:28928
    s_waitcnt lgkmcnt(10)
    v_mfma_f32_16x16x32_bf16 v[64:67], v[32:35], v[192:195], v[64:67]
    ds_read_b64_tr_b16 v[60:61], v12 offset:29696
    v_mfma_f32_16x16x32_bf16 v[68:71], v[32:35], v[196:199], v[68:71]
    ds_read_b64_tr_b16 v[62:63], v12 offset:29952
    v_mfma_f32_16x16x32_bf16 v[72:75], v[36:39], v[192:195], v[72:75]
    ds_read_b64_tr_b16 v[32:33], v13 offset:16384
    v_mfma_f32_16x16x32_bf16 v[76:79], v[36:39], v[196:199], v[76:79]
    ds_read_b64_tr_b16 v[34:35], v13 offset:16640
    s_waitcnt lgkmcnt(10)
    v_mfma_f32_16x16x32_bf16 v[64:67], v[40:43], v[200:203], v[64:67]
    ds_read_b64_tr_b16 v[36:37], v13 offset:17408
    v_mfma_f32_16x16x32_bf16 v[68:71], v[40:43], v[204:207], v[68:71]
    ds_read_b64_tr_b16 v[38:39], v13 offset:17664
    v_mfma_f32_16x16x32_bf16 v[72:75], v[44:47], v[200:203], v[72:75]
    ds_read_b64_tr_b16 v[40:41], v13 offset:20480
    v_mfma_f32_16x16x32_bf16 v[76:79], v[44:47], v[204:207], v[76:79]
    ds_read_b64_tr_b16 v[42:43], v13 offset:20736
    s_waitcnt lgkmcnt(10)
    v_mfma_f32_16x16x32_bf16 v[64:67], v[48:51], v[208:211], v[64:67]
    ds_read_b64_tr_b16 v[44:45], v13 offset:21504
    v_mfma_f32_16x16x32_bf16 v[68:71], v[48:51], v[212:215], v[68:71]
    ds_read_b64_tr_b16 v[46:47], v13 offset:21760
    v_mfma_f32_16x16x32_bf16 v[72:75], v[52:55], v[208:211], v[72:75]
    ds_read_b64_tr_b16 v[48:49], v13 offset:24576
    v_mfma_f32_16x16x32_bf16 v[76:79], v[52:55], v[212:215], v[76:79]
    ds_read_b64_tr_b16 v[50:51], v13 offset:24832
    s_waitcnt lgkmcnt(10)
    v_mfma_f32_16x16x32_bf16 v[64:67], v[56:59], v[216:219], v[64:67]
    ds_read_b64_tr_b16 v[52:53], v13 offset:25600
    ds_read_b64_tr_b16 v[54:55], v13 offset:25856
    v_mfma_f32_16x16x32_bf16 v[68:71], v[56:59], v[220:223], v[68:71]
    ds_read_b32 v16, v18
    v_mfma_f32_16x16x32_bf16 v[72:75], v[60:63], v[216:219], v[72:75]
    ds_read_b64_tr_b16 v[56:57], v13 offset:28672
    v_mfma_f32_16x16x32_bf16 v[76:79], v[60:63], v[220:223], v[76:79]
    ds_read_b64_tr_b16 v[58:59], v13 offset:28928
    s_waitcnt lgkmcnt(11)
    v_mfma_f32_16x16x32_bf16 v[80:83], v[32:35], v[192:195], v[80:83]
    ds_read_b64_tr_b16 v[60:61], v13 offset:29696
    ds_read_b64_tr_b16 v[62:63], v13 offset:29952
    v_mfma_f32_16x16x32_bf16 v[84:87], v[32:35], v[196:199], v[84:87]
    s_waitcnt lgkmcnt(4)
    v_cmp_ge_u32 vcc, 19, v16
    v_mfma_f32_16x16x32_bf16 v[88:91], v[36:39], v[192:195], v[88:91]
    v_mfma_f32_16x16x32_bf16 v[92:95], v[36:39], v[196:199], v[92:95]
    s_cbranch_vccz L_cb144
    s_movk_i32 s81, 20
    s_call_b64 s[82:83], L_spin_c
L_cb144:
    ds_read_b64_tr_b16 v[32:33], v12 offset:32768
    ds_read_b64_tr_b16 v[34:35], v12 offset:33024
    v_mfma_f32_16x16x32_bf16 v[80:83], v[40:43], v[200:203], v[80:83]
    ds_read_b64_tr_b16 v[36:37], v12 offset:33792
    v_mfma_f32_16x16x32_bf16 v[84:87], v[40:43], v[204:207], v[84:87]
    ds_read_b64_tr_b16 v[38:39], v12 offset:34048
    v_mfma_f32_16x16x32_bf16 v[88:91], v[44:47], v[200:203], v[88:91]
    ds_read_b64_tr_b16 v[40:41], v12 offset:36864
    v_mfma_f32_16x16x32_bf16 v[92:95], v[44:47], v[204:207], v[92:95]
    ds_read_b64_tr_b16 v[42:43], v12 offset:37120
    v_mfma_f32_16x16x32_bf16 v[80:83], v[48:51], v[208:211], v[80:83]
    ds_read_b64_tr_b16 v[44:45], v12 offset:37888
    v_mfma_f32_16x16x32_bf16 v[84:87], v[48:51], v[212:215], v[84:87]
    ds_read_b64_tr_b16 v[46:47], v12 offset:38144
    v_mfma_f32_16x16x32_bf16 v[88:91], v[52:55], v[208:211], v[88:91]
    ds_read_b64_tr_b16 v[48:49], v12 offset:40960
    v_mfma_f32_16x16x32_bf16 v[92:95], v[52:55], v[212:215], v[92:95]
    ds_read_b64_tr_b16 v[50:51], v12 offset:41216
    s_waitcnt lgkmcnt(10)
    v_mfma_f32_16x16x32_bf16 v[80:83], v[56:59], v[216:219], v[80:83]
    ds_read_b64_tr_b16 v[52:53], v12 offset:41984
    v_mfma_f32_16x16x32_bf16 v[84:87], v[56:59], v[220:223], v[84:87]
    ds_read_b64_tr_b16 v[54:55], v12 offset:42240
    v_mfma_f32_16x16x32_bf16 v[88:91], v[60:63], v[216:219], v[88:91]
    v_mov_b32 v23, 76
    global_load_lds_dword v23, s[88:89]
    v_mfma_f32_16x16x32_bf16 v[92:95], v[60:63], v[220:223], v[92:95]
    ds_read_b64_tr_b16 v[56:57], v12 offset:45056
    ds_read_b64_tr_b16 v[58:59], v12 offset:45312
    s_waitcnt lgkmcnt(10)
    v_mfma_f32_16x16x32_bf16 v[64:67], v[32:35], v[224:227], v[64:67]
    ds_read_b64_tr_b16 v[60:61], v12 offset:46080
    v_mfma_f32_16x16x32_bf16 v[68:71], v[32:35], v[228:231], v[68:71]
    ds_read_b64_tr_b16 v[62:63], v12 offset:46336
    v_mfma_f32_16x16x32_bf16 v[72:75], v[36:39], v[224:227], v[72:75]
    ds_read_b64_tr_b16 v[32:33], v13 offset:32768
    v_mfma_f32_16x16x32_bf16 v[76:79], v[36:39], v[228:231], v[76:79]
    ds_read_b64_tr_b16 v[34:35], v13 offset:33024
    s_waitcnt lgkmcnt(10)
    v_mfma_f32_16x16x32_bf16 v[64:67], v[40:43], v[232:235], v[64:67]
    ds_read_b64_tr_b16 v[36:37], v13 offset:33792
    v_mfma_f32_16x16x32_bf16 v[68:71], v[40:43], v[236:239], v[68:71]
    ds_read_b64_tr_b16 v[38:39], v13 offset:34048
    v_mfma_f32_16x16x32_bf16 v[72:75], v[44:47], v[232:235], v[72:75]
    ds_read_b64_tr_b16 v[40:41], v13 offset:36864
    v_mfma_f32_16x16x32_bf16 v[76:79], v[44:47], v[236:239], v[76:79]
    ds_read_b64_tr_b16 v[42:43], v13 offset:37120
    s_waitcnt lgkmcnt(10)
    v_mfma_f32_16x16x32_bf16 v[64:67], v[48:51], v[240:243], v[64:67]
    ds_read_b64_tr_b16 v[44:45], v13 offset:37888
    v_mfma_f32_16x16x32_bf16 v[68:71], v[48:51], v[244:247], v[68:71]
    ds_read_b64_tr_b16 v[46:47], v13 offset:38144
    v_mfma_f32_16x16x32_bf16 v[72:75], v[52:55], v[240:243], v[72:75]
    ds_read_b64_tr_b16 v[48:49], v13 offset:40960
    v_mfma_f32_16x16x32_bf16 v[76:79], v[52:55], v[244:247], v[76:79]
    ds_read_b64_tr_b16 v[50:51], v13 offset:41216
    s_waitcnt lgkmcnt(10)
    v_mfma_f32_16x16x32_bf16 v[64:67], v[56:59], v[248:251], v[64:67]
    ds_read_b64_tr_b16 v[52:53], v13 offset:41984
    v_mfma_f32_16x16x32_bf16 v[68:71], v[56:59], v[252:255], v[68:71]
    ds_read_b64_tr_b16 v[54:55], v13 offset:42240
    v_mfma_f32_16x16x32_bf16 v[72:75], v[60:63], v[248:251], v[72:75]
    ds_read_b64_tr_b16 v[56:57], v13 offset:45056
    v_mfma_f32_16x16x32_bf16 v[76:79], v[60:63], v[252:255], v[76:79]
    ds_read_b64_tr_b16 v[58:59], v13 offset:45312
    s_waitcnt lgkmcnt(10)
    v_mfma_f32_16x16x32_bf16 v[80:83], v[32:35], v[224:227], v[80:83]
    ds_read_b64_tr_b16 v[60:61], v13 offset:46080
    ds_read_b64_tr_b16 v[62:63], v13 offset:46336
    s_nop 0
    v_mul_f32 v64, v64, v72
    v_mfma_f32_16x16x32_bf16 v[84:87], v[32:35], v[228:231], v[84:87]
    v_mul_f32 v65, v65, v73
    v_mul_f32 v66, v66, v74
    v_mfma_f32_16x16x32_bf16 v[88:91], v[36:39], v[224:227], v[88:91]
    v_mul_f32 v67, v67, v75
    v_mul_f32 v68, v68, v76
    v_mfma_f32_16x16x32_bf16 v[92:95], v[36:39], v[228:231], v[92:95]
    v_mul_f32 v69, v69, v77
    s_waitcnt lgkmcnt(8)
    v_mfma_f32_16x16x32_bf16 v[80:83], v[40:43], v[232:235], v[80:83]
    v_mul_f32 v70, v70, v78
    v_mul_f32 v71, v71, v79
    v_mfma_f32_16x16x32_bf16 v[84:87], v[40:43], v[236:239], v[84:87]
    v_cvt_pk_bf16_f32 v72, v64, v65
    v_mfma_f32_16x16x32_bf16 v[88:91], v[44:47], v[232:235], v[88:91]
    v_cvt_pk_bf16_f32 v73, v66, v67
    v_cvt_pk_bf16_f32 v76, v68, v69
    v_mfma_f32_16x16x32_bf16 v[92:95], v[44:47], v[236:239], v[92:95]
    v_cvt_pk_bf16_f32 v77, v70, v71
    s_waitcnt lgkmcnt(4)
    v_mfma_f32_16x16x32_bf16 v[80:83], v[48:51], v[240:243], v[80:83]
    ds_read_b32 v16, v18
    v_mfma_f32_16x16x32_bf16 v[84:87], v[48:51], v[244:247], v[84:87]
    v_mfma_f32_16x16x32_bf16 v[88:91], v[52:55], v[240:243], v[88:91]
    ds_read_b32 v16, v18
    v_xor_b32 v2, 32, v28
    v_mfma_f32_16x16x32_bf16 v[92:95], v[52:55], v[244:247], v[92:95]
    v_xor_b32 v3, 32, v29
    v_xor_b32 v4, 32, v30
    s_waitcnt lgkmcnt(2)
    v_mfma_f32_16x16x32_bf16 v[80:83], v[56:59], v[248:251], v[80:83]
    v_mfma_f32_16x16x32_bf16 v[84:87], v[56:59], v[252:255], v[84:87]
    s_waitcnt lgkmcnt(1)
    v_cmp_ge_u32 vcc, 20, v16
    v_mfma_f32_16x16x32_bf16 v[88:91], v[60:63], v[248:251], v[88:91]
    v_mfma_f32_16x16x32_bf16 v[92:95], v[60:63], v[252:255], v[92:95]
    v_mov_b32 v23, 80
    global_load_lds_dword v23, s[88:89]
    s_nop 4
    v_mul_f32 v80, v80, v88
    v_mul_f32 v81, v81, v89
    v_mul_f32 v82, v82, v90
    v_mul_f32 v83, v83, v91
    v_mul_f32 v84, v84, v92
    v_mul_f32 v85, v85, v93
    v_mul_f32 v86, v86, v94
    v_mul_f32 v87, v87, v95
    v_cvt_pk_bf16_f32 v74, v80, v81
    v_cvt_pk_bf16_f32 v75, v82, v83
    buffer_store_dwordx4 v[72:75], v14, s[44:47], s77 offen offset:0 sc1
    v_cvt_pk_bf16_f32 v78, v84, v85
    v_cvt_pk_bf16_f32 v79, v86, v87
    buffer_store_dwordx4 v[76:79], v14, s[44:47], s77 offen offset:1024 sc1
L_compj:
    s_waitcnt vmcnt(0)
    s_mov_b64 exec, 1
    buffer_atomic_add v22, v24, s[44:47], 0 offen offset:256 sc1
    s_mov_b64 exec, -1
    ds_read_b32 v16, v18
    s_waitcnt lgkmcnt(0)
    v_cmp_ge_u32 vcc, 20, v16
    s_cbranch_vccz L_cb145
    s_movk_i32 s81, 21
    s_call_b64 s[82:83], L_spin_c
L_cb145:
    ds_read_b64_tr_b16 v[32:33], v30 offset:0
    ds_read_b64_tr_b16 v[34:35], v30 offset:4096
    ds_read_b128 v[128:131], v27 offset:2048
    ds_read_b128 v[132:135], v27 offset:3072
    ds_read_b64_tr_b16 v[36:37], v4 offset:0
    ds_read_b64_tr_b16 v[38:39], v4 offset:4096
    ds_read_b64_tr_b16 v[40:41], v30 offset:8192
    ds_read_b64_tr_b16 v[42:43], v30 offset:12288
    ds_read_b128 v[136:139], v27 offset:6144
    ds_read_b128 v[140:143], v27 offset:7168
    ds_read_b64_tr_b16 v[44:45], v4 offset:8192
    ds_read_b64_tr_b16 v[46:47], v4 offset:12288
    v_cmp_ge_u32 vcc, 21, v16
    s_waitcnt lgkmcnt(8)
    v_mfma_f32_16x16x32_bf16 v[176:179], v[32:35], v[128:131], 0
    v_mfma_f32_16x16x32_bf16 v[180:183], v[32:35], v[132:135], 0
    s_cbranch_vccz L_cb146
    s_movk_i32 s81, 22
    s_call_b64 s[82:83], L_spin_c
L_cb146:
    ds_read_b64_tr_b16 v[48:49], v30 offset:16384
    ds_read_b64_tr_b16 v[50:51], v30 offset:20480
    ds_read_b128 v[144:147], v27 offset:18432
    ds_read_b128 v[148:151], v27 offset:19456
    s_waitcnt lgkmcnt(10)
    v_mfma_f32_16x16x32_bf16 v[184:187], v[36:39], v[128:131], 0
    ds_read_b64_tr_b16 v[52:53], v4 offset:16384
    ds_read_b64_tr_b16 v[54:55], v4 offset:20480
    v_mfma_f32_16x16x32_bf16 v[188:191], v[36:39], v[132:135], 0
    ds_read_b32 v16, v18
    s_waitcnt lgkmcnt(9)
    v_mfma_f32_16x16x32_bf16 v[176:179], v[40:43], v[136:139], v[176:179]
    ds_read_b64_tr_b16 v[56:57], v30 offset:24576
    ds_read_b64_tr_b16 v[58:59], v30 offset:28672
    v_mfma_f32_16x16x32_bf16 v[180:183], v[40:43], v[140:143], v[180:183]
    ds_read_b128 v[152:155], v27 offset:22528
    ds_read_b128 v[156:159], v27 offset:23552
    s_waitcnt lgkmcnt(11)
    v_mfma_f32_16x16x32_bf16 v[184:187], v[44:47], v[136:139], v[184:187]
    ds_read_b64_tr_b16 v[60:61], v4 offset:24576
    ds_read_b64_tr_b16 v[62:63], v4 offset:28672
    v_mfma_f32_16x16x32_bf16 v[188:191], v[44:47], v[140:143], v[188:191]
    s_waitcnt lgkmcnt(6)
    v_cmp_ge_u32 vcc, 22, v16
    v_mfma_f32_16x16x32_bf16 v[176:179], v[48:51], v[144:147], v[176:179]
    v_mfma_f32_16x16x32_bf16 v[180:183], v[48:51], v[148:151], v[180:183]
    s_cbranch_vccz L_cb147
    s_movk_i32 s81, 23
    s_call_b64 s[82:83], L_spin_c
L_cb147:
    ds_read_b64_tr_b16 v[32:33], v29 offset:49152
    ds_read_b64_tr_b16 v[34:35], v29 offset:53248
    ds_read_b128 v[128:131], v26 offset:51200
    ds_read_b128 v[132:135], v26 offset:52224
    v_mfma_f32_16x16x32_bf16 v[184:187], v[52:55], v[144:147], v[184:187]
    ds_read_b64_tr_b16 v[36:37], v3 offset:49152
    ds_read_b64_tr_b16 v[38:39], v3 offset:53248
    v_mfma_f32_16x16x32_bf16 v[188:191], v[52:55], v[148:151], v[188:191]
    ds_read_b32 v16, v18
    s_waitcnt lgkmcnt(9)
    v_mfma_f32_16x16x32_bf16 v[176:179], v[56:59], v[152:155], v[176:179]
    ds_read_b64_tr_b16 v[40:41], v29 offset:57344
    ds_read_b64_tr_b16 v[42:43], v29 offset:61440
    v_mfma_f32_16x16x32_bf16 v[180:183], v[56:59], v[156:159], v[180:183]
    ds_read_b128 v[136:139], v26 offset:55296
    ds_read_b128 v[140:143], v26 offset:56320
    s_waitcnt lgkmcnt(11)
    v_mfma_f32_16x16x32_bf16 v[184:187], v[60:63], v[152:155], v[184:187]
    v_mov_b32 v23, 88
    global_load_lds_dword v23, s[88:89]
    ds_read_b64_tr_b16 v[44:45], v3 offset:57344
    v_mfma_f32_16x16x32_bf16 v[188:191], v[60:63], v[156:159], v[188:191]
    ds_read_b64_tr_b16 v[46:47], v3 offset:61440
    s_waitcnt lgkmcnt(6)
    v_cmp_ge_u32 vcc, 23, v16
    v_mfma_f32_16x16x32_bf16 v[176:179], v[32:35], v[128:131], v[176:179]
    v_mfma_f32_16x16x32_bf16 v[180:183], v[32:35], v[132:135], v[180:183]
    s_cbranch_vccz L_cb148
    s_movk_i32 s81, 24
    s_call_b64 s[82:83], L_spin_c
L_cb148:
    ds_read_b64_tr_b16 v[48:49], v28 offset:0
    ds_read_b64_tr_b16 v[50:51], v28 offset:4096
    ds_read_b128 v[144:147], v25 offset:2048
    ds_read_b128 v[148:151], v25 offset:3072
    v_mfma_f32_16x16x32_bf16 v[184:187], v[36:39], v[128:131], v[184:187]
    ds_read_b64_tr_b16 v[52:53], v2 offset:0
    ds_read_b64_tr_b16 v[54:55], v2 offset:4096
    v_mfma_f32_16x16x32_bf16 v[188:191], v[36:39], v[132:135], v[188:191]
    ds_read_b32 v16, v18
    s_waitcnt lgkmcnt(9)
    v_mfma_f32_16x16x32_bf16 v[176:179], v[40:43], v[136:139], v[176:179]
    ds_read_b64_tr_b16 v[56:57], v28 offset:8192
    ds_read_b64_tr_b16 v[58:59], v28 offset:12288
    v_mfma_f32_16x16x32_bf16 v[180:183], v[40:43], v[140:143], v[180:183]
    ds_read_b128 v[152:155], v25 offset:6144
    ds_read_b128 v[156:159], v25 offset:7168
    s_waitcnt lgkmcnt(11)
    v_mfma_f32_16x16x32_bf16 v[184:187], v[44:47], v[136:139], v[184:187]
    ds_read_b64_tr_b16 v[60:61], v2 offset:8192
    ds_read_b64_tr_b16 v[62:63], v2 offset:12288
    v_mfma_f32_16x16x32_bf16 v[188:191], v[44:47], v[140:143], v[188:191]
    s_waitcnt lgkmcnt(6)
    v_cmp_ge_u32 vcc, 24, v16
    v_mfma_f32_16x16x32_bf16 v[176:179], v[48:51], v[144:147], v[176:179]
    v_mfma_f32_16x16x32_bf16 v[180:183], v[48:51], v[148:151], v[180:183]
    s_cbranch_vccz L_cb149
    s_movk_i32 s81, 25
    s_call_b64 s[82:83], L_spin_c
L_cb149:
    ds_read_b64_tr_b16 v[32:33], v28 offset:32768
    ds_read_b64_tr_b16 v[34:35], v28 offset:36864
    ds_read_b128 v[128:131], v25 offset:34816
    ds_read_b128 v[132:135], v25 offset:35840
    v_mfma_f32_16x16x32_bf16 v[184:187], v[52:55], v[144:147], v[184:187]
    ds_read_b64_tr_b16 v[36:37], v2 offset:32768
    ds_read_b64_tr_b16 v[38:39], v2 offset:36864
    v_mfma_f32_16x16x32_bf16 v[188:191], v[52:55], v[148:151], v[188:191]
    ds_read_b32 v16, v18
    s_waitcnt lgkmcnt(9)
    v_mfma_f32_16x16x32_bf16 v[176:179], v[56:59], v[152:155], v[176:179]
    ds_read_b64_tr_b16 v[40:41], v28 offset:40960
    ds_read_b64_tr_b16 v[42:43], v28 offset:45056
    v_mfma_f32_16x16x32_bf16 v[180:183], v[56:59], v[156:159], v[180:183]
    ds_read_b128 v[136:139], v25 offset:38912
    ds_read_b128 v[140:143], v25 offset:39936
    s_waitcnt lgkmcnt(11)
    v_mfma_f32_16x16x32_bf16 v[184:187], v[60:63], v[152:155], v[184:187]
    v_mov_b32 v23, 96
    global_load_lds_dword v23, s[88:89]
    ds_read_b64_tr_b16 v[44:45], v2 offset:40960
    v_mfma_f32_16x16x32_bf16 v[188:191], v[60:63], v[156:159], v[188:191]
    ds_read_b64_tr_b16 v[46:47], v2 offset:45056
    s_waitcnt lgkmcnt(6)
    v_cmp_ge_u32 vcc, 25, v16
    v_mfma_f32_16x16x32_bf16 v[176:179], v[32:35], v[128:131], v[176:179]
    v_mfma_f32_16x16x32_bf16 v[180:183], v[32:35], v[132:135], v[180:183]
    s_cbranch_vccz L_cb150
    s_movk_i32 s81, 26
    s_call_b64 s[82:83], L_spin_c
L_cb150:
    ds_read_b64_tr_b16 v[48:49], v28 offset:49152
    ds_read_b64_tr_b16 v[50:51], v28 offset:53248
    ds_read_b128 v[144:147], v25 offset:51200
    ds_read_b128 v[148:151], v25 offset:52224
    v_mfma_f32_16x16x32_bf16 v[184:187], v[36:39], v[128:131], v[184:187]
    ds_read_b64_tr_b16 v[52:53], v2 offset:49152
    ds_read_b64_tr_b16 v[54:55], v2 offset:53248
    v_mfma_f32_16x16x32_bf16 v[188:191], v[36:39], v[132:135], v[188:191]
    ds_read_b32 v16, v18
    s_waitcnt lgkmcnt(9)
    v_mfma_f32_16x16x32_bf16 v[176:179], v[40:43], v[136:139], v[176:179]
    ds_read_b64_tr_b16 v[56:57], v28 offset:57344
    ds_read_b64_tr_b16 v[58:59], v28 offset:61440
    v_mfma_f32_16x16x32_bf16 v[180:183], v[40:43], v[140:143], v[180:183]
    ds_read_b128 v[152:155], v25 offset:55296
    ds_read_b128 v[156:159], v25 offset:56320
    s_waitcnt lgkmcnt(11)
    v_mfma_f32_16x16x32_bf16 v[184:187], v[44:47], v[136:139], v[184:187]
    ds_read_b64_tr_b16 v[60:61], v2 offset:57344
    ds_read_b64_tr_b16 v[62:63], v2 offset:61440
    v_mfma_f32_16x16x32_bf16 v[188:191], v[44:47], v[140:143], v[188:191]
    s_waitcnt lgkmcnt(6)
    v_cmp_ge_u32 vcc, 26, v16
    v_mfma_f32_16x16x32_bf16 v[176:179], v[48:51], v[144:147], v[176:179]
    v_mfma_f32_16x16x32_bf16 v[180:183], v[48:51], v[148:151], v[180:183]
    s_cbranch_vccz L_cb151
    s_movk_i32 s81, 27
    s_call_b64 s[82:83], L_spin_c
L_cb151:
    ds_read_b64_tr_b16 v[32:33], v29 offset:0
    ds_read_b64_tr_b16 v[34:35], v29 offset:4096
    ds_read_b128 v[128:131], v26 offset:2048
    ds_read_b128 v[132:135], v26 offset:3072
    v_mfma_f32_16x16x32_bf16 v[184:187], v[52:55], v[144:147], v[184:187]
    ds_read_b64_tr_b16 v[36:37], v3 offset:0
    ds_read_b64_tr_b16 v[38:39], v3 offset:4096
    v_mfma_f32_16x16x32_bf16 v[188:191], v[52:55], v[148:151], v[188:191]
    ds_read_b32 v16, v18
    s_waitcnt lgkmcnt(9)
    v_mfma_f32_16x16x32_bf16 v[176:179], v[56:59], v[152:155], v[176:179]
    ds_read_b64_tr_b16 v[40:41], v29 offset:8192
    ds_read_b64_tr_b16 v[42:43], v29 offset:12288
    v_mfma_f32_16x16x32_bf16 v[180:183], v[56:59], v[156:159], v[180:183]
    ds_read_b128 v[136:139], v26 offset:6144
    ds_read_b128 v[140:143], v26 offset:7168
    s_waitcnt lgkmcnt(11)
    v_mfma_f32_16x16x32_bf16 v[184:187], v[60:63], v[152:155], v[184:187]
    v_mov_b32 v23, 104
    global_load_lds_dword v23, s[88:89]
    ds_read_b64_tr_b16 v[44:45], v3 offset:8192
    v_mfma_f32_16x16x32_bf16 v[188:191], v[60:63], v[156:159], v[188:191]
    ds_read_b64_tr_b16 v[46:47], v3 offset:12288
    s_waitcnt lgkmcnt(6)
    v_cmp_ge_u32 vcc, 27, v16
    v_mfma_f32_16x16x32_bf16 v[176:179], v[32:35], v[128:131], v[176:179]
    v_mfma_f32_16x16x32_bf16 v[180:183], v[32:35], v[132:135], v[180:183]
    s_cbranch_vccz L_cb152
    s_movk_i32 s81, 28
    s_call_b64 s[82:83], L_spin_c
L_cb152:
    ds_read_b64_tr_b16 v[48:49], v29 offset:16384
    ds_read_b64_tr_b16 v[50:51], v29 offset:20480
    ds_read_b128 v[144:147], v26 offset:18432
    ds_read_b128 v[148:151], v26 offset:19456
    v_mfma_f32_16x16x32_bf16 v[184:187], v[36:39], v[128:131], v[184:187]
    ds_read_b64_tr_b16 v[52:53], v3 offset:16384
    ds_read_b64_tr_b16 v[54:55], v3 offset:20480
    v_mfma_f32_16x16x32_bf16 v[188:191], v[36:39], v[132:135], v[188:191]
    ds_read_b32 v16, v18
    s_waitcnt lgkmcnt(9)
    v_mfma_f32_16x16x32_bf16 v[176:179], v[40:43], v[136:139], v[176:179]
    ds_read_b64_tr_b16 v[56:57], v29 offset:24576
    ds_read_b64_tr_b16 v[58:59], v29 offset:28672
    v_mfma_f32_16x16x32_bf16 v[180:183], v[40:43], v[140:143], v[180:183]
    ds_read_b128 v[152:155], v26 offset:22528
    ds_read_b128 v[156:159], v26 offset:23552
    s_waitcnt lgkmcnt(11)
    v_mfma_f32_16x16x32_bf16 v[184:187], v[44:47], v[136:139], v[184:187]
    ds_read_b64_tr_b16 v[60:61], v3 offset:24576
    ds_read_b64_tr_b16 v[62:63], v3 offset:28672
    v_mfma_f32_16x16x32_bf16 v[188:191], v[44:47], v[140:143], v[188:191]
    s_waitcnt lgkmcnt(6)
    v_cmp_ge_u32 vcc, 28, v16
    v_mfma_f32_16x16x32_bf16 v[176:179], v[48:51], v[144:147], v[176:179]
    v_mfma_f32_16x16x32_bf16 v[180:183], v[48:51], v[148:151], v[180:183]
    s_cbranch_vccz L_cb153
    s_movk_i32 s81, 29
    s_call_b64 s[82:83], L_spin_c
L_cb153:
    ds_read_b64_tr_b16 v[32:33], v29 offset:32768
    ds_read_b64_tr_b16 v[34:35], v29 offset:36864
    ds_read_b128 v[128:131], v26 offset:34816
    ds_read_b128 v[132:135], v26 offset:35840
    v_mfma_f32_16x16x32_bf16 v[184:187], v[52:55], v[144:147], v[184:187]
    ds_read_b64_tr_b16 v[36:37], v3 offset:32768
    ds_read_b64_tr_b16 v[38:39], v3 offset:36864
    v_mfma_f32_16x16x32_bf16 v[188:191], v[52:55], v[148:151], v[188:191]
    ds_read_b32 v16, v18
    s_waitcnt lgkmcnt(9)
    v_mfma_f32_16x16x32_bf16 v[176:179], v[56:59], v[152:155], v[176:179]
    ds_read_b64_tr_b16 v[40:41], v29 offset:40960
    ds_read_b64_tr_b16 v[42:43], v29 offset:45056
    v_mfma_f32_16x16x32_bf16 v[180:183], v[56:59], v[156:159], v[180:183]
    ds_read_b128 v[136:139], v26 offset:38912
    ds_read_b128 v[140:143], v26 offset:39936
    s_waitcnt lgkmcnt(11)
    v_mfma_f32_16x16x32_bf16 v[184:187], v[60:63], v[152:155], v[184:187]
    v_mov_b32 v23, 112
    global_load_lds_dword v23, s[88:89]
    ds_read_b64_tr_b16 v[44:45], v3 offset:40960
    v_mfma_f32_16x16x32_bf16 v[188:191], v[60:63], v[156:159], v[188:191]
    ds_read_b64_tr_b16 v[46:47], v3 offset:45056
    s_waitcnt lgkmcnt(6)
    v_cmp_ge_u32 vcc, 29, v16
    v_mfma_f32_16x16x32_bf16 v[176:179], v[32:35], v[128:131], v[176:179]
    v_mfma_f32_16x16x32_bf16 v[180:183], v[32:35], v[132:135], v[180:183]
    s_cbranch_vccz L_cb154
    s_movk_i32 s81, 30
    s_call_b64 s[82:83], L_spin_c
L_cb154:
    ds_read_b64_tr_b16 v[48:49], v30 offset:0
    ds_read_b64_tr_b16 v[50:51], v30 offset:4096
    ds_read_b128 v[144:147], v27 offset:2048
    ds_read_b128 v[148:151], v27 offset:3072
    v_mfma_f32_16x16x32_bf16 v[184:187], v[36:39], v[128:131], v[184:187]
    ds_read_b64_tr_b16 v[52:53], v4 offset:0
    ds_read_b64_tr_b16 v[54:55], v4 offset:4096
    v_mfma_f32_16x16x32_bf16 v[188:191], v[36:39], v[132:135], v[188:191]
    ds_read_b32 v16, v18
    s_waitcnt lgkmcnt(9)
    v_mfma_f32_16x16x32_bf16 v[176:179], v[40:43], v[136:139], v[176:179]
    ds_read_b64_tr_b16 v[56:57], v30 offset:8192
    ds_read_b64_tr_b16 v[58:59], v30 offset:12288
    v_mfma_f32_16x16x32_bf16 v[180:183], v[40:43], v[140:143], v[180:183]
    ds_read_b128 v[152:155], v27 offset:6144
    ds_read_b128 v[156:159], v27 offset:7168
    s_waitcnt lgkmcnt(11)
    v_mfma_f32_16x16x32_bf16 v[184:187], v[44:47], v[136:139], v[184:187]
    ds_read_b64_tr_b16 v[60:61], v4 offset:8192
    ds_read_b64_tr_b16 v[62:63], v4 offset:12288
    v_mfma_f32_16x16x32_bf16 v[188:191], v[44:47], v[140:143], v[188:191]
    s_waitcnt lgkmcnt(6)
    v_cmp_ge_u32 vcc, 30, v16
    v_mfma_f32_16x16x32_bf16 v[176:179], v[48:51], v[144:147], v[176:179]
    v_mfma_f32_16x16x32_bf16 v[180:183], v[48:51], v[148:151], v[180:183]
    s_cbranch_vccz L_cb155
    s_movk_i32 s81, 31
    s_call_b64 s[82:83], L_spin_c
L_cb155:
    ds_read_b64_tr_b16 v[32:33], v30 offset:16384
    ds_read_b64_tr_b16 v[34:35], v30 offset:20480
    ds_read_b128 v[128:131], v27 offset:18432
    ds_read_b128 v[132:135], v27 offset:19456
    v_mfma_f32_16x16x32_bf16 v[184:187], v[52:55], v[144:147], v[184:187]
    ds_read_b64_tr_b16 v[36:37], v4 offset:16384
    ds_read_b64_tr_b16 v[38:39], v4 offset:20480
    v_mfma_f32_16x16x32_bf16 v[188:191], v[52:55], v[148:151], v[188:191]
    ds_read_b32 v16, v18
    s_waitcnt lgkmcnt(9)
    v_mfma_f32_16x16x32_bf16 v[176:179], v[56:59], v[152:155], v[176:179]
    ds_read_b64_tr_b16 v[40:41], v30 offset:24576
    ds_read_b64_tr_b16 v[42:43], v30 offset:28672
    v_mfma_f32_16x16x32_bf16 v[180:183], v[56:59], v[156:159], v[180:183]
    ds_read_b128 v[136:139], v27 offset:22528
    ds_read_b128 v[140:143], v27 offset:23552
    s_waitcnt lgkmcnt(11)
    v_mfma_f32_16x16x32_bf16 v[184:187], v[60:63], v[152:155], v[184:187]
    v_mov_b32 v23, 120
    global_load_lds_dword v23, s[88:89]
    ds_read_b64_tr_b16 v[44:45], v4 offset:24576
    v_mfma_f32_16x16x32_bf16 v[188:191], v[60:63], v[156:159], v[188:191]
    ds_read_b64_tr_b16 v[46:47], v4 offset:28672
    s_waitcnt lgkmcnt(6)
    v_cmp_ge_u32 vcc, 31, v16
    v_mfma_f32_16x16x32_bf16 v[176:179], v[32:35], v[128:131], v[176:179]
    v_mfma_f32_16x16x32_bf16 v[180:183], v[32:35], v[132:135], v[180:183]
    s_cbranch_vccz L_cb156
    s_movk_i32 s81, 32
    s_call_b64 s[82:83], L_spin_c
L_cb156:
    ds_read_b64_tr_b16 v[48:49], v29 offset:49152
    ds_read_b64_tr_b16 v[50:51], v29 offset:53248
    ds_read_b128 v[144:147], v26 offset:51200
    ds_read_b128 v[148:151], v26 offset:52224
    v_mfma_f32_16x16x32_bf16 v[184:187], v[36:39], v[128:131], v[184:187]
    ds_read_b64_tr_b16 v[52:53], v3 offset:49152
    ds_read_b64_tr_b16 v[54:55], v3 offset:53248
    v_mfma_f32_16x16x32_bf16 v[188:191], v[36:39], v[132:135], v[188:191]
    ds_read_b32 v16, v18
    s_waitcnt lgkmcnt(9)
    v_mfma_f32_16x16x32_bf16 v[176:179], v[40:43], v[136:139], v[176:179]
    ds_read_b64_tr_b16 v[56:57], v29 offset:57344
    ds_read_b64_tr_b16 v[58:59], v29 offset:61440
    v_mfma_f32_16x16x32_bf16 v[180:183], v[40:43], v[140:143], v[180:183]
    ds_read_b128 v[152:155], v26 offset:55296
    ds_read_b128 v[156:159], v26 offset:56320
    s_waitcnt lgkmcnt(11)
    v_mfma_f32_16x16x32_bf16 v[184:187], v[44:47], v[136:139], v[184:187]
    ds_read_b64_tr_b16 v[60:61], v3 offset:57344
    ds_read_b64_tr_b16 v[62:63], v3 offset:61440
    v_mfma_f32_16x16x32_bf16 v[188:191], v[44:47], v[140:143], v[188:191]
    s_waitcnt lgkmcnt(6)
    v_cmp_ge_u32 vcc, 32, v16
    v_mfma_f32_16x16x32_bf16 v[176:179], v[48:51], v[144:147], v[176:179]
    v_mfma_f32_16x16x32_bf16 v[180:183], v[48:51], v[148:151], v[180:183]
    s_cbranch_vccz L_cb157
    s_movk_i32 s81, 33
    s_call_b64 s[82:83], L_spin_c
L_cb157:
    ds_read_b64_tr_b16 v[32:33], v28 offset:0
    ds_read_b64_tr_b16 v[34:35], v28 offset:4096
    ds_read_b128 v[128:131], v25 offset:2048
    ds_read_b128 v[132:135], v25 offset:3072
    v_mfma_f32_16x16x32_bf16 v[184:187], v[52:55], v[144:147], v[184:187]
    ds_read_b64_tr_b16 v[36:37], v2 offset:0
    ds_read_b64_tr_b16 v[38:39], v2 offset:4096
    v_mfma_f32_16x16x32_bf16 v[188:191], v[52:55], v[148:151], v[188:191]
    ds_read_b32 v16, v18
    s_waitcnt lgkmcnt(9)
    v_mfma_f32_16x16x32_bf16 v[176:179], v[56:59], v[152:155], v[176:179]
    ds_read_b64_tr_b16 v[40:41], v28 offset:8192
    ds_read_b64_tr_b16 v[42:43], v28 offset:12288
    v_mfma_f32_16x16x32_bf16 v[180:183], v[56:59], v[156:159], v[180:183]
    ds_read_b128 v[136:139], v25 offset:6144
    ds_read_b128 v[140:143], v25 offset:7168
    s_waitcnt lgkmcnt(11)
    v_mfma_f32_16x16x32_bf16 v[184:187], v[60:63], v[152:155], v[184:187]
    v_mov_b32 v23, 128
    global_load_lds_dword v23, s[88:89]
    ds_read_b64_tr_b16 v[44:45], v2 offset:8192
    v_mfma_f32_16x16x32_bf16 v[188:191], v[60:63], v[156:159], v[188:191]
    ds_read_b64_tr_b16 v[46:47], v2 offset:12288
    s_waitcnt lgkmcnt(6)
    v_cmp_ge_u32 vcc, 33, v16
    v_mfma_f32_16x16x32_bf16 v[176:179], v[32:35], v[128:131], v[176:179]
    v_mfma_f32_16x16x32_bf16 v[180:183], v[32:35], v[132:135], v[180:183]
    s_cbranch_vccz L_cb158
    s_movk_i32 s81, 34
    s_call_b64 s[82:83], L_spin_c
L_cb158:
    ds_read_b64_tr_b16 v[48:49], v28 offset:32768
    ds_read_b64_tr_b16 v[50:51], v28 offset:36864
    ds_read_b128 v[144:147], v25 offset:34816
    ds_read_b128 v[148:151], v25 offset:35840
    v_mfma_f32_16x16x32_bf16 v[184:187], v[36:39], v[128:131], v[184:187]
    ds_read_b64_tr_b16 v[52:53], v2 offset:32768
    ds_read_b64_tr_b16 v[54:55], v2 offset:36864
    v_mfma_f32_16x16x32_bf16 v[188:191], v[36:39], v[132:135], v[188:191]
    ds_read_b32 v16, v18
    s_waitcnt lgkmcnt(9)
    v_mfma_f32_16x16x32_bf16 v[176:179], v[40:43], v[136:139], v[176:179]
    ds_read_b64_tr_b16 v[56:57], v28 offset:40960
    ds_read_b64_tr_b16 v[58:59], v28 offset:45056
    v_mfma_f32_16x16x32_bf16 v[180:183], v[40:43], v[140:143], v[180:183]
    ds_read_b128 v[152:155], v25 offset:38912
    ds_read_b128 v[156:159], v25 offset:39936
    s_waitcnt lgkmcnt(11)
    v_mfma_f32_16x16x32_bf16 v[184:187], v[44:47], v[136:139], v[184:187]
    ds_read_b64_tr_b16 v[60:61], v2 offset:40960
    ds_read_b64_tr_b16 v[62:63], v2 offset:45056
    v_mfma_f32_16x16x32_bf16 v[188:191], v[44:47], v[140:143], v[188:191]
    s_waitcnt lgkmcnt(6)
    v_cmp_ge_u32 vcc, 34, v16
    v_mfma_f32_16x16x32_bf16 v[176:179], v[48:51], v[144:147], v[176:179]
    v_mfma_f32_16x16x32_bf16 v[180:183], v[48:51], v[148:151], v[180:183]
    s_cbranch_vccz L_cb159
    s_movk_i32 s81, 35
    s_call_b64 s[82:83], L_spin_c
L_cb159:
    ds_read_b64_tr_b16 v[32:33], v28 offset:49152
    ds_read_b64_tr_b16 v[34:35], v28 offset:53248
    ds_read_b128 v[128:131], v25 offset:51200
    ds_read_b128 v[132:135], v25 offset:52224
    v_mfma_f32_16x16x32_bf16 v[184:187], v[52:55], v[144:147], v[184:187]
    ds_read_b64_tr_b16 v[36:37], v2 offset:49152
    ds_read_b64_tr_b16 v[38:39], v2 offset:53248
    v_mfma_f32_16x16x32_bf16 v[188:191], v[52:55], v[148:151], v[188:191]
    ds_read_b32 v16, v18
    s_waitcnt lgkmcnt(9)
    v_mfma_f32_16x16x32_bf16 v[176:179], v[56:59], v[152:155], v[176:179]
    ds_read_b64_tr_b16 v[40:41], v28 offset:57344
    ds_read_b64_tr_b16 v[42:43], v28 offset:61440
    v_mfma_f32_16x16x32_bf16 v[180:183], v[56:59], v[156:159], v[180:183]
    ds_read_b128 v[136:139], v25 offset:55296
    ds_read_b128 v[140:143], v25 offset:56320
    s_waitcnt lgkmcnt(11)
    v_mfma_f32_16x16x32_bf16 v[184:187], v[60:63], v[152:155], v[184:187]
    v_mov_b32 v23, 136
    global_load_lds_dword v23, s[88:89]
    ds_read_b64_tr_b16 v[44:45], v2 offset:57344
    v_mfma_f32_16x16x32_bf16 v[188:191], v[60:63], v[156:159], v[188:191]
    ds_read_b64_tr_b16 v[46:47], v2 offset:61440
    s_waitcnt lgkmcnt(6)
    v_cmp_ge_u32 vcc, 35, v16
    v_mfma_f32_16x16x32_bf16 v[176:179], v[32:35], v[128:131], v[176:179]
    v_mfma_f32_16x16x32_bf16 v[180:183], v[32:35], v[132:135], v[180:183]
    s_cbranch_vccz L_cb160
    s_movk_i32 s81, 36
    s_call_b64 s[82:83], L_spin_c
L_cb160:
    ds_read_b64_tr_b16 v[48:49], v29 offset:0
    ds_read_b64_tr_b16 v[50:51], v29 offset:4096
    ds_read_b128 v[144:147], v26 offset:2048
    ds_read_b128 v[148:151], v26 offset:3072
    v_mfma_f32_16x16x32_bf16 v[184:187], v[36:39], v[128:131], v[184:187]
    ds_read_b64_tr_b16 v[52:53], v3 offset:0
    ds_read_b64_tr_b16 v[54:55], v3 offset:4096
    v_mfma_f32_16x16x32_bf16 v[188:191], v[36:39], v[132:135], v[188:191]
    ds_read_b32 v16, v18
    s_waitcnt lgkmcnt(9)
    v_mfma_f32_16x16x32_bf16 v[176:179], v[40:43], v[136:139], v[176:179]
    ds_read_b64_tr_b16 v[56:57], v29 offset:8192
    ds_read_b64_tr_b16 v[58:59], v29 offset:12288
    v_mfma_f32_16x16x32_bf16 v[180:183], v[40:43], v[140:143], v[180:183]
    ds_read_b128 v[152:155], v26 offset:6144
    ds_read_b128 v[156:159], v26 offset:7168
    s_waitcnt lgkmcnt(11)
    v_mfma_f32_16x16x32_bf16 v[184:187], v[44:47], v[136:139], v[184:187]
    ds_read_b64_tr_b16 v[60:61], v3 offset:8192
    ds_read_b64_tr_b16 v[62:63], v3 offset:12288
    v_mfma_f32_16x16x32_bf16 v[188:191], v[44:47], v[140:143], v[188:191]
    s_waitcnt lgkmcnt(6)
    v_cmp_ge_u32 vcc, 36, v16
    v_mfma_f32_16x16x32_bf16 v[176:179], v[48:51], v[144:147], v[176:179]
    v_mfma_f32_16x16x32_bf16 v[180:183], v[48:51], v[148:151], v[180:183]
    s_cbranch_vccz L_cb161
    s_movk_i32 s81, 37
    s_call_b64 s[82:83], L_spin_c
L_cb161:
    ds_read_b64_tr_b16 v[32:33], v29 offset:16384
    ds_read_b64_tr_b16 v[34:35], v29 offset:20480
    ds_read_b128 v[128:131], v26 offset:18432
    ds_read_b128 v[132:135], v26 offset:19456
    v_mfma_f32_16x16x32_bf16 v[184:187], v[52:55], v[144:147], v[184:187]
    ds_read_b64_tr_b16 v[36:37], v3 offset:16384
    ds_read_b64_tr_b16 v[38:39], v3 offset:20480
    v_mfma_f32_16x16x32_bf16 v[188:191], v[52:55], v[148:151], v[188:191]
    ds_read_b32 v16, v18
    s_waitcnt lgkmcnt(9)
    v_mfma_f32_16x16x32_bf16 v[176:179], v[56:59], v[152:155], v[176:179]
    ds_read_b64_tr_b16 v[40:41], v29 offset:24576
    ds_read_b64_tr_b16 v[42:43], v29 offset:28672
    v_mfma_f32_16x16x32_bf16 v[180:183], v[56:59], v[156:159], v[180:183]
    ds_read_b128 v[136:139], v26 offset:22528
    ds_read_b128 v[140:143], v26 offset:23552
    s_waitcnt lgkmcnt(11)
    v_mfma_f32_16x16x32_bf16 v[184:187], v[60:63], v[152:155], v[184:187]
    v_mov_b32 v23, 144
    global_load_lds_dword v23, s[88:89]
    ds_read_b64_tr_b16 v[44:45], v3 offset:24576
    v_mfma_f32_16x16x32_bf16 v[188:191], v[60:63], v[156:159], v[188:191]
    ds_read_b64_tr_b16 v[46:47], v3 offset:28672
    s_waitcnt lgkmcnt(6)
    v_cmp_ge_u32 vcc, 37, v16
    v_mfma_f32_16x16x32_bf16 v[176:179], v[32:35], v[128:131], v[176:179]
    v_mfma_f32_16x16x32_bf16 v[180:183], v[32:35], v[132:135], v[180:183]
    s_cbranch_vccz L_cb162
    s_movk_i32 s81, 38
    s_call_b64 s[82:83], L_spin_c
L_cb162:
    ds_read_b64_tr_b16 v[48:49], v29 offset:32768
    ds_read_b64_tr_b16 v[50:51], v29 offset:36864
    ds_read_b128 v[144:147], v26 offset:34816
    ds_read_b128 v[148:151], v26 offset:35840
    v_mfma_f32_16x16x32_bf16 v[184:187], v[36:39], v[128:131], v[184:187]
    ds_read_b64_tr_b16 v[52:53], v3 offset:32768
    ds_read_b64_tr_b16 v[54:55], v3 offset:36864
    v_mfma_f32_16x16x32_bf16 v[188:191], v[36:39], v[132:135], v[188:191]
    ds_read_b32 v16, v18
    s_waitcnt lgkmcnt(9)
    v_mfma_f32_16x16x32_bf16 v[176:179], v[40:43], v[136:139], v[176:179]
    ds_read_b64_tr_b16 v[56:57], v29 offset:40960
    ds_read_b64_tr_b16 v[58:59], v29 offset:45056
    v_mfma_f32_16x16x32_bf16 v[180:183], v[40:43], v[140:143], v[180:183]
    ds_read_b128 v[152:155], v26 offset:38912
    ds_read_b128 v[156:159], v26 offset:39936
    s_waitcnt lgkmcnt(11)
    v_mfma_f32_16x16x32_bf16 v[184:187], v[44:47], v[136:139], v[184:187]
    ds_read_b64_tr_b16 v[60:61], v3 offset:40960
    ds_read_b64_tr_b16 v[62:63], v3 offset:45056
    v_mfma_f32_16x16x32_bf16 v[188:191], v[44:47], v[140:143], v[188:191]
    s_waitcnt lgkmcnt(6)
    v_cmp_ge_u32 vcc, 38, v16
    v_mfma_f32_16x16x32_bf16 v[176:179], v[48:51], v[144:147], v[176:179]
    v_mfma_f32_16x16x32_bf16 v[180:183], v[48:51], v[148:151], v[180:183]
    s_cbranch_vccz L_cb163
    s_movk_i32 s81, 39
    s_call_b64 s[82:83], L_spin_c
L_cb163:
    ds_read_b64_tr_b16 v[32:33], v30 offset:0
    ds_read_b64_tr_b16 v[34:35], v30 offset:4096
    ds_read_b128 v[128:131], v27 offset:2048
    ds_read_b128 v[132:135], v27 offset:3072
    v_mfma_f32_16x16x32_bf16 v[184:187], v[52:55], v[144:147], v[184:187]
    ds_read_b64_tr_b16 v[36:37], v4 offset:0
    ds_read_b64_tr_b16 v[38:39], v4 offset:4096
    v_mfma_f32_16x16x32_bf16 v[188:191], v[52:55], v[148:151], v[188:191]
    ds_read_b32 v16, v18
    s_waitcnt lgkmcnt(9)
    v_mfma_f32_16x16x32_bf16 v[176:179], v[56:59], v[152:155], v[176:179]
    ds_read_b64_tr_b16 v[40:41], v30 offset:8192
    ds_read_b64_tr_b16 v[42:43], v30 offset:12288
    v_mfma_f32_16x16x32_bf16 v[180:183], v[56:59], v[156:159], v[180:183]
    ds_read_b128 v[136:139], v27 offset:6144
    ds_read_b128 v[140:143], v27 offset:7168
    s_waitcnt lgkmcnt(11)
    v_mfma_f32_16x16x32_bf16 v[184:187], v[60:63], v[152:155], v[184:187]
    v_mov_b32 v23, 152
    global_load_lds_dword v23, s[88:89]
    ds_read_b64_tr_b16 v[44:45], v4 offset:8192
    v_mfma_f32_16x16x32_bf16 v[188:191], v[60:63], v[156:159], v[188:191]
    ds_read_b64_tr_b16 v[46:47], v4 offset:12288
    s_waitcnt lgkmcnt(6)
    v_cmp_ge_u32 vcc, 39, v16
    v_mfma_f32_16x16x32_bf16 v[176:179], v[32:35], v[128:131], v[176:179]
    v_mfma_f32_16x16x32_bf16 v[180:183], v[32:35], v[132:135], v[180:183]
    s_cbranch_vccz L_cb164
    s_movk_i32 s81, 40
    s_call_b64 s[82:83], L_spin_c
L_cb164:
    ds_read_b64_tr_b16 v[48:49], v30 offset:16384
    ds_read_b64_tr_b16 v[50:51], v30 offset:20480
    ds_read_b128 v[144:147], v27 offset:18432
    ds_read_b128 v[148:151], v27 offset:19456
    v_mfma_f32_16x16x32_bf16 v[184:187], v[36:39], v[128:131], v[184:187]
    ds_read_b64_tr_b16 v[52:53], v4 offset:16384
    ds_read_b64_tr_b16 v[54:55], v4 offset:20480
    v_mfma_f32_16x16x32_bf16 v[188:191], v[36:39], v[132:135], v[188:191]
    ds_read_b32 v16, v18
    s_waitcnt lgkmcnt(9)
    v_mfma_f32_16x16x32_bf16 v[176:179], v[40:43], v[136:139], v[176:179]
    ds_read_b64_tr_b16 v[56:57], v30 offset:24576
    ds_read_b64_tr_b16 v[58:59], v30 offset:28672
    v_mfma_f32_16x16x32_bf16 v[180:183], v[40:43], v[140:143], v[180:183]
    ds_read_b128 v[152:155], v27 offset:22528
    ds_read_b128 v[156:159], v27 offset:23552
    s_waitcnt lgkmcnt(11)
    v_mfma_f32_16x16x32_bf16 v[184:187], v[44:47], v[136:139], v[184:187]
    ds_read_b64_tr_b16 v[60:61], v4 offset:24576
    ds_read_b64_tr_b16 v[62:63], v4 offset:28672
    v_mfma_f32_16x16x32_bf16 v[188:191], v[44:47], v[140:143], v[188:191]
    s_waitcnt lgkmcnt(6)
    v_cmp_ge_u32 vcc, 40, v16
    v_mfma_f32_16x16x32_bf16 v[176:179], v[48:51], v[144:147], v[176:179]
    v_mfma_f32_16x16x32_bf16 v[180:183], v[48:51], v[148:151], v[180:183]
    s_cbranch_vccz L_cb165
    s_movk_i32 s81, 41
    s_call_b64 s[82:83], L_spin_c
L_cb165:
    ds_read_b64_tr_b16 v[32:33], v29 offset:49152
    ds_read_b64_tr_b16 v[34:35], v29 offset:53248
    ds_read_b128 v[128:131], v26 offset:51200
    ds_read_b128 v[132:135], v26 offset:52224
    v_mfma_f32_16x16x32_bf16 v[184:187], v[52:55], v[144:147], v[184:187]
    ds_read_b64_tr_b16 v[36:37], v3 offset:49152
    ds_read_b64_tr_b16 v[38:39], v3 offset:53248
    v_mfma_f32_16x16x32_bf16 v[188:191], v[52:55], v[148:151], v[188:191]
    ds_read_b32 v16, v18
    s_waitcnt lgkmcnt(9)
    v_mfma_f32_16x16x32_bf16 v[176:179], v[56:59], v[152:155], v[176:179]
    ds_read_b64_tr_b16 v[40:41], v29 offset:57344
    ds_read_b64_tr_b16 v[42:43], v29 offset:61440
    v_mfma_f32_16x16x32_bf16 v[180:183], v[56:59], v[156:159], v[180:183]
    ds_read_b128 v[136:139], v26 offset:55296
    ds_read_b128 v[140:143], v26 offset:56320
    s_waitcnt lgkmcnt(11)
    v_mfma_f32_16x16x32_bf16 v[184:187], v[60:63], v[152:155], v[184:187]
    v_mov_b32 v23, 160
    global_load_lds_dword v23, s[88:89]
    ds_read_b64_tr_b16 v[44:45], v3 offset:57344
    v_mfma_f32_16x16x32_bf16 v[188:191], v[60:63], v[156:159], v[188:191]
    ds_read_b64_tr_b16 v[46:47], v3 offset:61440
    s_waitcnt lgkmcnt(6)
    v_cmp_ge_u32 vcc, 41, v16
    v_mfma_f32_16x16x32_bf16 v[176:179], v[32:35], v[128:131], v[176:179]
    v_mfma_f32_16x16x32_bf16 v[180:183], v[32:35], v[132:135], v[180:183]
    s_cbranch_vccz L_cb166
    s_movk_i32 s81, 42
    s_call_b64 s[82:83], L_spin_c
L_cb166:
    ds_read_b64_tr_b16 v[48:49], v28 offset:0
    ds_read_b64_tr_b16 v[50:51], v28 offset:4096
    ds_read_b128 v[144:147], v25 offset:2048
    ds_read_b128 v[148:151], v25 offset:3072
    v_mfma_f32_16x16x32_bf16 v[184:187], v[36:39], v[128:131], v[184:187]
    ds_read_b64_tr_b16 v[52:53], v2 offset:0
    ds_read_b64_tr_b16 v[54:55], v2 offset:4096
    v_mfma_f32_16x16x32_bf16 v[188:191], v[36:39], v[132:135], v[188:191]
    ds_read_b32 v16, v18
    s_waitcnt lgkmcnt(9)
    v_mfma_f32_16x16x32_bf16 v[176:179], v[40:43], v[136:139], v[176:179]
    ds_read_b64_tr_b16 v[56:57], v28 offset:8192
    ds_read_b64_tr_b16 v[58:59], v28 offset:12288
    v_mfma_f32_16x16x32_bf16 v[180:183], v[40:43], v[140:143], v[180:183]
    ds_read_b128 v[152:155], v25 offset:6144
    ds_read_b128 v[156:159], v25 offset:7168
    s_waitcnt lgkmcnt(11)
    v_mfma_f32_16x16x32_bf16 v[184:187], v[44:47], v[136:139], v[184:187]
    ds_read_b64_tr_b16 v[60:61], v2 offset:8192
    ds_read_b64_tr_b16 v[62:63], v2 offset:12288
    v_mfma_f32_16x16x32_bf16 v[188:191], v[44:47], v[140:143], v[188:191]
    s_waitcnt lgkmcnt(6)
    v_cmp_ge_u32 vcc, 42, v16
    v_mfma_f32_16x16x32_bf16 v[176:179], v[48:51], v[144:147], v[176:179]
    v_mfma_f32_16x16x32_bf16 v[180:183], v[48:51], v[148:151], v[180:183]
    s_cbranch_vccz L_cb167
    s_movk_i32 s81, 43
    s_call_b64 s[82:83], L_spin_c
L_cb167:
    ds_read_b64_tr_b16 v[32:33], v28 offset:32768
    ds_read_b64_tr_b16 v[34:35], v28 offset:36864
    ds_read_b128 v[128:131], v25 offset:34816
    ds_read_b128 v[132:135], v25 offset:35840
    ds_read_b64 v[160:161], v17 offset:20480
    v_mfma_f32_16x16x32_bf16 v[184:187], v[52:55], v[144:147], v[184:187]
    ds_read_b64_tr_b16 v[36:37], v2 offset:32768
    ds_read_b64_tr_b16 v[38:39], v2 offset:36864
    v_mfma_f32_16x16x32_bf16 v[188:191], v[52:55], v[148:151], v[188:191]
    ds_read_b32 v16, v18
    ds_read_b64 v[162:163], v17 offset:22528
    s_waitcnt lgkmcnt(11)
    v_mfma_f32_16x16x32_bf16 v[176:179], v[56:59], v[152:155], v[176:179]
    ds_read_b64_tr_b16 v[40:41], v28 offset:40960
    ds_read_b64_tr_b16 v[42:43], v28 offset:45056
    ds_read_b128 v[136:139], v25 offset:38912
    v_mfma_f32_16x16x32_bf16 v[180:183], v[56:59], v[156:159], v[180:183]
    ds_read_b128 v[140:143], v25 offset:39936
    ds_read_b64 v[164:165], v17 offset:20512
    s_waitcnt lgkmcnt(14)
    v_mfma_f32_16x16x32_bf16 v[184:187], v[60:63], v[152:155], v[184:187]
    v_mov_b32 v23, 168
    global_load_lds_dword v23, s[88:89]
    ds_read_b64_tr_b16 v[44:45], v2 offset:40960
    ds_read_b64_tr_b16 v[46:47], v2 offset:45056
    v_mfma_f32_16x16x32_bf16 v[188:191], v[60:63], v[156:159], v[188:191]
    s_waitcnt lgkmcnt(8)
    v_cmp_ge_u32 vcc, 43, v16
    ds_read_b64 v[166:167], v17 offset:22560
    v_mfma_f32_16x16x32_bf16 v[176:179], v[32:35], v[128:131], v[176:179]
    v_mfma_f32_16x16x32_bf16 v[180:183], v[32:35], v[132:135], v[180:183]
    s_cbranch_vccz L_cb168
    s_movk_i32 s81, 44
    s_call_b64 s[82:83], L_spin_c
L_cb168:
    ds_read_b64_tr_b16 v[48:49], v28 offset:49152
    ds_read_b64_tr_b16 v[50:51], v28 offset:53248
    ds_read_b128 v[144:147], v25 offset:51200
    ds_read_b128 v[148:151], v25 offset:52224
    ds_read_b32 v168, v0 offset:19456
    v_mfma_f32_16x16x32_bf16 v[184:187], v[36:39], v[128:131], v[184:187]
    ds_read_b64_tr_b16 v[52:53], v2 offset:49152
    ds_read_b64_tr_b16 v[54:55], v2 offset:53248
    v_mfma_f32_16x16x32_bf16 v[188:191], v[36:39], v[132:135], v[188:191]
    ds_read_b32 v16, v18
    ds_read_b32 v169, v0 offset:19520
    s_waitcnt lgkmcnt(13)
    v_mfma_f32_16x16x32_bf16 v[176:179], v[40:43], v[136:139], v[176:179]
    ds_read_b64_tr_b16 v[56:57], v28 offset:57344
    ds_read_b64_tr_b16 v[58:59], v28 offset:61440
    v_mfma_f32_16x16x32_bf16 v[180:183], v[40:43], v[140:143], v[180:183]
    ds_read_b128 v[152:155], v25 offset:55296
    ds_read_b128 v[156:159], v25 offset:56320
    s_waitcnt lgkmcnt(14)
    v_mfma_f32_16x16x32_bf16 v[184:187], v[44:47], v[136:139], v[184:187]
    ds_read_b64_tr_b16 v[60:61], v2 offset:57344
    ds_read_b64_tr_b16 v[62:63], v2 offset:61440
    v_mfma_f32_16x16x32_bf16 v[188:191], v[44:47], v[140:143], v[188:191]
    s_waitcnt lgkmcnt(7)
    v_cmp_ge_u32 vcc, 44, v16
    v_mfma_f32_16x16x32_bf16 v[176:179], v[48:51], v[144:147], v[176:179]
    v_mfma_f32_16x16x32_bf16 v[180:183], v[48:51], v[148:151], v[180:183]
    s_cbranch_vccz L_cb169
    s_movk_i32 s81, 45
    s_call_b64 s[82:83], L_spin_c
L_cb169:
    ds_read_b64_tr_b16 v[32:33], v29 offset:0
    ds_read_b64_tr_b16 v[34:35], v29 offset:4096
    ds_read_b128 v[128:131], v26 offset:2048
    ds_read_b128 v[132:135], v26 offset:3072
    v_mfma_f32_16x16x32_bf16 v[184:187], v[52:55], v[144:147], v[184:187]
    ds_read_b64_tr_b16 v[36:37], v3 offset:0
    ds_read_b64_tr_b16 v[38:39], v3 offset:4096
    v_mfma_f32_16x16x32_bf16 v[188:191], v[52:55], v[148:151], v[188:191]
    ds_read_b32 v16, v18
    s_waitcnt lgkmcnt(9)
    v_mfma_f32_16x16x32_bf16 v[176:179], v[56:59], v[152:155], v[176:179]
    ds_read_b64_tr_b16 v[40:41], v29 offset:8192
    ds_read_b64_tr_b16 v[42:43], v29 offset:12288
    v_mfma_f32_16x16x32_bf16 v[180:183], v[56:59], v[156:159], v[180:183]
    ds_read_b128 v[136:139], v26 offset:6144
    ds_read_b128 v[140:143], v26 offset:7168
    s_waitcnt lgkmcnt(11)
    v_mfma_f32_16x16x32_bf16 v[184:187], v[60:63], v[152:155], v[184:187]
    v_mov_b32 v23, 176
    global_load_lds_dword v23, s[88:89]
    ds_read_b64_tr_b16 v[44:45], v3 offset:8192
    v_mfma_f32_16x16x32_bf16 v[188:191], v[60:63], v[156:159], v[188:191]
    ds_read_b64_tr_b16 v[46:47], v3 offset:12288
    s_waitcnt lgkmcnt(6)
    v_cmp_ge_u32 vcc, 45, v16
    v_mfma_f32_16x16x32_bf16 v[176:179], v[32:35], v[128:131], v[176:179]
    v_mfma_f32_16x16x32_bf16 v[180:183], v[32:35], v[132:135], v[180:183]
    s_cbranch_vccz L_cb170
    s_movk_i32 s81, 46
    s_call_b64 s[82:83], L_spin_c
L_cb170:
    ds_read_b64_tr_b16 v[48:49], v29 offset:16384
    ds_read_b64_tr_b16 v[50:51], v29 offset:20480
    ds_read_b128 v[144:147], v26 offset:18432
    ds_read_b128 v[148:151], v26 offset:19456
    v_mul_f32 v168, v168, v168
    v_mul_f32 v169, v169, v169
    v_mul_f32 v170, s72, v168
    v_mul_f32 v171, s72, v169
    v_mfma_f32_16x16x32_bf16 v[184:187], v[36:39], v[128:131], v[184:187]
    ds_read_b64_tr_b16 v[52:53], v3 offset:16384
    ds_read_b64_tr_b16 v[54:55], v3 offset:20480
    ds_read_b32 v16, v18
    v_lshlrev_b32 v224, 16, v160
    v_mfma_f32_16x16x32_bf16 v[188:191], v[36:39], v[132:135], v[188:191]
    v_and_b32 v225, 0xffff0000, v160
    v_lshlrev_b32 v226, 16, v161
    v_and_b32 v227, 0xffff0000, v161
    v_lshlrev_b32 v228, 16, v162
    s_waitcnt lgkmcnt(9)
    v_mfma_f32_16x16x32_bf16 v[176:179], v[40:43], v[136:139], v[176:179]
    ds_read_b64_tr_b16 v[56:57], v29 offset:24576
    ds_read_b64_tr_b16 v[58:59], v29 offset:28672
    ds_read_b128 v[152:155], v26 offset:22528
    ds_read_b128 v[156:159], v26 offset:23552
    v_and_b32 v229, 0xffff0000, v162
    v_mfma_f32_16x16x32_bf16 v[180:183], v[40:43], v[140:143], v[180:183]
    v_lshlrev_b32 v230, 16, v163
    v_and_b32 v231, 0xffff0000, v163
    v_lshlrev_b32 v232, 16, v164
    v_and_b32 v233, 0xffff0000, v164
    s_waitcnt lgkmcnt(11)
    v_mfma_f32_16x16x32_bf16 v[184:187], v[44:47], v[136:139], v[184:187]
    ds_read_b64_tr_b16 v[60:61], v3 offset:24576
    ds_read_b64_tr_b16 v[62:63], v3 offset:28672
    v_mfma_f32_16x16x32_bf16 v[188:191], v[44:47], v[140:143], v[188:191]
    s_waitcnt lgkmcnt(6)
    v_cmp_ge_u32 vcc, 46, v16
    v_lshlrev_b32 v234, 16, v165
    v_and_b32 v235, 0xffff0000, v165
    v_lshlrev_b32 v236, 16, v166
    v_and_b32 v237, 0xffff0000, v166
    v_lshlrev_b32 v238, 16, v167
    v_mfma_f32_16x16x32_bf16 v[176:179], v[48:51], v[144:147], v[176:179]
    v_mfma_f32_16x16x32_bf16 v[180:183], v[48:51], v[148:151], v[180:183]
    s_cbranch_vccz L_cb171
    s_movk_i32 s81, 47
    s_call_b64 s[82:83], L_spin_c
L_cb171:
    ds_read_b64_tr_b16 v[32:33], v29 offset:32768
    ds_read_b64_tr_b16 v[34:35], v29 offset:36864
    ds_read_b128 v[128:131], v26 offset:34816
    ds_read_b128 v[132:135], v26 offset:35840
    v_and_b32 v239, 0xffff0000, v167
    v_mfma_f32_16x16x32_bf16 v[184:187], v[52:55], v[144:147], v[184:187]
    ds_read_b64_tr_b16 v[36:37], v3 offset:32768
    ds_read_b64_tr_b16 v[38:39], v3 offset:36864
    v_mfma_f32_16x16x32_bf16 v[188:191], v[52:55], v[148:151], v[188:191]
    ds_read_b32 v16, v18
    s_waitcnt lgkmcnt(9)
    v_mfma_f32_16x16x32_bf16 v[176:179], v[56:59], v[152:155], v[176:179]
    ds_read_b64_tr_b16 v[40:41], v29 offset:40960
    ds_read_b64_tr_b16 v[42:43], v29 offset:45056
    v_mfma_f32_16x16x32_bf16 v[180:183], v[56:59], v[156:159], v[180:183]
    ds_read_b128 v[136:139], v26 offset:38912
    ds_read_b128 v[140:143], v26 offset:39936
    s_waitcnt lgkmcnt(11)
    v_mfma_f32_16x16x32_bf16 v[184:187], v[60:63], v[152:155], v[184:187]
    v_mov_b32 v23, 184
    global_load_lds_dword v23, s[88:89]
    ds_read_b64_tr_b16 v[44:45], v3 offset:40960
    v_mfma_f32_16x16x32_bf16 v[188:191], v[60:63], v[156:159], v[188:191]
    ds_read_b64_tr_b16 v[46:47], v3 offset:45056
    s_waitcnt lgkmcnt(6)
    v_cmp_ge_u32 vcc, 47, v16
    v_mfma_f32_16x16x32_bf16 v[176:179], v[32:35], v[128:131], v[176:179]
    v_mfma_f32_16x16x32_bf16 v[180:183], v[32:35], v[132:135], v[180:183]
    s_cbranch_vccz L_cb172
    s_movk_i32 s81, 48
    s_call_b64 s[82:83], L_spin_c
L_cb172:
    ds_read_b64_tr_b16 v[48:49], v30 offset:0
    ds_read_b64_tr_b16 v[50:51], v30 offset:4096
    ds_read_b128 v[144:147], v27 offset:2048
    ds_read_b128 v[148:151], v27 offset:3072
    v_mfma_f32_16x16x32_bf16 v[184:187], v[36:39], v[128:131], v[184:187]
    ds_read_b64_tr_b16 v[52:53], v4 offset:0
    v_mfma_f32_16x16x32_bf16 v[188:191], v[36:39], v[132:135], v[188:191]
    ds_read_b64_tr_b16 v[54:55], v4 offset:4096
    s_waitcnt lgkmcnt(8)
    v_mfma_f32_16x16x32_bf16 v[176:179], v[40:43], v[136:139], v[176:179]
    ds_read_b64_tr_b16 v[56:57], v30 offset:8192
    ds_read_b64_tr_b16 v[58:59], v30 offset:12288
    v_mfma_f32_16x16x32_bf16 v[180:183], v[40:43], v[140:143], v[180:183]
    ds_read_b128 v[152:155], v27 offset:6144
    ds_read_b128 v[156:159], v27 offset:7168
    s_waitcnt lgkmcnt(10)
    v_mfma_f32_16x16x32_bf16 v[184:187], v[44:47], v[136:139], v[184:187]
    ds_read_b64_tr_b16 v[60:61], v4 offset:8192
    v_mfma_f32_16x16x32_bf16 v[188:191], v[44:47], v[140:143], v[188:191]
    ds_read_b64_tr_b16 v[62:63], v4 offset:12288
    s_waitcnt lgkmcnt(8)
    v_mfma_f32_16x16x32_bf16 v[176:179], v[48:51], v[144:147], v[176:179]
    ds_read_b32 v16, v18
    v_mfma_f32_16x16x32_bf16 v[180:183], v[48:51], v[148:151], v[180:183]
    s_waitcnt lgkmcnt(7)
    v_mfma_f32_16x16x32_bf16 v[184:187], v[52:55], v[144:147], v[184:187]
    ds_read_b32 v16, v18
    v_mfma_f32_16x16x32_bf16 v[188:191], v[52:55], v[148:151], v[188:191]
    s_waitcnt lgkmcnt(4)
    v_mfma_f32_16x16x32_bf16 v[176:179], v[56:59], v[152:155], v[176:179]
    v_mfma_f32_16x16x32_bf16 v[180:183], v[56:59], v[156:159], v[180:183]
    s_waitcnt lgkmcnt(1)
    v_cmp_ge_u32 vcc, 48, v16
    v_mfma_f32_16x16x32_bf16 v[184:187], v[60:63], v[152:155], v[184:187]
    v_mfma_f32_16x16x32_bf16 v[188:191], v[60:63], v[156:159], v[188:191]
    v_mov_b32 v23, 192
    global_load_lds_dword v23, s[88:89]
    s_nop 0
    v_mul_f32 v208, v170, v176
    v_mul_f32 v209, v170, v177
    v_mul_f32 v210, v170, v178
    v_mul_f32 v211, v170, v179
    v_mul_f32 v212, v171, v180
    v_mul_f32 v213, v171, v181
    v_mul_f32 v214, v171, v182
    v_mul_f32 v215, v171, v183
    v_mul_f32 v216, v170, v184
    v_mul_f32 v217, v170, v185
    v_mul_f32 v218, v170, v186
    v_mul_f32 v219, v170, v187
    v_mul_f32 v220, v171, v188
    v_mul_f32 v221, v171, v189
    v_mul_f32 v222, v171, v190
    v_mul_f32 v223, v171, v191
    v_exp_f32 v208, -v208
    v_exp_f32 v209, -v209
    v_exp_f32 v210, -v210
    v_exp_f32 v211, -v211
    v_exp_f32 v212, -v212
    v_exp_f32 v213, -v213
    v_exp_f32 v214, -v214
    v_exp_f32 v215, -v215
    v_exp_f32 v216, -v216
    v_exp_f32 v217, -v217
    v_exp_f32 v218, -v218
    v_exp_f32 v219, -v219
    v_exp_f32 v220, -v220
    v_exp_f32 v221, -v221
    v_exp_f32 v222, -v222
    v_exp_f32 v223, -v223
    v_mul_f32 v176, v168, v176
    v_mul_f32 v177, v168, v177
    v_mul_f32 v178, v168, v178
    v_mul_f32 v179, v168, v179
    v_mul_f32 v180, v169, v180
    v_mul_f32 v181, v169, v181
    v_mul_f32 v182, v169, v182
    v_mul_f32 v183, v169, v183
    v_mul_f32 v184, v168, v184
    v_mul_f32 v185, v168, v185
    v_mul_f32 v186, v168, v186
    v_mul_f32 v187, v168, v187
    v_mul_f32 v188, v169, v188
    v_mul_f32 v189, v169, v189
    v_mul_f32 v190, v169, v190
    v_mul_f32 v191, v169, v191
    v_add_f32 v208, 1.0, v208
    v_add_f32 v209, 1.0, v209
    v_add_f32 v210, 1.0, v210
    v_add_f32 v211, 1.0, v211
    v_add_f32 v212, 1.0, v212
    v_add_f32 v213, 1.0, v213
    v_add_f32 v214, 1.0, v214
    v_add_f32 v215, 1.0, v215
    v_add_f32 v216, 1.0, v216
    v_add_f32 v217, 1.0, v217
    v_add_f32 v218, 1.0, v218
    v_add_f32 v219, 1.0, v219
    v_add_f32 v220, 1.0, v220
    v_add_f32 v221, 1.0, v221
    v_add_f32 v222, 1.0, v222
    v_add_f32 v223, 1.0, v223
    ds_read_b32 v16, v18
    s_waitcnt lgkmcnt(0)
    v_cmp_ge_u32 vcc, 48, v16
    s_cbranch_vccz L_cb173
    s_movk_i32 s81, 49
    s_call_b64 s[82:83], L_spin_c
L_cb173:
    ds_read_b64_tr_b16 v[32:33], v30 offset:16384
    ds_read_b64_tr_b16 v[34:35], v30 offset:24576
    ds_read_b128 v[128:131], v27 offset:18432
    ds_read_b128 v[132:135], v27 offset:19456
    ds_read_b64_tr_b16 v[36:37], v4 offset:16384
    ds_read_b64_tr_b16 v[38:39], v4 offset:24576
    ds_read_b64_tr_b16 v[40:41], v30 offset:20480
    ds_read_b64_tr_b16 v[42:43], v30 offset:28672
    ds_read_b128 v[136:139], v27 offset:22528
    ds_read_b128 v[140:143], v27 offset:23552
    ds_read_b64_tr_b16 v[44:45], v4 offset:20480
    ds_read_b64_tr_b16 v[46:47], v4 offset:28672
    v_cmp_ge_u32 vcc, 49, v16
    s_waitcnt lgkmcnt(8)
    v_mfma_f32_16x16x32_bf16 v[192:195], v[32:35], v[128:131], 0
    v_mfma_f32_16x16x32_bf16 v[196:199], v[32:35], v[132:135], 0
    s_cbranch_vccz L_cb174
    s_movk_i32 s81, 50
    s_call_b64 s[82:83], L_spin_c
L_cb174:
    ds_read_b64_tr_b16 v[48:49], v29 offset:49152
    ds_read_b64_tr_b16 v[50:51], v29 offset:57344
    ds_read_b128 v[144:147], v26 offset:51200
    ds_read_b128 v[148:151], v26 offset:52224
    s_waitcnt lgkmcnt(10)
    v_mfma_f32_16x16x32_bf16 v[200:203], v[36:39], v[128:131], 0
    ds_read_b64_tr_b16 v[52:53], v3 offset:49152
    ds_read_b64_tr_b16 v[54:55], v3 offset:57344
    ds_read_b32 v16, v18
    v_rcp_f32 v208, v208
    v_mfma_f32_16x16x32_bf16 v[204:207], v[36:39], v[132:135], 0
    v_rcp_f32 v209, v209
    v_rcp_f32 v210, v210
    v_rcp_f32 v211, v211
    v_rcp_f32 v212, v212
    s_waitcnt lgkmcnt(9)
    v_mfma_f32_16x16x32_bf16 v[192:195], v[40:43], v[136:139], v[192:195]
    ds_read_b64_tr_b16 v[56:57], v29 offset:53248
    ds_read_b64_tr_b16 v[58:59], v29 offset:61440
    ds_read_b128 v[152:155], v26 offset:55296
    ds_read_b128 v[156:159], v26 offset:56320
    v_rcp_f32 v213, v213
    v_mfma_f32_16x16x32_bf16 v[196:199], v[40:43], v[140:143], v[196:199]
    v_rcp_f32 v214, v214
    v_rcp_f32 v215, v215
    v_rcp_f32 v216, v216
    v_rcp_f32 v217, v217
    s_waitcnt lgkmcnt(11)
    v_mfma_f32_16x16x32_bf16 v[200:203], v[44:47], v[136:139], v[200:203]
    ds_read_b64_tr_b16 v[60:61], v3 offset:53248
    ds_read_b64_tr_b16 v[62:63], v3 offset:61440
    v_mfma_f32_16x16x32_bf16 v[204:207], v[44:47], v[140:143], v[204:207]
    s_waitcnt lgkmcnt(6)
    v_cmp_ge_u32 vcc, 50, v16
    v_rcp_f32 v218, v218
    v_rcp_f32 v219, v219
    v_rcp_f32 v220, v220
    v_rcp_f32 v221, v221
    v_rcp_f32 v222, v222
    v_mfma_f32_16x16x32_bf16 v[192:195], v[48:51], v[144:147], v[192:195]
    v_mfma_f32_16x16x32_bf16 v[196:199], v[48:51], v[148:151], v[196:199]
    s_cbranch_vccz L_cb175
    s_movk_i32 s81, 51
    s_call_b64 s[82:83], L_spin_c
L_cb175:
    ds_read_b64_tr_b16 v[32:33], v28 offset:0
    ds_read_b64_tr_b16 v[34:35], v28 offset:8192
    ds_read_b128 v[128:131], v25 offset:2048
    ds_read_b128 v[132:135], v25 offset:3072
    v_rcp_f32 v223, v223
    v_mul_f32 v208, v208, v176
    v_mul_f32 v209, v209, v177
    v_mul_f32 v210, v210, v178
    v_mul_f32 v211, v211, v179
    v_mfma_f32_16x16x32_bf16 v[200:203], v[52:55], v[144:147], v[200:203]
    ds_read_b64_tr_b16 v[36:37], v2 offset:0
    ds_read_b64_tr_b16 v[38:39], v2 offset:8192
    ds_read_b32 v16, v18
    v_mul_f32 v212, v212, v180
    v_mfma_f32_16x16x32_bf16 v[204:207], v[52:55], v[148:151], v[204:207]
    v_mul_f32 v213, v213, v181
    v_mul_f32 v214, v214, v182
    v_mul_f32 v215, v215, v183
    v_mul_f32 v216, v216, v184
    s_waitcnt lgkmcnt(9)
    v_mfma_f32_16x16x32_bf16 v[192:195], v[56:59], v[152:155], v[192:195]
    ds_read_b64_tr_b16 v[40:41], v28 offset:4096
    ds_read_b64_tr_b16 v[42:43], v28 offset:12288
    ds_read_b128 v[136:139], v25 offset:6144
    ds_read_b128 v[140:143], v25 offset:7168
    v_mul_f32 v217, v217, v185
    v_mfma_f32_16x16x32_bf16 v[196:199], v[56:59], v[156:159], v[196:199]
    v_mul_f32 v218, v218, v186
    v_mul_f32 v219, v219, v187
    v_mul_f32 v220, v220, v188
    v_mul_f32 v221, v221, v189
    s_waitcnt lgkmcnt(11)
    v_mfma_f32_16x16x32_bf16 v[200:203], v[60:63], v[152:155], v[200:203]
    ds_read_b64_tr_b16 v[44:45], v2 offset:4096
    ds_read_b64_tr_b16 v[46:47], v2 offset:12288
    v_mfma_f32_16x16x32_bf16 v[204:207], v[60:63], v[156:159], v[204:207]
    s_waitcnt lgkmcnt(6)
    v_cmp_ge_u32 vcc, 51, v16
    v_mul_f32 v222, v222, v190
    v_mul_f32 v223, v223, v191
    v_mfma_f32_16x16x32_bf16 v[192:195], v[32:35], v[128:131], v[192:195]
    v_mfma_f32_16x16x32_bf16 v[196:199], v[32:35], v[132:135], v[196:199]
    s_cbranch_vccz L_cb176
    s_movk_i32 s81, 52
    s_call_b64 s[82:83], L_spin_c
L_cb176:
    ds_read_b64_tr_b16 v[48:49], v28 offset:32768
    ds_read_b64_tr_b16 v[50:51], v28 offset:40960
    ds_read_b128 v[144:147], v25 offset:34816
    ds_read_b128 v[148:151], v25 offset:35840
    v_mfma_f32_16x16x32_bf16 v[200:203], v[36:39], v[128:131], v[200:203]
    ds_read_b64_tr_b16 v[52:53], v2 offset:32768
    ds_read_b64_tr_b16 v[54:55], v2 offset:40960
    v_mfma_f32_16x16x32_bf16 v[204:207], v[36:39], v[132:135], v[204:207]
    ds_read_b32 v16, v18
    s_waitcnt lgkmcnt(9)
    v_mfma_f32_16x16x32_bf16 v[192:195], v[40:43], v[136:139], v[192:195]
    ds_read_b64_tr_b16 v[56:57], v28 offset:36864
    ds_read_b64_tr_b16 v[58:59], v28 offset:45056
    v_mfma_f32_16x16x32_bf16 v[196:199], v[40:43], v[140:143], v[196:199]
    ds_read_b128 v[152:155], v25 offset:38912
    ds_read_b128 v[156:159], v25 offset:39936
    s_waitcnt lgkmcnt(11)
    v_mfma_f32_16x16x32_bf16 v[200:203], v[44:47], v[136:139], v[200:203]
    ds_read_b64_tr_b16 v[60:61], v2 offset:36864
    ds_read_b64_tr_b16 v[62:63], v2 offset:45056
    v_mfma_f32_16x16x32_bf16 v[204:207], v[44:47], v[140:143], v[204:207]
    s_waitcnt lgkmcnt(6)
    v_cmp_ge_u32 vcc, 52, v16
    v_mfma_f32_16x16x32_bf16 v[192:195], v[48:51], v[144:147], v[192:195]
    v_mfma_f32_16x16x32_bf16 v[196:199], v[48:51], v[148:151], v[196:199]
    s_cbranch_vccz L_cb177
    s_movk_i32 s81, 53
    s_call_b64 s[82:83], L_spin_c
L_cb177:
    ds_read_b64_tr_b16 v[32:33], v28 offset:49152
    ds_read_b64_tr_b16 v[34:35], v28 offset:57344
    ds_read_b128 v[128:131], v25 offset:51200
    ds_read_b128 v[132:135], v25 offset:52224
    v_mfma_f32_16x16x32_bf16 v[200:203], v[52:55], v[144:147], v[200:203]
    ds_read_b64_tr_b16 v[36:37], v2 offset:49152
    ds_read_b64_tr_b16 v[38:39], v2 offset:57344
    v_mfma_f32_16x16x32_bf16 v[204:207], v[52:55], v[148:151], v[204:207]
    ds_read_b32 v16, v18
    s_waitcnt lgkmcnt(9)
    v_mfma_f32_16x16x32_bf16 v[192:195], v[56:59], v[152:155], v[192:195]
    ds_read_b64_tr_b16 v[40:41], v28 offset:53248
    ds_read_b64_tr_b16 v[42:43], v28 offset:61440
    v_mfma_f32_16x16x32_bf16 v[196:199], v[56:59], v[156:159], v[196:199]
    ds_read_b128 v[136:139], v25 offset:55296
    ds_read_b128 v[140:143], v25 offset:56320
    s_waitcnt lgkmcnt(11)
    v_mfma_f32_16x16x32_bf16 v[200:203], v[60:63], v[152:155], v[200:203]
    ds_read_b64_tr_b16 v[44:45], v2 offset:53248
    ds_read_b64_tr_b16 v[46:47], v2 offset:61440
    v_mfma_f32_16x16x32_bf16 v[204:207], v[60:63], v[156:159], v[204:207]
    s_waitcnt lgkmcnt(6)
    v_cmp_ge_u32 vcc, 53, v16
    v_mfma_f32_16x16x32_bf16 v[192:195], v[32:35], v[128:131], v[192:195]
    v_mfma_f32_16x16x32_bf16 v[196:199], v[32:35], v[132:135], v[196:199]
    s_cbranch_vccz L_cb178
    s_movk_i32 s81, 54
    s_call_b64 s[82:83], L_spin_c
L_cb178:
    ds_read_b64_tr_b16 v[48:49], v29 offset:0
    ds_read_b64_tr_b16 v[50:51], v29 offset:8192
    ds_read_b128 v[144:147], v26 offset:2048
    ds_read_b128 v[148:151], v26 offset:3072
    v_mfma_f32_16x16x32_bf16 v[200:203], v[36:39], v[128:131], v[200:203]
    ds_read_b64_tr_b16 v[52:53], v3 offset:0
    ds_read_b64_tr_b16 v[54:55], v3 offset:8192
    v_mfma_f32_16x16x32_bf16 v[204:207], v[36:39], v[132:135], v[204:207]
    ds_read_b32 v16, v18
    s_waitcnt lgkmcnt(9)
    v_mfma_f32_16x16x32_bf16 v[192:195], v[40:43], v[136:139], v[192:195]
    ds_read_b64_tr_b16 v[56:57], v29 offset:4096
    ds_read_b64_tr_b16 v[58:59], v29 offset:12288
    v_mfma_f32_16x16x32_bf16 v[196:199], v[40:43], v[140:143], v[196:199]
    ds_read_b128 v[152:155], v26 offset:6144
    ds_read_b128 v[156:159], v26 offset:7168
    s_waitcnt lgkmcnt(11)
    v_mfma_f32_16x16x32_bf16 v[200:203], v[44:47], v[136:139], v[200:203]
    ds_read_b64_tr_b16 v[60:61], v3 offset:4096
    ds_read_b64_tr_b16 v[62:63], v3 offset:12288
    v_mfma_f32_16x16x32_bf16 v[204:207], v[44:47], v[140:143], v[204:207]
    s_waitcnt lgkmcnt(6)
    v_cmp_ge_u32 vcc, 54, v16
    v_mfma_f32_16x16x32_bf16 v[192:195], v[48:51], v[144:147], v[192:195]
    v_mfma_f32_16x16x32_bf16 v[196:199], v[48:51], v[148:151], v[196:199]
    s_cbranch_vccz L_cb179
    s_movk_i32 s81, 55
    s_call_b64 s[82:83], L_spin_c
L_cb179:
    ds_read_b64_tr_b16 v[32:33], v29 offset:16384
    ds_read_b64_tr_b16 v[34:35], v29 offset:24576
    ds_read_b128 v[128:131], v26 offset:18432
    ds_read_b128 v[132:135], v26 offset:19456
    v_mfma_f32_16x16x32_bf16 v[200:203], v[52:55], v[144:147], v[200:203]
    ds_read_b64_tr_b16 v[36:37], v3 offset:16384
    ds_read_b64_tr_b16 v[38:39], v3 offset:24576
    v_mfma_f32_16x16x32_bf16 v[204:207], v[52:55], v[148:151], v[204:207]
    ds_read_b32 v16, v18
    s_waitcnt lgkmcnt(9)
    v_mfma_f32_16x16x32_bf16 v[192:195], v[56:59], v[152:155], v[192:195]
    ds_read_b64_tr_b16 v[40:41], v29 offset:20480
    ds_read_b64_tr_b16 v[42:43], v29 offset:28672
    v_mfma_f32_16x16x32_bf16 v[196:199], v[56:59], v[156:159], v[196:199]
    ds_read_b128 v[136:139], v26 offset:22528
    ds_read_b128 v[140:143], v26 offset:23552
    s_waitcnt lgkmcnt(11)
    v_mfma_f32_16x16x32_bf16 v[200:203], v[60:63], v[152:155], v[200:203]
    ds_read_b64_tr_b16 v[44:45], v3 offset:20480
    ds_read_b64_tr_b16 v[46:47], v3 offset:28672
    v_mfma_f32_16x16x32_bf16 v[204:207], v[60:63], v[156:159], v[204:207]
    s_waitcnt lgkmcnt(6)
    v_cmp_ge_u32 vcc, 55, v16
    v_mfma_f32_16x16x32_bf16 v[192:195], v[32:35], v[128:131], v[192:195]
    v_mfma_f32_16x16x32_bf16 v[196:199], v[32:35], v[132:135], v[196:199]
    s_cbranch_vccz L_cb180
    s_movk_i32 s81, 56
    s_call_b64 s[82:83], L_spin_c
L_cb180:
    ds_read_b64_tr_b16 v[48:49], v29 offset:32768
    ds_read_b64_tr_b16 v[50:51], v29 offset:40960
    ds_read_b128 v[144:147], v26 offset:34816
    ds_read_b128 v[148:151], v26 offset:35840
    v_mfma_f32_16x16x32_bf16 v[200:203], v[36:39], v[128:131], v[200:203]
    ds_read_b64_tr_b16 v[52:53], v3 offset:32768
    v_mfma_f32_16x16x32_bf16 v[204:207], v[36:39], v[132:135], v[204:207]
    ds_read_b64_tr_b16 v[54:55], v3 offset:40960
    s_waitcnt lgkmcnt(8)
    v_mfma_f32_16x16x32_bf16 v[192:195], v[40:43], v[136:139], v[192:195]
    ds_read_b64_tr_b16 v[56:57], v29 offset:36864
    ds_read_b64_tr_b16 v[58:59], v29 offset:45056
    v_mfma_f32_16x16x32_bf16 v[196:199], v[40:43], v[140:143], v[196:199]
    ds_read_b128 v[152:155], v26 offset:38912
    ds_read_b128 v[156:159], v26 offset:39936
    s_waitcnt lgkmcnt(10)
    v_mfma_f32_16x16x32_bf16 v[200:203], v[44:47], v[136:139], v[200:203]
    ds_read_b64_tr_b16 v[60:61], v3 offset:36864
    v_mfma_f32_16x16x32_bf16 v[204:207], v[44:47], v[140:143], v[204:207]
    ds_read_b64_tr_b16 v[62:63], v3 offset:45056
    s_waitcnt lgkmcnt(8)
    v_mfma_f32_16x16x32_bf16 v[192:195], v[48:51], v[144:147], v[192:195]
    v_mfma_f32_16x16x32_bf16 v[196:199], v[48:51], v[148:151], v[196:199]
    s_waitcnt lgkmcnt(6)
    v_mfma_f32_16x16x32_bf16 v[200:203], v[52:55], v[144:147], v[200:203]
    v_mfma_f32_16x16x32_bf16 v[204:207], v[52:55], v[148:151], v[204:207]
    s_waitcnt lgkmcnt(2)
    v_mfma_f32_16x16x32_bf16 v[192:195], v[56:59], v[152:155], v[192:195]
    v_mfma_f32_16x16x32_bf16 v[196:199], v[56:59], v[156:159], v[196:199]
    s_waitcnt lgkmcnt(0)
    v_mfma_f32_16x16x32_bf16 v[200:203], v[60:63], v[152:155], v[200:203]
    v_mfma_f32_16x16x32_bf16 v[204:207], v[60:63], v[156:159], v[204:207]
    s_nop 3
    v_fma_f32 v208, v192, v208, v224
    v_fma_f32 v209, v193, v209, v225
    v_fma_f32 v210, v194, v210, v226
    v_fma_f32 v211, v195, v211, v227
    v_fma_f32 v212, v196, v212, v228
    v_fma_f32 v213, v197, v213, v229
    v_fma_f32 v214, v198, v214, v230
    v_fma_f32 v215, v199, v215, v231
    v_fma_f32 v216, v200, v216, v232
    v_fma_f32 v217, v201, v217, v233
    v_fma_f32 v218, v202, v218, v234
    v_fma_f32 v219, v203, v219, v235
    v_fma_f32 v220, v204, v220, v236
    v_fma_f32 v221, v205, v221, v237
    v_fma_f32 v222, v206, v222, v238
    v_fma_f32 v223, v207, v223, v239
    v_cvt_pk_bf16_f32 v224, v208, v209
    v_cvt_pk_bf16_f32 v225, v210, v211
    v_cvt_pk_bf16_f32 v228, v212, v213
    v_cvt_pk_bf16_f32 v229, v214, v215
    v_cvt_pk_bf16_f32 v226, v216, v217
    v_cvt_pk_bf16_f32 v227, v218, v219
    v_cvt_pk_bf16_f32 v230, v220, v221
    v_cvt_pk_bf16_f32 v231, v222, v223
    v_permlane16_swap_b32 v224, v226
    v_permlane16_swap_b32 v225, v227
    v_permlane16_swap_b32 v228, v230
    v_permlane16_swap_b32 v229, v231
    s_movk_i32 s66, 16384
    buffer_store_dwordx4 v[224:227], v31, s[36:39], 0 offen sc0 sc1
    buffer_store_dwordx4 v[228:231], v31, s[36:39], s66 offen sc0 sc1
    s_endpgm
L_spin_c:
    s_mov_b32 s80, 0
L_spl_c:
    s_sleep 1
    ds_read_b32 v16, v18
    s_add_u32 s80, s80, 1
    s_waitcnt lgkmcnt(0)
    s_cmp_ge_u32 s80, 0x1000000
    s_cbranch_scc1 L_spr_c
    v_cmp_gt_u32 vcc, s81, v16
    s_cbranch_vccnz L_spl_c
L_spr_c:
    s_setpc_b64 s[82:83]
L_spin_d:
    s_mov_b32 s80, 0
L_spl_d:
    s_sleep 2
    ds_read_b32 v28, v7
    s_add_u32 s80, s80, 1
    s_waitcnt lgkmcnt(0)
    s_cmp_ge_u32 s80, 0x1000000
    s_cbranch_scc1 L_spr_d
    v_cmp_gt_u32 vcc, s81, v28
    s_cbranch_vccnz L_spl_d
L_spr_d:
    s_setpc_b64 s[82:83]
L_exit:
    s_endpgm
.p2align 7
L_tab:
    .long 0
    .long 1
    .long 2
    .long 3
    .long 4
    .long 5
    .long 6
    .long 7
    .long 8
    .long 9
    .long 10
    .long 11
    .long 12
    .long 13
    .long 14
    .long 15
    .long 16
    .long 17
    .long 18
    .long 19
    .long 20
    .long 21
    .long 22
    .long 23
    .long 24
    .long 25
    .long 26
    .long 27
    .long 28
    .long 29
    .long 30
    .long 31
    .long 32
    .long 33
    .long 34
    .long 35
    .long 36
    .long 37
    .long 38
    .long 39
    .long 40
    .long 41
    .long 42
    .long 43
    .long 44
    .long 45
    .long 46
    .long 47
    .long 48
    .long 49
    .long 50
    .long 51
    .long 52
    .long 53
    .long 54
    .long 55
    .long 56
    .long 57
    .long 58
    .long 59
    .long 60
    .long 61
    .long 62
    .long 63
.section .rodata,"a"
.p2align 6
.amdhsa_kernel recurrent_scan__linear_kernel_hedgehog__glu_gated_bilinear__prompt_kernel
  .amdhsa_next_free_vgpr 256
  .amdhsa_next_free_sgpr 100
  .amdhsa_accum_offset 256
  .amdhsa_group_segment_fixed_size 0
  .amdhsa_kernarg_size 88
  .amdhsa_user_sgpr_count 2
  .amdhsa_user_sgpr_kernarg_segment_ptr 1
  .amdhsa_system_sgpr_workgroup_id_x 1
.end_amdhsa_kernel
```
